```python
import torch

def _softmax(x, axis=-1):
    return torch.softmax(x, dim=axis)

def _gelu(x):
    return torch.nn.functional.gelu(x, approximate='tanh')

def _silu(x):
    return torch.nn.functional.silu(x)

def _sigmoid(x):
    return torch.sigmoid(x)

def _layernorm(x, axis=-1, eps=1e-05):
    m = x.mean(dim=axis, keepdim=True)
    v = x.var(dim=axis, keepdim=True, unbiased=False)
    return (x - m) / torch.sqrt(v + eps)

def _scatter_add(tgt, idx, src, axis=0):
    return tgt.clone().index_add_(axis, idx, src)

def _segment_sum(src, seg, n):
    out = torch.zeros((n,) + src.shape[1:], dtype=src.dtype)
    return out.index_add_(0, seg, src)

def _pad(x, pw):
    flat = tuple((v for pair in reversed(pw) for v in pair))
    return torch.nn.functional.pad(x, flat)
kernel_name = 'recurrent_scan__memory_aug_recurrent_mem_tr__dense_activation_gelu__prompt'

def setup_inputs():

    _w = lambda a: (lambda t: t.to(torch.bfloat16) if t.is_floating_point() else t)(torch.as_tensor(a))

    def _A_setup():
        B, S, Dm = (1, 2048, 1024)
        H, Dh = (32, 128)
        M, seg = (8, 32)
        seg = min(seg, S)
        S = S // seg * seg
        return {'x': _w((lambda *s: torch.randn(*s, dtype=torch.bfloat16) * 0.1)(B, S, Dm)), 'mem0': _w((lambda *s: torch.randn(*s, dtype=torch.bfloat16) * 1.6)(B, M, Dm)), 'Wq': _w((lambda *s: torch.randn(*s, dtype=torch.bfloat16) * 0.8)(Dm, H, Dh) * Dm ** (-0.5)), 'Wk': _w((lambda *s: torch.randn(*s, dtype=torch.bfloat16) * 0.8)(Dm, H, Dh) * Dm ** (-0.5)), 'Wv': _w((lambda *s: torch.randn(*s, dtype=torch.bfloat16) * 1.6)(Dm, H, Dh) * Dm ** (-0.5)), 'Wo': _w((lambda *s: torch.randn(*s, dtype=torch.bfloat16) * 1.6)(H, Dh, Dm) * (H * Dh) ** (-0.5)), 'seg_len': seg}
    _A_in = _A_setup()

    def _B_setup():
        B, S, D, F = (1, 2048, 1024, 3584)
        return {'x': _w((lambda *s: torch.randn(*s, dtype=torch.bfloat16) * 0.1)(B, S, D)), 'w1': _w((lambda *s: torch.randn(*s, dtype=torch.bfloat16) * 0.4)(D, F) * D ** (-0.5)), 'b1': _w((lambda *s: torch.randn(*s, dtype=torch.bfloat16) * 0.4)(F) * 0.01), 'w2': _w((lambda *s: torch.randn(*s, dtype=torch.bfloat16) * 0.4)(F, D) * F ** (-0.5)), 'b2': _w((lambda *s: torch.randn(*s, dtype=torch.bfloat16) * 0.4)(D) * 0.01)}
    _B_in = _B_setup()
    return {'A_x': _A_in['x'], 'A_mem0': _A_in['mem0'], 'A_Wq': _A_in['Wq'], 'A_Wk': _A_in['Wk'], 'A_Wv': _A_in['Wv'], 'A_Wo': _A_in['Wo'], 'A_seg_len': _A_in['seg_len'], 'B_x': _B_in['x'], 'B_w1': _B_in['w1'], 'B_b1': _B_in['b1'], 'B_w2': _B_in['w2'], 'B_b2': _B_in['b2']}

def reference(A_x, A_mem0, A_Wq, A_Wk, A_Wv, A_Wo, A_seg_len, B_x, B_w1, B_b1, B_w2, B_b2):

    def _A_ref(x, mem0, Wq, Wk, Wv, Wo, seg_len):
        B, S, Dm = x.shape
        H, Dh = (Wq.shape[1], Wq.shape[2])
        M = mem0.shape[1]
        scale = Dh ** (-0.5)
        n_seg = S // seg_len
        L = M + seg_len
        idx = torch.arange(L)
        mask = (idx[:, None] < M) | (idx[:, None] >= idx[None, :])
        mem = mem0
        outs = []
        for s in range(n_seg):
            xs = x[:, s * seg_len:(s + 1) * seg_len, :].clone()
            h = torch.concatenate([mem, xs], axis=1)
            q = torch.einsum('btd,dhe->bhte', h, Wq)
            k = torch.einsum('btd,dhe->bhte', h, Wk)
            v = torch.einsum('btd,dhe->bhte', h, Wv)
            scores = torch.einsum('bhqe,bhke->bhqk', q, k) * scale
            scores = torch.where(mask[None, None], scores, -1000000000.0)
            p = _softmax(scores, axis=-1)
            o = torch.einsum('bhqk,bhke->bhqe', p, v)
            o = torch.einsum('bhte,hed->btd', o, Wo)
            mem = o[:, :M, :].clone()
            outs.append(o[:, M:, :])
        return torch.concatenate(outs, axis=1)

    def _B_ref(x, w1, b1, w2, b2):
        h = torch.einsum('bsd,df->bsf', x, w1) + b1
        h = _gelu(h)
        return torch.einsum('bsf,fd->bsd', h, w2) + b2
    x = A_x
    xn = _layernorm(x, axis=-1)
    s = _A_ref(xn, A_mem0, A_Wq, A_Wk, A_Wv, A_Wo, A_seg_len)
    g = _silu(_B_ref(xn, B_w1, B_b1, B_w2, B_b2))
    return x + s * g
```

```asm
; @launch grid=(256,1,1) block=(256,1,1) lds=163840
.amdgcn_target "amdgcn-amd-amdhsa--gfx950"
.text
.globl recurrent_scan__memory_aug_recurrent_mem_tr__dense_activation_gelu__prompt_kernel
.p2align 8
.type recurrent_scan__memory_aug_recurrent_mem_tr__dense_activation_gelu__prompt_kernel,@function
recurrent_scan__memory_aug_recurrent_mem_tr__dense_activation_gelu__prompt_kernel:
s_cmp_ge_u32 s2, 256
s_cbranch_scc1 M_END
s_load_dwordx2 s[4:5], s[0:1], 112
s_mov_b32 s6, 268435456
s_mov_b32 s7, 0x20000
s_load_dwordx2 s[16:17], s[0:1], 104
s_mov_b32 s18, 256
s_mov_b32 s19, 0x20000
v_and_b32 v1, 63, v0
v_lshrrev_b32 v2, 6, v0
s_getreg_b32 s22, hwreg(HW_REG_XCC_ID, 0, 4)
v_readfirstlane_b32 s24, v2
s_mov_b32 s23, 0
s_waitcnt lgkmcnt(0)
M_TRY:
s_add_u32 s25, s22, s23
s_and_b32 s25, s25, 7
s_lshr_b32 s26, s25, 2
s_lshl_b32 s26, s26, 7
s_and_b32 s27, s25, 3
s_lshl_b32 s27, s27, 2
s_add_u32 s26, s26, s27
s_cmp_lg_u32 s24, 0
s_cbranch_scc1 BA_1
v_mov_b32 v2, 1
v_mov_b32 v3, 0
v_mov_b32 v4, 163824
s_mov_b64 exec, 1
buffer_atomic_add v2, v3, s[16:19], s26 offen sc0 sc1
s_waitcnt vmcnt(0)
ds_write_b32 v4, v2
s_mov_b64 exec, -1
s_waitcnt lgkmcnt(0)
BA_1:
s_barrier
v_mov_b32 v4, 163824
ds_read_b32 v2, v4
s_waitcnt lgkmcnt(0)
v_readfirstlane_b32 s27, v2
s_barrier
s_cmp_lt_u32 s27, 32
s_cbranch_scc1 M_GOT
s_add_u32 s23, s23, 1
s_cmp_lt_u32 s23, 8
s_cbranch_scc1 M_TRY
s_branch M_END
M_GOT:
s_mov_b32 s20, s25
s_mov_b32 s21, s27
s_cmp_eq_u32 s25, 0
s_cbranch_scc1 R_S
s_cmp_lt_u32 s25, 3
s_cbranch_scc1 R_VO
W_INIT:
s_cmp_eq_u32 s20, 3
s_cbranch_scc1 WI_3
s_sub_u32 s29, s20, 4
s_lshl_b32 s29, s29, 5
s_add_u32 s29, s29, s21
s_load_dwordx2 s[8:9], s[0:1], 0
s_mov_b32 s10, 4194304
s_mov_b32 s11, 0x20000
v_and_b32 v2, 15, v1
v_lshrrev_b32 v3, 4, v1
v_lshlrev_b32 v4, 11, v2
v_lshl_add_u32 v4, v3, 3, v4
s_lshl_b32 s25, s29, 15
s_lshl_b32 s26, s24, 9
s_add_u32 s25, s25, s26
s_waitcnt lgkmcnt(0)
buffer_load_dwordx2 v[16:17], v4, s[8:11], s25 offen offset:0
buffer_load_dwordx2 v[18:19], v4, s[8:11], s25 offen offset:32
buffer_load_dwordx2 v[20:21], v4, s[8:11], s25 offen offset:64
buffer_load_dwordx2 v[22:23], v4, s[8:11], s25 offen offset:96
buffer_load_dwordx2 v[24:25], v4, s[8:11], s25 offen offset:128
buffer_load_dwordx2 v[26:27], v4, s[8:11], s25 offen offset:160
buffer_load_dwordx2 v[28:29], v4, s[8:11], s25 offen offset:192
buffer_load_dwordx2 v[30:31], v4, s[8:11], s25 offen offset:224
buffer_load_dwordx2 v[32:33], v4, s[8:11], s25 offen offset:256
buffer_load_dwordx2 v[34:35], v4, s[8:11], s25 offen offset:288
buffer_load_dwordx2 v[36:37], v4, s[8:11], s25 offen offset:320
buffer_load_dwordx2 v[38:39], v4, s[8:11], s25 offen offset:352
buffer_load_dwordx2 v[40:41], v4, s[8:11], s25 offen offset:384
buffer_load_dwordx2 v[42:43], v4, s[8:11], s25 offen offset:416
buffer_load_dwordx2 v[44:45], v4, s[8:11], s25 offen offset:448
buffer_load_dwordx2 v[46:47], v4, s[8:11], s25 offen offset:480
v_mov_b32 v8, 0
v_mov_b32 v9, 0
s_waitcnt vmcnt(15)
v_lshlrev_b32 v64, 16, v16
v_and_b32 v65, 0xffff0000, v16
v_add_f32 v8, v8, v64
v_add_f32 v9, v9, v65
v_lshlrev_b32 v66, 16, v17
v_and_b32 v67, 0xffff0000, v17
v_add_f32 v8, v8, v66
v_add_f32 v9, v9, v67
s_waitcnt vmcnt(14)
v_lshlrev_b32 v68, 16, v18
v_and_b32 v69, 0xffff0000, v18
v_add_f32 v8, v8, v68
v_add_f32 v9, v9, v69
v_lshlrev_b32 v70, 16, v19
v_and_b32 v71, 0xffff0000, v19
v_add_f32 v8, v8, v70
v_add_f32 v9, v9, v71
s_waitcnt vmcnt(13)
v_lshlrev_b32 v72, 16, v20
v_and_b32 v73, 0xffff0000, v20
v_add_f32 v8, v8, v72
v_add_f32 v9, v9, v73
v_lshlrev_b32 v74, 16, v21
v_and_b32 v75, 0xffff0000, v21
v_add_f32 v8, v8, v74
v_add_f32 v9, v9, v75
s_waitcnt vmcnt(12)
v_lshlrev_b32 v76, 16, v22
v_and_b32 v77, 0xffff0000, v22
v_add_f32 v8, v8, v76
v_add_f32 v9, v9, v77
v_lshlrev_b32 v78, 16, v23
v_and_b32 v79, 0xffff0000, v23
v_add_f32 v8, v8, v78
v_add_f32 v9, v9, v79
s_waitcnt vmcnt(11)
v_lshlrev_b32 v80, 16, v24
v_and_b32 v81, 0xffff0000, v24
v_add_f32 v8, v8, v80
v_add_f32 v9, v9, v81
v_lshlrev_b32 v82, 16, v25
v_and_b32 v83, 0xffff0000, v25
v_add_f32 v8, v8, v82
v_add_f32 v9, v9, v83
s_waitcnt vmcnt(10)
v_lshlrev_b32 v84, 16, v26
v_and_b32 v85, 0xffff0000, v26
v_add_f32 v8, v8, v84
v_add_f32 v9, v9, v85
v_lshlrev_b32 v86, 16, v27
v_and_b32 v87, 0xffff0000, v27
v_add_f32 v8, v8, v86
v_add_f32 v9, v9, v87
s_waitcnt vmcnt(9)
v_lshlrev_b32 v88, 16, v28
v_and_b32 v89, 0xffff0000, v28
v_add_f32 v8, v8, v88
v_add_f32 v9, v9, v89
v_lshlrev_b32 v90, 16, v29
v_and_b32 v91, 0xffff0000, v29
v_add_f32 v8, v8, v90
v_add_f32 v9, v9, v91
s_waitcnt vmcnt(8)
v_lshlrev_b32 v92, 16, v30
v_and_b32 v93, 0xffff0000, v30
v_add_f32 v8, v8, v92
v_add_f32 v9, v9, v93
v_lshlrev_b32 v94, 16, v31
v_and_b32 v95, 0xffff0000, v31
v_add_f32 v8, v8, v94
v_add_f32 v9, v9, v95
s_waitcnt vmcnt(7)
v_lshlrev_b32 v96, 16, v32
v_and_b32 v97, 0xffff0000, v32
v_add_f32 v8, v8, v96
v_add_f32 v9, v9, v97
v_lshlrev_b32 v98, 16, v33
v_and_b32 v99, 0xffff0000, v33
v_add_f32 v8, v8, v98
v_add_f32 v9, v9, v99
s_waitcnt vmcnt(6)
v_lshlrev_b32 v100, 16, v34
v_and_b32 v101, 0xffff0000, v34
v_add_f32 v8, v8, v100
v_add_f32 v9, v9, v101
v_lshlrev_b32 v102, 16, v35
v_and_b32 v103, 0xffff0000, v35
v_add_f32 v8, v8, v102
v_add_f32 v9, v9, v103
s_waitcnt vmcnt(5)
v_lshlrev_b32 v104, 16, v36
v_and_b32 v105, 0xffff0000, v36
v_add_f32 v8, v8, v104
v_add_f32 v9, v9, v105
v_lshlrev_b32 v106, 16, v37
v_and_b32 v107, 0xffff0000, v37
v_add_f32 v8, v8, v106
v_add_f32 v9, v9, v107
s_waitcnt vmcnt(4)
v_lshlrev_b32 v108, 16, v38
v_and_b32 v109, 0xffff0000, v38
v_add_f32 v8, v8, v108
v_add_f32 v9, v9, v109
v_lshlrev_b32 v110, 16, v39
v_and_b32 v111, 0xffff0000, v39
v_add_f32 v8, v8, v110
v_add_f32 v9, v9, v111
s_waitcnt vmcnt(3)
v_lshlrev_b32 v112, 16, v40
v_and_b32 v113, 0xffff0000, v40
v_add_f32 v8, v8, v112
v_add_f32 v9, v9, v113
v_lshlrev_b32 v114, 16, v41
v_and_b32 v115, 0xffff0000, v41
v_add_f32 v8, v8, v114
v_add_f32 v9, v9, v115
s_waitcnt vmcnt(2)
v_lshlrev_b32 v116, 16, v42
v_and_b32 v117, 0xffff0000, v42
v_add_f32 v8, v8, v116
v_add_f32 v9, v9, v117
v_lshlrev_b32 v118, 16, v43
v_and_b32 v119, 0xffff0000, v43
v_add_f32 v8, v8, v118
v_add_f32 v9, v9, v119
s_waitcnt vmcnt(1)
v_lshlrev_b32 v120, 16, v44
v_and_b32 v121, 0xffff0000, v44
v_add_f32 v8, v8, v120
v_add_f32 v9, v9, v121
v_lshlrev_b32 v122, 16, v45
v_and_b32 v123, 0xffff0000, v45
v_add_f32 v8, v8, v122
v_add_f32 v9, v9, v123
s_waitcnt vmcnt(0)
v_lshlrev_b32 v124, 16, v46
v_and_b32 v125, 0xffff0000, v46
v_add_f32 v8, v8, v124
v_add_f32 v9, v9, v125
v_lshlrev_b32 v126, 16, v47
v_and_b32 v127, 0xffff0000, v47
v_add_f32 v8, v8, v126
v_add_f32 v9, v9, v127
v_add_f32 v8, v8, v9
v_mov_b32 v9, v8
s_nop 1
v_permlane16_swap_b32 v8, v9
s_nop 1
v_add_f32 v8, v8, v9
v_mov_b32 v9, v8
s_nop 1
v_permlane32_swap_b32 v8, v9
s_nop 1
v_add_f32 v8, v8, v9
s_lshl_b32 s26, s24, 6
v_lshl_add_u32 v5, v2, 2, s26
v_lshlrev_b32 v6, 2, v2
ds_write_b32 v5, v8
s_waitcnt lgkmcnt(0)
s_barrier
ds_read2_b32 v[10:11], v6 offset0:0 offset1:16
ds_read2_b32 v[12:13], v6 offset0:32 offset1:48
s_waitcnt lgkmcnt(0)
v_add_f32 v10, v10, v11
v_add_f32 v12, v12, v13
v_add_f32 v8, v10, v12
v_mul_f32 v8, 0x3a800000, v8
v_mov_b32 v10, 0
v_mov_b32 v11, 0
v_sub_f32 v12, v64, v8
v_sub_f32 v13, v65, v8
v_fmac_f32 v10, v12, v12
v_fmac_f32 v11, v13, v13
v_sub_f32 v12, v66, v8
v_sub_f32 v13, v67, v8
v_fmac_f32 v10, v12, v12
v_fmac_f32 v11, v13, v13
v_sub_f32 v12, v68, v8
v_sub_f32 v13, v69, v8
v_fmac_f32 v10, v12, v12
v_fmac_f32 v11, v13, v13
v_sub_f32 v12, v70, v8
v_sub_f32 v13, v71, v8
v_fmac_f32 v10, v12, v12
v_fmac_f32 v11, v13, v13
v_sub_f32 v12, v72, v8
v_sub_f32 v13, v73, v8
v_fmac_f32 v10, v12, v12
v_fmac_f32 v11, v13, v13
v_sub_f32 v12, v74, v8
v_sub_f32 v13, v75, v8
v_fmac_f32 v10, v12, v12
v_fmac_f32 v11, v13, v13
v_sub_f32 v12, v76, v8
v_sub_f32 v13, v77, v8
v_fmac_f32 v10, v12, v12
v_fmac_f32 v11, v13, v13
v_sub_f32 v12, v78, v8
v_sub_f32 v13, v79, v8
v_fmac_f32 v10, v12, v12
v_fmac_f32 v11, v13, v13
v_sub_f32 v12, v80, v8
v_sub_f32 v13, v81, v8
v_fmac_f32 v10, v12, v12
v_fmac_f32 v11, v13, v13
v_sub_f32 v12, v82, v8
v_sub_f32 v13, v83, v8
v_fmac_f32 v10, v12, v12
v_fmac_f32 v11, v13, v13
v_sub_f32 v12, v84, v8
v_sub_f32 v13, v85, v8
v_fmac_f32 v10, v12, v12
v_fmac_f32 v11, v13, v13
v_sub_f32 v12, v86, v8
v_sub_f32 v13, v87, v8
v_fmac_f32 v10, v12, v12
v_fmac_f32 v11, v13, v13
v_sub_f32 v12, v88, v8
v_sub_f32 v13, v89, v8
v_fmac_f32 v10, v12, v12
v_fmac_f32 v11, v13, v13
v_sub_f32 v12, v90, v8
v_sub_f32 v13, v91, v8
v_fmac_f32 v10, v12, v12
v_fmac_f32 v11, v13, v13
v_sub_f32 v12, v92, v8
v_sub_f32 v13, v93, v8
v_fmac_f32 v10, v12, v12
v_fmac_f32 v11, v13, v13
v_sub_f32 v12, v94, v8
v_sub_f32 v13, v95, v8
v_fmac_f32 v10, v12, v12
v_fmac_f32 v11, v13, v13
v_sub_f32 v12, v96, v8
v_sub_f32 v13, v97, v8
v_fmac_f32 v10, v12, v12
v_fmac_f32 v11, v13, v13
v_sub_f32 v12, v98, v8
v_sub_f32 v13, v99, v8
v_fmac_f32 v10, v12, v12
v_fmac_f32 v11, v13, v13
v_sub_f32 v12, v100, v8
v_sub_f32 v13, v101, v8
v_fmac_f32 v10, v12, v12
v_fmac_f32 v11, v13, v13
v_sub_f32 v12, v102, v8
v_sub_f32 v13, v103, v8
v_fmac_f32 v10, v12, v12
v_fmac_f32 v11, v13, v13
v_sub_f32 v12, v104, v8
v_sub_f32 v13, v105, v8
v_fmac_f32 v10, v12, v12
v_fmac_f32 v11, v13, v13
v_sub_f32 v12, v106, v8
v_sub_f32 v13, v107, v8
v_fmac_f32 v10, v12, v12
v_fmac_f32 v11, v13, v13
v_sub_f32 v12, v108, v8
v_sub_f32 v13, v109, v8
v_fmac_f32 v10, v12, v12
v_fmac_f32 v11, v13, v13
v_sub_f32 v12, v110, v8
v_sub_f32 v13, v111, v8
v_fmac_f32 v10, v12, v12
v_fmac_f32 v11, v13, v13
v_sub_f32 v12, v112, v8
v_sub_f32 v13, v113, v8
v_fmac_f32 v10, v12, v12
v_fmac_f32 v11, v13, v13
v_sub_f32 v12, v114, v8
v_sub_f32 v13, v115, v8
v_fmac_f32 v10, v12, v12
v_fmac_f32 v11, v13, v13
v_sub_f32 v12, v116, v8
v_sub_f32 v13, v117, v8
v_fmac_f32 v10, v12, v12
v_fmac_f32 v11, v13, v13
v_sub_f32 v12, v118, v8
v_sub_f32 v13, v119, v8
v_fmac_f32 v10, v12, v12
v_fmac_f32 v11, v13, v13
v_sub_f32 v12, v120, v8
v_sub_f32 v13, v121, v8
v_fmac_f32 v10, v12, v12
v_fmac_f32 v11, v13, v13
v_sub_f32 v12, v122, v8
v_sub_f32 v13, v123, v8
v_fmac_f32 v10, v12, v12
v_fmac_f32 v11, v13, v13
v_sub_f32 v12, v124, v8
v_sub_f32 v13, v125, v8
v_fmac_f32 v10, v12, v12
v_fmac_f32 v11, v13, v13
v_sub_f32 v12, v126, v8
v_sub_f32 v13, v127, v8
v_fmac_f32 v10, v12, v12
v_fmac_f32 v11, v13, v13
v_add_f32 v10, v10, v11
v_mov_b32 v11, v10
s_nop 1
v_permlane16_swap_b32 v10, v11
s_nop 1
v_add_f32 v10, v10, v11
v_mov_b32 v11, v10
s_nop 1
v_permlane32_swap_b32 v10, v11
s_nop 1
v_add_f32 v10, v10, v11
ds_write_b32 v5, v10 offset:256
s_waitcnt lgkmcnt(0)
s_barrier
ds_read2_b32 v[10:11], v6 offset0:64 offset1:80
ds_read2_b32 v[12:13], v6 offset0:96 offset1:112
s_waitcnt lgkmcnt(0)
v_add_f32 v10, v10, v11
v_add_f32 v12, v12, v13
v_add_f32 v10, v10, v12
v_mul_f32 v10, 0x3a800000, v10
v_cvt_pk_bf16_f32 v8, v8, v8
v_lshlrev_b32 v8, 16, v8
v_cvt_pk_bf16_f32 v10, v10, v10
v_lshlrev_b32 v10, 16, v10
v_add_f32 v10, 0x3727c5ac, v10
v_cvt_pk_bf16_f32 v10, v10, v10
v_lshlrev_b32 v10, 16, v10
v_sqrt_f32 v10, v10
s_nop 0
v_cvt_pk_bf16_f32 v10, v10, v10
v_lshlrev_b32 v10, 16, v10
v_rcp_f32 v10, v10
s_lshr_b32 s25, s29, 4
s_lshl_b32 s25, s25, 19
s_and_b32 s26, s29, 15
s_lshl_b32 s26, s26, 10
s_add_u32 s25, s25, s26
s_lshl_b32 s26, s24, 17
s_add_u32 s25, s25, s26
s_add_u32 s25, s25, 0
v_lshlrev_b32 v4, 4, v1
v_sub_f32 v12, v64, v8
v_sub_f32 v13, v65, v8
v_cvt_pk_bf16_f32 v12, v12, v13
v_and_b32 v13, 0xffff0000, v12
v_lshlrev_b32 v12, 16, v12
v_mul_f32 v13, v13, v10
v_mul_f32 v12, v12, v10
v_cvt_pk_bf16_f32 v16, v12, v13
v_sub_f32 v12, v66, v8
v_sub_f32 v13, v67, v8
v_cvt_pk_bf16_f32 v12, v12, v13
v_and_b32 v13, 0xffff0000, v12
v_lshlrev_b32 v12, 16, v12
v_mul_f32 v13, v13, v10
v_mul_f32 v12, v12, v10
v_cvt_pk_bf16_f32 v17, v12, v13
v_sub_f32 v12, v68, v8
v_sub_f32 v13, v69, v8
v_cvt_pk_bf16_f32 v12, v12, v13
v_and_b32 v13, 0xffff0000, v12
v_lshlrev_b32 v12, 16, v12
v_mul_f32 v13, v13, v10
v_mul_f32 v12, v12, v10
v_cvt_pk_bf16_f32 v18, v12, v13
v_sub_f32 v12, v70, v8
v_sub_f32 v13, v71, v8
v_cvt_pk_bf16_f32 v12, v12, v13
v_and_b32 v13, 0xffff0000, v12
v_lshlrev_b32 v12, 16, v12
v_mul_f32 v13, v13, v10
v_mul_f32 v12, v12, v10
v_cvt_pk_bf16_f32 v19, v12, v13
buffer_store_dwordx4 v[16:19], v4, s[4:7], s25 offen sc1
s_add_u32 s25, s25, 16384
v_sub_f32 v12, v72, v8
v_sub_f32 v13, v73, v8
v_cvt_pk_bf16_f32 v12, v12, v13
v_and_b32 v13, 0xffff0000, v12
v_lshlrev_b32 v12, 16, v12
v_mul_f32 v13, v13, v10
v_mul_f32 v12, v12, v10
v_cvt_pk_bf16_f32 v20, v12, v13
v_sub_f32 v12, v74, v8
v_sub_f32 v13, v75, v8
v_cvt_pk_bf16_f32 v12, v12, v13
v_and_b32 v13, 0xffff0000, v12
v_lshlrev_b32 v12, 16, v12
v_mul_f32 v13, v13, v10
v_mul_f32 v12, v12, v10
v_cvt_pk_bf16_f32 v21, v12, v13
v_sub_f32 v12, v76, v8
v_sub_f32 v13, v77, v8
v_cvt_pk_bf16_f32 v12, v12, v13
v_and_b32 v13, 0xffff0000, v12
v_lshlrev_b32 v12, 16, v12
v_mul_f32 v13, v13, v10
v_mul_f32 v12, v12, v10
v_cvt_pk_bf16_f32 v22, v12, v13
v_sub_f32 v12, v78, v8
v_sub_f32 v13, v79, v8
v_cvt_pk_bf16_f32 v12, v12, v13
v_and_b32 v13, 0xffff0000, v12
v_lshlrev_b32 v12, 16, v12
v_mul_f32 v13, v13, v10
v_mul_f32 v12, v12, v10
v_cvt_pk_bf16_f32 v23, v12, v13
buffer_store_dwordx4 v[20:23], v4, s[4:7], s25 offen sc1
s_add_u32 s25, s25, 16384
v_sub_f32 v12, v80, v8
v_sub_f32 v13, v81, v8
v_cvt_pk_bf16_f32 v12, v12, v13
v_and_b32 v13, 0xffff0000, v12
v_lshlrev_b32 v12, 16, v12
v_mul_f32 v13, v13, v10
v_mul_f32 v12, v12, v10
v_cvt_pk_bf16_f32 v24, v12, v13
v_sub_f32 v12, v82, v8
v_sub_f32 v13, v83, v8
v_cvt_pk_bf16_f32 v12, v12, v13
v_and_b32 v13, 0xffff0000, v12
v_lshlrev_b32 v12, 16, v12
v_mul_f32 v13, v13, v10
v_mul_f32 v12, v12, v10
v_cvt_pk_bf16_f32 v25, v12, v13
v_sub_f32 v12, v84, v8
v_sub_f32 v13, v85, v8
v_cvt_pk_bf16_f32 v12, v12, v13
v_and_b32 v13, 0xffff0000, v12
v_lshlrev_b32 v12, 16, v12
v_mul_f32 v13, v13, v10
v_mul_f32 v12, v12, v10
v_cvt_pk_bf16_f32 v26, v12, v13
v_sub_f32 v12, v86, v8
v_sub_f32 v13, v87, v8
v_cvt_pk_bf16_f32 v12, v12, v13
v_and_b32 v13, 0xffff0000, v12
v_lshlrev_b32 v12, 16, v12
v_mul_f32 v13, v13, v10
v_mul_f32 v12, v12, v10
v_cvt_pk_bf16_f32 v27, v12, v13
buffer_store_dwordx4 v[24:27], v4, s[4:7], s25 offen sc1
s_add_u32 s25, s25, 16384
v_sub_f32 v12, v88, v8
v_sub_f32 v13, v89, v8
v_cvt_pk_bf16_f32 v12, v12, v13
v_and_b32 v13, 0xffff0000, v12
v_lshlrev_b32 v12, 16, v12
v_mul_f32 v13, v13, v10
v_mul_f32 v12, v12, v10
v_cvt_pk_bf16_f32 v28, v12, v13
v_sub_f32 v12, v90, v8
v_sub_f32 v13, v91, v8
v_cvt_pk_bf16_f32 v12, v12, v13
v_and_b32 v13, 0xffff0000, v12
v_lshlrev_b32 v12, 16, v12
v_mul_f32 v13, v13, v10
v_mul_f32 v12, v12, v10
v_cvt_pk_bf16_f32 v29, v12, v13
v_sub_f32 v12, v92, v8
v_sub_f32 v13, v93, v8
v_cvt_pk_bf16_f32 v12, v12, v13
v_and_b32 v13, 0xffff0000, v12
v_lshlrev_b32 v12, 16, v12
v_mul_f32 v13, v13, v10
v_mul_f32 v12, v12, v10
v_cvt_pk_bf16_f32 v30, v12, v13
v_sub_f32 v12, v94, v8
v_sub_f32 v13, v95, v8
v_cvt_pk_bf16_f32 v12, v12, v13
v_and_b32 v13, 0xffff0000, v12
v_lshlrev_b32 v12, 16, v12
v_mul_f32 v13, v13, v10
v_mul_f32 v12, v12, v10
v_cvt_pk_bf16_f32 v31, v12, v13
buffer_store_dwordx4 v[28:31], v4, s[4:7], s25 offen sc1
s_add_u32 s25, s25, 16384
v_sub_f32 v12, v96, v8
v_sub_f32 v13, v97, v8
v_cvt_pk_bf16_f32 v12, v12, v13
v_and_b32 v13, 0xffff0000, v12
v_lshlrev_b32 v12, 16, v12
v_mul_f32 v13, v13, v10
v_mul_f32 v12, v12, v10
v_cvt_pk_bf16_f32 v32, v12, v13
v_sub_f32 v12, v98, v8
v_sub_f32 v13, v99, v8
v_cvt_pk_bf16_f32 v12, v12, v13
v_and_b32 v13, 0xffff0000, v12
v_lshlrev_b32 v12, 16, v12
v_mul_f32 v13, v13, v10
v_mul_f32 v12, v12, v10
v_cvt_pk_bf16_f32 v33, v12, v13
v_sub_f32 v12, v100, v8
v_sub_f32 v13, v101, v8
v_cvt_pk_bf16_f32 v12, v12, v13
v_and_b32 v13, 0xffff0000, v12
v_lshlrev_b32 v12, 16, v12
v_mul_f32 v13, v13, v10
v_mul_f32 v12, v12, v10
v_cvt_pk_bf16_f32 v34, v12, v13
v_sub_f32 v12, v102, v8
v_sub_f32 v13, v103, v8
v_cvt_pk_bf16_f32 v12, v12, v13
v_and_b32 v13, 0xffff0000, v12
v_lshlrev_b32 v12, 16, v12
v_mul_f32 v13, v13, v10
v_mul_f32 v12, v12, v10
v_cvt_pk_bf16_f32 v35, v12, v13
buffer_store_dwordx4 v[32:35], v4, s[4:7], s25 offen sc1
s_add_u32 s25, s25, 16384
v_sub_f32 v12, v104, v8
v_sub_f32 v13, v105, v8
v_cvt_pk_bf16_f32 v12, v12, v13
v_and_b32 v13, 0xffff0000, v12
v_lshlrev_b32 v12, 16, v12
v_mul_f32 v13, v13, v10
v_mul_f32 v12, v12, v10
v_cvt_pk_bf16_f32 v36, v12, v13
v_sub_f32 v12, v106, v8
v_sub_f32 v13, v107, v8
v_cvt_pk_bf16_f32 v12, v12, v13
v_and_b32 v13, 0xffff0000, v12
v_lshlrev_b32 v12, 16, v12
v_mul_f32 v13, v13, v10
v_mul_f32 v12, v12, v10
v_cvt_pk_bf16_f32 v37, v12, v13
v_sub_f32 v12, v108, v8
v_sub_f32 v13, v109, v8
v_cvt_pk_bf16_f32 v12, v12, v13
v_and_b32 v13, 0xffff0000, v12
v_lshlrev_b32 v12, 16, v12
v_mul_f32 v13, v13, v10
v_mul_f32 v12, v12, v10
v_cvt_pk_bf16_f32 v38, v12, v13
v_sub_f32 v12, v110, v8
v_sub_f32 v13, v111, v8
v_cvt_pk_bf16_f32 v12, v12, v13
v_and_b32 v13, 0xffff0000, v12
v_lshlrev_b32 v12, 16, v12
v_mul_f32 v13, v13, v10
v_mul_f32 v12, v12, v10
v_cvt_pk_bf16_f32 v39, v12, v13
buffer_store_dwordx4 v[36:39], v4, s[4:7], s25 offen sc1
s_add_u32 s25, s25, 16384
v_sub_f32 v12, v112, v8
v_sub_f32 v13, v113, v8
v_cvt_pk_bf16_f32 v12, v12, v13
v_and_b32 v13, 0xffff0000, v12
v_lshlrev_b32 v12, 16, v12
v_mul_f32 v13, v13, v10
v_mul_f32 v12, v12, v10
v_cvt_pk_bf16_f32 v40, v12, v13
v_sub_f32 v12, v114, v8
v_sub_f32 v13, v115, v8
v_cvt_pk_bf16_f32 v12, v12, v13
v_and_b32 v13, 0xffff0000, v12
v_lshlrev_b32 v12, 16, v12
v_mul_f32 v13, v13, v10
v_mul_f32 v12, v12, v10
v_cvt_pk_bf16_f32 v41, v12, v13
v_sub_f32 v12, v116, v8
v_sub_f32 v13, v117, v8
v_cvt_pk_bf16_f32 v12, v12, v13
v_and_b32 v13, 0xffff0000, v12
v_lshlrev_b32 v12, 16, v12
v_mul_f32 v13, v13, v10
v_mul_f32 v12, v12, v10
v_cvt_pk_bf16_f32 v42, v12, v13
v_sub_f32 v12, v118, v8
v_sub_f32 v13, v119, v8
v_cvt_pk_bf16_f32 v12, v12, v13
v_and_b32 v13, 0xffff0000, v12
v_lshlrev_b32 v12, 16, v12
v_mul_f32 v13, v13, v10
v_mul_f32 v12, v12, v10
v_cvt_pk_bf16_f32 v43, v12, v13
buffer_store_dwordx4 v[40:43], v4, s[4:7], s25 offen sc1
s_add_u32 s25, s25, 16384
v_sub_f32 v12, v120, v8
v_sub_f32 v13, v121, v8
v_cvt_pk_bf16_f32 v12, v12, v13
v_and_b32 v13, 0xffff0000, v12
v_lshlrev_b32 v12, 16, v12
v_mul_f32 v13, v13, v10
v_mul_f32 v12, v12, v10
v_cvt_pk_bf16_f32 v44, v12, v13
v_sub_f32 v12, v122, v8
v_sub_f32 v13, v123, v8
v_cvt_pk_bf16_f32 v12, v12, v13
v_and_b32 v13, 0xffff0000, v12
v_lshlrev_b32 v12, 16, v12
v_mul_f32 v13, v13, v10
v_mul_f32 v12, v12, v10
v_cvt_pk_bf16_f32 v45, v12, v13
v_sub_f32 v12, v124, v8
v_sub_f32 v13, v125, v8
v_cvt_pk_bf16_f32 v12, v12, v13
v_and_b32 v13, 0xffff0000, v12
v_lshlrev_b32 v12, 16, v12
v_mul_f32 v13, v13, v10
v_mul_f32 v12, v12, v10
v_cvt_pk_bf16_f32 v46, v12, v13
v_sub_f32 v12, v126, v8
v_sub_f32 v13, v127, v8
v_cvt_pk_bf16_f32 v12, v12, v13
v_and_b32 v13, 0xffff0000, v12
v_lshlrev_b32 v12, 16, v12
v_mul_f32 v13, v13, v10
v_mul_f32 v12, v12, v10
v_cvt_pk_bf16_f32 v47, v12, v13
buffer_store_dwordx4 v[44:47], v4, s[4:7], s25 offen sc1
s_add_u32 s25, s25, 16384
s_branch WI_Z
WI_3:
s_sub_u32 s29, s21, 8
s_cmp_lt_u32 s29, 4
s_cbranch_scc0 WI_M
s_lshl_b32 s25, s29, 15
s_add_u32 s25, s25, 119537664
v_lshlrev_b32 v4, 4, v0
v_mov_b32 v8, 0
v_mov_b32 v9, 0
v_mov_b32 v10, 0
v_mov_b32 v11, 0
buffer_store_dwordx4 v[8:11], v4, s[4:7], s25 offen sc1
s_add_u32 s25, s25, 4096
buffer_store_dwordx4 v[8:11], v4, s[4:7], s25 offen sc1
s_add_u32 s25, s25, 4096
buffer_store_dwordx4 v[8:11], v4, s[4:7], s25 offen sc1
s_add_u32 s25, s25, 4096
buffer_store_dwordx4 v[8:11], v4, s[4:7], s25 offen sc1
s_add_u32 s25, s25, 4096
buffer_store_dwordx4 v[8:11], v4, s[4:7], s25 offen sc1
s_add_u32 s25, s25, 4096
buffer_store_dwordx4 v[8:11], v4, s[4:7], s25 offen sc1
s_add_u32 s25, s25, 4096
buffer_store_dwordx4 v[8:11], v4, s[4:7], s25 offen sc1
s_add_u32 s25, s25, 4096
buffer_store_dwordx4 v[8:11], v4, s[4:7], s25 offen sc1
s_add_u32 s25, s25, 4096
s_waitcnt vmcnt(0)
s_barrier
s_lshl_b32 s25, s24, 12
s_add_u32 s25, s25, 192
v_mov_b32 v8, 1
v_mov_b32 v9, s25
s_mov_b64 exec, 1
buffer_atomic_add v8, v9, s[16:19], 0 offen sc1
s_mov_b64 exec, -1
s_branch WI_S
WI_M:
s_sub_u32 s29, s21, 16
s_cmp_lt_u32 s29, 11
s_cbranch_scc0 WI_S
s_lshl_b32 s26, s29, 21
s_add_u32 s26, s26, 94339072
s_lshl_b32 s27, s24, 10
s_add_u32 s27, s27, s26
s_add_u32 s28, s27, 8192
v_lshlrev_b32 v5, 4, v1
v_mov_b32 v6, 0
s_mov_b32 s36, -1
s_mov_b32 s37, -1
buffer_store_dwordx4 v[4:7], v5, s[4:7], s27 offen sc1
buffer_store_dwordx4 v[4:7], v5, s[4:7], s28 offen sc1
s_mov_b64 exec, 1
s_waitcnt vmcnt(0)
s_barrier
s_memtime s[38:39]
s_waitcnt lgkmcnt(0)
buffer_load_dword v7, v6, s[4:7], s27 offen offset:0 sc1
s_waitcnt vmcnt(0)
s_memtime s[40:41]
s_waitcnt lgkmcnt(0)
s_sub_u32 s40, s40, s38
s_min_u32 s36, s36, s40
s_waitcnt vmcnt(0)
s_barrier
s_memtime s[38:39]
s_waitcnt lgkmcnt(0)
buffer_load_dword v7, v6, s[4:7], s28 offen offset:0 sc1
s_waitcnt vmcnt(0)
s_memtime s[40:41]
s_waitcnt lgkmcnt(0)
s_sub_u32 s40, s40, s38
s_min_u32 s37, s37, s40
s_waitcnt vmcnt(0)
s_barrier
s_memtime s[38:39]
s_waitcnt lgkmcnt(0)
buffer_load_dword v7, v6, s[4:7], s27 offen offset:128 sc1
s_waitcnt vmcnt(0)
s_memtime s[40:41]
s_waitcnt lgkmcnt(0)
s_sub_u32 s40, s40, s38
s_min_u32 s36, s36, s40
s_waitcnt vmcnt(0)
s_barrier
s_memtime s[38:39]
s_waitcnt lgkmcnt(0)
buffer_load_dword v7, v6, s[4:7], s28 offen offset:128 sc1
s_waitcnt vmcnt(0)
s_memtime s[40:41]
s_waitcnt lgkmcnt(0)
s_sub_u32 s40, s40, s38
s_min_u32 s37, s37, s40
s_waitcnt vmcnt(0)
s_barrier
s_memtime s[38:39]
s_waitcnt lgkmcnt(0)
buffer_load_dword v7, v6, s[4:7], s27 offen offset:256 sc1
s_waitcnt vmcnt(0)
s_memtime s[40:41]
s_waitcnt lgkmcnt(0)
s_sub_u32 s40, s40, s38
s_min_u32 s36, s36, s40
s_waitcnt vmcnt(0)
s_barrier
s_memtime s[38:39]
s_waitcnt lgkmcnt(0)
buffer_load_dword v7, v6, s[4:7], s28 offen offset:256 sc1
s_waitcnt vmcnt(0)
s_memtime s[40:41]
s_waitcnt lgkmcnt(0)
s_sub_u32 s40, s40, s38
s_min_u32 s37, s37, s40
s_mov_b64 exec, -1
s_lshl_b32 s28, s24, 3
v_mov_b32 v7, s28
v_mov_b32 v12, s36
v_mov_b32 v13, s37
ds_write_b64 v7, v[12:13]
s_waitcnt lgkmcnt(0)
s_barrier
ds_read_b128 v[12:15], v6
ds_read_b128 v[16:19], v6 offset:16
s_waitcnt lgkmcnt(0)
v_min_u32 v14, v14, v16
v_min_u32 v15, v15, v17
v_min_u32 v12, v12, v18
v_min_u32 v13, v13, v19
v_min_u32 v12, v12, v14
v_min_u32 v13, v13, v15
s_nop 0
v_readfirstlane_b32 s36, v12
v_readfirstlane_b32 s37, v13
s_lshr_b32 s34, s22, 2
s_cmp_lt_u32 s37, s36
s_cselect_b32 s35, 1, 0
s_xor_b32 s35, s35, s34
s_xor_b32 s35, s35, 0
s_lshl_b32 s35, s35, 16
s_or_b32 s35, s35, 1
s_lshl_b32 s35, s35, s29
s_lshl_b32 s25, s24, 12
s_add_u32 s25, s25, 196
v_mov_b32 v8, s35
v_mov_b32 v9, s25
s_mov_b64 exec, 1
buffer_atomic_or v8, v9, s[16:19], 0 offen sc1
s_mov_b64 exec, -1
WI_S:
s_sleep 16
WI_Z:
v_mov_b32 v2, 0
s_mov_b32 s44, 0
WI_ZT:
buffer_load_dword v3, v2, s[16:19], 0 offen offset:192 sc1
s_waitcnt vmcnt(0)
v_cmp_eq_u32 vcc, 4, v3
s_cbranch_vccnz WI_ZOK
s_sleep 8
s_add_u32 s44, s44, 1
s_cmp_lt_u32 s44, 40000
s_cbranch_scc1 WI_ZT
s_branch M_END
WI_ZOK:
s_barrier
s_cmp_lg_u32 s24, 0
s_cbranch_scc1 WI_T
s_cmp_eq_u32 s20, 3
s_cbranch_scc1 WI_P
s_lshl_b32 s25, s29, 7
s_add_u32 s25, s25, 119545856
v_mov_b32 v3, 1
s_mov_b64 exec, 1
buffer_store_dword v3, v2, s[4:7], s25 offen sc1
s_mov_b64 exec, -1
WI_P:
s_lshr_b32 s25, s21, 4
s_lshl_b32 s25, s25, 3
s_lshl_b32 s46, 255, s25
s_cmp_eq_u32 s20, 3
s_cselect_b32 s46, 0xffff0000, s46
s_mov_b32 s47, 0
v_lshlrev_b32 v2, 7, v1
v_mov_b32 v4, 2147483648
s_mov_b32 s25, 119545856
v_cndmask_b32 v2, v4, v2, s[46:47]
s_mov_b32 s44, 0
WI_PT:
s_sleep 4
buffer_load_dword v3, v2, s[4:7], s25 offen sc1
s_waitcnt vmcnt(0)
v_cmp_ne_u32 vcc, 0, v3
s_cmp_eq_u64 vcc, s[46:47]
s_cbranch_scc1 WI_GO
s_add_u32 s44, s44, 1
s_cmp_lt_u32 s44, 40000
s_cbranch_scc1 WI_PT
s_branch WI_GO
WI_T:
s_sub_u32 s38, s20, 3
s_lshl_b32 s38, s38, 5
s_add_u32 s38, s38, s21
s_mul_i32 s38, s38, 3
s_add_u32 s38, s38, s24
s_sub_u32 s38, s38, 1
s_load_dwordx2 s[72:73], s[0:1], 64
s_mov_b32 s74, 7340032
s_mov_b32 s75, 0x20000
s_mul_i32 s38, s38, 16384
v_lshlrev_b32 v240, 7, v1
v_add_u32 v240, s38, v240
v_add_u32 v241, 8192, v240
s_waitcnt lgkmcnt(0)
buffer_load_dword v255, v240, s[72:75], 0 offen
buffer_load_dword v255, v241, s[72:75], 0 offen
WI_GO:
s_barrier
s_mov_b32 s27, s21
s_branch W_TASK
W_LOOP:
s_lshl_b32 s26, s20, 8
s_add_u32 s26, s26, 119537664
s_cmp_lg_u32 s24, 0
s_cbranch_scc1 BA_2
v_mov_b32 v2, 1
v_mov_b32 v3, 0
v_mov_b32 v4, 163824
s_mov_b64 exec, 1
buffer_atomic_add v2, v3, s[4:7], s26 offen sc0 sc1
s_waitcnt vmcnt(0)
ds_write_b32 v4, v2
s_mov_b64 exec, -1
s_waitcnt lgkmcnt(0)
BA_2:
s_barrier
v_mov_b32 v4, 163824
ds_read_b32 v2, v4
s_waitcnt lgkmcnt(0)
v_readfirstlane_b32 s27, v2
s_barrier
s_branch W_NEXT
W_TICKET:
s_waitcnt lgkmcnt(0)
v_readfirstlane_b32 s27, v2
W_NEXT:
s_add_u32 s27, s27, 32
W_TASK:
s_cmp_lg_u32 s20, 3
s_cbranch_scc1 TC_3
s_cmp_lt_u32 s27, 16
s_cbranch_scc0 TK_4
s_sub_u32 s29, s27, 0
s_mul_i32 s28, s29, 4096
s_lshr_b32 s28, s28, 16
s_mul_i32 s26, s28, 16
s_sub_u32 s29, s29, s26
s_add_u32 s29, s29, 0
s_add_u32 s28, s28, 1
s_branch T_K
TK_4:
s_cmp_lt_u32 s27, 32
s_cbranch_scc0 TK_5
s_sub_u32 s29, s27, 16
s_mul_i32 s28, s29, 4096
s_lshr_b32 s28, s28, 16
s_mul_i32 s26, s28, 16
s_sub_u32 s29, s29, s26
s_add_u32 s29, s29, 0
s_add_u32 s28, s28, 1
s_branch T_V
TK_5:
s_cmp_lt_u32 s27, 48
s_cbranch_scc0 TK_6
s_sub_u32 s29, s27, 32
s_mul_i32 s28, s29, 4096
s_lshr_b32 s28, s28, 16
s_mul_i32 s26, s28, 16
s_sub_u32 s29, s29, s26
s_add_u32 s29, s29, 0
s_add_u32 s28, s28, 2
s_branch T_K
TK_6:
s_cmp_lt_u32 s27, 64
s_cbranch_scc0 TK_7
s_sub_u32 s29, s27, 48
s_mul_i32 s28, s29, 4096
s_lshr_b32 s28, s28, 16
s_mul_i32 s26, s28, 16
s_sub_u32 s29, s29, s26
s_add_u32 s29, s29, 0
s_add_u32 s28, s28, 2
s_branch T_V
TK_7:
s_cmp_lt_u32 s27, 96
s_cbranch_scc0 TK_8
s_sub_u32 s29, s27, 64
s_mul_i32 s28, s29, 4096
s_lshr_b32 s28, s28, 16
s_mul_i32 s26, s28, 16
s_sub_u32 s29, s29, s26
s_add_u32 s29, s29, 0
s_add_u32 s28, s28, 0
s_branch T_Q
TK_8:
s_cmp_lt_u32 s27, 128
s_cbranch_scc0 TK_9
s_sub_u32 s29, s27, 96
s_mul_i32 s28, s29, 4096
s_lshr_b32 s28, s28, 16
s_mul_i32 s26, s28, 16
s_sub_u32 s29, s29, s26
s_add_u32 s29, s29, 0
s_add_u32 s28, s28, 2
s_branch T_Q
TK_9:
s_branch W_END
TC_3:
s_cmp_lg_u32 s20, 4
s_cbranch_scc1 TC_10
s_cmp_lt_u32 s27, 32
s_cbranch_scc0 TK_11
s_sub_u32 s29, s27, 0
s_mul_i32 s28, s29, 8192
s_lshr_b32 s28, s28, 16
s_mul_i32 s26, s28, 8
s_sub_u32 s29, s29, s26
s_add_u32 s29, s29, 0
s_add_u32 s28, s28, 0
s_branch T_K64
TK_11:
s_cmp_lt_u32 s27, 36
s_cbranch_scc0 TK_12
s_sub_u32 s29, s27, 32
s_mul_i32 s28, s29, 16384
s_lshr_b32 s28, s28, 16
s_mul_i32 s26, s28, 4
s_sub_u32 s29, s29, s26
s_add_u32 s29, s29, 0
s_add_u32 s28, s28, 3
s_branch T_K
TK_12:
s_cmp_lt_u32 s27, 64
s_cbranch_scc0 TK_13
s_sub_u32 s29, s27, 36
s_mul_i32 s28, s29, 9363
s_lshr_b32 s28, s28, 16
s_mul_i32 s26, s28, 7
s_sub_u32 s29, s29, s26
s_add_u32 s29, s29, 0
s_add_u32 s28, s28, 0
s_branch T_F1
TK_13:
s_cmp_lt_u32 s27, 68
s_cbranch_scc0 TK_14
s_sub_u32 s29, s27, 64
s_mul_i32 s28, s29, 16384
s_lshr_b32 s28, s28, 16
s_mul_i32 s26, s28, 4
s_sub_u32 s29, s29, s26
s_add_u32 s29, s29, 4
s_add_u32 s28, s28, 3
s_branch T_K
TK_14:
s_cmp_lt_u32 s27, 84
s_cbranch_scc0 TK_15
s_sub_u32 s29, s27, 68
s_mul_i32 s28, s29, 16384
s_lshr_b32 s28, s28, 16
s_mul_i32 s26, s28, 4
s_sub_u32 s29, s29, s26
s_add_u32 s29, s29, 0
s_add_u32 s28, s28, 0
s_branch T_F2
TK_15:
s_cmp_lt_u32 s27, 116
s_cbranch_scc0 TK_16
s_sub_u32 s29, s27, 84
s_mul_i32 s28, s29, 8192
s_lshr_b32 s28, s28, 16
s_mul_i32 s26, s28, 8
s_sub_u32 s29, s29, s26
s_add_u32 s29, s29, 0
s_add_u32 s28, s28, 4
s_branch T_K
TK_16:
s_cmp_lt_u32 s27, 132
s_cbranch_scc0 TK_17
s_sub_u32 s29, s27, 116
s_mul_i32 s28, s29, 16384
s_lshr_b32 s28, s28, 16
s_mul_i32 s26, s28, 4
s_sub_u32 s29, s29, s26
s_add_u32 s29, s29, 0
s_add_u32 s28, s28, 4
s_branch T_Q
TK_17:
s_branch W_END
TC_10:
s_cmp_lg_u32 s20, 5
s_cbranch_scc1 TC_18
s_cmp_lt_u32 s27, 32
s_cbranch_scc0 TK_19
s_sub_u32 s29, s27, 0
s_mul_i32 s28, s29, 8192
s_lshr_b32 s28, s28, 16
s_mul_i32 s26, s28, 8
s_sub_u32 s29, s29, s26
s_add_u32 s29, s29, 8
s_add_u32 s28, s28, 0
s_branch T_K64
TK_19:
s_cmp_lt_u32 s27, 36
s_cbranch_scc0 TK_20
s_sub_u32 s29, s27, 32
s_mul_i32 s28, s29, 16384
s_lshr_b32 s28, s28, 16
s_mul_i32 s26, s28, 4
s_sub_u32 s29, s29, s26
s_add_u32 s29, s29, 8
s_add_u32 s28, s28, 3
s_branch T_K
TK_20:
s_cmp_lt_u32 s27, 64
s_cbranch_scc0 TK_21
s_sub_u32 s29, s27, 36
s_mul_i32 s28, s29, 9363
s_lshr_b32 s28, s28, 16
s_mul_i32 s26, s28, 7
s_sub_u32 s29, s29, s26
s_add_u32 s29, s29, 7
s_add_u32 s28, s28, 0
s_branch T_F1
TK_21:
s_cmp_lt_u32 s27, 68
s_cbranch_scc0 TK_22
s_sub_u32 s29, s27, 64
s_mul_i32 s28, s29, 16384
s_lshr_b32 s28, s28, 16
s_mul_i32 s26, s28, 4
s_sub_u32 s29, s29, s26
s_add_u32 s29, s29, 12
s_add_u32 s28, s28, 3
s_branch T_K
TK_22:
s_cmp_lt_u32 s27, 84
s_cbranch_scc0 TK_23
s_sub_u32 s29, s27, 68
s_mul_i32 s28, s29, 16384
s_lshr_b32 s28, s28, 16
s_mul_i32 s26, s28, 4
s_sub_u32 s29, s29, s26
s_add_u32 s29, s29, 0
s_add_u32 s28, s28, 4
s_branch T_F2
TK_23:
s_cmp_lt_u32 s27, 116
s_cbranch_scc0 TK_24
s_sub_u32 s29, s27, 84
s_mul_i32 s28, s29, 8192
s_lshr_b32 s28, s28, 16
s_mul_i32 s26, s28, 8
s_sub_u32 s29, s29, s26
s_add_u32 s29, s29, 8
s_add_u32 s28, s28, 4
s_branch T_K
TK_24:
s_cmp_lt_u32 s27, 132
s_cbranch_scc0 TK_25
s_sub_u32 s29, s27, 116
s_mul_i32 s28, s29, 16384
s_lshr_b32 s28, s28, 16
s_mul_i32 s26, s28, 4
s_sub_u32 s29, s29, s26
s_add_u32 s29, s29, 4
s_add_u32 s28, s28, 4
s_branch T_Q
TK_25:
s_branch W_END
TC_18:
s_cmp_lg_u32 s20, 6
s_cbranch_scc1 TC_26
s_cmp_lt_u32 s27, 32
s_cbranch_scc0 TK_27
s_sub_u32 s29, s27, 0
s_mul_i32 s28, s29, 8192
s_lshr_b32 s28, s28, 16
s_mul_i32 s26, s28, 8
s_sub_u32 s29, s29, s26
s_add_u32 s29, s29, 0
s_add_u32 s28, s28, 0
s_branch T_V64
TK_27:
s_cmp_lt_u32 s27, 36
s_cbranch_scc0 TK_28
s_sub_u32 s29, s27, 32
s_mul_i32 s28, s29, 16384
s_lshr_b32 s28, s28, 16
s_mul_i32 s26, s28, 4
s_sub_u32 s29, s29, s26
s_add_u32 s29, s29, 0
s_add_u32 s28, s28, 3
s_branch T_V
TK_28:
s_cmp_lt_u32 s27, 64
s_cbranch_scc0 TK_29
s_sub_u32 s29, s27, 36
s_mul_i32 s28, s29, 9363
s_lshr_b32 s28, s28, 16
s_mul_i32 s26, s28, 7
s_sub_u32 s29, s29, s26
s_add_u32 s29, s29, 0
s_add_u32 s28, s28, 4
s_branch T_F1
TK_29:
s_cmp_lt_u32 s27, 68
s_cbranch_scc0 TK_30
s_sub_u32 s29, s27, 64
s_mul_i32 s28, s29, 16384
s_lshr_b32 s28, s28, 16
s_mul_i32 s26, s28, 4
s_sub_u32 s29, s29, s26
s_add_u32 s29, s29, 4
s_add_u32 s28, s28, 3
s_branch T_V
TK_30:
s_cmp_lt_u32 s27, 84
s_cbranch_scc0 TK_31
s_sub_u32 s29, s27, 68
s_mul_i32 s28, s29, 16384
s_lshr_b32 s28, s28, 16
s_mul_i32 s26, s28, 4
s_sub_u32 s29, s29, s26
s_add_u32 s29, s29, 0
s_add_u32 s28, s28, 8
s_branch T_F2
TK_31:
s_cmp_lt_u32 s27, 116
s_cbranch_scc0 TK_32
s_sub_u32 s29, s27, 84
s_mul_i32 s28, s29, 8192
s_lshr_b32 s28, s28, 16
s_mul_i32 s26, s28, 8
s_sub_u32 s29, s29, s26
s_add_u32 s29, s29, 0
s_add_u32 s28, s28, 4
s_branch T_V
TK_32:
s_cmp_lt_u32 s27, 132
s_cbranch_scc0 TK_33
s_sub_u32 s29, s27, 116
s_mul_i32 s28, s29, 16384
s_lshr_b32 s28, s28, 16
s_mul_i32 s26, s28, 4
s_sub_u32 s29, s29, s26
s_add_u32 s29, s29, 8
s_add_u32 s28, s28, 4
s_branch T_Q
TK_33:
s_branch W_END
TC_26:
s_cmp_lt_u32 s27, 32
s_cbranch_scc0 TK_35
s_sub_u32 s29, s27, 0
s_mul_i32 s28, s29, 8192
s_lshr_b32 s28, s28, 16
s_mul_i32 s26, s28, 8
s_sub_u32 s29, s29, s26
s_add_u32 s29, s29, 8
s_add_u32 s28, s28, 0
s_branch T_V64
TK_35:
s_cmp_lt_u32 s27, 36
s_cbranch_scc0 TK_36
s_sub_u32 s29, s27, 32
s_mul_i32 s28, s29, 16384
s_lshr_b32 s28, s28, 16
s_mul_i32 s26, s28, 4
s_sub_u32 s29, s29, s26
s_add_u32 s29, s29, 8
s_add_u32 s28, s28, 3
s_branch T_V
TK_36:
s_cmp_lt_u32 s27, 64
s_cbranch_scc0 TK_37
s_sub_u32 s29, s27, 36
s_mul_i32 s28, s29, 9363
s_lshr_b32 s28, s28, 16
s_mul_i32 s26, s28, 7
s_sub_u32 s29, s29, s26
s_add_u32 s29, s29, 7
s_add_u32 s28, s28, 4
s_branch T_F1
TK_37:
s_cmp_lt_u32 s27, 68
s_cbranch_scc0 TK_38
s_sub_u32 s29, s27, 64
s_mul_i32 s28, s29, 16384
s_lshr_b32 s28, s28, 16
s_mul_i32 s26, s28, 4
s_sub_u32 s29, s29, s26
s_add_u32 s29, s29, 12
s_add_u32 s28, s28, 3
s_branch T_V
TK_38:
s_cmp_lt_u32 s27, 84
s_cbranch_scc0 TK_39
s_sub_u32 s29, s27, 68
s_mul_i32 s28, s29, 16384
s_lshr_b32 s28, s28, 16
s_mul_i32 s26, s28, 4
s_sub_u32 s29, s29, s26
s_add_u32 s29, s29, 0
s_add_u32 s28, s28, 12
s_branch T_F2
TK_39:
s_cmp_lt_u32 s27, 116
s_cbranch_scc0 TK_40
s_sub_u32 s29, s27, 84
s_mul_i32 s28, s29, 8192
s_lshr_b32 s28, s28, 16
s_mul_i32 s26, s28, 8
s_sub_u32 s29, s29, s26
s_add_u32 s29, s29, 8
s_add_u32 s28, s28, 4
s_branch T_V
TK_40:
s_cmp_lt_u32 s27, 132
s_cbranch_scc0 TK_41
s_sub_u32 s29, s27, 116
s_mul_i32 s28, s29, 16384
s_lshr_b32 s28, s28, 16
s_mul_i32 s26, s28, 4
s_sub_u32 s29, s29, s26
s_add_u32 s29, s29, 12
s_add_u32 s28, s28, 4
s_branch T_Q
TK_41:
W_END:
s_mov_b32 s27, s21
s_cmp_eq_u32 s20, 3
s_cbranch_scc1 R_A
s_lshl_b32 s26, s20, 8
s_add_u32 s26, s26, 119537792
s_cmp_lg_u32 s24, 0
s_cbranch_scc1 BA_42
v_mov_b32 v2, 1
v_mov_b32 v3, 0
v_mov_b32 v4, 163824
s_mov_b64 exec, 1
buffer_atomic_add v2, v3, s[4:7], s26 offen sc0 sc1
s_waitcnt vmcnt(0)
ds_write_b32 v4, v2
s_mov_b64 exec, -1
s_waitcnt lgkmcnt(0)
BA_42:
s_barrier
v_mov_b32 v4, 163824
ds_read_b32 v2, v4
s_waitcnt lgkmcnt(0)
v_readfirstlane_b32 s27, v2
s_barrier
s_sub_u32 s26, s20, 4
s_lshl_b32 s25, s26, 5
s_add_u32 s25, s25, s27
s_bfe_u32 s26, s25, 131075
s_lshr_b32 s27, s25, 5
s_lshl_b32 s27, s27, 3
s_and_b32 s25, s25, 7
s_or_b32 s27, s27, s25
s_branch R_P
s_branch M_END
T_K:
s_load_dwordx2 s[8:9], s[0:1], 24
s_mov_b32 s10, 8388608
s_mov_b32 s11, 0x20000
s_lshl_b32 s30, s29, 9
s_mul_i32 s31, s28, 524288
s_add_u32 s31, s31, 0
s_lshl_b32 s32, s24, 12
s_add_u32 s33, s32, 65536
s_lshr_b32 s34, s24, 1
s_and_b32 s35, s24, 1
v_lshrrev_b32 v16, 5, v1
v_and_b32 v17, 31, v1
v_lshlrev_b32 v18, 1, v16
v_xor_b32 v17, v17, v18
s_lshl_b32 s36, s24, 3
v_add_u32 v16, s36, v16
s_mov_b32 s36, 8192
v_mul_lo_u32 v16, v16, s36
v_xor_b32 v18, 0, v17
v_lshl_add_u32 v18, v18, 4, v16
v_add_u32 v11, 0, v18
v_xor_b32 v18, 4, v17
v_lshl_add_u32 v18, v18, 4, v16
v_add_u32 v12, 15360, v18
v_xor_b32 v18, 8, v17
v_lshl_add_u32 v18, v18, 4, v16
v_add_u32 v13, 30720, v18
v_xor_b32 v18, 12, v17
v_lshl_add_u32 v18, v18, 4, v16
v_add_u32 v14, 46080, v18
v_lshlrev_b32 v61, 4, v1
v_add_u32 v15, s32, v61
s_lshl_b32 s36, s34, 13
s_add_u32 s36, s36, 65536
v_add_u32 v10, s36, v61
v_lshrrev_b32 v16, 2, v1
v_and_b32 v17, 7, v16
v_lshlrev_b32 v17, 1, v17
v_lshlrev_b32 v16, 9, v16
v_and_b32 v18, 3, v1
v_lshl_add_u32 v16, v18, 3, v16
s_lshl_b32 s36, s35, 8
v_add_u32 v16, s36, v16
v_xor_b32 v18, 0, v17
v_lshl_add_u32 v2, v18, 4, v16
v_xor_b32 v18, 2, v17
v_lshl_add_u32 v3, v18, 4, v16
v_xor_b32 v18, 4, v17
v_lshl_add_u32 v4, v18, 4, v16
v_xor_b32 v18, 6, v17
v_lshl_add_u32 v5, v18, 4, v16
v_xor_b32 v18, 8, v17
v_lshl_add_u32 v6, v18, 4, v16
v_xor_b32 v18, 10, v17
v_lshl_add_u32 v7, v18, 4, v16
v_xor_b32 v18, 12, v17
v_lshl_add_u32 v8, v18, 4, v16
v_xor_b32 v18, 14, v17
v_lshl_add_u32 v9, v18, 4, v16
s_waitcnt lgkmcnt(0)
v_mov_b32 v16, 0
v_mov_b32 v17, 0
v_mov_b32 v18, 0
v_mov_b32 v19, 0
v_mov_b32 v20, 0
v_mov_b32 v21, 0
v_mov_b32 v22, 0
v_mov_b32 v23, 0
v_mov_b32 v24, 0
v_mov_b32 v25, 0
v_mov_b32 v26, 0
v_mov_b32 v27, 0
v_mov_b32 v28, 0
v_mov_b32 v29, 0
v_mov_b32 v30, 0
v_mov_b32 v31, 0
v_mov_b32 v32, 0
v_mov_b32 v33, 0
v_mov_b32 v34, 0
v_mov_b32 v35, 0
v_mov_b32 v36, 0
v_mov_b32 v37, 0
v_mov_b32 v38, 0
v_mov_b32 v39, 0
v_mov_b32 v40, 0
v_mov_b32 v41, 0
v_mov_b32 v42, 0
v_mov_b32 v43, 0
v_mov_b32 v44, 0
v_mov_b32 v45, 0
v_mov_b32 v46, 0
v_mov_b32 v47, 0
v_mov_b32 v48, 0
v_mov_b32 v49, 0
v_mov_b32 v50, 0
v_mov_b32 v51, 0
v_mov_b32 v52, 0
v_mov_b32 v53, 0
v_mov_b32 v54, 0
v_mov_b32 v55, 0
s_add_u32 m0, s32, 0
s_nop 0
buffer_load_dwordx4 v11, s[8:11], s30 offen offset:0 lds
buffer_load_dwordx4 v12, s[8:11], s30 offen offset:1024 lds
buffer_load_dwordx4 v13, s[8:11], s30 offen offset:2048 lds
buffer_load_dwordx4 v14, s[8:11], s30 offen offset:3072 lds
s_add_u32 m0, s33, 0
s_nop 0
buffer_load_dwordx4 v15, s[4:7], s31 offen offset:0 sc1 lds
buffer_load_dwordx4 v15, s[4:7], s31 offen offset:1024 sc1 lds
buffer_load_dwordx4 v15, s[4:7], s31 offen offset:2048 sc1 lds
buffer_load_dwordx4 v15, s[4:7], s31 offen offset:3072 sc1 lds
s_add_u32 s30, s30, 262144
s_add_u32 s31, s31, 16384
s_add_u32 m0, s32, 16384
s_nop 0
buffer_load_dwordx4 v11, s[8:11], s30 offen offset:0 lds
buffer_load_dwordx4 v12, s[8:11], s30 offen offset:1024 lds
buffer_load_dwordx4 v13, s[8:11], s30 offen offset:2048 lds
buffer_load_dwordx4 v14, s[8:11], s30 offen offset:3072 lds
s_add_u32 m0, s33, 16384
s_nop 0
buffer_load_dwordx4 v15, s[4:7], s31 offen offset:0 sc1 lds
buffer_load_dwordx4 v15, s[4:7], s31 offen offset:1024 sc1 lds
buffer_load_dwordx4 v15, s[4:7], s31 offen offset:2048 sc1 lds
buffer_load_dwordx4 v15, s[4:7], s31 offen offset:3072 sc1 lds
s_add_u32 s30, s30, 262144
s_add_u32 s31, s31, 16384
s_add_u32 m0, s32, 32768
s_nop 0
buffer_load_dwordx4 v11, s[8:11], s30 offen offset:0 lds
buffer_load_dwordx4 v12, s[8:11], s30 offen offset:1024 lds
buffer_load_dwordx4 v13, s[8:11], s30 offen offset:2048 lds
buffer_load_dwordx4 v14, s[8:11], s30 offen offset:3072 lds
s_add_u32 m0, s33, 32768
s_nop 0
buffer_load_dwordx4 v15, s[4:7], s31 offen offset:0 sc1 lds
buffer_load_dwordx4 v15, s[4:7], s31 offen offset:1024 sc1 lds
buffer_load_dwordx4 v15, s[4:7], s31 offen offset:2048 sc1 lds
buffer_load_dwordx4 v15, s[4:7], s31 offen offset:3072 sc1 lds
s_add_u32 s30, s30, 262144
s_add_u32 s31, s31, 16384
v_mfma_f32_16x16x32_bf16 a[0:3], v[16:19], v[48:51], 0
v_mfma_f32_16x16x32_bf16 a[4:7], v[16:19], v[48:51], 0
v_mfma_f32_16x16x32_bf16 a[8:11], v[16:19], v[48:51], 0
v_mfma_f32_16x16x32_bf16 a[12:15], v[16:19], v[48:51], 0
v_mfma_f32_16x16x32_bf16 a[16:19], v[16:19], v[48:51], 0
v_mfma_f32_16x16x32_bf16 a[20:23], v[16:19], v[48:51], 0
v_mfma_f32_16x16x32_bf16 a[24:27], v[16:19], v[48:51], 0
v_mfma_f32_16x16x32_bf16 a[28:31], v[16:19], v[48:51], 0
v_mfma_f32_16x16x32_bf16 a[32:35], v[20:23], v[48:51], 0
v_mfma_f32_16x16x32_bf16 a[36:39], v[20:23], v[48:51], 0
v_mfma_f32_16x16x32_bf16 a[40:43], v[20:23], v[48:51], 0
v_mfma_f32_16x16x32_bf16 a[44:47], v[20:23], v[48:51], 0
v_mfma_f32_16x16x32_bf16 a[48:51], v[20:23], v[48:51], 0
v_mfma_f32_16x16x32_bf16 a[52:55], v[20:23], v[48:51], 0
v_mfma_f32_16x16x32_bf16 a[56:59], v[20:23], v[48:51], 0
v_mfma_f32_16x16x32_bf16 a[60:63], v[20:23], v[48:51], 0
v_mfma_f32_16x16x32_bf16 a[64:67], v[24:27], v[48:51], 0
v_mfma_f32_16x16x32_bf16 a[68:71], v[24:27], v[48:51], 0
v_mfma_f32_16x16x32_bf16 a[72:75], v[24:27], v[48:51], 0
v_mfma_f32_16x16x32_bf16 a[76:79], v[24:27], v[48:51], 0
v_mfma_f32_16x16x32_bf16 a[80:83], v[24:27], v[48:51], 0
v_mfma_f32_16x16x32_bf16 a[84:87], v[24:27], v[48:51], 0
v_mfma_f32_16x16x32_bf16 a[88:91], v[24:27], v[48:51], 0
v_mfma_f32_16x16x32_bf16 a[92:95], v[24:27], v[48:51], 0
v_mfma_f32_16x16x32_bf16 a[96:99], v[28:31], v[48:51], 0
v_mfma_f32_16x16x32_bf16 a[100:103], v[28:31], v[48:51], 0
v_mfma_f32_16x16x32_bf16 a[104:107], v[28:31], v[48:51], 0
v_mfma_f32_16x16x32_bf16 a[108:111], v[28:31], v[48:51], 0
v_mfma_f32_16x16x32_bf16 a[112:115], v[28:31], v[48:51], 0
v_mfma_f32_16x16x32_bf16 a[116:119], v[28:31], v[48:51], 0
v_mfma_f32_16x16x32_bf16 a[120:123], v[28:31], v[48:51], 0
v_mfma_f32_16x16x32_bf16 a[124:127], v[28:31], v[48:51], 0
v_mfma_f32_16x16x32_bf16 a[128:131], v[32:35], v[48:51], 0
v_mfma_f32_16x16x32_bf16 a[132:135], v[32:35], v[48:51], 0
v_mfma_f32_16x16x32_bf16 a[136:139], v[32:35], v[48:51], 0
v_mfma_f32_16x16x32_bf16 a[140:143], v[32:35], v[48:51], 0
v_mfma_f32_16x16x32_bf16 a[144:147], v[32:35], v[48:51], 0
v_mfma_f32_16x16x32_bf16 a[148:151], v[32:35], v[48:51], 0
v_mfma_f32_16x16x32_bf16 a[152:155], v[32:35], v[48:51], 0
v_mfma_f32_16x16x32_bf16 a[156:159], v[32:35], v[48:51], 0
v_mfma_f32_16x16x32_bf16 a[160:163], v[36:39], v[48:51], 0
v_mfma_f32_16x16x32_bf16 a[164:167], v[36:39], v[48:51], 0
v_mfma_f32_16x16x32_bf16 a[168:171], v[36:39], v[48:51], 0
v_mfma_f32_16x16x32_bf16 a[172:175], v[36:39], v[48:51], 0
v_mfma_f32_16x16x32_bf16 a[176:179], v[36:39], v[48:51], 0
v_mfma_f32_16x16x32_bf16 a[180:183], v[36:39], v[48:51], 0
v_mfma_f32_16x16x32_bf16 a[184:187], v[36:39], v[48:51], 0
v_mfma_f32_16x16x32_bf16 a[188:191], v[36:39], v[48:51], 0
v_mfma_f32_16x16x32_bf16 a[192:195], v[40:43], v[48:51], 0
v_mfma_f32_16x16x32_bf16 a[196:199], v[40:43], v[48:51], 0
v_mfma_f32_16x16x32_bf16 a[200:203], v[40:43], v[48:51], 0
v_mfma_f32_16x16x32_bf16 a[204:207], v[40:43], v[48:51], 0
v_mfma_f32_16x16x32_bf16 a[208:211], v[40:43], v[48:51], 0
v_mfma_f32_16x16x32_bf16 a[212:215], v[40:43], v[48:51], 0
v_mfma_f32_16x16x32_bf16 a[216:219], v[40:43], v[48:51], 0
v_mfma_f32_16x16x32_bf16 a[220:223], v[40:43], v[48:51], 0
v_mfma_f32_16x16x32_bf16 a[224:227], v[44:47], v[48:51], 0
v_mfma_f32_16x16x32_bf16 a[228:231], v[44:47], v[48:51], 0
v_mfma_f32_16x16x32_bf16 a[232:235], v[44:47], v[48:51], 0
v_mfma_f32_16x16x32_bf16 a[236:239], v[44:47], v[48:51], 0
v_mfma_f32_16x16x32_bf16 a[240:243], v[44:47], v[48:51], 0
v_mfma_f32_16x16x32_bf16 a[244:247], v[44:47], v[48:51], 0
v_mfma_f32_16x16x32_bf16 a[248:251], v[44:47], v[48:51], 0
v_mfma_f32_16x16x32_bf16 a[252:255], v[44:47], v[48:51], 0
s_waitcnt vmcnt(16)
s_barrier
ds_read_b128 v[96:99], v10 offset:0
ds_read_b128 v[100:103], v10 offset:1024
ds_read_b128 v[104:107], v10 offset:2048
ds_read_b128 v[108:111], v10 offset:3072
ds_read_b128 v[112:115], v10 offset:4096
ds_read_b128 v[116:119], v10 offset:5120
ds_read_b128 v[120:123], v10 offset:6144
ds_read_b128 v[124:127], v10 offset:7168
ds_read_b64_tr_b16 v[64:65], v2 offset:0
ds_read_b64_tr_b16 v[66:67], v2 offset:8192
ds_read_b64_tr_b16 v[68:69], v3 offset:0
ds_read_b64_tr_b16 v[70:71], v3 offset:8192
ds_read_b64_tr_b16 v[72:73], v4 offset:0
ds_read_b64_tr_b16 v[74:75], v4 offset:8192
ds_read_b64_tr_b16 v[76:77], v5 offset:0
ds_read_b64_tr_b16 v[78:79], v5 offset:8192
ds_read_b64_tr_b16 v[80:81], v6 offset:0
ds_read_b64_tr_b16 v[82:83], v6 offset:8192
ds_read_b64_tr_b16 v[84:85], v7 offset:0
ds_read_b64_tr_b16 v[86:87], v7 offset:8192
ds_read_b64_tr_b16 v[88:89], v8 offset:0
ds_read_b64_tr_b16 v[90:91], v8 offset:8192
ds_read_b64_tr_b16 v[92:93], v9 offset:0
ds_read_b64_tr_b16 v[94:95], v9 offset:8192
s_mov_b32 s37, 7
GL_43:
s_waitcnt lgkmcnt(0)
v_mfma_f32_16x16x32_bf16 a[0:3], v[64:67], v[96:99], a[0:3]
v_mfma_f32_16x16x32_bf16 a[4:7], v[64:67], v[100:103], a[4:7]
s_waitcnt vmcnt(8)
s_barrier
v_mfma_f32_16x16x32_bf16 a[8:11], v[64:67], v[104:107], a[8:11]
ds_read_b128 v[160:163], v10 offset:16384
v_mfma_f32_16x16x32_bf16 a[12:15], v[64:67], v[108:111], a[12:15]
ds_read_b128 v[164:167], v10 offset:17408
v_mfma_f32_16x16x32_bf16 a[16:19], v[64:67], v[112:115], a[16:19]
ds_read_b128 v[168:171], v10 offset:18432
v_mfma_f32_16x16x32_bf16 a[20:23], v[64:67], v[116:119], a[20:23]
ds_read_b128 v[172:175], v10 offset:19456
v_mfma_f32_16x16x32_bf16 a[24:27], v[64:67], v[120:123], a[24:27]
ds_read_b128 v[176:179], v10 offset:20480
v_mfma_f32_16x16x32_bf16 a[28:31], v[64:67], v[124:127], a[28:31]
ds_read_b128 v[180:183], v10 offset:21504
v_mfma_f32_16x16x32_bf16 a[32:35], v[68:71], v[96:99], a[32:35]
ds_read_b128 v[184:187], v10 offset:22528
v_mfma_f32_16x16x32_bf16 a[36:39], v[68:71], v[100:103], a[36:39]
ds_read_b128 v[188:191], v10 offset:23552
v_mfma_f32_16x16x32_bf16 a[40:43], v[68:71], v[104:107], a[40:43]
ds_read_b64_tr_b16 v[128:129], v2 offset:16384
v_mfma_f32_16x16x32_bf16 a[44:47], v[68:71], v[108:111], a[44:47]
ds_read_b64_tr_b16 v[130:131], v2 offset:24576
v_mfma_f32_16x16x32_bf16 a[48:51], v[68:71], v[112:115], a[48:51]
ds_read_b64_tr_b16 v[132:133], v3 offset:16384
v_mfma_f32_16x16x32_bf16 a[52:55], v[68:71], v[116:119], a[52:55]
ds_read_b64_tr_b16 v[134:135], v3 offset:24576
v_mfma_f32_16x16x32_bf16 a[56:59], v[68:71], v[120:123], a[56:59]
ds_read_b64_tr_b16 v[136:137], v4 offset:16384
v_mfma_f32_16x16x32_bf16 a[60:63], v[68:71], v[124:127], a[60:63]
ds_read_b64_tr_b16 v[138:139], v4 offset:24576
v_mfma_f32_16x16x32_bf16 a[64:67], v[72:75], v[96:99], a[64:67]
ds_read_b64_tr_b16 v[140:141], v5 offset:16384
v_mfma_f32_16x16x32_bf16 a[68:71], v[72:75], v[100:103], a[68:71]
ds_read_b64_tr_b16 v[142:143], v5 offset:24576
v_mfma_f32_16x16x32_bf16 a[72:75], v[72:75], v[104:107], a[72:75]
ds_read_b64_tr_b16 v[144:145], v6 offset:16384
v_mfma_f32_16x16x32_bf16 a[76:79], v[72:75], v[108:111], a[76:79]
ds_read_b64_tr_b16 v[146:147], v6 offset:24576
v_mfma_f32_16x16x32_bf16 a[80:83], v[72:75], v[112:115], a[80:83]
ds_read_b64_tr_b16 v[148:149], v7 offset:16384
v_mfma_f32_16x16x32_bf16 a[84:87], v[72:75], v[116:119], a[84:87]
ds_read_b64_tr_b16 v[150:151], v7 offset:24576
v_mfma_f32_16x16x32_bf16 a[88:91], v[72:75], v[120:123], a[88:91]
ds_read_b64_tr_b16 v[152:153], v8 offset:16384
v_mfma_f32_16x16x32_bf16 a[92:95], v[72:75], v[124:127], a[92:95]
ds_read_b64_tr_b16 v[154:155], v8 offset:24576
v_mfma_f32_16x16x32_bf16 a[96:99], v[76:79], v[96:99], a[96:99]
ds_read_b64_tr_b16 v[156:157], v9 offset:16384
v_mfma_f32_16x16x32_bf16 a[100:103], v[76:79], v[100:103], a[100:103]
ds_read_b64_tr_b16 v[158:159], v9 offset:24576
v_mfma_f32_16x16x32_bf16 a[104:107], v[76:79], v[104:107], a[104:107]
v_mfma_f32_16x16x32_bf16 a[108:111], v[76:79], v[108:111], a[108:111]
s_add_u32 m0, s32, 49152
v_mfma_f32_16x16x32_bf16 a[112:115], v[76:79], v[112:115], a[112:115]
buffer_load_dwordx4 v11, s[8:11], s30 offen offset:0 lds
v_mfma_f32_16x16x32_bf16 a[116:119], v[76:79], v[116:119], a[116:119]
v_mfma_f32_16x16x32_bf16 a[120:123], v[76:79], v[120:123], a[120:123]
v_mfma_f32_16x16x32_bf16 a[124:127], v[76:79], v[124:127], a[124:127]
v_mfma_f32_16x16x32_bf16 a[128:131], v[80:83], v[96:99], a[128:131]
buffer_load_dwordx4 v12, s[8:11], s30 offen offset:1024 lds
v_mfma_f32_16x16x32_bf16 a[132:135], v[80:83], v[100:103], a[132:135]
v_mfma_f32_16x16x32_bf16 a[136:139], v[80:83], v[104:107], a[136:139]
v_mfma_f32_16x16x32_bf16 a[140:143], v[80:83], v[108:111], a[140:143]
v_mfma_f32_16x16x32_bf16 a[144:147], v[80:83], v[112:115], a[144:147]
buffer_load_dwordx4 v13, s[8:11], s30 offen offset:2048 lds
v_mfma_f32_16x16x32_bf16 a[148:151], v[80:83], v[116:119], a[148:151]
v_mfma_f32_16x16x32_bf16 a[152:155], v[80:83], v[120:123], a[152:155]
v_mfma_f32_16x16x32_bf16 a[156:159], v[80:83], v[124:127], a[156:159]
v_mfma_f32_16x16x32_bf16 a[160:163], v[84:87], v[96:99], a[160:163]
buffer_load_dwordx4 v14, s[8:11], s30 offen offset:3072 lds
v_mfma_f32_16x16x32_bf16 a[164:167], v[84:87], v[100:103], a[164:167]
v_mfma_f32_16x16x32_bf16 a[168:171], v[84:87], v[104:107], a[168:171]
v_mfma_f32_16x16x32_bf16 a[172:175], v[84:87], v[108:111], a[172:175]
s_add_u32 m0, s33, 49152
v_mfma_f32_16x16x32_bf16 a[176:179], v[84:87], v[112:115], a[176:179]
buffer_load_dwordx4 v15, s[4:7], s31 offen offset:0 sc1 lds
v_mfma_f32_16x16x32_bf16 a[180:183], v[84:87], v[116:119], a[180:183]
v_mfma_f32_16x16x32_bf16 a[184:187], v[84:87], v[120:123], a[184:187]
v_mfma_f32_16x16x32_bf16 a[188:191], v[84:87], v[124:127], a[188:191]
v_mfma_f32_16x16x32_bf16 a[192:195], v[88:91], v[96:99], a[192:195]
buffer_load_dwordx4 v15, s[4:7], s31 offen offset:1024 sc1 lds
v_mfma_f32_16x16x32_bf16 a[196:199], v[88:91], v[100:103], a[196:199]
v_mfma_f32_16x16x32_bf16 a[200:203], v[88:91], v[104:107], a[200:203]
v_mfma_f32_16x16x32_bf16 a[204:207], v[88:91], v[108:111], a[204:207]
v_mfma_f32_16x16x32_bf16 a[208:211], v[88:91], v[112:115], a[208:211]
buffer_load_dwordx4 v15, s[4:7], s31 offen offset:2048 sc1 lds
v_mfma_f32_16x16x32_bf16 a[212:215], v[88:91], v[116:119], a[212:215]
v_mfma_f32_16x16x32_bf16 a[216:219], v[88:91], v[120:123], a[216:219]
v_mfma_f32_16x16x32_bf16 a[220:223], v[88:91], v[124:127], a[220:223]
v_mfma_f32_16x16x32_bf16 a[224:227], v[92:95], v[96:99], a[224:227]
buffer_load_dwordx4 v15, s[4:7], s31 offen offset:3072 sc1 lds
v_mfma_f32_16x16x32_bf16 a[228:231], v[92:95], v[100:103], a[228:231]
v_mfma_f32_16x16x32_bf16 a[232:235], v[92:95], v[104:107], a[232:235]
s_add_u32 s30, s30, 262144
v_mfma_f32_16x16x32_bf16 a[236:239], v[92:95], v[108:111], a[236:239]
s_add_u32 s31, s31, 16384
v_mfma_f32_16x16x32_bf16 a[240:243], v[92:95], v[112:115], a[240:243]
v_mfma_f32_16x16x32_bf16 a[244:247], v[92:95], v[116:119], a[244:247]
v_mfma_f32_16x16x32_bf16 a[248:251], v[92:95], v[120:123], a[248:251]
v_mfma_f32_16x16x32_bf16 a[252:255], v[92:95], v[124:127], a[252:255]
s_waitcnt lgkmcnt(0)
v_mfma_f32_16x16x32_bf16 a[0:3], v[128:131], v[160:163], a[0:3]
v_mfma_f32_16x16x32_bf16 a[4:7], v[128:131], v[164:167], a[4:7]
s_waitcnt vmcnt(8)
s_barrier
v_mfma_f32_16x16x32_bf16 a[8:11], v[128:131], v[168:171], a[8:11]
ds_read_b128 v[96:99], v10 offset:32768
v_mfma_f32_16x16x32_bf16 a[12:15], v[128:131], v[172:175], a[12:15]
ds_read_b128 v[100:103], v10 offset:33792
v_mfma_f32_16x16x32_bf16 a[16:19], v[128:131], v[176:179], a[16:19]
ds_read_b128 v[104:107], v10 offset:34816
v_mfma_f32_16x16x32_bf16 a[20:23], v[128:131], v[180:183], a[20:23]
ds_read_b128 v[108:111], v10 offset:35840
v_mfma_f32_16x16x32_bf16 a[24:27], v[128:131], v[184:187], a[24:27]
ds_read_b128 v[112:115], v10 offset:36864
v_mfma_f32_16x16x32_bf16 a[28:31], v[128:131], v[188:191], a[28:31]
ds_read_b128 v[116:119], v10 offset:37888
v_mfma_f32_16x16x32_bf16 a[32:35], v[132:135], v[160:163], a[32:35]
ds_read_b128 v[120:123], v10 offset:38912
v_mfma_f32_16x16x32_bf16 a[36:39], v[132:135], v[164:167], a[36:39]
ds_read_b128 v[124:127], v10 offset:39936
v_mfma_f32_16x16x32_bf16 a[40:43], v[132:135], v[168:171], a[40:43]
ds_read_b64_tr_b16 v[64:65], v2 offset:32768
v_mfma_f32_16x16x32_bf16 a[44:47], v[132:135], v[172:175], a[44:47]
ds_read_b64_tr_b16 v[66:67], v2 offset:40960
v_mfma_f32_16x16x32_bf16 a[48:51], v[132:135], v[176:179], a[48:51]
ds_read_b64_tr_b16 v[68:69], v3 offset:32768
v_mfma_f32_16x16x32_bf16 a[52:55], v[132:135], v[180:183], a[52:55]
ds_read_b64_tr_b16 v[70:71], v3 offset:40960
v_mfma_f32_16x16x32_bf16 a[56:59], v[132:135], v[184:187], a[56:59]
ds_read_b64_tr_b16 v[72:73], v4 offset:32768
v_mfma_f32_16x16x32_bf16 a[60:63], v[132:135], v[188:191], a[60:63]
ds_read_b64_tr_b16 v[74:75], v4 offset:40960
v_mfma_f32_16x16x32_bf16 a[64:67], v[136:139], v[160:163], a[64:67]
ds_read_b64_tr_b16 v[76:77], v5 offset:32768
v_mfma_f32_16x16x32_bf16 a[68:71], v[136:139], v[164:167], a[68:71]
ds_read_b64_tr_b16 v[78:79], v5 offset:40960
v_mfma_f32_16x16x32_bf16 a[72:75], v[136:139], v[168:171], a[72:75]
ds_read_b64_tr_b16 v[80:81], v6 offset:32768
v_mfma_f32_16x16x32_bf16 a[76:79], v[136:139], v[172:175], a[76:79]
ds_read_b64_tr_b16 v[82:83], v6 offset:40960
v_mfma_f32_16x16x32_bf16 a[80:83], v[136:139], v[176:179], a[80:83]
ds_read_b64_tr_b16 v[84:85], v7 offset:32768
v_mfma_f32_16x16x32_bf16 a[84:87], v[136:139], v[180:183], a[84:87]
ds_read_b64_tr_b16 v[86:87], v7 offset:40960
v_mfma_f32_16x16x32_bf16 a[88:91], v[136:139], v[184:187], a[88:91]
ds_read_b64_tr_b16 v[88:89], v8 offset:32768
v_mfma_f32_16x16x32_bf16 a[92:95], v[136:139], v[188:191], a[92:95]
ds_read_b64_tr_b16 v[90:91], v8 offset:40960
v_mfma_f32_16x16x32_bf16 a[96:99], v[140:143], v[160:163], a[96:99]
ds_read_b64_tr_b16 v[92:93], v9 offset:32768
v_mfma_f32_16x16x32_bf16 a[100:103], v[140:143], v[164:167], a[100:103]
ds_read_b64_tr_b16 v[94:95], v9 offset:40960
v_mfma_f32_16x16x32_bf16 a[104:107], v[140:143], v[168:171], a[104:107]
v_mfma_f32_16x16x32_bf16 a[108:111], v[140:143], v[172:175], a[108:111]
s_add_u32 m0, s32, 0
v_mfma_f32_16x16x32_bf16 a[112:115], v[140:143], v[176:179], a[112:115]
buffer_load_dwordx4 v11, s[8:11], s30 offen offset:0 lds
v_mfma_f32_16x16x32_bf16 a[116:119], v[140:143], v[180:183], a[116:119]
v_mfma_f32_16x16x32_bf16 a[120:123], v[140:143], v[184:187], a[120:123]
v_mfma_f32_16x16x32_bf16 a[124:127], v[140:143], v[188:191], a[124:127]
v_mfma_f32_16x16x32_bf16 a[128:131], v[144:147], v[160:163], a[128:131]
buffer_load_dwordx4 v12, s[8:11], s30 offen offset:1024 lds
v_mfma_f32_16x16x32_bf16 a[132:135], v[144:147], v[164:167], a[132:135]
v_mfma_f32_16x16x32_bf16 a[136:139], v[144:147], v[168:171], a[136:139]
v_mfma_f32_16x16x32_bf16 a[140:143], v[144:147], v[172:175], a[140:143]
v_mfma_f32_16x16x32_bf16 a[144:147], v[144:147], v[176:179], a[144:147]
buffer_load_dwordx4 v13, s[8:11], s30 offen offset:2048 lds
v_mfma_f32_16x16x32_bf16 a[148:151], v[144:147], v[180:183], a[148:151]
v_mfma_f32_16x16x32_bf16 a[152:155], v[144:147], v[184:187], a[152:155]
v_mfma_f32_16x16x32_bf16 a[156:159], v[144:147], v[188:191], a[156:159]
v_mfma_f32_16x16x32_bf16 a[160:163], v[148:151], v[160:163], a[160:163]
buffer_load_dwordx4 v14, s[8:11], s30 offen offset:3072 lds
v_mfma_f32_16x16x32_bf16 a[164:167], v[148:151], v[164:167], a[164:167]
v_mfma_f32_16x16x32_bf16 a[168:171], v[148:151], v[168:171], a[168:171]
v_mfma_f32_16x16x32_bf16 a[172:175], v[148:151], v[172:175], a[172:175]
s_add_u32 m0, s33, 0
v_mfma_f32_16x16x32_bf16 a[176:179], v[148:151], v[176:179], a[176:179]
buffer_load_dwordx4 v15, s[4:7], s31 offen offset:0 sc1 lds
v_mfma_f32_16x16x32_bf16 a[180:183], v[148:151], v[180:183], a[180:183]
v_mfma_f32_16x16x32_bf16 a[184:187], v[148:151], v[184:187], a[184:187]
v_mfma_f32_16x16x32_bf16 a[188:191], v[148:151], v[188:191], a[188:191]
v_mfma_f32_16x16x32_bf16 a[192:195], v[152:155], v[160:163], a[192:195]
buffer_load_dwordx4 v15, s[4:7], s31 offen offset:1024 sc1 lds
v_mfma_f32_16x16x32_bf16 a[196:199], v[152:155], v[164:167], a[196:199]
v_mfma_f32_16x16x32_bf16 a[200:203], v[152:155], v[168:171], a[200:203]
v_mfma_f32_16x16x32_bf16 a[204:207], v[152:155], v[172:175], a[204:207]
v_mfma_f32_16x16x32_bf16 a[208:211], v[152:155], v[176:179], a[208:211]
buffer_load_dwordx4 v15, s[4:7], s31 offen offset:2048 sc1 lds
v_mfma_f32_16x16x32_bf16 a[212:215], v[152:155], v[180:183], a[212:215]
v_mfma_f32_16x16x32_bf16 a[216:219], v[152:155], v[184:187], a[216:219]
v_mfma_f32_16x16x32_bf16 a[220:223], v[152:155], v[188:191], a[220:223]
v_mfma_f32_16x16x32_bf16 a[224:227], v[156:159], v[160:163], a[224:227]
buffer_load_dwordx4 v15, s[4:7], s31 offen offset:3072 sc1 lds
v_mfma_f32_16x16x32_bf16 a[228:231], v[156:159], v[164:167], a[228:231]
v_mfma_f32_16x16x32_bf16 a[232:235], v[156:159], v[168:171], a[232:235]
s_add_u32 s30, s30, 262144
v_mfma_f32_16x16x32_bf16 a[236:239], v[156:159], v[172:175], a[236:239]
s_add_u32 s31, s31, 16384
v_mfma_f32_16x16x32_bf16 a[240:243], v[156:159], v[176:179], a[240:243]
v_mfma_f32_16x16x32_bf16 a[244:247], v[156:159], v[180:183], a[244:247]
v_mfma_f32_16x16x32_bf16 a[248:251], v[156:159], v[184:187], a[248:251]
v_mfma_f32_16x16x32_bf16 a[252:255], v[156:159], v[188:191], a[252:255]
s_waitcnt lgkmcnt(0)
v_mfma_f32_16x16x32_bf16 a[0:3], v[64:67], v[96:99], a[0:3]
v_mfma_f32_16x16x32_bf16 a[4:7], v[64:67], v[100:103], a[4:7]
s_waitcnt vmcnt(8)
s_barrier
v_mfma_f32_16x16x32_bf16 a[8:11], v[64:67], v[104:107], a[8:11]
ds_read_b128 v[160:163], v10 offset:49152
v_mfma_f32_16x16x32_bf16 a[12:15], v[64:67], v[108:111], a[12:15]
ds_read_b128 v[164:167], v10 offset:50176
v_mfma_f32_16x16x32_bf16 a[16:19], v[64:67], v[112:115], a[16:19]
ds_read_b128 v[168:171], v10 offset:51200
v_mfma_f32_16x16x32_bf16 a[20:23], v[64:67], v[116:119], a[20:23]
ds_read_b128 v[172:175], v10 offset:52224
v_mfma_f32_16x16x32_bf16 a[24:27], v[64:67], v[120:123], a[24:27]
ds_read_b128 v[176:179], v10 offset:53248
v_mfma_f32_16x16x32_bf16 a[28:31], v[64:67], v[124:127], a[28:31]
ds_read_b128 v[180:183], v10 offset:54272
v_mfma_f32_16x16x32_bf16 a[32:35], v[68:71], v[96:99], a[32:35]
ds_read_b128 v[184:187], v10 offset:55296
v_mfma_f32_16x16x32_bf16 a[36:39], v[68:71], v[100:103], a[36:39]
ds_read_b128 v[188:191], v10 offset:56320
v_mfma_f32_16x16x32_bf16 a[40:43], v[68:71], v[104:107], a[40:43]
ds_read_b64_tr_b16 v[128:129], v2 offset:49152
v_mfma_f32_16x16x32_bf16 a[44:47], v[68:71], v[108:111], a[44:47]
ds_read_b64_tr_b16 v[130:131], v2 offset:57344
v_mfma_f32_16x16x32_bf16 a[48:51], v[68:71], v[112:115], a[48:51]
ds_read_b64_tr_b16 v[132:133], v3 offset:49152
v_mfma_f32_16x16x32_bf16 a[52:55], v[68:71], v[116:119], a[52:55]
ds_read_b64_tr_b16 v[134:135], v3 offset:57344
v_mfma_f32_16x16x32_bf16 a[56:59], v[68:71], v[120:123], a[56:59]
ds_read_b64_tr_b16 v[136:137], v4 offset:49152
v_mfma_f32_16x16x32_bf16 a[60:63], v[68:71], v[124:127], a[60:63]
ds_read_b64_tr_b16 v[138:139], v4 offset:57344
v_mfma_f32_16x16x32_bf16 a[64:67], v[72:75], v[96:99], a[64:67]
ds_read_b64_tr_b16 v[140:141], v5 offset:49152
v_mfma_f32_16x16x32_bf16 a[68:71], v[72:75], v[100:103], a[68:71]
ds_read_b64_tr_b16 v[142:143], v5 offset:57344
v_mfma_f32_16x16x32_bf16 a[72:75], v[72:75], v[104:107], a[72:75]
ds_read_b64_tr_b16 v[144:145], v6 offset:49152
v_mfma_f32_16x16x32_bf16 a[76:79], v[72:75], v[108:111], a[76:79]
ds_read_b64_tr_b16 v[146:147], v6 offset:57344
v_mfma_f32_16x16x32_bf16 a[80:83], v[72:75], v[112:115], a[80:83]
ds_read_b64_tr_b16 v[148:149], v7 offset:49152
v_mfma_f32_16x16x32_bf16 a[84:87], v[72:75], v[116:119], a[84:87]
ds_read_b64_tr_b16 v[150:151], v7 offset:57344
v_mfma_f32_16x16x32_bf16 a[88:91], v[72:75], v[120:123], a[88:91]
ds_read_b64_tr_b16 v[152:153], v8 offset:49152
v_mfma_f32_16x16x32_bf16 a[92:95], v[72:75], v[124:127], a[92:95]
ds_read_b64_tr_b16 v[154:155], v8 offset:57344
v_mfma_f32_16x16x32_bf16 a[96:99], v[76:79], v[96:99], a[96:99]
ds_read_b64_tr_b16 v[156:157], v9 offset:49152
v_mfma_f32_16x16x32_bf16 a[100:103], v[76:79], v[100:103], a[100:103]
ds_read_b64_tr_b16 v[158:159], v9 offset:57344
v_mfma_f32_16x16x32_bf16 a[104:107], v[76:79], v[104:107], a[104:107]
v_mfma_f32_16x16x32_bf16 a[108:111], v[76:79], v[108:111], a[108:111]
s_add_u32 m0, s32, 16384
v_mfma_f32_16x16x32_bf16 a[112:115], v[76:79], v[112:115], a[112:115]
buffer_load_dwordx4 v11, s[8:11], s30 offen offset:0 lds
v_mfma_f32_16x16x32_bf16 a[116:119], v[76:79], v[116:119], a[116:119]
v_mfma_f32_16x16x32_bf16 a[120:123], v[76:79], v[120:123], a[120:123]
v_mfma_f32_16x16x32_bf16 a[124:127], v[76:79], v[124:127], a[124:127]
v_mfma_f32_16x16x32_bf16 a[128:131], v[80:83], v[96:99], a[128:131]
buffer_load_dwordx4 v12, s[8:11], s30 offen offset:1024 lds
v_mfma_f32_16x16x32_bf16 a[132:135], v[80:83], v[100:103], a[132:135]
v_mfma_f32_16x16x32_bf16 a[136:139], v[80:83], v[104:107], a[136:139]
v_mfma_f32_16x16x32_bf16 a[140:143], v[80:83], v[108:111], a[140:143]
v_mfma_f32_16x16x32_bf16 a[144:147], v[80:83], v[112:115], a[144:147]
buffer_load_dwordx4 v13, s[8:11], s30 offen offset:2048 lds
v_mfma_f32_16x16x32_bf16 a[148:151], v[80:83], v[116:119], a[148:151]
v_mfma_f32_16x16x32_bf16 a[152:155], v[80:83], v[120:123], a[152:155]
v_mfma_f32_16x16x32_bf16 a[156:159], v[80:83], v[124:127], a[156:159]
v_mfma_f32_16x16x32_bf16 a[160:163], v[84:87], v[96:99], a[160:163]
buffer_load_dwordx4 v14, s[8:11], s30 offen offset:3072 lds
v_mfma_f32_16x16x32_bf16 a[164:167], v[84:87], v[100:103], a[164:167]
v_mfma_f32_16x16x32_bf16 a[168:171], v[84:87], v[104:107], a[168:171]
v_mfma_f32_16x16x32_bf16 a[172:175], v[84:87], v[108:111], a[172:175]
s_add_u32 m0, s33, 16384
v_mfma_f32_16x16x32_bf16 a[176:179], v[84:87], v[112:115], a[176:179]
buffer_load_dwordx4 v15, s[4:7], s31 offen offset:0 sc1 lds
v_mfma_f32_16x16x32_bf16 a[180:183], v[84:87], v[116:119], a[180:183]
v_mfma_f32_16x16x32_bf16 a[184:187], v[84:87], v[120:123], a[184:187]
v_mfma_f32_16x16x32_bf16 a[188:191], v[84:87], v[124:127], a[188:191]
v_mfma_f32_16x16x32_bf16 a[192:195], v[88:91], v[96:99], a[192:195]
buffer_load_dwordx4 v15, s[4:7], s31 offen offset:1024 sc1 lds
v_mfma_f32_16x16x32_bf16 a[196:199], v[88:91], v[100:103], a[196:199]
v_mfma_f32_16x16x32_bf16 a[200:203], v[88:91], v[104:107], a[200:203]
v_mfma_f32_16x16x32_bf16 a[204:207], v[88:91], v[108:111], a[204:207]
v_mfma_f32_16x16x32_bf16 a[208:211], v[88:91], v[112:115], a[208:211]
buffer_load_dwordx4 v15, s[4:7], s31 offen offset:2048 sc1 lds
v_mfma_f32_16x16x32_bf16 a[212:215], v[88:91], v[116:119], a[212:215]
v_mfma_f32_16x16x32_bf16 a[216:219], v[88:91], v[120:123], a[216:219]
v_mfma_f32_16x16x32_bf16 a[220:223], v[88:91], v[124:127], a[220:223]
v_mfma_f32_16x16x32_bf16 a[224:227], v[92:95], v[96:99], a[224:227]
buffer_load_dwordx4 v15, s[4:7], s31 offen offset:3072 sc1 lds
v_mfma_f32_16x16x32_bf16 a[228:231], v[92:95], v[100:103], a[228:231]
v_mfma_f32_16x16x32_bf16 a[232:235], v[92:95], v[104:107], a[232:235]
s_add_u32 s30, s30, 262144
v_mfma_f32_16x16x32_bf16 a[236:239], v[92:95], v[108:111], a[236:239]
s_add_u32 s31, s31, 16384
v_mfma_f32_16x16x32_bf16 a[240:243], v[92:95], v[112:115], a[240:243]
v_mfma_f32_16x16x32_bf16 a[244:247], v[92:95], v[116:119], a[244:247]
v_mfma_f32_16x16x32_bf16 a[248:251], v[92:95], v[120:123], a[248:251]
v_mfma_f32_16x16x32_bf16 a[252:255], v[92:95], v[124:127], a[252:255]
s_waitcnt lgkmcnt(0)
v_mfma_f32_16x16x32_bf16 a[0:3], v[128:131], v[160:163], a[0:3]
v_mfma_f32_16x16x32_bf16 a[4:7], v[128:131], v[164:167], a[4:7]
s_waitcnt vmcnt(8)
s_barrier
v_mfma_f32_16x16x32_bf16 a[8:11], v[128:131], v[168:171], a[8:11]
ds_read_b128 v[96:99], v10 offset:0
v_mfma_f32_16x16x32_bf16 a[12:15], v[128:131], v[172:175], a[12:15]
ds_read_b128 v[100:103], v10 offset:1024
v_mfma_f32_16x16x32_bf16 a[16:19], v[128:131], v[176:179], a[16:19]
ds_read_b128 v[104:107], v10 offset:2048
v_mfma_f32_16x16x32_bf16 a[20:23], v[128:131], v[180:183], a[20:23]
ds_read_b128 v[108:111], v10 offset:3072
v_mfma_f32_16x16x32_bf16 a[24:27], v[128:131], v[184:187], a[24:27]
ds_read_b128 v[112:115], v10 offset:4096
v_mfma_f32_16x16x32_bf16 a[28:31], v[128:131], v[188:191], a[28:31]
ds_read_b128 v[116:119], v10 offset:5120
v_mfma_f32_16x16x32_bf16 a[32:35], v[132:135], v[160:163], a[32:35]
ds_read_b128 v[120:123], v10 offset:6144
v_mfma_f32_16x16x32_bf16 a[36:39], v[132:135], v[164:167], a[36:39]
ds_read_b128 v[124:127], v10 offset:7168
v_mfma_f32_16x16x32_bf16 a[40:43], v[132:135], v[168:171], a[40:43]
ds_read_b64_tr_b16 v[64:65], v2 offset:0
v_mfma_f32_16x16x32_bf16 a[44:47], v[132:135], v[172:175], a[44:47]
ds_read_b64_tr_b16 v[66:67], v2 offset:8192
v_mfma_f32_16x16x32_bf16 a[48:51], v[132:135], v[176:179], a[48:51]
ds_read_b64_tr_b16 v[68:69], v3 offset:0
v_mfma_f32_16x16x32_bf16 a[52:55], v[132:135], v[180:183], a[52:55]
ds_read_b64_tr_b16 v[70:71], v3 offset:8192
v_mfma_f32_16x16x32_bf16 a[56:59], v[132:135], v[184:187], a[56:59]
ds_read_b64_tr_b16 v[72:73], v4 offset:0
v_mfma_f32_16x16x32_bf16 a[60:63], v[132:135], v[188:191], a[60:63]
ds_read_b64_tr_b16 v[74:75], v4 offset:8192
v_mfma_f32_16x16x32_bf16 a[64:67], v[136:139], v[160:163], a[64:67]
ds_read_b64_tr_b16 v[76:77], v5 offset:0
v_mfma_f32_16x16x32_bf16 a[68:71], v[136:139], v[164:167], a[68:71]
ds_read_b64_tr_b16 v[78:79], v5 offset:8192
v_mfma_f32_16x16x32_bf16 a[72:75], v[136:139], v[168:171], a[72:75]
ds_read_b64_tr_b16 v[80:81], v6 offset:0
v_mfma_f32_16x16x32_bf16 a[76:79], v[136:139], v[172:175], a[76:79]
ds_read_b64_tr_b16 v[82:83], v6 offset:8192
v_mfma_f32_16x16x32_bf16 a[80:83], v[136:139], v[176:179], a[80:83]
ds_read_b64_tr_b16 v[84:85], v7 offset:0
v_mfma_f32_16x16x32_bf16 a[84:87], v[136:139], v[180:183], a[84:87]
ds_read_b64_tr_b16 v[86:87], v7 offset:8192
v_mfma_f32_16x16x32_bf16 a[88:91], v[136:139], v[184:187], a[88:91]
ds_read_b64_tr_b16 v[88:89], v8 offset:0
v_mfma_f32_16x16x32_bf16 a[92:95], v[136:139], v[188:191], a[92:95]
ds_read_b64_tr_b16 v[90:91], v8 offset:8192
v_mfma_f32_16x16x32_bf16 a[96:99], v[140:143], v[160:163], a[96:99]
ds_read_b64_tr_b16 v[92:93], v9 offset:0
v_mfma_f32_16x16x32_bf16 a[100:103], v[140:143], v[164:167], a[100:103]
ds_read_b64_tr_b16 v[94:95], v9 offset:8192
v_mfma_f32_16x16x32_bf16 a[104:107], v[140:143], v[168:171], a[104:107]
v_mfma_f32_16x16x32_bf16 a[108:111], v[140:143], v[172:175], a[108:111]
s_add_u32 m0, s32, 32768
v_mfma_f32_16x16x32_bf16 a[112:115], v[140:143], v[176:179], a[112:115]
buffer_load_dwordx4 v11, s[8:11], s30 offen offset:0 lds
v_mfma_f32_16x16x32_bf16 a[116:119], v[140:143], v[180:183], a[116:119]
v_mfma_f32_16x16x32_bf16 a[120:123], v[140:143], v[184:187], a[120:123]
v_mfma_f32_16x16x32_bf16 a[124:127], v[140:143], v[188:191], a[124:127]
v_mfma_f32_16x16x32_bf16 a[128:131], v[144:147], v[160:163], a[128:131]
buffer_load_dwordx4 v12, s[8:11], s30 offen offset:1024 lds
v_mfma_f32_16x16x32_bf16 a[132:135], v[144:147], v[164:167], a[132:135]
v_mfma_f32_16x16x32_bf16 a[136:139], v[144:147], v[168:171], a[136:139]
v_mfma_f32_16x16x32_bf16 a[140:143], v[144:147], v[172:175], a[140:143]
v_mfma_f32_16x16x32_bf16 a[144:147], v[144:147], v[176:179], a[144:147]
buffer_load_dwordx4 v13, s[8:11], s30 offen offset:2048 lds
v_mfma_f32_16x16x32_bf16 a[148:151], v[144:147], v[180:183], a[148:151]
v_mfma_f32_16x16x32_bf16 a[152:155], v[144:147], v[184:187], a[152:155]
v_mfma_f32_16x16x32_bf16 a[156:159], v[144:147], v[188:191], a[156:159]
v_mfma_f32_16x16x32_bf16 a[160:163], v[148:151], v[160:163], a[160:163]
buffer_load_dwordx4 v14, s[8:11], s30 offen offset:3072 lds
v_mfma_f32_16x16x32_bf16 a[164:167], v[148:151], v[164:167], a[164:167]
v_mfma_f32_16x16x32_bf16 a[168:171], v[148:151], v[168:171], a[168:171]
v_mfma_f32_16x16x32_bf16 a[172:175], v[148:151], v[172:175], a[172:175]
s_add_u32 m0, s33, 32768
v_mfma_f32_16x16x32_bf16 a[176:179], v[148:151], v[176:179], a[176:179]
buffer_load_dwordx4 v15, s[4:7], s31 offen offset:0 sc1 lds
v_mfma_f32_16x16x32_bf16 a[180:183], v[148:151], v[180:183], a[180:183]
v_mfma_f32_16x16x32_bf16 a[184:187], v[148:151], v[184:187], a[184:187]
v_mfma_f32_16x16x32_bf16 a[188:191], v[148:151], v[188:191], a[188:191]
v_mfma_f32_16x16x32_bf16 a[192:195], v[152:155], v[160:163], a[192:195]
buffer_load_dwordx4 v15, s[4:7], s31 offen offset:1024 sc1 lds
v_mfma_f32_16x16x32_bf16 a[196:199], v[152:155], v[164:167], a[196:199]
v_mfma_f32_16x16x32_bf16 a[200:203], v[152:155], v[168:171], a[200:203]
v_mfma_f32_16x16x32_bf16 a[204:207], v[152:155], v[172:175], a[204:207]
v_mfma_f32_16x16x32_bf16 a[208:211], v[152:155], v[176:179], a[208:211]
buffer_load_dwordx4 v15, s[4:7], s31 offen offset:2048 sc1 lds
v_mfma_f32_16x16x32_bf16 a[212:215], v[152:155], v[180:183], a[212:215]
v_mfma_f32_16x16x32_bf16 a[216:219], v[152:155], v[184:187], a[216:219]
v_mfma_f32_16x16x32_bf16 a[220:223], v[152:155], v[188:191], a[220:223]
v_mfma_f32_16x16x32_bf16 a[224:227], v[156:159], v[160:163], a[224:227]
buffer_load_dwordx4 v15, s[4:7], s31 offen offset:3072 sc1 lds
v_mfma_f32_16x16x32_bf16 a[228:231], v[156:159], v[164:167], a[228:231]
v_mfma_f32_16x16x32_bf16 a[232:235], v[156:159], v[168:171], a[232:235]
s_add_u32 s30, s30, 262144
v_mfma_f32_16x16x32_bf16 a[236:239], v[156:159], v[172:175], a[236:239]
s_add_u32 s31, s31, 16384
v_mfma_f32_16x16x32_bf16 a[240:243], v[156:159], v[176:179], a[240:243]
v_mfma_f32_16x16x32_bf16 a[244:247], v[156:159], v[180:183], a[244:247]
v_mfma_f32_16x16x32_bf16 a[248:251], v[156:159], v[184:187], a[248:251]
v_mfma_f32_16x16x32_bf16 a[252:255], v[156:159], v[188:191], a[252:255]
s_sub_u32 s37, s37, 1
s_cmp_lg_u32 s37, 0
s_cbranch_scc1 GL_43
s_waitcnt lgkmcnt(0)
v_mfma_f32_16x16x32_bf16 a[0:3], v[64:67], v[96:99], a[0:3]
v_mfma_f32_16x16x32_bf16 a[4:7], v[64:67], v[100:103], a[4:7]
s_waitcnt vmcnt(8)
s_barrier
v_mfma_f32_16x16x32_bf16 a[8:11], v[64:67], v[104:107], a[8:11]
ds_read_b128 v[160:163], v10 offset:16384
v_mfma_f32_16x16x32_bf16 a[12:15], v[64:67], v[108:111], a[12:15]
ds_read_b128 v[164:167], v10 offset:17408
v_mfma_f32_16x16x32_bf16 a[16:19], v[64:67], v[112:115], a[16:19]
ds_read_b128 v[168:171], v10 offset:18432
v_mfma_f32_16x16x32_bf16 a[20:23], v[64:67], v[116:119], a[20:23]
ds_read_b128 v[172:175], v10 offset:19456
v_mfma_f32_16x16x32_bf16 a[24:27], v[64:67], v[120:123], a[24:27]
ds_read_b128 v[176:179], v10 offset:20480
v_mfma_f32_16x16x32_bf16 a[28:31], v[64:67], v[124:127], a[28:31]
ds_read_b128 v[180:183], v10 offset:21504
v_mfma_f32_16x16x32_bf16 a[32:35], v[68:71], v[96:99], a[32:35]
ds_read_b128 v[184:187], v10 offset:22528
v_mfma_f32_16x16x32_bf16 a[36:39], v[68:71], v[100:103], a[36:39]
ds_read_b128 v[188:191], v10 offset:23552
v_mfma_f32_16x16x32_bf16 a[40:43], v[68:71], v[104:107], a[40:43]
ds_read_b64_tr_b16 v[128:129], v2 offset:16384
v_mfma_f32_16x16x32_bf16 a[44:47], v[68:71], v[108:111], a[44:47]
ds_read_b64_tr_b16 v[130:131], v2 offset:24576
v_mfma_f32_16x16x32_bf16 a[48:51], v[68:71], v[112:115], a[48:51]
ds_read_b64_tr_b16 v[132:133], v3 offset:16384
v_mfma_f32_16x16x32_bf16 a[52:55], v[68:71], v[116:119], a[52:55]
ds_read_b64_tr_b16 v[134:135], v3 offset:24576
v_mfma_f32_16x16x32_bf16 a[56:59], v[68:71], v[120:123], a[56:59]
ds_read_b64_tr_b16 v[136:137], v4 offset:16384
v_mfma_f32_16x16x32_bf16 a[60:63], v[68:71], v[124:127], a[60:63]
ds_read_b64_tr_b16 v[138:139], v4 offset:24576
v_mfma_f32_16x16x32_bf16 a[64:67], v[72:75], v[96:99], a[64:67]
ds_read_b64_tr_b16 v[140:141], v5 offset:16384
v_mfma_f32_16x16x32_bf16 a[68:71], v[72:75], v[100:103], a[68:71]
ds_read_b64_tr_b16 v[142:143], v5 offset:24576
v_mfma_f32_16x16x32_bf16 a[72:75], v[72:75], v[104:107], a[72:75]
ds_read_b64_tr_b16 v[144:145], v6 offset:16384
v_mfma_f32_16x16x32_bf16 a[76:79], v[72:75], v[108:111], a[76:79]
ds_read_b64_tr_b16 v[146:147], v6 offset:24576
v_mfma_f32_16x16x32_bf16 a[80:83], v[72:75], v[112:115], a[80:83]
ds_read_b64_tr_b16 v[148:149], v7 offset:16384
v_mfma_f32_16x16x32_bf16 a[84:87], v[72:75], v[116:119], a[84:87]
ds_read_b64_tr_b16 v[150:151], v7 offset:24576
v_mfma_f32_16x16x32_bf16 a[88:91], v[72:75], v[120:123], a[88:91]
ds_read_b64_tr_b16 v[152:153], v8 offset:16384
v_mfma_f32_16x16x32_bf16 a[92:95], v[72:75], v[124:127], a[92:95]
ds_read_b64_tr_b16 v[154:155], v8 offset:24576
v_mfma_f32_16x16x32_bf16 a[96:99], v[76:79], v[96:99], a[96:99]
ds_read_b64_tr_b16 v[156:157], v9 offset:16384
v_mfma_f32_16x16x32_bf16 a[100:103], v[76:79], v[100:103], a[100:103]
ds_read_b64_tr_b16 v[158:159], v9 offset:24576
v_mfma_f32_16x16x32_bf16 a[104:107], v[76:79], v[104:107], a[104:107]
v_mfma_f32_16x16x32_bf16 a[108:111], v[76:79], v[108:111], a[108:111]
s_add_u32 m0, s32, 49152
v_mfma_f32_16x16x32_bf16 a[112:115], v[76:79], v[112:115], a[112:115]
buffer_load_dwordx4 v11, s[8:11], s30 offen offset:0 lds
v_mfma_f32_16x16x32_bf16 a[116:119], v[76:79], v[116:119], a[116:119]
v_mfma_f32_16x16x32_bf16 a[120:123], v[76:79], v[120:123], a[120:123]
v_mfma_f32_16x16x32_bf16 a[124:127], v[76:79], v[124:127], a[124:127]
v_mfma_f32_16x16x32_bf16 a[128:131], v[80:83], v[96:99], a[128:131]
buffer_load_dwordx4 v12, s[8:11], s30 offen offset:1024 lds
v_mfma_f32_16x16x32_bf16 a[132:135], v[80:83], v[100:103], a[132:135]
v_mfma_f32_16x16x32_bf16 a[136:139], v[80:83], v[104:107], a[136:139]
v_mfma_f32_16x16x32_bf16 a[140:143], v[80:83], v[108:111], a[140:143]
v_mfma_f32_16x16x32_bf16 a[144:147], v[80:83], v[112:115], a[144:147]
buffer_load_dwordx4 v13, s[8:11], s30 offen offset:2048 lds
v_mfma_f32_16x16x32_bf16 a[148:151], v[80:83], v[116:119], a[148:151]
v_mfma_f32_16x16x32_bf16 a[152:155], v[80:83], v[120:123], a[152:155]
v_mfma_f32_16x16x32_bf16 a[156:159], v[80:83], v[124:127], a[156:159]
v_mfma_f32_16x16x32_bf16 a[160:163], v[84:87], v[96:99], a[160:163]
buffer_load_dwordx4 v14, s[8:11], s30 offen offset:3072 lds
v_mfma_f32_16x16x32_bf16 a[164:167], v[84:87], v[100:103], a[164:167]
v_mfma_f32_16x16x32_bf16 a[168:171], v[84:87], v[104:107], a[168:171]
v_mfma_f32_16x16x32_bf16 a[172:175], v[84:87], v[108:111], a[172:175]
s_add_u32 m0, s33, 49152
v_mfma_f32_16x16x32_bf16 a[176:179], v[84:87], v[112:115], a[176:179]
buffer_load_dwordx4 v15, s[4:7], s31 offen offset:0 sc1 lds
v_mfma_f32_16x16x32_bf16 a[180:183], v[84:87], v[116:119], a[180:183]
v_mfma_f32_16x16x32_bf16 a[184:187], v[84:87], v[120:123], a[184:187]
v_mfma_f32_16x16x32_bf16 a[188:191], v[84:87], v[124:127], a[188:191]
v_mfma_f32_16x16x32_bf16 a[192:195], v[88:91], v[96:99], a[192:195]
buffer_load_dwordx4 v15, s[4:7], s31 offen offset:1024 sc1 lds
v_mfma_f32_16x16x32_bf16 a[196:199], v[88:91], v[100:103], a[196:199]
v_mfma_f32_16x16x32_bf16 a[200:203], v[88:91], v[104:107], a[200:203]
v_mfma_f32_16x16x32_bf16 a[204:207], v[88:91], v[108:111], a[204:207]
v_mfma_f32_16x16x32_bf16 a[208:211], v[88:91], v[112:115], a[208:211]
buffer_load_dwordx4 v15, s[4:7], s31 offen offset:2048 sc1 lds
v_mfma_f32_16x16x32_bf16 a[212:215], v[88:91], v[116:119], a[212:215]
v_mfma_f32_16x16x32_bf16 a[216:219], v[88:91], v[120:123], a[216:219]
v_mfma_f32_16x16x32_bf16 a[220:223], v[88:91], v[124:127], a[220:223]
v_mfma_f32_16x16x32_bf16 a[224:227], v[92:95], v[96:99], a[224:227]
buffer_load_dwordx4 v15, s[4:7], s31 offen offset:3072 sc1 lds
v_mfma_f32_16x16x32_bf16 a[228:231], v[92:95], v[100:103], a[228:231]
v_mfma_f32_16x16x32_bf16 a[232:235], v[92:95], v[104:107], a[232:235]
s_add_u32 s30, s30, 262144
v_mfma_f32_16x16x32_bf16 a[236:239], v[92:95], v[108:111], a[236:239]
s_add_u32 s31, s31, 16384
v_mfma_f32_16x16x32_bf16 a[240:243], v[92:95], v[112:115], a[240:243]
v_mfma_f32_16x16x32_bf16 a[244:247], v[92:95], v[116:119], a[244:247]
v_mfma_f32_16x16x32_bf16 a[248:251], v[92:95], v[120:123], a[248:251]
v_mfma_f32_16x16x32_bf16 a[252:255], v[92:95], v[124:127], a[252:255]
s_waitcnt lgkmcnt(0)
v_mfma_f32_16x16x32_bf16 a[0:3], v[128:131], v[160:163], a[0:3]
v_mfma_f32_16x16x32_bf16 a[4:7], v[128:131], v[164:167], a[4:7]
s_waitcnt vmcnt(8)
s_barrier
v_mfma_f32_16x16x32_bf16 a[8:11], v[128:131], v[168:171], a[8:11]
ds_read_b128 v[96:99], v10 offset:32768
v_mfma_f32_16x16x32_bf16 a[12:15], v[128:131], v[172:175], a[12:15]
ds_read_b128 v[100:103], v10 offset:33792
v_mfma_f32_16x16x32_bf16 a[16:19], v[128:131], v[176:179], a[16:19]
ds_read_b128 v[104:107], v10 offset:34816
v_mfma_f32_16x16x32_bf16 a[20:23], v[128:131], v[180:183], a[20:23]
ds_read_b128 v[108:111], v10 offset:35840
v_mfma_f32_16x16x32_bf16 a[24:27], v[128:131], v[184:187], a[24:27]
ds_read_b128 v[112:115], v10 offset:36864
v_mfma_f32_16x16x32_bf16 a[28:31], v[128:131], v[188:191], a[28:31]
ds_read_b128 v[116:119], v10 offset:37888
v_mfma_f32_16x16x32_bf16 a[32:35], v[132:135], v[160:163], a[32:35]
ds_read_b128 v[120:123], v10 offset:38912
v_mfma_f32_16x16x32_bf16 a[36:39], v[132:135], v[164:167], a[36:39]
ds_read_b128 v[124:127], v10 offset:39936
v_mfma_f32_16x16x32_bf16 a[40:43], v[132:135], v[168:171], a[40:43]
ds_read_b64_tr_b16 v[64:65], v2 offset:32768
v_mfma_f32_16x16x32_bf16 a[44:47], v[132:135], v[172:175], a[44:47]
ds_read_b64_tr_b16 v[66:67], v2 offset:40960
v_mfma_f32_16x16x32_bf16 a[48:51], v[132:135], v[176:179], a[48:51]
ds_read_b64_tr_b16 v[68:69], v3 offset:32768
v_mfma_f32_16x16x32_bf16 a[52:55], v[132:135], v[180:183], a[52:55]
ds_read_b64_tr_b16 v[70:71], v3 offset:40960
v_mfma_f32_16x16x32_bf16 a[56:59], v[132:135], v[184:187], a[56:59]
ds_read_b64_tr_b16 v[72:73], v4 offset:32768
v_mfma_f32_16x16x32_bf16 a[60:63], v[132:135], v[188:191], a[60:63]
ds_read_b64_tr_b16 v[74:75], v4 offset:40960
v_mfma_f32_16x16x32_bf16 a[64:67], v[136:139], v[160:163], a[64:67]
ds_read_b64_tr_b16 v[76:77], v5 offset:32768
v_mfma_f32_16x16x32_bf16 a[68:71], v[136:139], v[164:167], a[68:71]
ds_read_b64_tr_b16 v[78:79], v5 offset:40960
v_mfma_f32_16x16x32_bf16 a[72:75], v[136:139], v[168:171], a[72:75]
ds_read_b64_tr_b16 v[80:81], v6 offset:32768
v_mfma_f32_16x16x32_bf16 a[76:79], v[136:139], v[172:175], a[76:79]
ds_read_b64_tr_b16 v[82:83], v6 offset:40960
v_mfma_f32_16x16x32_bf16 a[80:83], v[136:139], v[176:179], a[80:83]
ds_read_b64_tr_b16 v[84:85], v7 offset:32768
v_mfma_f32_16x16x32_bf16 a[84:87], v[136:139], v[180:183], a[84:87]
ds_read_b64_tr_b16 v[86:87], v7 offset:40960
v_mfma_f32_16x16x32_bf16 a[88:91], v[136:139], v[184:187], a[88:91]
ds_read_b64_tr_b16 v[88:89], v8 offset:32768
v_mfma_f32_16x16x32_bf16 a[92:95], v[136:139], v[188:191], a[92:95]
ds_read_b64_tr_b16 v[90:91], v8 offset:40960
v_mfma_f32_16x16x32_bf16 a[96:99], v[140:143], v[160:163], a[96:99]
ds_read_b64_tr_b16 v[92:93], v9 offset:32768
v_mfma_f32_16x16x32_bf16 a[100:103], v[140:143], v[164:167], a[100:103]
ds_read_b64_tr_b16 v[94:95], v9 offset:40960
v_mfma_f32_16x16x32_bf16 a[104:107], v[140:143], v[168:171], a[104:107]
v_mfma_f32_16x16x32_bf16 a[108:111], v[140:143], v[172:175], a[108:111]
v_mfma_f32_16x16x32_bf16 a[112:115], v[140:143], v[176:179], a[112:115]
v_mfma_f32_16x16x32_bf16 a[116:119], v[140:143], v[180:183], a[116:119]
v_mfma_f32_16x16x32_bf16 a[120:123], v[140:143], v[184:187], a[120:123]
v_mfma_f32_16x16x32_bf16 a[124:127], v[140:143], v[188:191], a[124:127]
v_mfma_f32_16x16x32_bf16 a[128:131], v[144:147], v[160:163], a[128:131]
v_mfma_f32_16x16x32_bf16 a[132:135], v[144:147], v[164:167], a[132:135]
v_mfma_f32_16x16x32_bf16 a[136:139], v[144:147], v[168:171], a[136:139]
v_mfma_f32_16x16x32_bf16 a[140:143], v[144:147], v[172:175], a[140:143]
v_mfma_f32_16x16x32_bf16 a[144:147], v[144:147], v[176:179], a[144:147]
v_mfma_f32_16x16x32_bf16 a[148:151], v[144:147], v[180:183], a[148:151]
v_mfma_f32_16x16x32_bf16 a[152:155], v[144:147], v[184:187], a[152:155]
v_mfma_f32_16x16x32_bf16 a[156:159], v[144:147], v[188:191], a[156:159]
v_mfma_f32_16x16x32_bf16 a[160:163], v[148:151], v[160:163], a[160:163]
v_mfma_f32_16x16x32_bf16 a[164:167], v[148:151], v[164:167], a[164:167]
v_mfma_f32_16x16x32_bf16 a[168:171], v[148:151], v[168:171], a[168:171]
v_mfma_f32_16x16x32_bf16 a[172:175], v[148:151], v[172:175], a[172:175]
v_mfma_f32_16x16x32_bf16 a[176:179], v[148:151], v[176:179], a[176:179]
v_mfma_f32_16x16x32_bf16 a[180:183], v[148:151], v[180:183], a[180:183]
v_mfma_f32_16x16x32_bf16 a[184:187], v[148:151], v[184:187], a[184:187]
v_mfma_f32_16x16x32_bf16 a[188:191], v[148:151], v[188:191], a[188:191]
v_mfma_f32_16x16x32_bf16 a[192:195], v[152:155], v[160:163], a[192:195]
v_mfma_f32_16x16x32_bf16 a[196:199], v[152:155], v[164:167], a[196:199]
v_mfma_f32_16x16x32_bf16 a[200:203], v[152:155], v[168:171], a[200:203]
v_mfma_f32_16x16x32_bf16 a[204:207], v[152:155], v[172:175], a[204:207]
v_mfma_f32_16x16x32_bf16 a[208:211], v[152:155], v[176:179], a[208:211]
v_mfma_f32_16x16x32_bf16 a[212:215], v[152:155], v[180:183], a[212:215]
v_mfma_f32_16x16x32_bf16 a[216:219], v[152:155], v[184:187], a[216:219]
v_mfma_f32_16x16x32_bf16 a[220:223], v[152:155], v[188:191], a[220:223]
v_mfma_f32_16x16x32_bf16 a[224:227], v[156:159], v[160:163], a[224:227]
v_mfma_f32_16x16x32_bf16 a[228:231], v[156:159], v[164:167], a[228:231]
v_mfma_f32_16x16x32_bf16 a[232:235], v[156:159], v[168:171], a[232:235]
v_mfma_f32_16x16x32_bf16 a[236:239], v[156:159], v[172:175], a[236:239]
v_mfma_f32_16x16x32_bf16 a[240:243], v[156:159], v[176:179], a[240:243]
v_mfma_f32_16x16x32_bf16 a[244:247], v[156:159], v[180:183], a[244:247]
v_mfma_f32_16x16x32_bf16 a[248:251], v[156:159], v[184:187], a[248:251]
v_mfma_f32_16x16x32_bf16 a[252:255], v[156:159], v[188:191], a[252:255]
s_waitcnt lgkmcnt(0)
v_mfma_f32_16x16x32_bf16 a[0:3], v[64:67], v[96:99], a[0:3]
v_mfma_f32_16x16x32_bf16 a[4:7], v[64:67], v[100:103], a[4:7]
s_waitcnt vmcnt(0)
s_barrier
v_mfma_f32_16x16x32_bf16 a[8:11], v[64:67], v[104:107], a[8:11]
ds_read_b128 v[160:163], v10 offset:49152
v_mfma_f32_16x16x32_bf16 a[12:15], v[64:67], v[108:111], a[12:15]
ds_read_b128 v[164:167], v10 offset:50176
v_mfma_f32_16x16x32_bf16 a[16:19], v[64:67], v[112:115], a[16:19]
ds_read_b128 v[168:171], v10 offset:51200
v_mfma_f32_16x16x32_bf16 a[20:23], v[64:67], v[116:119], a[20:23]
ds_read_b128 v[172:175], v10 offset:52224
v_mfma_f32_16x16x32_bf16 a[24:27], v[64:67], v[120:123], a[24:27]
ds_read_b128 v[176:179], v10 offset:53248
v_mfma_f32_16x16x32_bf16 a[28:31], v[64:67], v[124:127], a[28:31]
ds_read_b128 v[180:183], v10 offset:54272
v_mfma_f32_16x16x32_bf16 a[32:35], v[68:71], v[96:99], a[32:35]
ds_read_b128 v[184:187], v10 offset:55296
v_mfma_f32_16x16x32_bf16 a[36:39], v[68:71], v[100:103], a[36:39]
ds_read_b128 v[188:191], v10 offset:56320
v_mfma_f32_16x16x32_bf16 a[40:43], v[68:71], v[104:107], a[40:43]
ds_read_b64_tr_b16 v[128:129], v2 offset:49152
v_mfma_f32_16x16x32_bf16 a[44:47], v[68:71], v[108:111], a[44:47]
ds_read_b64_tr_b16 v[130:131], v2 offset:57344
v_mfma_f32_16x16x32_bf16 a[48:51], v[68:71], v[112:115], a[48:51]
ds_read_b64_tr_b16 v[132:133], v3 offset:49152
v_mfma_f32_16x16x32_bf16 a[52:55], v[68:71], v[116:119], a[52:55]
ds_read_b64_tr_b16 v[134:135], v3 offset:57344
v_mfma_f32_16x16x32_bf16 a[56:59], v[68:71], v[120:123], a[56:59]
ds_read_b64_tr_b16 v[136:137], v4 offset:49152
v_mfma_f32_16x16x32_bf16 a[60:63], v[68:71], v[124:127], a[60:63]
ds_read_b64_tr_b16 v[138:139], v4 offset:57344
v_mfma_f32_16x16x32_bf16 a[64:67], v[72:75], v[96:99], a[64:67]
ds_read_b64_tr_b16 v[140:141], v5 offset:49152
v_mfma_f32_16x16x32_bf16 a[68:71], v[72:75], v[100:103], a[68:71]
ds_read_b64_tr_b16 v[142:143], v5 offset:57344
v_mfma_f32_16x16x32_bf16 a[72:75], v[72:75], v[104:107], a[72:75]
ds_read_b64_tr_b16 v[144:145], v6 offset:49152
v_mfma_f32_16x16x32_bf16 a[76:79], v[72:75], v[108:111], a[76:79]
ds_read_b64_tr_b16 v[146:147], v6 offset:57344
v_mfma_f32_16x16x32_bf16 a[80:83], v[72:75], v[112:115], a[80:83]
ds_read_b64_tr_b16 v[148:149], v7 offset:49152
v_mfma_f32_16x16x32_bf16 a[84:87], v[72:75], v[116:119], a[84:87]
ds_read_b64_tr_b16 v[150:151], v7 offset:57344
v_mfma_f32_16x16x32_bf16 a[88:91], v[72:75], v[120:123], a[88:91]
ds_read_b64_tr_b16 v[152:153], v8 offset:49152
v_mfma_f32_16x16x32_bf16 a[92:95], v[72:75], v[124:127], a[92:95]
ds_read_b64_tr_b16 v[154:155], v8 offset:57344
v_mfma_f32_16x16x32_bf16 a[96:99], v[76:79], v[96:99], a[96:99]
ds_read_b64_tr_b16 v[156:157], v9 offset:49152
v_mfma_f32_16x16x32_bf16 a[100:103], v[76:79], v[100:103], a[100:103]
ds_read_b64_tr_b16 v[158:159], v9 offset:57344
v_mfma_f32_16x16x32_bf16 a[104:107], v[76:79], v[104:107], a[104:107]
v_mfma_f32_16x16x32_bf16 a[108:111], v[76:79], v[108:111], a[108:111]
v_mfma_f32_16x16x32_bf16 a[112:115], v[76:79], v[112:115], a[112:115]
v_mfma_f32_16x16x32_bf16 a[116:119], v[76:79], v[116:119], a[116:119]
v_mfma_f32_16x16x32_bf16 a[120:123], v[76:79], v[120:123], a[120:123]
v_mfma_f32_16x16x32_bf16 a[124:127], v[76:79], v[124:127], a[124:127]
v_mfma_f32_16x16x32_bf16 a[128:131], v[80:83], v[96:99], a[128:131]
v_mfma_f32_16x16x32_bf16 a[132:135], v[80:83], v[100:103], a[132:135]
v_mfma_f32_16x16x32_bf16 a[136:139], v[80:83], v[104:107], a[136:139]
v_mfma_f32_16x16x32_bf16 a[140:143], v[80:83], v[108:111], a[140:143]
v_mfma_f32_16x16x32_bf16 a[144:147], v[80:83], v[112:115], a[144:147]
v_mfma_f32_16x16x32_bf16 a[148:151], v[80:83], v[116:119], a[148:151]
v_mfma_f32_16x16x32_bf16 a[152:155], v[80:83], v[120:123], a[152:155]
v_mfma_f32_16x16x32_bf16 a[156:159], v[80:83], v[124:127], a[156:159]
v_mfma_f32_16x16x32_bf16 a[160:163], v[84:87], v[96:99], a[160:163]
v_mfma_f32_16x16x32_bf16 a[164:167], v[84:87], v[100:103], a[164:167]
v_mfma_f32_16x16x32_bf16 a[168:171], v[84:87], v[104:107], a[168:171]
v_mfma_f32_16x16x32_bf16 a[172:175], v[84:87], v[108:111], a[172:175]
v_mfma_f32_16x16x32_bf16 a[176:179], v[84:87], v[112:115], a[176:179]
v_mfma_f32_16x16x32_bf16 a[180:183], v[84:87], v[116:119], a[180:183]
v_mfma_f32_16x16x32_bf16 a[184:187], v[84:87], v[120:123], a[184:187]
v_mfma_f32_16x16x32_bf16 a[188:191], v[84:87], v[124:127], a[188:191]
v_mfma_f32_16x16x32_bf16 a[192:195], v[88:91], v[96:99], a[192:195]
v_mfma_f32_16x16x32_bf16 a[196:199], v[88:91], v[100:103], a[196:199]
v_mfma_f32_16x16x32_bf16 a[200:203], v[88:91], v[104:107], a[200:203]
v_mfma_f32_16x16x32_bf16 a[204:207], v[88:91], v[108:111], a[204:207]
v_mfma_f32_16x16x32_bf16 a[208:211], v[88:91], v[112:115], a[208:211]
v_mfma_f32_16x16x32_bf16 a[212:215], v[88:91], v[116:119], a[212:215]
v_mfma_f32_16x16x32_bf16 a[216:219], v[88:91], v[120:123], a[216:219]
v_mfma_f32_16x16x32_bf16 a[220:223], v[88:91], v[124:127], a[220:223]
v_mfma_f32_16x16x32_bf16 a[224:227], v[92:95], v[96:99], a[224:227]
v_mfma_f32_16x16x32_bf16 a[228:231], v[92:95], v[100:103], a[228:231]
v_mfma_f32_16x16x32_bf16 a[232:235], v[92:95], v[104:107], a[232:235]
v_mfma_f32_16x16x32_bf16 a[236:239], v[92:95], v[108:111], a[236:239]
v_mfma_f32_16x16x32_bf16 a[240:243], v[92:95], v[112:115], a[240:243]
v_mfma_f32_16x16x32_bf16 a[244:247], v[92:95], v[116:119], a[244:247]
v_mfma_f32_16x16x32_bf16 a[248:251], v[92:95], v[120:123], a[248:251]
v_mfma_f32_16x16x32_bf16 a[252:255], v[92:95], v[124:127], a[252:255]
s_waitcnt lgkmcnt(0)
v_mfma_f32_16x16x32_bf16 a[0:3], v[128:131], v[160:163], a[0:3]
v_mfma_f32_16x16x32_bf16 a[4:7], v[128:131], v[164:167], a[4:7]
v_mfma_f32_16x16x32_bf16 a[8:11], v[128:131], v[168:171], a[8:11]
v_mfma_f32_16x16x32_bf16 a[12:15], v[128:131], v[172:175], a[12:15]
v_mfma_f32_16x16x32_bf16 a[16:19], v[128:131], v[176:179], a[16:19]
v_mfma_f32_16x16x32_bf16 a[20:23], v[128:131], v[180:183], a[20:23]
v_mfma_f32_16x16x32_bf16 a[24:27], v[128:131], v[184:187], a[24:27]
v_mfma_f32_16x16x32_bf16 a[28:31], v[128:131], v[188:191], a[28:31]
v_mfma_f32_16x16x32_bf16 a[32:35], v[132:135], v[160:163], a[32:35]
v_mfma_f32_16x16x32_bf16 a[36:39], v[132:135], v[164:167], a[36:39]
v_mfma_f32_16x16x32_bf16 a[40:43], v[132:135], v[168:171], a[40:43]
v_mfma_f32_16x16x32_bf16 a[44:47], v[132:135], v[172:175], a[44:47]
v_mfma_f32_16x16x32_bf16 a[48:51], v[132:135], v[176:179], a[48:51]
v_mfma_f32_16x16x32_bf16 a[52:55], v[132:135], v[180:183], a[52:55]
v_mfma_f32_16x16x32_bf16 a[56:59], v[132:135], v[184:187], a[56:59]
v_mfma_f32_16x16x32_bf16 a[60:63], v[132:135], v[188:191], a[60:63]
v_mfma_f32_16x16x32_bf16 a[64:67], v[136:139], v[160:163], a[64:67]
v_mfma_f32_16x16x32_bf16 a[68:71], v[136:139], v[164:167], a[68:71]
v_mfma_f32_16x16x32_bf16 a[72:75], v[136:139], v[168:171], a[72:75]
v_mfma_f32_16x16x32_bf16 a[76:79], v[136:139], v[172:175], a[76:79]
v_mfma_f32_16x16x32_bf16 a[80:83], v[136:139], v[176:179], a[80:83]
v_mfma_f32_16x16x32_bf16 a[84:87], v[136:139], v[180:183], a[84:87]
v_mfma_f32_16x16x32_bf16 a[88:91], v[136:139], v[184:187], a[88:91]
v_mfma_f32_16x16x32_bf16 a[92:95], v[136:139], v[188:191], a[92:95]
v_mfma_f32_16x16x32_bf16 a[96:99], v[140:143], v[160:163], a[96:99]
v_mfma_f32_16x16x32_bf16 a[100:103], v[140:143], v[164:167], a[100:103]
v_mfma_f32_16x16x32_bf16 a[104:107], v[140:143], v[168:171], a[104:107]
v_mfma_f32_16x16x32_bf16 a[108:111], v[140:143], v[172:175], a[108:111]
v_mfma_f32_16x16x32_bf16 a[112:115], v[140:143], v[176:179], a[112:115]
v_mfma_f32_16x16x32_bf16 a[116:119], v[140:143], v[180:183], a[116:119]
v_mfma_f32_16x16x32_bf16 a[120:123], v[140:143], v[184:187], a[120:123]
v_mfma_f32_16x16x32_bf16 a[124:127], v[140:143], v[188:191], a[124:127]
v_mfma_f32_16x16x32_bf16 a[128:131], v[144:147], v[160:163], a[128:131]
v_mfma_f32_16x16x32_bf16 a[132:135], v[144:147], v[164:167], a[132:135]
v_mfma_f32_16x16x32_bf16 a[136:139], v[144:147], v[168:171], a[136:139]
v_mfma_f32_16x16x32_bf16 a[140:143], v[144:147], v[172:175], a[140:143]
v_mfma_f32_16x16x32_bf16 a[144:147], v[144:147], v[176:179], a[144:147]
v_mfma_f32_16x16x32_bf16 a[148:151], v[144:147], v[180:183], a[148:151]
v_mfma_f32_16x16x32_bf16 a[152:155], v[144:147], v[184:187], a[152:155]
v_mfma_f32_16x16x32_bf16 a[156:159], v[144:147], v[188:191], a[156:159]
v_mfma_f32_16x16x32_bf16 a[160:163], v[148:151], v[160:163], a[160:163]
v_mfma_f32_16x16x32_bf16 a[164:167], v[148:151], v[164:167], a[164:167]
v_mfma_f32_16x16x32_bf16 a[168:171], v[148:151], v[168:171], a[168:171]
v_mfma_f32_16x16x32_bf16 a[172:175], v[148:151], v[172:175], a[172:175]
v_mfma_f32_16x16x32_bf16 a[176:179], v[148:151], v[176:179], a[176:179]
v_mfma_f32_16x16x32_bf16 a[180:183], v[148:151], v[180:183], a[180:183]
v_mfma_f32_16x16x32_bf16 a[184:187], v[148:151], v[184:187], a[184:187]
v_mfma_f32_16x16x32_bf16 a[188:191], v[148:151], v[188:191], a[188:191]
v_mfma_f32_16x16x32_bf16 a[192:195], v[152:155], v[160:163], a[192:195]
v_mfma_f32_16x16x32_bf16 a[196:199], v[152:155], v[164:167], a[196:199]
v_mfma_f32_16x16x32_bf16 a[200:203], v[152:155], v[168:171], a[200:203]
v_mfma_f32_16x16x32_bf16 a[204:207], v[152:155], v[172:175], a[204:207]
v_mfma_f32_16x16x32_bf16 a[208:211], v[152:155], v[176:179], a[208:211]
v_mfma_f32_16x16x32_bf16 a[212:215], v[152:155], v[180:183], a[212:215]
v_mfma_f32_16x16x32_bf16 a[216:219], v[152:155], v[184:187], a[216:219]
v_mfma_f32_16x16x32_bf16 a[220:223], v[152:155], v[188:191], a[220:223]
v_mfma_f32_16x16x32_bf16 a[224:227], v[156:159], v[160:163], a[224:227]
v_mfma_f32_16x16x32_bf16 a[228:231], v[156:159], v[164:167], a[228:231]
v_mfma_f32_16x16x32_bf16 a[232:235], v[156:159], v[168:171], a[232:235]
v_mfma_f32_16x16x32_bf16 a[236:239], v[156:159], v[172:175], a[236:239]
v_mfma_f32_16x16x32_bf16 a[240:243], v[156:159], v[176:179], a[240:243]
v_mfma_f32_16x16x32_bf16 a[244:247], v[156:159], v[180:183], a[244:247]
v_mfma_f32_16x16x32_bf16 a[248:251], v[156:159], v[184:187], a[248:251]
v_mfma_f32_16x16x32_bf16 a[252:255], v[156:159], v[188:191], a[252:255]
s_nop 7
s_mov_b32 s42, 1.0
s_cmp_eq_u32 s28, 2
s_cselect_b32 s39, s34, 0
s_cmp_eq_u32 s39, 0
s_cbranch_scc1 HB_44
s_barrier
HB_44:
s_lshl_b32 s36, s28, 21
s_lshl_b32 s37, s34, 20
s_add_u32 s36, s36, s37
s_lshl_b32 s37, s29, 14
s_add_u32 s36, s36, s37
s_lshl_b32 s37, s35, 13
s_add_u32 s36, s36, s37
s_add_u32 s36, s36, 41943040
s_add_u32 s38, s36, 0
v_accvgpr_read_b32 v64, a0
v_accvgpr_read_b32 v65, a1
v_accvgpr_read_b32 v66, a2
v_accvgpr_read_b32 v67, a3
v_accvgpr_read_b32 v68, a32
v_accvgpr_read_b32 v69, a33
v_accvgpr_read_b32 v70, a34
v_accvgpr_read_b32 v71, a35
v_cvt_pk_bf16_f32 v72, v64, v65
v_cvt_pk_bf16_f32 v73, v66, v67
v_cvt_pk_bf16_f32 v74, v68, v69
v_cvt_pk_bf16_f32 v75, v70, v71
buffer_store_dwordx4 v[72:75], v61, s[4:7], s38 offen offset:0 sc1
v_accvgpr_read_b32 v80, a64
v_accvgpr_read_b32 v81, a65
v_accvgpr_read_b32 v82, a66
v_accvgpr_read_b32 v83, a67
v_accvgpr_read_b32 v84, a96
v_accvgpr_read_b32 v85, a97
v_accvgpr_read_b32 v86, a98
v_accvgpr_read_b32 v87, a99
v_cvt_pk_bf16_f32 v88, v80, v81
v_cvt_pk_bf16_f32 v89, v82, v83
v_cvt_pk_bf16_f32 v90, v84, v85
v_cvt_pk_bf16_f32 v91, v86, v87
buffer_store_dwordx4 v[88:91], v61, s[4:7], s38 offen offset:1024 sc1
v_accvgpr_read_b32 v96, a128
v_accvgpr_read_b32 v97, a129
v_accvgpr_read_b32 v98, a130
v_accvgpr_read_b32 v99, a131
v_accvgpr_read_b32 v100, a160
v_accvgpr_read_b32 v101, a161
v_accvgpr_read_b32 v102, a162
v_accvgpr_read_b32 v103, a163
v_cvt_pk_bf16_f32 v104, v96, v97
v_cvt_pk_bf16_f32 v105, v98, v99
v_cvt_pk_bf16_f32 v106, v100, v101
v_cvt_pk_bf16_f32 v107, v102, v103
buffer_store_dwordx4 v[104:107], v61, s[4:7], s38 offen offset:2048 sc1
v_accvgpr_read_b32 v112, a192
v_accvgpr_read_b32 v113, a193
v_accvgpr_read_b32 v114, a194
v_accvgpr_read_b32 v115, a195
v_accvgpr_read_b32 v116, a224
v_accvgpr_read_b32 v117, a225
v_accvgpr_read_b32 v118, a226
v_accvgpr_read_b32 v119, a227
v_cvt_pk_bf16_f32 v120, v112, v113
v_cvt_pk_bf16_f32 v121, v114, v115
v_cvt_pk_bf16_f32 v122, v116, v117
v_cvt_pk_bf16_f32 v123, v118, v119
buffer_store_dwordx4 v[120:123], v61, s[4:7], s38 offen offset:3072 sc1
s_add_u32 s38, s36, 4096
v_accvgpr_read_b32 v64, a4
v_accvgpr_read_b32 v65, a5
v_accvgpr_read_b32 v66, a6
v_accvgpr_read_b32 v67, a7
v_accvgpr_read_b32 v68, a36
v_accvgpr_read_b32 v69, a37
v_accvgpr_read_b32 v70, a38
v_accvgpr_read_b32 v71, a39
v_cvt_pk_bf16_f32 v72, v64, v65
v_cvt_pk_bf16_f32 v73, v66, v67
v_cvt_pk_bf16_f32 v74, v68, v69
v_cvt_pk_bf16_f32 v75, v70, v71
buffer_store_dwordx4 v[72:75], v61, s[4:7], s38 offen offset:0 sc1
v_accvgpr_read_b32 v80, a68
v_accvgpr_read_b32 v81, a69
v_accvgpr_read_b32 v82, a70
v_accvgpr_read_b32 v83, a71
v_accvgpr_read_b32 v84, a100
v_accvgpr_read_b32 v85, a101
v_accvgpr_read_b32 v86, a102
v_accvgpr_read_b32 v87, a103
v_cvt_pk_bf16_f32 v88, v80, v81
v_cvt_pk_bf16_f32 v89, v82, v83
v_cvt_pk_bf16_f32 v90, v84, v85
v_cvt_pk_bf16_f32 v91, v86, v87
buffer_store_dwordx4 v[88:91], v61, s[4:7], s38 offen offset:1024 sc1
v_accvgpr_read_b32 v96, a132
v_accvgpr_read_b32 v97, a133
v_accvgpr_read_b32 v98, a134
v_accvgpr_read_b32 v99, a135
v_accvgpr_read_b32 v100, a164
v_accvgpr_read_b32 v101, a165
v_accvgpr_read_b32 v102, a166
v_accvgpr_read_b32 v103, a167
v_cvt_pk_bf16_f32 v104, v96, v97
v_cvt_pk_bf16_f32 v105, v98, v99
v_cvt_pk_bf16_f32 v106, v100, v101
v_cvt_pk_bf16_f32 v107, v102, v103
buffer_store_dwordx4 v[104:107], v61, s[4:7], s38 offen offset:2048 sc1
v_accvgpr_read_b32 v112, a196
v_accvgpr_read_b32 v113, a197
v_accvgpr_read_b32 v114, a198
v_accvgpr_read_b32 v115, a199
v_accvgpr_read_b32 v116, a228
v_accvgpr_read_b32 v117, a229
v_accvgpr_read_b32 v118, a230
v_accvgpr_read_b32 v119, a231
v_cvt_pk_bf16_f32 v120, v112, v113
v_cvt_pk_bf16_f32 v121, v114, v115
v_cvt_pk_bf16_f32 v122, v116, v117
v_cvt_pk_bf16_f32 v123, v118, v119
buffer_store_dwordx4 v[120:123], v61, s[4:7], s38 offen offset:3072 sc1
s_add_u32 s38, s36, 262144
v_accvgpr_read_b32 v64, a8
v_accvgpr_read_b32 v65, a9
v_accvgpr_read_b32 v66, a10
v_accvgpr_read_b32 v67, a11
v_accvgpr_read_b32 v68, a40
v_accvgpr_read_b32 v69, a41
v_accvgpr_read_b32 v70, a42
v_accvgpr_read_b32 v71, a43
v_cvt_pk_bf16_f32 v72, v64, v65
v_cvt_pk_bf16_f32 v73, v66, v67
v_cvt_pk_bf16_f32 v74, v68, v69
v_cvt_pk_bf16_f32 v75, v70, v71
buffer_store_dwordx4 v[72:75], v61, s[4:7], s38 offen offset:0 sc1
v_accvgpr_read_b32 v80, a72
v_accvgpr_read_b32 v81, a73
v_accvgpr_read_b32 v82, a74
v_accvgpr_read_b32 v83, a75
v_accvgpr_read_b32 v84, a104
v_accvgpr_read_b32 v85, a105
v_accvgpr_read_b32 v86, a106
v_accvgpr_read_b32 v87, a107
v_cvt_pk_bf16_f32 v88, v80, v81
v_cvt_pk_bf16_f32 v89, v82, v83
v_cvt_pk_bf16_f32 v90, v84, v85
v_cvt_pk_bf16_f32 v91, v86, v87
buffer_store_dwordx4 v[88:91], v61, s[4:7], s38 offen offset:1024 sc1
v_accvgpr_read_b32 v96, a136
v_accvgpr_read_b32 v97, a137
v_accvgpr_read_b32 v98, a138
v_accvgpr_read_b32 v99, a139
v_accvgpr_read_b32 v100, a168
v_accvgpr_read_b32 v101, a169
v_accvgpr_read_b32 v102, a170
v_accvgpr_read_b32 v103, a171
v_cvt_pk_bf16_f32 v104, v96, v97
v_cvt_pk_bf16_f32 v105, v98, v99
v_cvt_pk_bf16_f32 v106, v100, v101
v_cvt_pk_bf16_f32 v107, v102, v103
buffer_store_dwordx4 v[104:107], v61, s[4:7], s38 offen offset:2048 sc1
v_accvgpr_read_b32 v112, a200
v_accvgpr_read_b32 v113, a201
v_accvgpr_read_b32 v114, a202
v_accvgpr_read_b32 v115, a203
v_accvgpr_read_b32 v116, a232
v_accvgpr_read_b32 v117, a233
v_accvgpr_read_b32 v118, a234
v_accvgpr_read_b32 v119, a235
v_cvt_pk_bf16_f32 v120, v112, v113
v_cvt_pk_bf16_f32 v121, v114, v115
v_cvt_pk_bf16_f32 v122, v116, v117
v_cvt_pk_bf16_f32 v123, v118, v119
buffer_store_dwordx4 v[120:123], v61, s[4:7], s38 offen offset:3072 sc1
s_add_u32 s38, s36, 266240
v_accvgpr_read_b32 v64, a12
v_accvgpr_read_b32 v65, a13
v_accvgpr_read_b32 v66, a14
v_accvgpr_read_b32 v67, a15
v_accvgpr_read_b32 v68, a44
v_accvgpr_read_b32 v69, a45
v_accvgpr_read_b32 v70, a46
v_accvgpr_read_b32 v71, a47
v_cvt_pk_bf16_f32 v72, v64, v65
v_cvt_pk_bf16_f32 v73, v66, v67
v_cvt_pk_bf16_f32 v74, v68, v69
v_cvt_pk_bf16_f32 v75, v70, v71
buffer_store_dwordx4 v[72:75], v61, s[4:7], s38 offen offset:0 sc1
v_accvgpr_read_b32 v80, a76
v_accvgpr_read_b32 v81, a77
v_accvgpr_read_b32 v82, a78
v_accvgpr_read_b32 v83, a79
v_accvgpr_read_b32 v84, a108
v_accvgpr_read_b32 v85, a109
v_accvgpr_read_b32 v86, a110
v_accvgpr_read_b32 v87, a111
v_cvt_pk_bf16_f32 v88, v80, v81
v_cvt_pk_bf16_f32 v89, v82, v83
v_cvt_pk_bf16_f32 v90, v84, v85
v_cvt_pk_bf16_f32 v91, v86, v87
buffer_store_dwordx4 v[88:91], v61, s[4:7], s38 offen offset:1024 sc1
v_accvgpr_read_b32 v96, a140
v_accvgpr_read_b32 v97, a141
v_accvgpr_read_b32 v98, a142
v_accvgpr_read_b32 v99, a143
v_accvgpr_read_b32 v100, a172
v_accvgpr_read_b32 v101, a173
v_accvgpr_read_b32 v102, a174
v_accvgpr_read_b32 v103, a175
v_cvt_pk_bf16_f32 v104, v96, v97
v_cvt_pk_bf16_f32 v105, v98, v99
v_cvt_pk_bf16_f32 v106, v100, v101
v_cvt_pk_bf16_f32 v107, v102, v103
buffer_store_dwordx4 v[104:107], v61, s[4:7], s38 offen offset:2048 sc1
v_accvgpr_read_b32 v112, a204
v_accvgpr_read_b32 v113, a205
v_accvgpr_read_b32 v114, a206
v_accvgpr_read_b32 v115, a207
v_accvgpr_read_b32 v116, a236
v_accvgpr_read_b32 v117, a237
v_accvgpr_read_b32 v118, a238
v_accvgpr_read_b32 v119, a239
v_cvt_pk_bf16_f32 v120, v112, v113
v_cvt_pk_bf16_f32 v121, v114, v115
v_cvt_pk_bf16_f32 v122, v116, v117
v_cvt_pk_bf16_f32 v123, v118, v119
buffer_store_dwordx4 v[120:123], v61, s[4:7], s38 offen offset:3072 sc1
s_cmp_eq_u32 s28, 2
s_cselect_b32 s39, s34, 1
s_cmp_lg_u32 s39, 0
s_cbranch_scc1 HB_45
s_waitcnt vmcnt(0)
s_barrier
s_cmp_lg_u32 s24, 0
s_cbranch_scc1 HB_45
s_lshl_b32 s39, s29, 7
s_add_u32 s39, s39, 119578624
v_mov_b32 v16, 1
v_mov_b32 v17, 0
s_mov_b64 exec, 1
buffer_store_dword v16, v17, s[4:7], s39 offen sc1
s_mov_b64 exec, -1
HB_45:
s_add_u32 s38, s36, 524288
v_accvgpr_read_b32 v64, a16
v_accvgpr_read_b32 v65, a17
v_accvgpr_read_b32 v66, a18
v_accvgpr_read_b32 v67, a19
v_accvgpr_read_b32 v68, a48
v_accvgpr_read_b32 v69, a49
v_accvgpr_read_b32 v70, a50
v_accvgpr_read_b32 v71, a51
v_cvt_pk_bf16_f32 v72, v64, v65
v_cvt_pk_bf16_f32 v73, v66, v67
v_cvt_pk_bf16_f32 v74, v68, v69
v_cvt_pk_bf16_f32 v75, v70, v71
buffer_store_dwordx4 v[72:75], v61, s[4:7], s38 offen offset:0 sc1
v_accvgpr_read_b32 v80, a80
v_accvgpr_read_b32 v81, a81
v_accvgpr_read_b32 v82, a82
v_accvgpr_read_b32 v83, a83
v_accvgpr_read_b32 v84, a112
v_accvgpr_read_b32 v85, a113
v_accvgpr_read_b32 v86, a114
v_accvgpr_read_b32 v87, a115
v_cvt_pk_bf16_f32 v88, v80, v81
v_cvt_pk_bf16_f32 v89, v82, v83
v_cvt_pk_bf16_f32 v90, v84, v85
v_cvt_pk_bf16_f32 v91, v86, v87
buffer_store_dwordx4 v[88:91], v61, s[4:7], s38 offen offset:1024 sc1
v_accvgpr_read_b32 v96, a144
v_accvgpr_read_b32 v97, a145
v_accvgpr_read_b32 v98, a146
v_accvgpr_read_b32 v99, a147
v_accvgpr_read_b32 v100, a176
v_accvgpr_read_b32 v101, a177
v_accvgpr_read_b32 v102, a178
v_accvgpr_read_b32 v103, a179
v_cvt_pk_bf16_f32 v104, v96, v97
v_cvt_pk_bf16_f32 v105, v98, v99
v_cvt_pk_bf16_f32 v106, v100, v101
v_cvt_pk_bf16_f32 v107, v102, v103
buffer_store_dwordx4 v[104:107], v61, s[4:7], s38 offen offset:2048 sc1
v_accvgpr_read_b32 v112, a208
v_accvgpr_read_b32 v113, a209
v_accvgpr_read_b32 v114, a210
v_accvgpr_read_b32 v115, a211
v_accvgpr_read_b32 v116, a240
v_accvgpr_read_b32 v117, a241
v_accvgpr_read_b32 v118, a242
v_accvgpr_read_b32 v119, a243
v_cvt_pk_bf16_f32 v120, v112, v113
v_cvt_pk_bf16_f32 v121, v114, v115
v_cvt_pk_bf16_f32 v122, v116, v117
v_cvt_pk_bf16_f32 v123, v118, v119
buffer_store_dwordx4 v[120:123], v61, s[4:7], s38 offen offset:3072 sc1
s_add_u32 s38, s36, 528384
v_accvgpr_read_b32 v64, a20
v_accvgpr_read_b32 v65, a21
v_accvgpr_read_b32 v66, a22
v_accvgpr_read_b32 v67, a23
v_accvgpr_read_b32 v68, a52
v_accvgpr_read_b32 v69, a53
v_accvgpr_read_b32 v70, a54
v_accvgpr_read_b32 v71, a55
v_cvt_pk_bf16_f32 v72, v64, v65
v_cvt_pk_bf16_f32 v73, v66, v67
v_cvt_pk_bf16_f32 v74, v68, v69
v_cvt_pk_bf16_f32 v75, v70, v71
buffer_store_dwordx4 v[72:75], v61, s[4:7], s38 offen offset:0 sc1
v_accvgpr_read_b32 v80, a84
v_accvgpr_read_b32 v81, a85
v_accvgpr_read_b32 v82, a86
v_accvgpr_read_b32 v83, a87
v_accvgpr_read_b32 v84, a116
v_accvgpr_read_b32 v85, a117
v_accvgpr_read_b32 v86, a118
v_accvgpr_read_b32 v87, a119
v_cvt_pk_bf16_f32 v88, v80, v81
v_cvt_pk_bf16_f32 v89, v82, v83
v_cvt_pk_bf16_f32 v90, v84, v85
v_cvt_pk_bf16_f32 v91, v86, v87
buffer_store_dwordx4 v[88:91], v61, s[4:7], s38 offen offset:1024 sc1
v_accvgpr_read_b32 v96, a148
v_accvgpr_read_b32 v97, a149
v_accvgpr_read_b32 v98, a150
v_accvgpr_read_b32 v99, a151
v_accvgpr_read_b32 v100, a180
v_accvgpr_read_b32 v101, a181
v_accvgpr_read_b32 v102, a182
v_accvgpr_read_b32 v103, a183
v_cvt_pk_bf16_f32 v104, v96, v97
v_cvt_pk_bf16_f32 v105, v98, v99
v_cvt_pk_bf16_f32 v106, v100, v101
v_cvt_pk_bf16_f32 v107, v102, v103
buffer_store_dwordx4 v[104:107], v61, s[4:7], s38 offen offset:2048 sc1
v_accvgpr_read_b32 v112, a212
v_accvgpr_read_b32 v113, a213
v_accvgpr_read_b32 v114, a214
v_accvgpr_read_b32 v115, a215
v_accvgpr_read_b32 v116, a244
v_accvgpr_read_b32 v117, a245
v_accvgpr_read_b32 v118, a246
v_accvgpr_read_b32 v119, a247
v_cvt_pk_bf16_f32 v120, v112, v113
v_cvt_pk_bf16_f32 v121, v114, v115
v_cvt_pk_bf16_f32 v122, v116, v117
v_cvt_pk_bf16_f32 v123, v118, v119
buffer_store_dwordx4 v[120:123], v61, s[4:7], s38 offen offset:3072 sc1
s_add_u32 s38, s36, 786432
v_accvgpr_read_b32 v64, a24
v_accvgpr_read_b32 v65, a25
v_accvgpr_read_b32 v66, a26
v_accvgpr_read_b32 v67, a27
v_accvgpr_read_b32 v68, a56
v_accvgpr_read_b32 v69, a57
v_accvgpr_read_b32 v70, a58
v_accvgpr_read_b32 v71, a59
v_cvt_pk_bf16_f32 v72, v64, v65
v_cvt_pk_bf16_f32 v73, v66, v67
v_cvt_pk_bf16_f32 v74, v68, v69
v_cvt_pk_bf16_f32 v75, v70, v71
buffer_store_dwordx4 v[72:75], v61, s[4:7], s38 offen offset:0 sc1
v_accvgpr_read_b32 v80, a88
v_accvgpr_read_b32 v81, a89
v_accvgpr_read_b32 v82, a90
v_accvgpr_read_b32 v83, a91
v_accvgpr_read_b32 v84, a120
v_accvgpr_read_b32 v85, a121
v_accvgpr_read_b32 v86, a122
v_accvgpr_read_b32 v87, a123
v_cvt_pk_bf16_f32 v88, v80, v81
v_cvt_pk_bf16_f32 v89, v82, v83
v_cvt_pk_bf16_f32 v90, v84, v85
v_cvt_pk_bf16_f32 v91, v86, v87
buffer_store_dwordx4 v[88:91], v61, s[4:7], s38 offen offset:1024 sc1
v_accvgpr_read_b32 v96, a152
v_accvgpr_read_b32 v97, a153
v_accvgpr_read_b32 v98, a154
v_accvgpr_read_b32 v99, a155
v_accvgpr_read_b32 v100, a184
v_accvgpr_read_b32 v101, a185
v_accvgpr_read_b32 v102, a186
v_accvgpr_read_b32 v103, a187
v_cvt_pk_bf16_f32 v104, v96, v97
v_cvt_pk_bf16_f32 v105, v98, v99
v_cvt_pk_bf16_f32 v106, v100, v101
v_cvt_pk_bf16_f32 v107, v102, v103
buffer_store_dwordx4 v[104:107], v61, s[4:7], s38 offen offset:2048 sc1
v_accvgpr_read_b32 v112, a216
v_accvgpr_read_b32 v113, a217
v_accvgpr_read_b32 v114, a218
v_accvgpr_read_b32 v115, a219
v_accvgpr_read_b32 v116, a248
v_accvgpr_read_b32 v117, a249
v_accvgpr_read_b32 v118, a250
v_accvgpr_read_b32 v119, a251
v_cvt_pk_bf16_f32 v120, v112, v113
v_cvt_pk_bf16_f32 v121, v114, v115
v_cvt_pk_bf16_f32 v122, v116, v117
v_cvt_pk_bf16_f32 v123, v118, v119
buffer_store_dwordx4 v[120:123], v61, s[4:7], s38 offen offset:3072 sc1
s_add_u32 s38, s36, 790528
v_accvgpr_read_b32 v64, a28
v_accvgpr_read_b32 v65, a29
v_accvgpr_read_b32 v66, a30
v_accvgpr_read_b32 v67, a31
v_accvgpr_read_b32 v68, a60
v_accvgpr_read_b32 v69, a61
v_accvgpr_read_b32 v70, a62
v_accvgpr_read_b32 v71, a63
v_cvt_pk_bf16_f32 v72, v64, v65
v_cvt_pk_bf16_f32 v73, v66, v67
v_cvt_pk_bf16_f32 v74, v68, v69
v_cvt_pk_bf16_f32 v75, v70, v71
buffer_store_dwordx4 v[72:75], v61, s[4:7], s38 offen offset:0 sc1
v_accvgpr_read_b32 v80, a92
v_accvgpr_read_b32 v81, a93
v_accvgpr_read_b32 v82, a94
v_accvgpr_read_b32 v83, a95
v_accvgpr_read_b32 v84, a124
v_accvgpr_read_b32 v85, a125
v_accvgpr_read_b32 v86, a126
v_accvgpr_read_b32 v87, a127
v_cvt_pk_bf16_f32 v88, v80, v81
v_cvt_pk_bf16_f32 v89, v82, v83
v_cvt_pk_bf16_f32 v90, v84, v85
v_cvt_pk_bf16_f32 v91, v86, v87
buffer_store_dwordx4 v[88:91], v61, s[4:7], s38 offen offset:1024 sc1
v_accvgpr_read_b32 v96, a156
v_accvgpr_read_b32 v97, a157
v_accvgpr_read_b32 v98, a158
v_accvgpr_read_b32 v99, a159
v_accvgpr_read_b32 v100, a188
v_accvgpr_read_b32 v101, a189
v_accvgpr_read_b32 v102, a190
v_accvgpr_read_b32 v103, a191
v_cvt_pk_bf16_f32 v104, v96, v97
v_cvt_pk_bf16_f32 v105, v98, v99
v_cvt_pk_bf16_f32 v106, v100, v101
v_cvt_pk_bf16_f32 v107, v102, v103
buffer_store_dwordx4 v[104:107], v61, s[4:7], s38 offen offset:2048 sc1
v_accvgpr_read_b32 v112, a220
v_accvgpr_read_b32 v113, a221
v_accvgpr_read_b32 v114, a222
v_accvgpr_read_b32 v115, a223
v_accvgpr_read_b32 v116, a252
v_accvgpr_read_b32 v117, a253
v_accvgpr_read_b32 v118, a254
v_accvgpr_read_b32 v119, a255
v_cvt_pk_bf16_f32 v120, v112, v113
v_cvt_pk_bf16_f32 v121, v114, v115
v_cvt_pk_bf16_f32 v122, v116, v117
v_cvt_pk_bf16_f32 v123, v118, v119
buffer_store_dwordx4 v[120:123], v61, s[4:7], s38 offen offset:3072 sc1
s_lshl_b32 s36, s28, 11
s_lshl_b32 s37, s29, 7
s_add_u32 s36, s36, s37
s_add_u32 s36, s36, 119578624
v_lshlrev_b32 v7, 7, v1
s_mov_b32 s46, 119545856
s_mov_b32 s47, 119554048
s_cmp_lg_u32 s24, 0
s_cbranch_scc1 TI_46
s_lshl_b32 s26, s20, 8
s_add_u32 s26, s26, 119537664
v_mov_b32 v2, 1
v_mov_b32 v3, 0
buffer_load_dword v5, v7, s[4:7], s46 offen sc1
buffer_load_dword v6, v7, s[4:7], s47 offen sc1
s_mov_b64 exec, 1
buffer_atomic_add v2, v3, s[4:7], s26 offen sc0 sc1
s_mov_b64 exec, -1
TI_46:
v_mov_b32 v4, 163808
s_waitcnt vmcnt(0)
s_cmp_lg_u32 s24, 0
s_cbranch_scc1 TP_47
s_mov_b32 s44, 0
TPL_48:
v_and_b32 v5, v5, v6
v_cmp_eq_u32 vcc, 0, v5
s_cbranch_vccz TPK_49
buffer_load_dword v5, v7, s[4:7], s46 offen sc1
buffer_load_dword v6, v7, s[4:7], s47 offen sc1
s_add_u32 s44, s44, 1
s_waitcnt vmcnt(0)
s_cmp_lt_u32 s44, 40000
s_cbranch_scc1 TPL_48
TPK_49:
s_mov_b64 exec, 1
ds_write_b32 v4, v2
s_mov_b64 exec, -1
s_waitcnt lgkmcnt(0)
TP_47:
s_barrier
ds_read_b32 v2, v4
s_cmp_lg_u32 s24, 0
s_cbranch_scc1 W_TICKET
v_mov_b32 v16, 1
v_mov_b32 v17, 0
s_mov_b64 exec, 1
buffer_store_dword v16, v17, s[4:7], s36 offen sc1
s_mov_b64 exec, -1
s_branch W_TICKET
T_V:
s_load_dwordx2 s[8:9], s[0:1], 32
s_mov_b32 s10, 8388608
s_mov_b32 s11, 0x20000
s_lshl_b32 s30, s29, 9
s_mul_i32 s31, s28, 524288
s_add_u32 s31, s31, 0
s_lshl_b32 s32, s24, 12
s_add_u32 s33, s32, 65536
s_lshr_b32 s34, s24, 1
s_and_b32 s35, s24, 1
v_lshrrev_b32 v16, 5, v1
v_and_b32 v17, 31, v1
v_lshlrev_b32 v18, 1, v16
v_xor_b32 v17, v17, v18
s_lshl_b32 s36, s24, 3
v_add_u32 v16, s36, v16
s_mov_b32 s36, 8192
v_mul_lo_u32 v16, v16, s36
v_xor_b32 v18, 0, v17
v_lshl_add_u32 v18, v18, 4, v16
v_add_u32 v11, 0, v18
v_xor_b32 v18, 4, v17
v_lshl_add_u32 v18, v18, 4, v16
v_add_u32 v12, 15360, v18
v_xor_b32 v18, 8, v17
v_lshl_add_u32 v18, v18, 4, v16
v_add_u32 v13, 30720, v18
v_xor_b32 v18, 12, v17
v_lshl_add_u32 v18, v18, 4, v16
v_add_u32 v14, 46080, v18
v_lshlrev_b32 v61, 4, v1
v_add_u32 v15, s32, v61
s_lshl_b32 s36, s34, 13
s_add_u32 s36, s36, 65536
v_add_u32 v10, s36, v61
v_lshrrev_b32 v16, 2, v1
v_and_b32 v17, 7, v16
v_lshlrev_b32 v17, 1, v17
v_lshlrev_b32 v16, 9, v16
v_and_b32 v18, 3, v1
v_lshl_add_u32 v16, v18, 3, v16
s_lshl_b32 s36, s35, 8
v_add_u32 v16, s36, v16
v_xor_b32 v18, 0, v17
v_lshl_add_u32 v2, v18, 4, v16
v_xor_b32 v18, 2, v17
v_lshl_add_u32 v3, v18, 4, v16
v_xor_b32 v18, 4, v17
v_lshl_add_u32 v4, v18, 4, v16
v_xor_b32 v18, 6, v17
v_lshl_add_u32 v5, v18, 4, v16
v_xor_b32 v18, 8, v17
v_lshl_add_u32 v6, v18, 4, v16
v_xor_b32 v18, 10, v17
v_lshl_add_u32 v7, v18, 4, v16
v_xor_b32 v18, 12, v17
v_lshl_add_u32 v8, v18, 4, v16
v_xor_b32 v18, 14, v17
v_lshl_add_u32 v9, v18, 4, v16
s_waitcnt lgkmcnt(0)
v_mov_b32 v16, 0
v_mov_b32 v17, 0
v_mov_b32 v18, 0
v_mov_b32 v19, 0
v_mov_b32 v20, 0
v_mov_b32 v21, 0
v_mov_b32 v22, 0
v_mov_b32 v23, 0
v_mov_b32 v24, 0
v_mov_b32 v25, 0
v_mov_b32 v26, 0
v_mov_b32 v27, 0
v_mov_b32 v28, 0
v_mov_b32 v29, 0
v_mov_b32 v30, 0
v_mov_b32 v31, 0
v_mov_b32 v32, 0
v_mov_b32 v33, 0
v_mov_b32 v34, 0
v_mov_b32 v35, 0
v_mov_b32 v36, 0
v_mov_b32 v37, 0
v_mov_b32 v38, 0
v_mov_b32 v39, 0
v_mov_b32 v40, 0
v_mov_b32 v41, 0
v_mov_b32 v42, 0
v_mov_b32 v43, 0
v_mov_b32 v44, 0
v_mov_b32 v45, 0
v_mov_b32 v46, 0
v_mov_b32 v47, 0
v_mov_b32 v48, 0
v_mov_b32 v49, 0
v_mov_b32 v50, 0
v_mov_b32 v51, 0
v_mov_b32 v52, 0
v_mov_b32 v53, 0
v_mov_b32 v54, 0
v_mov_b32 v55, 0
s_add_u32 m0, s32, 0
s_nop 0
buffer_load_dwordx4 v11, s[8:11], s30 offen offset:0 lds
buffer_load_dwordx4 v12, s[8:11], s30 offen offset:1024 lds
buffer_load_dwordx4 v13, s[8:11], s30 offen offset:2048 lds
buffer_load_dwordx4 v14, s[8:11], s30 offen offset:3072 lds
s_add_u32 m0, s33, 0
s_nop 0
buffer_load_dwordx4 v15, s[4:7], s31 offen offset:0 sc1 lds
buffer_load_dwordx4 v15, s[4:7], s31 offen offset:1024 sc1 lds
buffer_load_dwordx4 v15, s[4:7], s31 offen offset:2048 sc1 lds
buffer_load_dwordx4 v15, s[4:7], s31 offen offset:3072 sc1 lds
s_add_u32 s30, s30, 262144
s_add_u32 s31, s31, 16384
s_add_u32 m0, s32, 16384
s_nop 0
buffer_load_dwordx4 v11, s[8:11], s30 offen offset:0 lds
buffer_load_dwordx4 v12, s[8:11], s30 offen offset:1024 lds
buffer_load_dwordx4 v13, s[8:11], s30 offen offset:2048 lds
buffer_load_dwordx4 v14, s[8:11], s30 offen offset:3072 lds
s_add_u32 m0, s33, 16384
s_nop 0
buffer_load_dwordx4 v15, s[4:7], s31 offen offset:0 sc1 lds
buffer_load_dwordx4 v15, s[4:7], s31 offen offset:1024 sc1 lds
buffer_load_dwordx4 v15, s[4:7], s31 offen offset:2048 sc1 lds
buffer_load_dwordx4 v15, s[4:7], s31 offen offset:3072 sc1 lds
s_add_u32 s30, s30, 262144
s_add_u32 s31, s31, 16384
s_add_u32 m0, s32, 32768
s_nop 0
buffer_load_dwordx4 v11, s[8:11], s30 offen offset:0 lds
buffer_load_dwordx4 v12, s[8:11], s30 offen offset:1024 lds
buffer_load_dwordx4 v13, s[8:11], s30 offen offset:2048 lds
buffer_load_dwordx4 v14, s[8:11], s30 offen offset:3072 lds
s_add_u32 m0, s33, 32768
s_nop 0
buffer_load_dwordx4 v15, s[4:7], s31 offen offset:0 sc1 lds
buffer_load_dwordx4 v15, s[4:7], s31 offen offset:1024 sc1 lds
buffer_load_dwordx4 v15, s[4:7], s31 offen offset:2048 sc1 lds
buffer_load_dwordx4 v15, s[4:7], s31 offen offset:3072 sc1 lds
s_add_u32 s30, s30, 262144
s_add_u32 s31, s31, 16384
v_mfma_f32_16x16x32_bf16 a[0:3], v[16:19], v[48:51], 0
v_mfma_f32_16x16x32_bf16 a[4:7], v[16:19], v[48:51], 0
v_mfma_f32_16x16x32_bf16 a[8:11], v[16:19], v[48:51], 0
v_mfma_f32_16x16x32_bf16 a[12:15], v[16:19], v[48:51], 0
v_mfma_f32_16x16x32_bf16 a[16:19], v[16:19], v[48:51], 0
v_mfma_f32_16x16x32_bf16 a[20:23], v[16:19], v[48:51], 0
v_mfma_f32_16x16x32_bf16 a[24:27], v[16:19], v[48:51], 0
v_mfma_f32_16x16x32_bf16 a[28:31], v[16:19], v[48:51], 0
v_mfma_f32_16x16x32_bf16 a[32:35], v[20:23], v[48:51], 0
v_mfma_f32_16x16x32_bf16 a[36:39], v[20:23], v[48:51], 0
v_mfma_f32_16x16x32_bf16 a[40:43], v[20:23], v[48:51], 0
v_mfma_f32_16x16x32_bf16 a[44:47], v[20:23], v[48:51], 0
v_mfma_f32_16x16x32_bf16 a[48:51], v[20:23], v[48:51], 0
v_mfma_f32_16x16x32_bf16 a[52:55], v[20:23], v[48:51], 0
v_mfma_f32_16x16x32_bf16 a[56:59], v[20:23], v[48:51], 0
v_mfma_f32_16x16x32_bf16 a[60:63], v[20:23], v[48:51], 0
v_mfma_f32_16x16x32_bf16 a[64:67], v[24:27], v[48:51], 0
v_mfma_f32_16x16x32_bf16 a[68:71], v[24:27], v[48:51], 0
v_mfma_f32_16x16x32_bf16 a[72:75], v[24:27], v[48:51], 0
v_mfma_f32_16x16x32_bf16 a[76:79], v[24:27], v[48:51], 0
v_mfma_f32_16x16x32_bf16 a[80:83], v[24:27], v[48:51], 0
v_mfma_f32_16x16x32_bf16 a[84:87], v[24:27], v[48:51], 0
v_mfma_f32_16x16x32_bf16 a[88:91], v[24:27], v[48:51], 0
v_mfma_f32_16x16x32_bf16 a[92:95], v[24:27], v[48:51], 0
v_mfma_f32_16x16x32_bf16 a[96:99], v[28:31], v[48:51], 0
v_mfma_f32_16x16x32_bf16 a[100:103], v[28:31], v[48:51], 0
v_mfma_f32_16x16x32_bf16 a[104:107], v[28:31], v[48:51], 0
v_mfma_f32_16x16x32_bf16 a[108:111], v[28:31], v[48:51], 0
v_mfma_f32_16x16x32_bf16 a[112:115], v[28:31], v[48:51], 0
v_mfma_f32_16x16x32_bf16 a[116:119], v[28:31], v[48:51], 0
v_mfma_f32_16x16x32_bf16 a[120:123], v[28:31], v[48:51], 0
v_mfma_f32_16x16x32_bf16 a[124:127], v[28:31], v[48:51], 0
v_mfma_f32_16x16x32_bf16 a[128:131], v[32:35], v[48:51], 0
v_mfma_f32_16x16x32_bf16 a[132:135], v[32:35], v[48:51], 0
v_mfma_f32_16x16x32_bf16 a[136:139], v[32:35], v[48:51], 0
v_mfma_f32_16x16x32_bf16 a[140:143], v[32:35], v[48:51], 0
v_mfma_f32_16x16x32_bf16 a[144:147], v[32:35], v[48:51], 0
v_mfma_f32_16x16x32_bf16 a[148:151], v[32:35], v[48:51], 0
v_mfma_f32_16x16x32_bf16 a[152:155], v[32:35], v[48:51], 0
v_mfma_f32_16x16x32_bf16 a[156:159], v[32:35], v[48:51], 0
v_mfma_f32_16x16x32_bf16 a[160:163], v[36:39], v[48:51], 0
v_mfma_f32_16x16x32_bf16 a[164:167], v[36:39], v[48:51], 0
v_mfma_f32_16x16x32_bf16 a[168:171], v[36:39], v[48:51], 0
v_mfma_f32_16x16x32_bf16 a[172:175], v[36:39], v[48:51], 0
v_mfma_f32_16x16x32_bf16 a[176:179], v[36:39], v[48:51], 0
v_mfma_f32_16x16x32_bf16 a[180:183], v[36:39], v[48:51], 0
v_mfma_f32_16x16x32_bf16 a[184:187], v[36:39], v[48:51], 0
v_mfma_f32_16x16x32_bf16 a[188:191], v[36:39], v[48:51], 0
v_mfma_f32_16x16x32_bf16 a[192:195], v[40:43], v[48:51], 0
v_mfma_f32_16x16x32_bf16 a[196:199], v[40:43], v[48:51], 0
v_mfma_f32_16x16x32_bf16 a[200:203], v[40:43], v[48:51], 0
v_mfma_f32_16x16x32_bf16 a[204:207], v[40:43], v[48:51], 0
v_mfma_f32_16x16x32_bf16 a[208:211], v[40:43], v[48:51], 0
v_mfma_f32_16x16x32_bf16 a[212:215], v[40:43], v[48:51], 0
v_mfma_f32_16x16x32_bf16 a[216:219], v[40:43], v[48:51], 0
v_mfma_f32_16x16x32_bf16 a[220:223], v[40:43], v[48:51], 0
v_mfma_f32_16x16x32_bf16 a[224:227], v[44:47], v[48:51], 0
v_mfma_f32_16x16x32_bf16 a[228:231], v[44:47], v[48:51], 0
v_mfma_f32_16x16x32_bf16 a[232:235], v[44:47], v[48:51], 0
v_mfma_f32_16x16x32_bf16 a[236:239], v[44:47], v[48:51], 0
v_mfma_f32_16x16x32_bf16 a[240:243], v[44:47], v[48:51], 0
v_mfma_f32_16x16x32_bf16 a[244:247], v[44:47], v[48:51], 0
v_mfma_f32_16x16x32_bf16 a[248:251], v[44:47], v[48:51], 0
v_mfma_f32_16x16x32_bf16 a[252:255], v[44:47], v[48:51], 0
s_waitcnt vmcnt(16)
s_barrier
ds_read_b128 v[96:99], v10 offset:0
ds_read_b128 v[100:103], v10 offset:1024
ds_read_b128 v[104:107], v10 offset:2048
ds_read_b128 v[108:111], v10 offset:3072
ds_read_b128 v[112:115], v10 offset:4096
ds_read_b128 v[116:119], v10 offset:5120
ds_read_b128 v[120:123], v10 offset:6144
ds_read_b128 v[124:127], v10 offset:7168
ds_read_b64_tr_b16 v[64:65], v2 offset:0
ds_read_b64_tr_b16 v[66:67], v2 offset:8192
ds_read_b64_tr_b16 v[68:69], v3 offset:0
ds_read_b64_tr_b16 v[70:71], v3 offset:8192
ds_read_b64_tr_b16 v[72:73], v4 offset:0
ds_read_b64_tr_b16 v[74:75], v4 offset:8192
ds_read_b64_tr_b16 v[76:77], v5 offset:0
ds_read_b64_tr_b16 v[78:79], v5 offset:8192
ds_read_b64_tr_b16 v[80:81], v6 offset:0
ds_read_b64_tr_b16 v[82:83], v6 offset:8192
ds_read_b64_tr_b16 v[84:85], v7 offset:0
ds_read_b64_tr_b16 v[86:87], v7 offset:8192
ds_read_b64_tr_b16 v[88:89], v8 offset:0
ds_read_b64_tr_b16 v[90:91], v8 offset:8192
ds_read_b64_tr_b16 v[92:93], v9 offset:0
ds_read_b64_tr_b16 v[94:95], v9 offset:8192
s_mov_b32 s37, 7
GL_50:
s_waitcnt lgkmcnt(0)
v_mfma_f32_16x16x32_bf16 a[0:3], v[96:99], v[64:67], a[0:3]
v_mfma_f32_16x16x32_bf16 a[4:7], v[100:103], v[64:67], a[4:7]
s_waitcnt vmcnt(8)
s_barrier
v_mfma_f32_16x16x32_bf16 a[8:11], v[104:107], v[64:67], a[8:11]
ds_read_b128 v[160:163], v10 offset:16384
v_mfma_f32_16x16x32_bf16 a[12:15], v[108:111], v[64:67], a[12:15]
ds_read_b128 v[164:167], v10 offset:17408
v_mfma_f32_16x16x32_bf16 a[16:19], v[112:115], v[64:67], a[16:19]
ds_read_b128 v[168:171], v10 offset:18432
v_mfma_f32_16x16x32_bf16 a[20:23], v[116:119], v[64:67], a[20:23]
ds_read_b128 v[172:175], v10 offset:19456
v_mfma_f32_16x16x32_bf16 a[24:27], v[120:123], v[64:67], a[24:27]
ds_read_b128 v[176:179], v10 offset:20480
v_mfma_f32_16x16x32_bf16 a[28:31], v[124:127], v[64:67], a[28:31]
ds_read_b128 v[180:183], v10 offset:21504
v_mfma_f32_16x16x32_bf16 a[32:35], v[96:99], v[68:71], a[32:35]
ds_read_b128 v[184:187], v10 offset:22528
v_mfma_f32_16x16x32_bf16 a[36:39], v[100:103], v[68:71], a[36:39]
ds_read_b128 v[188:191], v10 offset:23552
v_mfma_f32_16x16x32_bf16 a[40:43], v[104:107], v[68:71], a[40:43]
ds_read_b64_tr_b16 v[128:129], v2 offset:16384
v_mfma_f32_16x16x32_bf16 a[44:47], v[108:111], v[68:71], a[44:47]
ds_read_b64_tr_b16 v[130:131], v2 offset:24576
v_mfma_f32_16x16x32_bf16 a[48:51], v[112:115], v[68:71], a[48:51]
ds_read_b64_tr_b16 v[132:133], v3 offset:16384
v_mfma_f32_16x16x32_bf16 a[52:55], v[116:119], v[68:71], a[52:55]
ds_read_b64_tr_b16 v[134:135], v3 offset:24576
v_mfma_f32_16x16x32_bf16 a[56:59], v[120:123], v[68:71], a[56:59]
ds_read_b64_tr_b16 v[136:137], v4 offset:16384
v_mfma_f32_16x16x32_bf16 a[60:63], v[124:127], v[68:71], a[60:63]
ds_read_b64_tr_b16 v[138:139], v4 offset:24576
v_mfma_f32_16x16x32_bf16 a[64:67], v[96:99], v[72:75], a[64:67]
ds_read_b64_tr_b16 v[140:141], v5 offset:16384
v_mfma_f32_16x16x32_bf16 a[68:71], v[100:103], v[72:75], a[68:71]
ds_read_b64_tr_b16 v[142:143], v5 offset:24576
v_mfma_f32_16x16x32_bf16 a[72:75], v[104:107], v[72:75], a[72:75]
ds_read_b64_tr_b16 v[144:145], v6 offset:16384
v_mfma_f32_16x16x32_bf16 a[76:79], v[108:111], v[72:75], a[76:79]
ds_read_b64_tr_b16 v[146:147], v6 offset:24576
v_mfma_f32_16x16x32_bf16 a[80:83], v[112:115], v[72:75], a[80:83]
ds_read_b64_tr_b16 v[148:149], v7 offset:16384
v_mfma_f32_16x16x32_bf16 a[84:87], v[116:119], v[72:75], a[84:87]
ds_read_b64_tr_b16 v[150:151], v7 offset:24576
v_mfma_f32_16x16x32_bf16 a[88:91], v[120:123], v[72:75], a[88:91]
ds_read_b64_tr_b16 v[152:153], v8 offset:16384
v_mfma_f32_16x16x32_bf16 a[92:95], v[124:127], v[72:75], a[92:95]
ds_read_b64_tr_b16 v[154:155], v8 offset:24576
v_mfma_f32_16x16x32_bf16 a[96:99], v[96:99], v[76:79], a[96:99]
ds_read_b64_tr_b16 v[156:157], v9 offset:16384
v_mfma_f32_16x16x32_bf16 a[100:103], v[100:103], v[76:79], a[100:103]
ds_read_b64_tr_b16 v[158:159], v9 offset:24576
v_mfma_f32_16x16x32_bf16 a[104:107], v[104:107], v[76:79], a[104:107]
v_mfma_f32_16x16x32_bf16 a[108:111], v[108:111], v[76:79], a[108:111]
s_add_u32 m0, s32, 49152
v_mfma_f32_16x16x32_bf16 a[112:115], v[112:115], v[76:79], a[112:115]
buffer_load_dwordx4 v11, s[8:11], s30 offen offset:0 lds
v_mfma_f32_16x16x32_bf16 a[116:119], v[116:119], v[76:79], a[116:119]
v_mfma_f32_16x16x32_bf16 a[120:123], v[120:123], v[76:79], a[120:123]
v_mfma_f32_16x16x32_bf16 a[124:127], v[124:127], v[76:79], a[124:127]
v_mfma_f32_16x16x32_bf16 a[128:131], v[96:99], v[80:83], a[128:131]
buffer_load_dwordx4 v12, s[8:11], s30 offen offset:1024 lds
v_mfma_f32_16x16x32_bf16 a[132:135], v[100:103], v[80:83], a[132:135]
v_mfma_f32_16x16x32_bf16 a[136:139], v[104:107], v[80:83], a[136:139]
v_mfma_f32_16x16x32_bf16 a[140:143], v[108:111], v[80:83], a[140:143]
v_mfma_f32_16x16x32_bf16 a[144:147], v[112:115], v[80:83], a[144:147]
buffer_load_dwordx4 v13, s[8:11], s30 offen offset:2048 lds
v_mfma_f32_16x16x32_bf16 a[148:151], v[116:119], v[80:83], a[148:151]
v_mfma_f32_16x16x32_bf16 a[152:155], v[120:123], v[80:83], a[152:155]
v_mfma_f32_16x16x32_bf16 a[156:159], v[124:127], v[80:83], a[156:159]
v_mfma_f32_16x16x32_bf16 a[160:163], v[96:99], v[84:87], a[160:163]
buffer_load_dwordx4 v14, s[8:11], s30 offen offset:3072 lds
v_mfma_f32_16x16x32_bf16 a[164:167], v[100:103], v[84:87], a[164:167]
v_mfma_f32_16x16x32_bf16 a[168:171], v[104:107], v[84:87], a[168:171]
v_mfma_f32_16x16x32_bf16 a[172:175], v[108:111], v[84:87], a[172:175]
s_add_u32 m0, s33, 49152
v_mfma_f32_16x16x32_bf16 a[176:179], v[112:115], v[84:87], a[176:179]
buffer_load_dwordx4 v15, s[4:7], s31 offen offset:0 sc1 lds
v_mfma_f32_16x16x32_bf16 a[180:183], v[116:119], v[84:87], a[180:183]
v_mfma_f32_16x16x32_bf16 a[184:187], v[120:123], v[84:87], a[184:187]
v_mfma_f32_16x16x32_bf16 a[188:191], v[124:127], v[84:87], a[188:191]
v_mfma_f32_16x16x32_bf16 a[192:195], v[96:99], v[88:91], a[192:195]
buffer_load_dwordx4 v15, s[4:7], s31 offen offset:1024 sc1 lds
v_mfma_f32_16x16x32_bf16 a[196:199], v[100:103], v[88:91], a[196:199]
v_mfma_f32_16x16x32_bf16 a[200:203], v[104:107], v[88:91], a[200:203]
v_mfma_f32_16x16x32_bf16 a[204:207], v[108:111], v[88:91], a[204:207]
v_mfma_f32_16x16x32_bf16 a[208:211], v[112:115], v[88:91], a[208:211]
buffer_load_dwordx4 v15, s[4:7], s31 offen offset:2048 sc1 lds
v_mfma_f32_16x16x32_bf16 a[212:215], v[116:119], v[88:91], a[212:215]
v_mfma_f32_16x16x32_bf16 a[216:219], v[120:123], v[88:91], a[216:219]
v_mfma_f32_16x16x32_bf16 a[220:223], v[124:127], v[88:91], a[220:223]
v_mfma_f32_16x16x32_bf16 a[224:227], v[96:99], v[92:95], a[224:227]
buffer_load_dwordx4 v15, s[4:7], s31 offen offset:3072 sc1 lds
v_mfma_f32_16x16x32_bf16 a[228:231], v[100:103], v[92:95], a[228:231]
v_mfma_f32_16x16x32_bf16 a[232:235], v[104:107], v[92:95], a[232:235]
s_add_u32 s30, s30, 262144
v_mfma_f32_16x16x32_bf16 a[236:239], v[108:111], v[92:95], a[236:239]
s_add_u32 s31, s31, 16384
v_mfma_f32_16x16x32_bf16 a[240:243], v[112:115], v[92:95], a[240:243]
v_mfma_f32_16x16x32_bf16 a[244:247], v[116:119], v[92:95], a[244:247]
v_mfma_f32_16x16x32_bf16 a[248:251], v[120:123], v[92:95], a[248:251]
v_mfma_f32_16x16x32_bf16 a[252:255], v[124:127], v[92:95], a[252:255]
s_waitcnt lgkmcnt(0)
v_mfma_f32_16x16x32_bf16 a[0:3], v[160:163], v[128:131], a[0:3]
v_mfma_f32_16x16x32_bf16 a[4:7], v[164:167], v[128:131], a[4:7]
s_waitcnt vmcnt(8)
s_barrier
v_mfma_f32_16x16x32_bf16 a[8:11], v[168:171], v[128:131], a[8:11]
ds_read_b128 v[96:99], v10 offset:32768
v_mfma_f32_16x16x32_bf16 a[12:15], v[172:175], v[128:131], a[12:15]
ds_read_b128 v[100:103], v10 offset:33792
v_mfma_f32_16x16x32_bf16 a[16:19], v[176:179], v[128:131], a[16:19]
ds_read_b128 v[104:107], v10 offset:34816
v_mfma_f32_16x16x32_bf16 a[20:23], v[180:183], v[128:131], a[20:23]
ds_read_b128 v[108:111], v10 offset:35840
v_mfma_f32_16x16x32_bf16 a[24:27], v[184:187], v[128:131], a[24:27]
ds_read_b128 v[112:115], v10 offset:36864
v_mfma_f32_16x16x32_bf16 a[28:31], v[188:191], v[128:131], a[28:31]
ds_read_b128 v[116:119], v10 offset:37888
v_mfma_f32_16x16x32_bf16 a[32:35], v[160:163], v[132:135], a[32:35]
ds_read_b128 v[120:123], v10 offset:38912
v_mfma_f32_16x16x32_bf16 a[36:39], v[164:167], v[132:135], a[36:39]
ds_read_b128 v[124:127], v10 offset:39936
v_mfma_f32_16x16x32_bf16 a[40:43], v[168:171], v[132:135], a[40:43]
ds_read_b64_tr_b16 v[64:65], v2 offset:32768
v_mfma_f32_16x16x32_bf16 a[44:47], v[172:175], v[132:135], a[44:47]
ds_read_b64_tr_b16 v[66:67], v2 offset:40960
v_mfma_f32_16x16x32_bf16 a[48:51], v[176:179], v[132:135], a[48:51]
ds_read_b64_tr_b16 v[68:69], v3 offset:32768
v_mfma_f32_16x16x32_bf16 a[52:55], v[180:183], v[132:135], a[52:55]
ds_read_b64_tr_b16 v[70:71], v3 offset:40960
v_mfma_f32_16x16x32_bf16 a[56:59], v[184:187], v[132:135], a[56:59]
ds_read_b64_tr_b16 v[72:73], v4 offset:32768
v_mfma_f32_16x16x32_bf16 a[60:63], v[188:191], v[132:135], a[60:63]
ds_read_b64_tr_b16 v[74:75], v4 offset:40960
v_mfma_f32_16x16x32_bf16 a[64:67], v[160:163], v[136:139], a[64:67]
ds_read_b64_tr_b16 v[76:77], v5 offset:32768
v_mfma_f32_16x16x32_bf16 a[68:71], v[164:167], v[136:139], a[68:71]
ds_read_b64_tr_b16 v[78:79], v5 offset:40960
v_mfma_f32_16x16x32_bf16 a[72:75], v[168:171], v[136:139], a[72:75]
ds_read_b64_tr_b16 v[80:81], v6 offset:32768
v_mfma_f32_16x16x32_bf16 a[76:79], v[172:175], v[136:139], a[76:79]
ds_read_b64_tr_b16 v[82:83], v6 offset:40960
v_mfma_f32_16x16x32_bf16 a[80:83], v[176:179], v[136:139], a[80:83]
ds_read_b64_tr_b16 v[84:85], v7 offset:32768
v_mfma_f32_16x16x32_bf16 a[84:87], v[180:183], v[136:139], a[84:87]
ds_read_b64_tr_b16 v[86:87], v7 offset:40960
v_mfma_f32_16x16x32_bf16 a[88:91], v[184:187], v[136:139], a[88:91]
ds_read_b64_tr_b16 v[88:89], v8 offset:32768
v_mfma_f32_16x16x32_bf16 a[92:95], v[188:191], v[136:139], a[92:95]
ds_read_b64_tr_b16 v[90:91], v8 offset:40960
v_mfma_f32_16x16x32_bf16 a[96:99], v[160:163], v[140:143], a[96:99]
ds_read_b64_tr_b16 v[92:93], v9 offset:32768
v_mfma_f32_16x16x32_bf16 a[100:103], v[164:167], v[140:143], a[100:103]
ds_read_b64_tr_b16 v[94:95], v9 offset:40960
v_mfma_f32_16x16x32_bf16 a[104:107], v[168:171], v[140:143], a[104:107]
v_mfma_f32_16x16x32_bf16 a[108:111], v[172:175], v[140:143], a[108:111]
s_add_u32 m0, s32, 0
v_mfma_f32_16x16x32_bf16 a[112:115], v[176:179], v[140:143], a[112:115]
buffer_load_dwordx4 v11, s[8:11], s30 offen offset:0 lds
v_mfma_f32_16x16x32_bf16 a[116:119], v[180:183], v[140:143], a[116:119]
v_mfma_f32_16x16x32_bf16 a[120:123], v[184:187], v[140:143], a[120:123]
v_mfma_f32_16x16x32_bf16 a[124:127], v[188:191], v[140:143], a[124:127]
v_mfma_f32_16x16x32_bf16 a[128:131], v[160:163], v[144:147], a[128:131]
buffer_load_dwordx4 v12, s[8:11], s30 offen offset:1024 lds
v_mfma_f32_16x16x32_bf16 a[132:135], v[164:167], v[144:147], a[132:135]
v_mfma_f32_16x16x32_bf16 a[136:139], v[168:171], v[144:147], a[136:139]
v_mfma_f32_16x16x32_bf16 a[140:143], v[172:175], v[144:147], a[140:143]
v_mfma_f32_16x16x32_bf16 a[144:147], v[176:179], v[144:147], a[144:147]
buffer_load_dwordx4 v13, s[8:11], s30 offen offset:2048 lds
v_mfma_f32_16x16x32_bf16 a[148:151], v[180:183], v[144:147], a[148:151]
v_mfma_f32_16x16x32_bf16 a[152:155], v[184:187], v[144:147], a[152:155]
v_mfma_f32_16x16x32_bf16 a[156:159], v[188:191], v[144:147], a[156:159]
v_mfma_f32_16x16x32_bf16 a[160:163], v[160:163], v[148:151], a[160:163]
buffer_load_dwordx4 v14, s[8:11], s30 offen offset:3072 lds
v_mfma_f32_16x16x32_bf16 a[164:167], v[164:167], v[148:151], a[164:167]
v_mfma_f32_16x16x32_bf16 a[168:171], v[168:171], v[148:151], a[168:171]
v_mfma_f32_16x16x32_bf16 a[172:175], v[172:175], v[148:151], a[172:175]
s_add_u32 m0, s33, 0
v_mfma_f32_16x16x32_bf16 a[176:179], v[176:179], v[148:151], a[176:179]
buffer_load_dwordx4 v15, s[4:7], s31 offen offset:0 sc1 lds
v_mfma_f32_16x16x32_bf16 a[180:183], v[180:183], v[148:151], a[180:183]
v_mfma_f32_16x16x32_bf16 a[184:187], v[184:187], v[148:151], a[184:187]
v_mfma_f32_16x16x32_bf16 a[188:191], v[188:191], v[148:151], a[188:191]
v_mfma_f32_16x16x32_bf16 a[192:195], v[160:163], v[152:155], a[192:195]
buffer_load_dwordx4 v15, s[4:7], s31 offen offset:1024 sc1 lds
v_mfma_f32_16x16x32_bf16 a[196:199], v[164:167], v[152:155], a[196:199]
v_mfma_f32_16x16x32_bf16 a[200:203], v[168:171], v[152:155], a[200:203]
v_mfma_f32_16x16x32_bf16 a[204:207], v[172:175], v[152:155], a[204:207]
v_mfma_f32_16x16x32_bf16 a[208:211], v[176:179], v[152:155], a[208:211]
buffer_load_dwordx4 v15, s[4:7], s31 offen offset:2048 sc1 lds
v_mfma_f32_16x16x32_bf16 a[212:215], v[180:183], v[152:155], a[212:215]
v_mfma_f32_16x16x32_bf16 a[216:219], v[184:187], v[152:155], a[216:219]
v_mfma_f32_16x16x32_bf16 a[220:223], v[188:191], v[152:155], a[220:223]
v_mfma_f32_16x16x32_bf16 a[224:227], v[160:163], v[156:159], a[224:227]
buffer_load_dwordx4 v15, s[4:7], s31 offen offset:3072 sc1 lds
v_mfma_f32_16x16x32_bf16 a[228:231], v[164:167], v[156:159], a[228:231]
v_mfma_f32_16x16x32_bf16 a[232:235], v[168:171], v[156:159], a[232:235]
s_add_u32 s30, s30, 262144
v_mfma_f32_16x16x32_bf16 a[236:239], v[172:175], v[156:159], a[236:239]
s_add_u32 s31, s31, 16384
v_mfma_f32_16x16x32_bf16 a[240:243], v[176:179], v[156:159], a[240:243]
v_mfma_f32_16x16x32_bf16 a[244:247], v[180:183], v[156:159], a[244:247]
v_mfma_f32_16x16x32_bf16 a[248:251], v[184:187], v[156:159], a[248:251]
v_mfma_f32_16x16x32_bf16 a[252:255], v[188:191], v[156:159], a[252:255]
s_waitcnt lgkmcnt(0)
v_mfma_f32_16x16x32_bf16 a[0:3], v[96:99], v[64:67], a[0:3]
v_mfma_f32_16x16x32_bf16 a[4:7], v[100:103], v[64:67], a[4:7]
s_waitcnt vmcnt(8)
s_barrier
v_mfma_f32_16x16x32_bf16 a[8:11], v[104:107], v[64:67], a[8:11]
ds_read_b128 v[160:163], v10 offset:49152
v_mfma_f32_16x16x32_bf16 a[12:15], v[108:111], v[64:67], a[12:15]
ds_read_b128 v[164:167], v10 offset:50176
v_mfma_f32_16x16x32_bf16 a[16:19], v[112:115], v[64:67], a[16:19]
ds_read_b128 v[168:171], v10 offset:51200
v_mfma_f32_16x16x32_bf16 a[20:23], v[116:119], v[64:67], a[20:23]
ds_read_b128 v[172:175], v10 offset:52224
v_mfma_f32_16x16x32_bf16 a[24:27], v[120:123], v[64:67], a[24:27]
ds_read_b128 v[176:179], v10 offset:53248
v_mfma_f32_16x16x32_bf16 a[28:31], v[124:127], v[64:67], a[28:31]
ds_read_b128 v[180:183], v10 offset:54272
v_mfma_f32_16x16x32_bf16 a[32:35], v[96:99], v[68:71], a[32:35]
ds_read_b128 v[184:187], v10 offset:55296
v_mfma_f32_16x16x32_bf16 a[36:39], v[100:103], v[68:71], a[36:39]
ds_read_b128 v[188:191], v10 offset:56320
v_mfma_f32_16x16x32_bf16 a[40:43], v[104:107], v[68:71], a[40:43]
ds_read_b64_tr_b16 v[128:129], v2 offset:49152
v_mfma_f32_16x16x32_bf16 a[44:47], v[108:111], v[68:71], a[44:47]
ds_read_b64_tr_b16 v[130:131], v2 offset:57344
v_mfma_f32_16x16x32_bf16 a[48:51], v[112:115], v[68:71], a[48:51]
ds_read_b64_tr_b16 v[132:133], v3 offset:49152
v_mfma_f32_16x16x32_bf16 a[52:55], v[116:119], v[68:71], a[52:55]
ds_read_b64_tr_b16 v[134:135], v3 offset:57344
v_mfma_f32_16x16x32_bf16 a[56:59], v[120:123], v[68:71], a[56:59]
ds_read_b64_tr_b16 v[136:137], v4 offset:49152
v_mfma_f32_16x16x32_bf16 a[60:63], v[124:127], v[68:71], a[60:63]
ds_read_b64_tr_b16 v[138:139], v4 offset:57344
v_mfma_f32_16x16x32_bf16 a[64:67], v[96:99], v[72:75], a[64:67]
ds_read_b64_tr_b16 v[140:141], v5 offset:49152
v_mfma_f32_16x16x32_bf16 a[68:71], v[100:103], v[72:75], a[68:71]
ds_read_b64_tr_b16 v[142:143], v5 offset:57344
v_mfma_f32_16x16x32_bf16 a[72:75], v[104:107], v[72:75], a[72:75]
ds_read_b64_tr_b16 v[144:145], v6 offset:49152
v_mfma_f32_16x16x32_bf16 a[76:79], v[108:111], v[72:75], a[76:79]
ds_read_b64_tr_b16 v[146:147], v6 offset:57344
v_mfma_f32_16x16x32_bf16 a[80:83], v[112:115], v[72:75], a[80:83]
ds_read_b64_tr_b16 v[148:149], v7 offset:49152
v_mfma_f32_16x16x32_bf16 a[84:87], v[116:119], v[72:75], a[84:87]
ds_read_b64_tr_b16 v[150:151], v7 offset:57344
v_mfma_f32_16x16x32_bf16 a[88:91], v[120:123], v[72:75], a[88:91]
ds_read_b64_tr_b16 v[152:153], v8 offset:49152
v_mfma_f32_16x16x32_bf16 a[92:95], v[124:127], v[72:75], a[92:95]
ds_read_b64_tr_b16 v[154:155], v8 offset:57344
v_mfma_f32_16x16x32_bf16 a[96:99], v[96:99], v[76:79], a[96:99]
ds_read_b64_tr_b16 v[156:157], v9 offset:49152
v_mfma_f32_16x16x32_bf16 a[100:103], v[100:103], v[76:79], a[100:103]
ds_read_b64_tr_b16 v[158:159], v9 offset:57344
v_mfma_f32_16x16x32_bf16 a[104:107], v[104:107], v[76:79], a[104:107]
v_mfma_f32_16x16x32_bf16 a[108:111], v[108:111], v[76:79], a[108:111]
s_add_u32 m0, s32, 16384
v_mfma_f32_16x16x32_bf16 a[112:115], v[112:115], v[76:79], a[112:115]
buffer_load_dwordx4 v11, s[8:11], s30 offen offset:0 lds
v_mfma_f32_16x16x32_bf16 a[116:119], v[116:119], v[76:79], a[116:119]
v_mfma_f32_16x16x32_bf16 a[120:123], v[120:123], v[76:79], a[120:123]
v_mfma_f32_16x16x32_bf16 a[124:127], v[124:127], v[76:79], a[124:127]
v_mfma_f32_16x16x32_bf16 a[128:131], v[96:99], v[80:83], a[128:131]
buffer_load_dwordx4 v12, s[8:11], s30 offen offset:1024 lds
v_mfma_f32_16x16x32_bf16 a[132:135], v[100:103], v[80:83], a[132:135]
v_mfma_f32_16x16x32_bf16 a[136:139], v[104:107], v[80:83], a[136:139]
v_mfma_f32_16x16x32_bf16 a[140:143], v[108:111], v[80:83], a[140:143]
v_mfma_f32_16x16x32_bf16 a[144:147], v[112:115], v[80:83], a[144:147]
buffer_load_dwordx4 v13, s[8:11], s30 offen offset:2048 lds
v_mfma_f32_16x16x32_bf16 a[148:151], v[116:119], v[80:83], a[148:151]
v_mfma_f32_16x16x32_bf16 a[152:155], v[120:123], v[80:83], a[152:155]
v_mfma_f32_16x16x32_bf16 a[156:159], v[124:127], v[80:83], a[156:159]
v_mfma_f32_16x16x32_bf16 a[160:163], v[96:99], v[84:87], a[160:163]
buffer_load_dwordx4 v14, s[8:11], s30 offen offset:3072 lds
v_mfma_f32_16x16x32_bf16 a[164:167], v[100:103], v[84:87], a[164:167]
v_mfma_f32_16x16x32_bf16 a[168:171], v[104:107], v[84:87], a[168:171]
v_mfma_f32_16x16x32_bf16 a[172:175], v[108:111], v[84:87], a[172:175]
s_add_u32 m0, s33, 16384
v_mfma_f32_16x16x32_bf16 a[176:179], v[112:115], v[84:87], a[176:179]
buffer_load_dwordx4 v15, s[4:7], s31 offen offset:0 sc1 lds
v_mfma_f32_16x16x32_bf16 a[180:183], v[116:119], v[84:87], a[180:183]
v_mfma_f32_16x16x32_bf16 a[184:187], v[120:123], v[84:87], a[184:187]
v_mfma_f32_16x16x32_bf16 a[188:191], v[124:127], v[84:87], a[188:191]
v_mfma_f32_16x16x32_bf16 a[192:195], v[96:99], v[88:91], a[192:195]
buffer_load_dwordx4 v15, s[4:7], s31 offen offset:1024 sc1 lds
v_mfma_f32_16x16x32_bf16 a[196:199], v[100:103], v[88:91], a[196:199]
v_mfma_f32_16x16x32_bf16 a[200:203], v[104:107], v[88:91], a[200:203]
v_mfma_f32_16x16x32_bf16 a[204:207], v[108:111], v[88:91], a[204:207]
v_mfma_f32_16x16x32_bf16 a[208:211], v[112:115], v[88:91], a[208:211]
buffer_load_dwordx4 v15, s[4:7], s31 offen offset:2048 sc1 lds
v_mfma_f32_16x16x32_bf16 a[212:215], v[116:119], v[88:91], a[212:215]
v_mfma_f32_16x16x32_bf16 a[216:219], v[120:123], v[88:91], a[216:219]
v_mfma_f32_16x16x32_bf16 a[220:223], v[124:127], v[88:91], a[220:223]
v_mfma_f32_16x16x32_bf16 a[224:227], v[96:99], v[92:95], a[224:227]
buffer_load_dwordx4 v15, s[4:7], s31 offen offset:3072 sc1 lds
v_mfma_f32_16x16x32_bf16 a[228:231], v[100:103], v[92:95], a[228:231]
v_mfma_f32_16x16x32_bf16 a[232:235], v[104:107], v[92:95], a[232:235]
s_add_u32 s30, s30, 262144
v_mfma_f32_16x16x32_bf16 a[236:239], v[108:111], v[92:95], a[236:239]
s_add_u32 s31, s31, 16384
v_mfma_f32_16x16x32_bf16 a[240:243], v[112:115], v[92:95], a[240:243]
v_mfma_f32_16x16x32_bf16 a[244:247], v[116:119], v[92:95], a[244:247]
v_mfma_f32_16x16x32_bf16 a[248:251], v[120:123], v[92:95], a[248:251]
v_mfma_f32_16x16x32_bf16 a[252:255], v[124:127], v[92:95], a[252:255]
s_waitcnt lgkmcnt(0)
v_mfma_f32_16x16x32_bf16 a[0:3], v[160:163], v[128:131], a[0:3]
v_mfma_f32_16x16x32_bf16 a[4:7], v[164:167], v[128:131], a[4:7]
s_waitcnt vmcnt(8)
s_barrier
v_mfma_f32_16x16x32_bf16 a[8:11], v[168:171], v[128:131], a[8:11]
ds_read_b128 v[96:99], v10 offset:0
v_mfma_f32_16x16x32_bf16 a[12:15], v[172:175], v[128:131], a[12:15]
ds_read_b128 v[100:103], v10 offset:1024
v_mfma_f32_16x16x32_bf16 a[16:19], v[176:179], v[128:131], a[16:19]
ds_read_b128 v[104:107], v10 offset:2048
v_mfma_f32_16x16x32_bf16 a[20:23], v[180:183], v[128:131], a[20:23]
ds_read_b128 v[108:111], v10 offset:3072
v_mfma_f32_16x16x32_bf16 a[24:27], v[184:187], v[128:131], a[24:27]
ds_read_b128 v[112:115], v10 offset:4096
v_mfma_f32_16x16x32_bf16 a[28:31], v[188:191], v[128:131], a[28:31]
ds_read_b128 v[116:119], v10 offset:5120
v_mfma_f32_16x16x32_bf16 a[32:35], v[160:163], v[132:135], a[32:35]
ds_read_b128 v[120:123], v10 offset:6144
v_mfma_f32_16x16x32_bf16 a[36:39], v[164:167], v[132:135], a[36:39]
ds_read_b128 v[124:127], v10 offset:7168
v_mfma_f32_16x16x32_bf16 a[40:43], v[168:171], v[132:135], a[40:43]
ds_read_b64_tr_b16 v[64:65], v2 offset:0
v_mfma_f32_16x16x32_bf16 a[44:47], v[172:175], v[132:135], a[44:47]
ds_read_b64_tr_b16 v[66:67], v2 offset:8192
v_mfma_f32_16x16x32_bf16 a[48:51], v[176:179], v[132:135], a[48:51]
ds_read_b64_tr_b16 v[68:69], v3 offset:0
v_mfma_f32_16x16x32_bf16 a[52:55], v[180:183], v[132:135], a[52:55]
ds_read_b64_tr_b16 v[70:71], v3 offset:8192
v_mfma_f32_16x16x32_bf16 a[56:59], v[184:187], v[132:135], a[56:59]
ds_read_b64_tr_b16 v[72:73], v4 offset:0
v_mfma_f32_16x16x32_bf16 a[60:63], v[188:191], v[132:135], a[60:63]
ds_read_b64_tr_b16 v[74:75], v4 offset:8192
v_mfma_f32_16x16x32_bf16 a[64:67], v[160:163], v[136:139], a[64:67]
ds_read_b64_tr_b16 v[76:77], v5 offset:0
v_mfma_f32_16x16x32_bf16 a[68:71], v[164:167], v[136:139], a[68:71]
ds_read_b64_tr_b16 v[78:79], v5 offset:8192
v_mfma_f32_16x16x32_bf16 a[72:75], v[168:171], v[136:139], a[72:75]
ds_read_b64_tr_b16 v[80:81], v6 offset:0
v_mfma_f32_16x16x32_bf16 a[76:79], v[172:175], v[136:139], a[76:79]
ds_read_b64_tr_b16 v[82:83], v6 offset:8192
v_mfma_f32_16x16x32_bf16 a[80:83], v[176:179], v[136:139], a[80:83]
ds_read_b64_tr_b16 v[84:85], v7 offset:0
v_mfma_f32_16x16x32_bf16 a[84:87], v[180:183], v[136:139], a[84:87]
ds_read_b64_tr_b16 v[86:87], v7 offset:8192
v_mfma_f32_16x16x32_bf16 a[88:91], v[184:187], v[136:139], a[88:91]
ds_read_b64_tr_b16 v[88:89], v8 offset:0
v_mfma_f32_16x16x32_bf16 a[92:95], v[188:191], v[136:139], a[92:95]
ds_read_b64_tr_b16 v[90:91], v8 offset:8192
v_mfma_f32_16x16x32_bf16 a[96:99], v[160:163], v[140:143], a[96:99]
ds_read_b64_tr_b16 v[92:93], v9 offset:0
v_mfma_f32_16x16x32_bf16 a[100:103], v[164:167], v[140:143], a[100:103]
ds_read_b64_tr_b16 v[94:95], v9 offset:8192
v_mfma_f32_16x16x32_bf16 a[104:107], v[168:171], v[140:143], a[104:107]
v_mfma_f32_16x16x32_bf16 a[108:111], v[172:175], v[140:143], a[108:111]
s_add_u32 m0, s32, 32768
v_mfma_f32_16x16x32_bf16 a[112:115], v[176:179], v[140:143], a[112:115]
buffer_load_dwordx4 v11, s[8:11], s30 offen offset:0 lds
v_mfma_f32_16x16x32_bf16 a[116:119], v[180:183], v[140:143], a[116:119]
v_mfma_f32_16x16x32_bf16 a[120:123], v[184:187], v[140:143], a[120:123]
v_mfma_f32_16x16x32_bf16 a[124:127], v[188:191], v[140:143], a[124:127]
v_mfma_f32_16x16x32_bf16 a[128:131], v[160:163], v[144:147], a[128:131]
buffer_load_dwordx4 v12, s[8:11], s30 offen offset:1024 lds
v_mfma_f32_16x16x32_bf16 a[132:135], v[164:167], v[144:147], a[132:135]
v_mfma_f32_16x16x32_bf16 a[136:139], v[168:171], v[144:147], a[136:139]
v_mfma_f32_16x16x32_bf16 a[140:143], v[172:175], v[144:147], a[140:143]
v_mfma_f32_16x16x32_bf16 a[144:147], v[176:179], v[144:147], a[144:147]
buffer_load_dwordx4 v13, s[8:11], s30 offen offset:2048 lds
v_mfma_f32_16x16x32_bf16 a[148:151], v[180:183], v[144:147], a[148:151]
v_mfma_f32_16x16x32_bf16 a[152:155], v[184:187], v[144:147], a[152:155]
v_mfma_f32_16x16x32_bf16 a[156:159], v[188:191], v[144:147], a[156:159]
v_mfma_f32_16x16x32_bf16 a[160:163], v[160:163], v[148:151], a[160:163]
buffer_load_dwordx4 v14, s[8:11], s30 offen offset:3072 lds
v_mfma_f32_16x16x32_bf16 a[164:167], v[164:167], v[148:151], a[164:167]
v_mfma_f32_16x16x32_bf16 a[168:171], v[168:171], v[148:151], a[168:171]
v_mfma_f32_16x16x32_bf16 a[172:175], v[172:175], v[148:151], a[172:175]
s_add_u32 m0, s33, 32768
v_mfma_f32_16x16x32_bf16 a[176:179], v[176:179], v[148:151], a[176:179]
buffer_load_dwordx4 v15, s[4:7], s31 offen offset:0 sc1 lds
v_mfma_f32_16x16x32_bf16 a[180:183], v[180:183], v[148:151], a[180:183]
v_mfma_f32_16x16x32_bf16 a[184:187], v[184:187], v[148:151], a[184:187]
v_mfma_f32_16x16x32_bf16 a[188:191], v[188:191], v[148:151], a[188:191]
v_mfma_f32_16x16x32_bf16 a[192:195], v[160:163], v[152:155], a[192:195]
buffer_load_dwordx4 v15, s[4:7], s31 offen offset:1024 sc1 lds
v_mfma_f32_16x16x32_bf16 a[196:199], v[164:167], v[152:155], a[196:199]
v_mfma_f32_16x16x32_bf16 a[200:203], v[168:171], v[152:155], a[200:203]
v_mfma_f32_16x16x32_bf16 a[204:207], v[172:175], v[152:155], a[204:207]
v_mfma_f32_16x16x32_bf16 a[208:211], v[176:179], v[152:155], a[208:211]
buffer_load_dwordx4 v15, s[4:7], s31 offen offset:2048 sc1 lds
v_mfma_f32_16x16x32_bf16 a[212:215], v[180:183], v[152:155], a[212:215]
v_mfma_f32_16x16x32_bf16 a[216:219], v[184:187], v[152:155], a[216:219]
v_mfma_f32_16x16x32_bf16 a[220:223], v[188:191], v[152:155], a[220:223]
v_mfma_f32_16x16x32_bf16 a[224:227], v[160:163], v[156:159], a[224:227]
buffer_load_dwordx4 v15, s[4:7], s31 offen offset:3072 sc1 lds
v_mfma_f32_16x16x32_bf16 a[228:231], v[164:167], v[156:159], a[228:231]
v_mfma_f32_16x16x32_bf16 a[232:235], v[168:171], v[156:159], a[232:235]
s_add_u32 s30, s30, 262144
v_mfma_f32_16x16x32_bf16 a[236:239], v[172:175], v[156:159], a[236:239]
s_add_u32 s31, s31, 16384
v_mfma_f32_16x16x32_bf16 a[240:243], v[176:179], v[156:159], a[240:243]
v_mfma_f32_16x16x32_bf16 a[244:247], v[180:183], v[156:159], a[244:247]
v_mfma_f32_16x16x32_bf16 a[248:251], v[184:187], v[156:159], a[248:251]
v_mfma_f32_16x16x32_bf16 a[252:255], v[188:191], v[156:159], a[252:255]
s_sub_u32 s37, s37, 1
s_cmp_lg_u32 s37, 0
s_cbranch_scc1 GL_50
s_waitcnt lgkmcnt(0)
v_mfma_f32_16x16x32_bf16 a[0:3], v[96:99], v[64:67], a[0:3]
v_mfma_f32_16x16x32_bf16 a[4:7], v[100:103], v[64:67], a[4:7]
s_waitcnt vmcnt(8)
s_barrier
v_mfma_f32_16x16x32_bf16 a[8:11], v[104:107], v[64:67], a[8:11]
ds_read_b128 v[160:163], v10 offset:16384
v_mfma_f32_16x16x32_bf16 a[12:15], v[108:111], v[64:67], a[12:15]
ds_read_b128 v[164:167], v10 offset:17408
v_mfma_f32_16x16x32_bf16 a[16:19], v[112:115], v[64:67], a[16:19]
ds_read_b128 v[168:171], v10 offset:18432
v_mfma_f32_16x16x32_bf16 a[20:23], v[116:119], v[64:67], a[20:23]
ds_read_b128 v[172:175], v10 offset:19456
v_mfma_f32_16x16x32_bf16 a[24:27], v[120:123], v[64:67], a[24:27]
ds_read_b128 v[176:179], v10 offset:20480
v_mfma_f32_16x16x32_bf16 a[28:31], v[124:127], v[64:67], a[28:31]
ds_read_b128 v[180:183], v10 offset:21504
v_mfma_f32_16x16x32_bf16 a[32:35], v[96:99], v[68:71], a[32:35]
ds_read_b128 v[184:187], v10 offset:22528
v_mfma_f32_16x16x32_bf16 a[36:39], v[100:103], v[68:71], a[36:39]
ds_read_b128 v[188:191], v10 offset:23552
v_mfma_f32_16x16x32_bf16 a[40:43], v[104:107], v[68:71], a[40:43]
ds_read_b64_tr_b16 v[128:129], v2 offset:16384
v_mfma_f32_16x16x32_bf16 a[44:47], v[108:111], v[68:71], a[44:47]
ds_read_b64_tr_b16 v[130:131], v2 offset:24576
v_mfma_f32_16x16x32_bf16 a[48:51], v[112:115], v[68:71], a[48:51]
ds_read_b64_tr_b16 v[132:133], v3 offset:16384
v_mfma_f32_16x16x32_bf16 a[52:55], v[116:119], v[68:71], a[52:55]
ds_read_b64_tr_b16 v[134:135], v3 offset:24576
v_mfma_f32_16x16x32_bf16 a[56:59], v[120:123], v[68:71], a[56:59]
ds_read_b64_tr_b16 v[136:137], v4 offset:16384
v_mfma_f32_16x16x32_bf16 a[60:63], v[124:127], v[68:71], a[60:63]
ds_read_b64_tr_b16 v[138:139], v4 offset:24576
v_mfma_f32_16x16x32_bf16 a[64:67], v[96:99], v[72:75], a[64:67]
ds_read_b64_tr_b16 v[140:141], v5 offset:16384
v_mfma_f32_16x16x32_bf16 a[68:71], v[100:103], v[72:75], a[68:71]
ds_read_b64_tr_b16 v[142:143], v5 offset:24576
v_mfma_f32_16x16x32_bf16 a[72:75], v[104:107], v[72:75], a[72:75]
ds_read_b64_tr_b16 v[144:145], v6 offset:16384
v_mfma_f32_16x16x32_bf16 a[76:79], v[108:111], v[72:75], a[76:79]
ds_read_b64_tr_b16 v[146:147], v6 offset:24576
v_mfma_f32_16x16x32_bf16 a[80:83], v[112:115], v[72:75], a[80:83]
ds_read_b64_tr_b16 v[148:149], v7 offset:16384
v_mfma_f32_16x16x32_bf16 a[84:87], v[116:119], v[72:75], a[84:87]
ds_read_b64_tr_b16 v[150:151], v7 offset:24576
v_mfma_f32_16x16x32_bf16 a[88:91], v[120:123], v[72:75], a[88:91]
ds_read_b64_tr_b16 v[152:153], v8 offset:16384
v_mfma_f32_16x16x32_bf16 a[92:95], v[124:127], v[72:75], a[92:95]
ds_read_b64_tr_b16 v[154:155], v8 offset:24576
v_mfma_f32_16x16x32_bf16 a[96:99], v[96:99], v[76:79], a[96:99]
ds_read_b64_tr_b16 v[156:157], v9 offset:16384
v_mfma_f32_16x16x32_bf16 a[100:103], v[100:103], v[76:79], a[100:103]
ds_read_b64_tr_b16 v[158:159], v9 offset:24576
v_mfma_f32_16x16x32_bf16 a[104:107], v[104:107], v[76:79], a[104:107]
v_mfma_f32_16x16x32_bf16 a[108:111], v[108:111], v[76:79], a[108:111]
s_add_u32 m0, s32, 49152
v_mfma_f32_16x16x32_bf16 a[112:115], v[112:115], v[76:79], a[112:115]
buffer_load_dwordx4 v11, s[8:11], s30 offen offset:0 lds
v_mfma_f32_16x16x32_bf16 a[116:119], v[116:119], v[76:79], a[116:119]
v_mfma_f32_16x16x32_bf16 a[120:123], v[120:123], v[76:79], a[120:123]
v_mfma_f32_16x16x32_bf16 a[124:127], v[124:127], v[76:79], a[124:127]
v_mfma_f32_16x16x32_bf16 a[128:131], v[96:99], v[80:83], a[128:131]
buffer_load_dwordx4 v12, s[8:11], s30 offen offset:1024 lds
v_mfma_f32_16x16x32_bf16 a[132:135], v[100:103], v[80:83], a[132:135]
v_mfma_f32_16x16x32_bf16 a[136:139], v[104:107], v[80:83], a[136:139]
v_mfma_f32_16x16x32_bf16 a[140:143], v[108:111], v[80:83], a[140:143]
v_mfma_f32_16x16x32_bf16 a[144:147], v[112:115], v[80:83], a[144:147]
buffer_load_dwordx4 v13, s[8:11], s30 offen offset:2048 lds
v_mfma_f32_16x16x32_bf16 a[148:151], v[116:119], v[80:83], a[148:151]
v_mfma_f32_16x16x32_bf16 a[152:155], v[120:123], v[80:83], a[152:155]
v_mfma_f32_16x16x32_bf16 a[156:159], v[124:127], v[80:83], a[156:159]
v_mfma_f32_16x16x32_bf16 a[160:163], v[96:99], v[84:87], a[160:163]
buffer_load_dwordx4 v14, s[8:11], s30 offen offset:3072 lds
v_mfma_f32_16x16x32_bf16 a[164:167], v[100:103], v[84:87], a[164:167]
v_mfma_f32_16x16x32_bf16 a[168:171], v[104:107], v[84:87], a[168:171]
v_mfma_f32_16x16x32_bf16 a[172:175], v[108:111], v[84:87], a[172:175]
s_add_u32 m0, s33, 49152
v_mfma_f32_16x16x32_bf16 a[176:179], v[112:115], v[84:87], a[176:179]
buffer_load_dwordx4 v15, s[4:7], s31 offen offset:0 sc1 lds
v_mfma_f32_16x16x32_bf16 a[180:183], v[116:119], v[84:87], a[180:183]
v_mfma_f32_16x16x32_bf16 a[184:187], v[120:123], v[84:87], a[184:187]
v_mfma_f32_16x16x32_bf16 a[188:191], v[124:127], v[84:87], a[188:191]
v_mfma_f32_16x16x32_bf16 a[192:195], v[96:99], v[88:91], a[192:195]
buffer_load_dwordx4 v15, s[4:7], s31 offen offset:1024 sc1 lds
v_mfma_f32_16x16x32_bf16 a[196:199], v[100:103], v[88:91], a[196:199]
v_mfma_f32_16x16x32_bf16 a[200:203], v[104:107], v[88:91], a[200:203]
v_mfma_f32_16x16x32_bf16 a[204:207], v[108:111], v[88:91], a[204:207]
v_mfma_f32_16x16x32_bf16 a[208:211], v[112:115], v[88:91], a[208:211]
buffer_load_dwordx4 v15, s[4:7], s31 offen offset:2048 sc1 lds
v_mfma_f32_16x16x32_bf16 a[212:215], v[116:119], v[88:91], a[212:215]
v_mfma_f32_16x16x32_bf16 a[216:219], v[120:123], v[88:91], a[216:219]
v_mfma_f32_16x16x32_bf16 a[220:223], v[124:127], v[88:91], a[220:223]
v_mfma_f32_16x16x32_bf16 a[224:227], v[96:99], v[92:95], a[224:227]
buffer_load_dwordx4 v15, s[4:7], s31 offen offset:3072 sc1 lds
v_mfma_f32_16x16x32_bf16 a[228:231], v[100:103], v[92:95], a[228:231]
v_mfma_f32_16x16x32_bf16 a[232:235], v[104:107], v[92:95], a[232:235]
s_add_u32 s30, s30, 262144
v_mfma_f32_16x16x32_bf16 a[236:239], v[108:111], v[92:95], a[236:239]
s_add_u32 s31, s31, 16384
v_mfma_f32_16x16x32_bf16 a[240:243], v[112:115], v[92:95], a[240:243]
v_mfma_f32_16x16x32_bf16 a[244:247], v[116:119], v[92:95], a[244:247]
v_mfma_f32_16x16x32_bf16 a[248:251], v[120:123], v[92:95], a[248:251]
v_mfma_f32_16x16x32_bf16 a[252:255], v[124:127], v[92:95], a[252:255]
s_waitcnt lgkmcnt(0)
v_mfma_f32_16x16x32_bf16 a[0:3], v[160:163], v[128:131], a[0:3]
v_mfma_f32_16x16x32_bf16 a[4:7], v[164:167], v[128:131], a[4:7]
s_waitcnt vmcnt(8)
s_barrier
v_mfma_f32_16x16x32_bf16 a[8:11], v[168:171], v[128:131], a[8:11]
ds_read_b128 v[96:99], v10 offset:32768
v_mfma_f32_16x16x32_bf16 a[12:15], v[172:175], v[128:131], a[12:15]
ds_read_b128 v[100:103], v10 offset:33792
v_mfma_f32_16x16x32_bf16 a[16:19], v[176:179], v[128:131], a[16:19]
ds_read_b128 v[104:107], v10 offset:34816
v_mfma_f32_16x16x32_bf16 a[20:23], v[180:183], v[128:131], a[20:23]
ds_read_b128 v[108:111], v10 offset:35840
v_mfma_f32_16x16x32_bf16 a[24:27], v[184:187], v[128:131], a[24:27]
ds_read_b128 v[112:115], v10 offset:36864
v_mfma_f32_16x16x32_bf16 a[28:31], v[188:191], v[128:131], a[28:31]
ds_read_b128 v[116:119], v10 offset:37888
v_mfma_f32_16x16x32_bf16 a[32:35], v[160:163], v[132:135], a[32:35]
ds_read_b128 v[120:123], v10 offset:38912
v_mfma_f32_16x16x32_bf16 a[36:39], v[164:167], v[132:135], a[36:39]
ds_read_b128 v[124:127], v10 offset:39936
v_mfma_f32_16x16x32_bf16 a[40:43], v[168:171], v[132:135], a[40:43]
ds_read_b64_tr_b16 v[64:65], v2 offset:32768
v_mfma_f32_16x16x32_bf16 a[44:47], v[172:175], v[132:135], a[44:47]
ds_read_b64_tr_b16 v[66:67], v2 offset:40960
v_mfma_f32_16x16x32_bf16 a[48:51], v[176:179], v[132:135], a[48:51]
ds_read_b64_tr_b16 v[68:69], v3 offset:32768
v_mfma_f32_16x16x32_bf16 a[52:55], v[180:183], v[132:135], a[52:55]
ds_read_b64_tr_b16 v[70:71], v3 offset:40960
v_mfma_f32_16x16x32_bf16 a[56:59], v[184:187], v[132:135], a[56:59]
ds_read_b64_tr_b16 v[72:73], v4 offset:32768
v_mfma_f32_16x16x32_bf16 a[60:63], v[188:191], v[132:135], a[60:63]
ds_read_b64_tr_b16 v[74:75], v4 offset:40960
v_mfma_f32_16x16x32_bf16 a[64:67], v[160:163], v[136:139], a[64:67]
ds_read_b64_tr_b16 v[76:77], v5 offset:32768
v_mfma_f32_16x16x32_bf16 a[68:71], v[164:167], v[136:139], a[68:71]
ds_read_b64_tr_b16 v[78:79], v5 offset:40960
v_mfma_f32_16x16x32_bf16 a[72:75], v[168:171], v[136:139], a[72:75]
ds_read_b64_tr_b16 v[80:81], v6 offset:32768
v_mfma_f32_16x16x32_bf16 a[76:79], v[172:175], v[136:139], a[76:79]
ds_read_b64_tr_b16 v[82:83], v6 offset:40960
v_mfma_f32_16x16x32_bf16 a[80:83], v[176:179], v[136:139], a[80:83]
ds_read_b64_tr_b16 v[84:85], v7 offset:32768
v_mfma_f32_16x16x32_bf16 a[84:87], v[180:183], v[136:139], a[84:87]
ds_read_b64_tr_b16 v[86:87], v7 offset:40960
v_mfma_f32_16x16x32_bf16 a[88:91], v[184:187], v[136:139], a[88:91]
ds_read_b64_tr_b16 v[88:89], v8 offset:32768
v_mfma_f32_16x16x32_bf16 a[92:95], v[188:191], v[136:139], a[92:95]
ds_read_b64_tr_b16 v[90:91], v8 offset:40960
v_mfma_f32_16x16x32_bf16 a[96:99], v[160:163], v[140:143], a[96:99]
ds_read_b64_tr_b16 v[92:93], v9 offset:32768
v_mfma_f32_16x16x32_bf16 a[100:103], v[164:167], v[140:143], a[100:103]
ds_read_b64_tr_b16 v[94:95], v9 offset:40960
v_mfma_f32_16x16x32_bf16 a[104:107], v[168:171], v[140:143], a[104:107]
v_mfma_f32_16x16x32_bf16 a[108:111], v[172:175], v[140:143], a[108:111]
v_mfma_f32_16x16x32_bf16 a[112:115], v[176:179], v[140:143], a[112:115]
v_mfma_f32_16x16x32_bf16 a[116:119], v[180:183], v[140:143], a[116:119]
v_mfma_f32_16x16x32_bf16 a[120:123], v[184:187], v[140:143], a[120:123]
v_mfma_f32_16x16x32_bf16 a[124:127], v[188:191], v[140:143], a[124:127]
v_mfma_f32_16x16x32_bf16 a[128:131], v[160:163], v[144:147], a[128:131]
v_mfma_f32_16x16x32_bf16 a[132:135], v[164:167], v[144:147], a[132:135]
v_mfma_f32_16x16x32_bf16 a[136:139], v[168:171], v[144:147], a[136:139]
v_mfma_f32_16x16x32_bf16 a[140:143], v[172:175], v[144:147], a[140:143]
v_mfma_f32_16x16x32_bf16 a[144:147], v[176:179], v[144:147], a[144:147]
v_mfma_f32_16x16x32_bf16 a[148:151], v[180:183], v[144:147], a[148:151]
v_mfma_f32_16x16x32_bf16 a[152:155], v[184:187], v[144:147], a[152:155]
v_mfma_f32_16x16x32_bf16 a[156:159], v[188:191], v[144:147], a[156:159]
v_mfma_f32_16x16x32_bf16 a[160:163], v[160:163], v[148:151], a[160:163]
v_mfma_f32_16x16x32_bf16 a[164:167], v[164:167], v[148:151], a[164:167]
v_mfma_f32_16x16x32_bf16 a[168:171], v[168:171], v[148:151], a[168:171]
v_mfma_f32_16x16x32_bf16 a[172:175], v[172:175], v[148:151], a[172:175]
v_mfma_f32_16x16x32_bf16 a[176:179], v[176:179], v[148:151], a[176:179]
v_mfma_f32_16x16x32_bf16 a[180:183], v[180:183], v[148:151], a[180:183]
v_mfma_f32_16x16x32_bf16 a[184:187], v[184:187], v[148:151], a[184:187]
v_mfma_f32_16x16x32_bf16 a[188:191], v[188:191], v[148:151], a[188:191]
v_mfma_f32_16x16x32_bf16 a[192:195], v[160:163], v[152:155], a[192:195]
v_mfma_f32_16x16x32_bf16 a[196:199], v[164:167], v[152:155], a[196:199]
v_mfma_f32_16x16x32_bf16 a[200:203], v[168:171], v[152:155], a[200:203]
v_mfma_f32_16x16x32_bf16 a[204:207], v[172:175], v[152:155], a[204:207]
v_mfma_f32_16x16x32_bf16 a[208:211], v[176:179], v[152:155], a[208:211]
v_mfma_f32_16x16x32_bf16 a[212:215], v[180:183], v[152:155], a[212:215]
v_mfma_f32_16x16x32_bf16 a[216:219], v[184:187], v[152:155], a[216:219]
v_mfma_f32_16x16x32_bf16 a[220:223], v[188:191], v[152:155], a[220:223]
v_mfma_f32_16x16x32_bf16 a[224:227], v[160:163], v[156:159], a[224:227]
v_mfma_f32_16x16x32_bf16 a[228:231], v[164:167], v[156:159], a[228:231]
v_mfma_f32_16x16x32_bf16 a[232:235], v[168:171], v[156:159], a[232:235]
v_mfma_f32_16x16x32_bf16 a[236:239], v[172:175], v[156:159], a[236:239]
v_mfma_f32_16x16x32_bf16 a[240:243], v[176:179], v[156:159], a[240:243]
v_mfma_f32_16x16x32_bf16 a[244:247], v[180:183], v[156:159], a[244:247]
v_mfma_f32_16x16x32_bf16 a[248:251], v[184:187], v[156:159], a[248:251]
v_mfma_f32_16x16x32_bf16 a[252:255], v[188:191], v[156:159], a[252:255]
s_waitcnt lgkmcnt(0)
v_mfma_f32_16x16x32_bf16 a[0:3], v[96:99], v[64:67], a[0:3]
v_mfma_f32_16x16x32_bf16 a[4:7], v[100:103], v[64:67], a[4:7]
s_waitcnt vmcnt(0)
s_barrier
v_mfma_f32_16x16x32_bf16 a[8:11], v[104:107], v[64:67], a[8:11]
ds_read_b128 v[160:163], v10 offset:49152
v_mfma_f32_16x16x32_bf16 a[12:15], v[108:111], v[64:67], a[12:15]
ds_read_b128 v[164:167], v10 offset:50176
v_mfma_f32_16x16x32_bf16 a[16:19], v[112:115], v[64:67], a[16:19]
ds_read_b128 v[168:171], v10 offset:51200
v_mfma_f32_16x16x32_bf16 a[20:23], v[116:119], v[64:67], a[20:23]
ds_read_b128 v[172:175], v10 offset:52224
v_mfma_f32_16x16x32_bf16 a[24:27], v[120:123], v[64:67], a[24:27]
ds_read_b128 v[176:179], v10 offset:53248
v_mfma_f32_16x16x32_bf16 a[28:31], v[124:127], v[64:67], a[28:31]
ds_read_b128 v[180:183], v10 offset:54272
v_mfma_f32_16x16x32_bf16 a[32:35], v[96:99], v[68:71], a[32:35]
ds_read_b128 v[184:187], v10 offset:55296
v_mfma_f32_16x16x32_bf16 a[36:39], v[100:103], v[68:71], a[36:39]
ds_read_b128 v[188:191], v10 offset:56320
v_mfma_f32_16x16x32_bf16 a[40:43], v[104:107], v[68:71], a[40:43]
ds_read_b64_tr_b16 v[128:129], v2 offset:49152
v_mfma_f32_16x16x32_bf16 a[44:47], v[108:111], v[68:71], a[44:47]
ds_read_b64_tr_b16 v[130:131], v2 offset:57344
v_mfma_f32_16x16x32_bf16 a[48:51], v[112:115], v[68:71], a[48:51]
ds_read_b64_tr_b16 v[132:133], v3 offset:49152
v_mfma_f32_16x16x32_bf16 a[52:55], v[116:119], v[68:71], a[52:55]
ds_read_b64_tr_b16 v[134:135], v3 offset:57344
v_mfma_f32_16x16x32_bf16 a[56:59], v[120:123], v[68:71], a[56:59]
ds_read_b64_tr_b16 v[136:137], v4 offset:49152
v_mfma_f32_16x16x32_bf16 a[60:63], v[124:127], v[68:71], a[60:63]
ds_read_b64_tr_b16 v[138:139], v4 offset:57344
v_mfma_f32_16x16x32_bf16 a[64:67], v[96:99], v[72:75], a[64:67]
ds_read_b64_tr_b16 v[140:141], v5 offset:49152
v_mfma_f32_16x16x32_bf16 a[68:71], v[100:103], v[72:75], a[68:71]
ds_read_b64_tr_b16 v[142:143], v5 offset:57344
v_mfma_f32_16x16x32_bf16 a[72:75], v[104:107], v[72:75], a[72:75]
ds_read_b64_tr_b16 v[144:145], v6 offset:49152
v_mfma_f32_16x16x32_bf16 a[76:79], v[108:111], v[72:75], a[76:79]
ds_read_b64_tr_b16 v[146:147], v6 offset:57344
v_mfma_f32_16x16x32_bf16 a[80:83], v[112:115], v[72:75], a[80:83]
ds_read_b64_tr_b16 v[148:149], v7 offset:49152
v_mfma_f32_16x16x32_bf16 a[84:87], v[116:119], v[72:75], a[84:87]
ds_read_b64_tr_b16 v[150:151], v7 offset:57344
v_mfma_f32_16x16x32_bf16 a[88:91], v[120:123], v[72:75], a[88:91]
ds_read_b64_tr_b16 v[152:153], v8 offset:49152
v_mfma_f32_16x16x32_bf16 a[92:95], v[124:127], v[72:75], a[92:95]
ds_read_b64_tr_b16 v[154:155], v8 offset:57344
v_mfma_f32_16x16x32_bf16 a[96:99], v[96:99], v[76:79], a[96:99]
ds_read_b64_tr_b16 v[156:157], v9 offset:49152
v_mfma_f32_16x16x32_bf16 a[100:103], v[100:103], v[76:79], a[100:103]
ds_read_b64_tr_b16 v[158:159], v9 offset:57344
v_mfma_f32_16x16x32_bf16 a[104:107], v[104:107], v[76:79], a[104:107]
v_mfma_f32_16x16x32_bf16 a[108:111], v[108:111], v[76:79], a[108:111]
v_mfma_f32_16x16x32_bf16 a[112:115], v[112:115], v[76:79], a[112:115]
v_mfma_f32_16x16x32_bf16 a[116:119], v[116:119], v[76:79], a[116:119]
v_mfma_f32_16x16x32_bf16 a[120:123], v[120:123], v[76:79], a[120:123]
v_mfma_f32_16x16x32_bf16 a[124:127], v[124:127], v[76:79], a[124:127]
v_mfma_f32_16x16x32_bf16 a[128:131], v[96:99], v[80:83], a[128:131]
v_mfma_f32_16x16x32_bf16 a[132:135], v[100:103], v[80:83], a[132:135]
v_mfma_f32_16x16x32_bf16 a[136:139], v[104:107], v[80:83], a[136:139]
v_mfma_f32_16x16x32_bf16 a[140:143], v[108:111], v[80:83], a[140:143]
v_mfma_f32_16x16x32_bf16 a[144:147], v[112:115], v[80:83], a[144:147]
v_mfma_f32_16x16x32_bf16 a[148:151], v[116:119], v[80:83], a[148:151]
v_mfma_f32_16x16x32_bf16 a[152:155], v[120:123], v[80:83], a[152:155]
v_mfma_f32_16x16x32_bf16 a[156:159], v[124:127], v[80:83], a[156:159]
v_mfma_f32_16x16x32_bf16 a[160:163], v[96:99], v[84:87], a[160:163]
v_mfma_f32_16x16x32_bf16 a[164:167], v[100:103], v[84:87], a[164:167]
v_mfma_f32_16x16x32_bf16 a[168:171], v[104:107], v[84:87], a[168:171]
v_mfma_f32_16x16x32_bf16 a[172:175], v[108:111], v[84:87], a[172:175]
v_mfma_f32_16x16x32_bf16 a[176:179], v[112:115], v[84:87], a[176:179]
v_mfma_f32_16x16x32_bf16 a[180:183], v[116:119], v[84:87], a[180:183]
v_mfma_f32_16x16x32_bf16 a[184:187], v[120:123], v[84:87], a[184:187]
v_mfma_f32_16x16x32_bf16 a[188:191], v[124:127], v[84:87], a[188:191]
v_mfma_f32_16x16x32_bf16 a[192:195], v[96:99], v[88:91], a[192:195]
v_mfma_f32_16x16x32_bf16 a[196:199], v[100:103], v[88:91], a[196:199]
v_mfma_f32_16x16x32_bf16 a[200:203], v[104:107], v[88:91], a[200:203]
v_mfma_f32_16x16x32_bf16 a[204:207], v[108:111], v[88:91], a[204:207]
v_mfma_f32_16x16x32_bf16 a[208:211], v[112:115], v[88:91], a[208:211]
v_mfma_f32_16x16x32_bf16 a[212:215], v[116:119], v[88:91], a[212:215]
v_mfma_f32_16x16x32_bf16 a[216:219], v[120:123], v[88:91], a[216:219]
v_mfma_f32_16x16x32_bf16 a[220:223], v[124:127], v[88:91], a[220:223]
v_mfma_f32_16x16x32_bf16 a[224:227], v[96:99], v[92:95], a[224:227]
v_mfma_f32_16x16x32_bf16 a[228:231], v[100:103], v[92:95], a[228:231]
v_mfma_f32_16x16x32_bf16 a[232:235], v[104:107], v[92:95], a[232:235]
v_mfma_f32_16x16x32_bf16 a[236:239], v[108:111], v[92:95], a[236:239]
v_mfma_f32_16x16x32_bf16 a[240:243], v[112:115], v[92:95], a[240:243]
v_mfma_f32_16x16x32_bf16 a[244:247], v[116:119], v[92:95], a[244:247]
v_mfma_f32_16x16x32_bf16 a[248:251], v[120:123], v[92:95], a[248:251]
v_mfma_f32_16x16x32_bf16 a[252:255], v[124:127], v[92:95], a[252:255]
s_waitcnt lgkmcnt(0)
v_mfma_f32_16x16x32_bf16 a[0:3], v[160:163], v[128:131], a[0:3]
v_mfma_f32_16x16x32_bf16 a[4:7], v[164:167], v[128:131], a[4:7]
v_mfma_f32_16x16x32_bf16 a[8:11], v[168:171], v[128:131], a[8:11]
v_mfma_f32_16x16x32_bf16 a[12:15], v[172:175], v[128:131], a[12:15]
v_mfma_f32_16x16x32_bf16 a[16:19], v[176:179], v[128:131], a[16:19]
v_mfma_f32_16x16x32_bf16 a[20:23], v[180:183], v[128:131], a[20:23]
v_mfma_f32_16x16x32_bf16 a[24:27], v[184:187], v[128:131], a[24:27]
v_mfma_f32_16x16x32_bf16 a[28:31], v[188:191], v[128:131], a[28:31]
v_mfma_f32_16x16x32_bf16 a[32:35], v[160:163], v[132:135], a[32:35]
v_mfma_f32_16x16x32_bf16 a[36:39], v[164:167], v[132:135], a[36:39]
v_mfma_f32_16x16x32_bf16 a[40:43], v[168:171], v[132:135], a[40:43]
v_mfma_f32_16x16x32_bf16 a[44:47], v[172:175], v[132:135], a[44:47]
v_mfma_f32_16x16x32_bf16 a[48:51], v[176:179], v[132:135], a[48:51]
v_mfma_f32_16x16x32_bf16 a[52:55], v[180:183], v[132:135], a[52:55]
v_mfma_f32_16x16x32_bf16 a[56:59], v[184:187], v[132:135], a[56:59]
v_mfma_f32_16x16x32_bf16 a[60:63], v[188:191], v[132:135], a[60:63]
v_mfma_f32_16x16x32_bf16 a[64:67], v[160:163], v[136:139], a[64:67]
v_mfma_f32_16x16x32_bf16 a[68:71], v[164:167], v[136:139], a[68:71]
v_mfma_f32_16x16x32_bf16 a[72:75], v[168:171], v[136:139], a[72:75]
v_mfma_f32_16x16x32_bf16 a[76:79], v[172:175], v[136:139], a[76:79]
v_mfma_f32_16x16x32_bf16 a[80:83], v[176:179], v[136:139], a[80:83]
v_mfma_f32_16x16x32_bf16 a[84:87], v[180:183], v[136:139], a[84:87]
v_mfma_f32_16x16x32_bf16 a[88:91], v[184:187], v[136:139], a[88:91]
v_mfma_f32_16x16x32_bf16 a[92:95], v[188:191], v[136:139], a[92:95]
v_mfma_f32_16x16x32_bf16 a[96:99], v[160:163], v[140:143], a[96:99]
v_mfma_f32_16x16x32_bf16 a[100:103], v[164:167], v[140:143], a[100:103]
v_mfma_f32_16x16x32_bf16 a[104:107], v[168:171], v[140:143], a[104:107]
v_mfma_f32_16x16x32_bf16 a[108:111], v[172:175], v[140:143], a[108:111]
v_mfma_f32_16x16x32_bf16 a[112:115], v[176:179], v[140:143], a[112:115]
v_mfma_f32_16x16x32_bf16 a[116:119], v[180:183], v[140:143], a[116:119]
v_mfma_f32_16x16x32_bf16 a[120:123], v[184:187], v[140:143], a[120:123]
v_mfma_f32_16x16x32_bf16 a[124:127], v[188:191], v[140:143], a[124:127]
v_mfma_f32_16x16x32_bf16 a[128:131], v[160:163], v[144:147], a[128:131]
v_mfma_f32_16x16x32_bf16 a[132:135], v[164:167], v[144:147], a[132:135]
v_mfma_f32_16x16x32_bf16 a[136:139], v[168:171], v[144:147], a[136:139]
v_mfma_f32_16x16x32_bf16 a[140:143], v[172:175], v[144:147], a[140:143]
v_mfma_f32_16x16x32_bf16 a[144:147], v[176:179], v[144:147], a[144:147]
v_mfma_f32_16x16x32_bf16 a[148:151], v[180:183], v[144:147], a[148:151]
v_mfma_f32_16x16x32_bf16 a[152:155], v[184:187], v[144:147], a[152:155]
v_mfma_f32_16x16x32_bf16 a[156:159], v[188:191], v[144:147], a[156:159]
v_mfma_f32_16x16x32_bf16 a[160:163], v[160:163], v[148:151], a[160:163]
v_mfma_f32_16x16x32_bf16 a[164:167], v[164:167], v[148:151], a[164:167]
v_mfma_f32_16x16x32_bf16 a[168:171], v[168:171], v[148:151], a[168:171]
v_mfma_f32_16x16x32_bf16 a[172:175], v[172:175], v[148:151], a[172:175]
v_mfma_f32_16x16x32_bf16 a[176:179], v[176:179], v[148:151], a[176:179]
v_mfma_f32_16x16x32_bf16 a[180:183], v[180:183], v[148:151], a[180:183]
v_mfma_f32_16x16x32_bf16 a[184:187], v[184:187], v[148:151], a[184:187]
v_mfma_f32_16x16x32_bf16 a[188:191], v[188:191], v[148:151], a[188:191]
v_mfma_f32_16x16x32_bf16 a[192:195], v[160:163], v[152:155], a[192:195]
v_mfma_f32_16x16x32_bf16 a[196:199], v[164:167], v[152:155], a[196:199]
v_mfma_f32_16x16x32_bf16 a[200:203], v[168:171], v[152:155], a[200:203]
v_mfma_f32_16x16x32_bf16 a[204:207], v[172:175], v[152:155], a[204:207]
v_mfma_f32_16x16x32_bf16 a[208:211], v[176:179], v[152:155], a[208:211]
v_mfma_f32_16x16x32_bf16 a[212:215], v[180:183], v[152:155], a[212:215]
v_mfma_f32_16x16x32_bf16 a[216:219], v[184:187], v[152:155], a[216:219]
v_mfma_f32_16x16x32_bf16 a[220:223], v[188:191], v[152:155], a[220:223]
v_mfma_f32_16x16x32_bf16 a[224:227], v[160:163], v[156:159], a[224:227]
v_mfma_f32_16x16x32_bf16 a[228:231], v[164:167], v[156:159], a[228:231]
v_mfma_f32_16x16x32_bf16 a[232:235], v[168:171], v[156:159], a[232:235]
v_mfma_f32_16x16x32_bf16 a[236:239], v[172:175], v[156:159], a[236:239]
v_mfma_f32_16x16x32_bf16 a[240:243], v[176:179], v[156:159], a[240:243]
v_mfma_f32_16x16x32_bf16 a[244:247], v[180:183], v[156:159], a[244:247]
v_mfma_f32_16x16x32_bf16 a[248:251], v[184:187], v[156:159], a[248:251]
v_mfma_f32_16x16x32_bf16 a[252:255], v[188:191], v[156:159], a[252:255]
s_nop 7
s_mov_b32 s42, 1.0
s_cmp_eq_u32 s28, 2
s_cselect_b32 s39, s34, 0
s_cmp_eq_u32 s39, 0
s_cbranch_scc1 HB_51
s_barrier
HB_51:
s_lshl_b32 s36, s28, 21
s_lshl_b32 s37, s34, 20
s_add_u32 s36, s36, s37
s_lshl_b32 s37, s29, 14
s_add_u32 s36, s36, s37
s_lshl_b32 s37, s35, 13
s_add_u32 s36, s36, s37
s_add_u32 s36, s36, 58720256
s_add_u32 s38, s36, 0
v_accvgpr_read_b32 v64, a0
v_accvgpr_read_b32 v65, a1
v_accvgpr_read_b32 v66, a2
v_accvgpr_read_b32 v67, a3
v_accvgpr_read_b32 v68, a4
v_accvgpr_read_b32 v69, a5
v_accvgpr_read_b32 v70, a6
v_accvgpr_read_b32 v71, a7
v_cvt_pk_bf16_f32 v72, v64, v65
v_cvt_pk_bf16_f32 v73, v66, v67
v_cvt_pk_bf16_f32 v74, v68, v69
v_cvt_pk_bf16_f32 v75, v70, v71
buffer_store_dwordx4 v[72:75], v61, s[4:7], s38 offen offset:0 sc1
v_accvgpr_read_b32 v80, a32
v_accvgpr_read_b32 v81, a33
v_accvgpr_read_b32 v82, a34
v_accvgpr_read_b32 v83, a35
v_accvgpr_read_b32 v84, a36
v_accvgpr_read_b32 v85, a37
v_accvgpr_read_b32 v86, a38
v_accvgpr_read_b32 v87, a39
v_cvt_pk_bf16_f32 v88, v80, v81
v_cvt_pk_bf16_f32 v89, v82, v83
v_cvt_pk_bf16_f32 v90, v84, v85
v_cvt_pk_bf16_f32 v91, v86, v87
buffer_store_dwordx4 v[88:91], v61, s[4:7], s38 offen offset:1024 sc1
v_accvgpr_read_b32 v96, a64
v_accvgpr_read_b32 v97, a65
v_accvgpr_read_b32 v98, a66
v_accvgpr_read_b32 v99, a67
v_accvgpr_read_b32 v100, a68
v_accvgpr_read_b32 v101, a69
v_accvgpr_read_b32 v102, a70
v_accvgpr_read_b32 v103, a71
v_cvt_pk_bf16_f32 v104, v96, v97
v_cvt_pk_bf16_f32 v105, v98, v99
v_cvt_pk_bf16_f32 v106, v100, v101
v_cvt_pk_bf16_f32 v107, v102, v103
buffer_store_dwordx4 v[104:107], v61, s[4:7], s38 offen offset:2048 sc1
v_accvgpr_read_b32 v112, a96
v_accvgpr_read_b32 v113, a97
v_accvgpr_read_b32 v114, a98
v_accvgpr_read_b32 v115, a99
v_accvgpr_read_b32 v116, a100
v_accvgpr_read_b32 v117, a101
v_accvgpr_read_b32 v118, a102
v_accvgpr_read_b32 v119, a103
v_cvt_pk_bf16_f32 v120, v112, v113
v_cvt_pk_bf16_f32 v121, v114, v115
v_cvt_pk_bf16_f32 v122, v116, v117
v_cvt_pk_bf16_f32 v123, v118, v119
buffer_store_dwordx4 v[120:123], v61, s[4:7], s38 offen offset:3072 sc1
s_add_u32 s38, s36, 4096
v_accvgpr_read_b32 v64, a128
v_accvgpr_read_b32 v65, a129
v_accvgpr_read_b32 v66, a130
v_accvgpr_read_b32 v67, a131
v_accvgpr_read_b32 v68, a132
v_accvgpr_read_b32 v69, a133
v_accvgpr_read_b32 v70, a134
v_accvgpr_read_b32 v71, a135
v_cvt_pk_bf16_f32 v72, v64, v65
v_cvt_pk_bf16_f32 v73, v66, v67
v_cvt_pk_bf16_f32 v74, v68, v69
v_cvt_pk_bf16_f32 v75, v70, v71
buffer_store_dwordx4 v[72:75], v61, s[4:7], s38 offen offset:0 sc1
v_accvgpr_read_b32 v80, a160
v_accvgpr_read_b32 v81, a161
v_accvgpr_read_b32 v82, a162
v_accvgpr_read_b32 v83, a163
v_accvgpr_read_b32 v84, a164
v_accvgpr_read_b32 v85, a165
v_accvgpr_read_b32 v86, a166
v_accvgpr_read_b32 v87, a167
v_cvt_pk_bf16_f32 v88, v80, v81
v_cvt_pk_bf16_f32 v89, v82, v83
v_cvt_pk_bf16_f32 v90, v84, v85
v_cvt_pk_bf16_f32 v91, v86, v87
buffer_store_dwordx4 v[88:91], v61, s[4:7], s38 offen offset:1024 sc1
v_accvgpr_read_b32 v96, a192
v_accvgpr_read_b32 v97, a193
v_accvgpr_read_b32 v98, a194
v_accvgpr_read_b32 v99, a195
v_accvgpr_read_b32 v100, a196
v_accvgpr_read_b32 v101, a197
v_accvgpr_read_b32 v102, a198
v_accvgpr_read_b32 v103, a199
v_cvt_pk_bf16_f32 v104, v96, v97
v_cvt_pk_bf16_f32 v105, v98, v99
v_cvt_pk_bf16_f32 v106, v100, v101
v_cvt_pk_bf16_f32 v107, v102, v103
buffer_store_dwordx4 v[104:107], v61, s[4:7], s38 offen offset:2048 sc1
v_accvgpr_read_b32 v112, a224
v_accvgpr_read_b32 v113, a225
v_accvgpr_read_b32 v114, a226
v_accvgpr_read_b32 v115, a227
v_accvgpr_read_b32 v116, a228
v_accvgpr_read_b32 v117, a229
v_accvgpr_read_b32 v118, a230
v_accvgpr_read_b32 v119, a231
v_cvt_pk_bf16_f32 v120, v112, v113
v_cvt_pk_bf16_f32 v121, v114, v115
v_cvt_pk_bf16_f32 v122, v116, v117
v_cvt_pk_bf16_f32 v123, v118, v119
buffer_store_dwordx4 v[120:123], v61, s[4:7], s38 offen offset:3072 sc1
s_add_u32 s38, s36, 262144
v_accvgpr_read_b32 v64, a8
v_accvgpr_read_b32 v65, a9
v_accvgpr_read_b32 v66, a10
v_accvgpr_read_b32 v67, a11
v_accvgpr_read_b32 v68, a12
v_accvgpr_read_b32 v69, a13
v_accvgpr_read_b32 v70, a14
v_accvgpr_read_b32 v71, a15
v_cvt_pk_bf16_f32 v72, v64, v65
v_cvt_pk_bf16_f32 v73, v66, v67
v_cvt_pk_bf16_f32 v74, v68, v69
v_cvt_pk_bf16_f32 v75, v70, v71
buffer_store_dwordx4 v[72:75], v61, s[4:7], s38 offen offset:0 sc1
v_accvgpr_read_b32 v80, a40
v_accvgpr_read_b32 v81, a41
v_accvgpr_read_b32 v82, a42
v_accvgpr_read_b32 v83, a43
v_accvgpr_read_b32 v84, a44
v_accvgpr_read_b32 v85, a45
v_accvgpr_read_b32 v86, a46
v_accvgpr_read_b32 v87, a47
v_cvt_pk_bf16_f32 v88, v80, v81
v_cvt_pk_bf16_f32 v89, v82, v83
v_cvt_pk_bf16_f32 v90, v84, v85
v_cvt_pk_bf16_f32 v91, v86, v87
buffer_store_dwordx4 v[88:91], v61, s[4:7], s38 offen offset:1024 sc1
v_accvgpr_read_b32 v96, a72
v_accvgpr_read_b32 v97, a73
v_accvgpr_read_b32 v98, a74
v_accvgpr_read_b32 v99, a75
v_accvgpr_read_b32 v100, a76
v_accvgpr_read_b32 v101, a77
v_accvgpr_read_b32 v102, a78
v_accvgpr_read_b32 v103, a79
v_cvt_pk_bf16_f32 v104, v96, v97
v_cvt_pk_bf16_f32 v105, v98, v99
v_cvt_pk_bf16_f32 v106, v100, v101
v_cvt_pk_bf16_f32 v107, v102, v103
buffer_store_dwordx4 v[104:107], v61, s[4:7], s38 offen offset:2048 sc1
v_accvgpr_read_b32 v112, a104
v_accvgpr_read_b32 v113, a105
v_accvgpr_read_b32 v114, a106
v_accvgpr_read_b32 v115, a107
v_accvgpr_read_b32 v116, a108
v_accvgpr_read_b32 v117, a109
v_accvgpr_read_b32 v118, a110
v_accvgpr_read_b32 v119, a111
v_cvt_pk_bf16_f32 v120, v112, v113
v_cvt_pk_bf16_f32 v121, v114, v115
v_cvt_pk_bf16_f32 v122, v116, v117
v_cvt_pk_bf16_f32 v123, v118, v119
buffer_store_dwordx4 v[120:123], v61, s[4:7], s38 offen offset:3072 sc1
s_add_u32 s38, s36, 266240
v_accvgpr_read_b32 v64, a136
v_accvgpr_read_b32 v65, a137
v_accvgpr_read_b32 v66, a138
v_accvgpr_read_b32 v67, a139
v_accvgpr_read_b32 v68, a140
v_accvgpr_read_b32 v69, a141
v_accvgpr_read_b32 v70, a142
v_accvgpr_read_b32 v71, a143
v_cvt_pk_bf16_f32 v72, v64, v65
v_cvt_pk_bf16_f32 v73, v66, v67
v_cvt_pk_bf16_f32 v74, v68, v69
v_cvt_pk_bf16_f32 v75, v70, v71
buffer_store_dwordx4 v[72:75], v61, s[4:7], s38 offen offset:0 sc1
v_accvgpr_read_b32 v80, a168
v_accvgpr_read_b32 v81, a169
v_accvgpr_read_b32 v82, a170
v_accvgpr_read_b32 v83, a171
v_accvgpr_read_b32 v84, a172
v_accvgpr_read_b32 v85, a173
v_accvgpr_read_b32 v86, a174
v_accvgpr_read_b32 v87, a175
v_cvt_pk_bf16_f32 v88, v80, v81
v_cvt_pk_bf16_f32 v89, v82, v83
v_cvt_pk_bf16_f32 v90, v84, v85
v_cvt_pk_bf16_f32 v91, v86, v87
buffer_store_dwordx4 v[88:91], v61, s[4:7], s38 offen offset:1024 sc1
v_accvgpr_read_b32 v96, a200
v_accvgpr_read_b32 v97, a201
v_accvgpr_read_b32 v98, a202
v_accvgpr_read_b32 v99, a203
v_accvgpr_read_b32 v100, a204
v_accvgpr_read_b32 v101, a205
v_accvgpr_read_b32 v102, a206
v_accvgpr_read_b32 v103, a207
v_cvt_pk_bf16_f32 v104, v96, v97
v_cvt_pk_bf16_f32 v105, v98, v99
v_cvt_pk_bf16_f32 v106, v100, v101
v_cvt_pk_bf16_f32 v107, v102, v103
buffer_store_dwordx4 v[104:107], v61, s[4:7], s38 offen offset:2048 sc1
v_accvgpr_read_b32 v112, a232
v_accvgpr_read_b32 v113, a233
v_accvgpr_read_b32 v114, a234
v_accvgpr_read_b32 v115, a235
v_accvgpr_read_b32 v116, a236
v_accvgpr_read_b32 v117, a237
v_accvgpr_read_b32 v118, a238
v_accvgpr_read_b32 v119, a239
v_cvt_pk_bf16_f32 v120, v112, v113
v_cvt_pk_bf16_f32 v121, v114, v115
v_cvt_pk_bf16_f32 v122, v116, v117
v_cvt_pk_bf16_f32 v123, v118, v119
buffer_store_dwordx4 v[120:123], v61, s[4:7], s38 offen offset:3072 sc1
s_cmp_eq_u32 s28, 2
s_cselect_b32 s39, s34, 1
s_cmp_lg_u32 s39, 0
s_cbranch_scc1 HB_52
s_waitcnt vmcnt(0)
s_barrier
s_cmp_lg_u32 s24, 0
s_cbranch_scc1 HB_52
s_lshl_b32 s39, s29, 7
s_add_u32 s39, s39, 119578628
v_mov_b32 v16, 1
v_mov_b32 v17, 0
s_mov_b64 exec, 1
buffer_store_dword v16, v17, s[4:7], s39 offen sc1
s_mov_b64 exec, -1
HB_52:
s_add_u32 s38, s36, 524288
v_accvgpr_read_b32 v64, a16
v_accvgpr_read_b32 v65, a17
v_accvgpr_read_b32 v66, a18
v_accvgpr_read_b32 v67, a19
v_accvgpr_read_b32 v68, a20
v_accvgpr_read_b32 v69, a21
v_accvgpr_read_b32 v70, a22
v_accvgpr_read_b32 v71, a23
v_cvt_pk_bf16_f32 v72, v64, v65
v_cvt_pk_bf16_f32 v73, v66, v67
v_cvt_pk_bf16_f32 v74, v68, v69
v_cvt_pk_bf16_f32 v75, v70, v71
buffer_store_dwordx4 v[72:75], v61, s[4:7], s38 offen offset:0 sc1
v_accvgpr_read_b32 v80, a48
v_accvgpr_read_b32 v81, a49
v_accvgpr_read_b32 v82, a50
v_accvgpr_read_b32 v83, a51
v_accvgpr_read_b32 v84, a52
v_accvgpr_read_b32 v85, a53
v_accvgpr_read_b32 v86, a54
v_accvgpr_read_b32 v87, a55
v_cvt_pk_bf16_f32 v88, v80, v81
v_cvt_pk_bf16_f32 v89, v82, v83
v_cvt_pk_bf16_f32 v90, v84, v85
v_cvt_pk_bf16_f32 v91, v86, v87
buffer_store_dwordx4 v[88:91], v61, s[4:7], s38 offen offset:1024 sc1
v_accvgpr_read_b32 v96, a80
v_accvgpr_read_b32 v97, a81
v_accvgpr_read_b32 v98, a82
v_accvgpr_read_b32 v99, a83
v_accvgpr_read_b32 v100, a84
v_accvgpr_read_b32 v101, a85
v_accvgpr_read_b32 v102, a86
v_accvgpr_read_b32 v103, a87
v_cvt_pk_bf16_f32 v104, v96, v97
v_cvt_pk_bf16_f32 v105, v98, v99
v_cvt_pk_bf16_f32 v106, v100, v101
v_cvt_pk_bf16_f32 v107, v102, v103
buffer_store_dwordx4 v[104:107], v61, s[4:7], s38 offen offset:2048 sc1
v_accvgpr_read_b32 v112, a112
v_accvgpr_read_b32 v113, a113
v_accvgpr_read_b32 v114, a114
v_accvgpr_read_b32 v115, a115
v_accvgpr_read_b32 v116, a116
v_accvgpr_read_b32 v117, a117
v_accvgpr_read_b32 v118, a118
v_accvgpr_read_b32 v119, a119
v_cvt_pk_bf16_f32 v120, v112, v113
v_cvt_pk_bf16_f32 v121, v114, v115
v_cvt_pk_bf16_f32 v122, v116, v117
v_cvt_pk_bf16_f32 v123, v118, v119
buffer_store_dwordx4 v[120:123], v61, s[4:7], s38 offen offset:3072 sc1
s_add_u32 s38, s36, 528384
v_accvgpr_read_b32 v64, a144
v_accvgpr_read_b32 v65, a145
v_accvgpr_read_b32 v66, a146
v_accvgpr_read_b32 v67, a147
v_accvgpr_read_b32 v68, a148
v_accvgpr_read_b32 v69, a149
v_accvgpr_read_b32 v70, a150
v_accvgpr_read_b32 v71, a151
v_cvt_pk_bf16_f32 v72, v64, v65
v_cvt_pk_bf16_f32 v73, v66, v67
v_cvt_pk_bf16_f32 v74, v68, v69
v_cvt_pk_bf16_f32 v75, v70, v71
buffer_store_dwordx4 v[72:75], v61, s[4:7], s38 offen offset:0 sc1
v_accvgpr_read_b32 v80, a176
v_accvgpr_read_b32 v81, a177
v_accvgpr_read_b32 v82, a178
v_accvgpr_read_b32 v83, a179
v_accvgpr_read_b32 v84, a180
v_accvgpr_read_b32 v85, a181
v_accvgpr_read_b32 v86, a182
v_accvgpr_read_b32 v87, a183
v_cvt_pk_bf16_f32 v88, v80, v81
v_cvt_pk_bf16_f32 v89, v82, v83
v_cvt_pk_bf16_f32 v90, v84, v85
v_cvt_pk_bf16_f32 v91, v86, v87
buffer_store_dwordx4 v[88:91], v61, s[4:7], s38 offen offset:1024 sc1
v_accvgpr_read_b32 v96, a208
v_accvgpr_read_b32 v97, a209
v_accvgpr_read_b32 v98, a210
v_accvgpr_read_b32 v99, a211
v_accvgpr_read_b32 v100, a212
v_accvgpr_read_b32 v101, a213
v_accvgpr_read_b32 v102, a214
v_accvgpr_read_b32 v103, a215
v_cvt_pk_bf16_f32 v104, v96, v97
v_cvt_pk_bf16_f32 v105, v98, v99
v_cvt_pk_bf16_f32 v106, v100, v101
v_cvt_pk_bf16_f32 v107, v102, v103
buffer_store_dwordx4 v[104:107], v61, s[4:7], s38 offen offset:2048 sc1
v_accvgpr_read_b32 v112, a240
v_accvgpr_read_b32 v113, a241
v_accvgpr_read_b32 v114, a242
v_accvgpr_read_b32 v115, a243
v_accvgpr_read_b32 v116, a244
v_accvgpr_read_b32 v117, a245
v_accvgpr_read_b32 v118, a246
v_accvgpr_read_b32 v119, a247
v_cvt_pk_bf16_f32 v120, v112, v113
v_cvt_pk_bf16_f32 v121, v114, v115
v_cvt_pk_bf16_f32 v122, v116, v117
v_cvt_pk_bf16_f32 v123, v118, v119
buffer_store_dwordx4 v[120:123], v61, s[4:7], s38 offen offset:3072 sc1
s_add_u32 s38, s36, 786432
v_accvgpr_read_b32 v64, a24
v_accvgpr_read_b32 v65, a25
v_accvgpr_read_b32 v66, a26
v_accvgpr_read_b32 v67, a27
v_accvgpr_read_b32 v68, a28
v_accvgpr_read_b32 v69, a29
v_accvgpr_read_b32 v70, a30
v_accvgpr_read_b32 v71, a31
v_cvt_pk_bf16_f32 v72, v64, v65
v_cvt_pk_bf16_f32 v73, v66, v67
v_cvt_pk_bf16_f32 v74, v68, v69
v_cvt_pk_bf16_f32 v75, v70, v71
buffer_store_dwordx4 v[72:75], v61, s[4:7], s38 offen offset:0 sc1
v_accvgpr_read_b32 v80, a56
v_accvgpr_read_b32 v81, a57
v_accvgpr_read_b32 v82, a58
v_accvgpr_read_b32 v83, a59
v_accvgpr_read_b32 v84, a60
v_accvgpr_read_b32 v85, a61
v_accvgpr_read_b32 v86, a62
v_accvgpr_read_b32 v87, a63
v_cvt_pk_bf16_f32 v88, v80, v81
v_cvt_pk_bf16_f32 v89, v82, v83
v_cvt_pk_bf16_f32 v90, v84, v85
v_cvt_pk_bf16_f32 v91, v86, v87
buffer_store_dwordx4 v[88:91], v61, s[4:7], s38 offen offset:1024 sc1
v_accvgpr_read_b32 v96, a88
v_accvgpr_read_b32 v97, a89
v_accvgpr_read_b32 v98, a90
v_accvgpr_read_b32 v99, a91
v_accvgpr_read_b32 v100, a92
v_accvgpr_read_b32 v101, a93
v_accvgpr_read_b32 v102, a94
v_accvgpr_read_b32 v103, a95
v_cvt_pk_bf16_f32 v104, v96, v97
v_cvt_pk_bf16_f32 v105, v98, v99
v_cvt_pk_bf16_f32 v106, v100, v101
v_cvt_pk_bf16_f32 v107, v102, v103
buffer_store_dwordx4 v[104:107], v61, s[4:7], s38 offen offset:2048 sc1
v_accvgpr_read_b32 v112, a120
v_accvgpr_read_b32 v113, a121
v_accvgpr_read_b32 v114, a122
v_accvgpr_read_b32 v115, a123
v_accvgpr_read_b32 v116, a124
v_accvgpr_read_b32 v117, a125
v_accvgpr_read_b32 v118, a126
v_accvgpr_read_b32 v119, a127
v_cvt_pk_bf16_f32 v120, v112, v113
v_cvt_pk_bf16_f32 v121, v114, v115
v_cvt_pk_bf16_f32 v122, v116, v117
v_cvt_pk_bf16_f32 v123, v118, v119
buffer_store_dwordx4 v[120:123], v61, s[4:7], s38 offen offset:3072 sc1
s_add_u32 s38, s36, 790528
v_accvgpr_read_b32 v64, a152
v_accvgpr_read_b32 v65, a153
v_accvgpr_read_b32 v66, a154
v_accvgpr_read_b32 v67, a155
v_accvgpr_read_b32 v68, a156
v_accvgpr_read_b32 v69, a157
v_accvgpr_read_b32 v70, a158
v_accvgpr_read_b32 v71, a159
v_cvt_pk_bf16_f32 v72, v64, v65
v_cvt_pk_bf16_f32 v73, v66, v67
v_cvt_pk_bf16_f32 v74, v68, v69
v_cvt_pk_bf16_f32 v75, v70, v71
buffer_store_dwordx4 v[72:75], v61, s[4:7], s38 offen offset:0 sc1
v_accvgpr_read_b32 v80, a184
v_accvgpr_read_b32 v81, a185
v_accvgpr_read_b32 v82, a186
v_accvgpr_read_b32 v83, a187
v_accvgpr_read_b32 v84, a188
v_accvgpr_read_b32 v85, a189
v_accvgpr_read_b32 v86, a190
v_accvgpr_read_b32 v87, a191
v_cvt_pk_bf16_f32 v88, v80, v81
v_cvt_pk_bf16_f32 v89, v82, v83
v_cvt_pk_bf16_f32 v90, v84, v85
v_cvt_pk_bf16_f32 v91, v86, v87
buffer_store_dwordx4 v[88:91], v61, s[4:7], s38 offen offset:1024 sc1
v_accvgpr_read_b32 v96, a216
v_accvgpr_read_b32 v97, a217
v_accvgpr_read_b32 v98, a218
v_accvgpr_read_b32 v99, a219
v_accvgpr_read_b32 v100, a220
v_accvgpr_read_b32 v101, a221
v_accvgpr_read_b32 v102, a222
v_accvgpr_read_b32 v103, a223
v_cvt_pk_bf16_f32 v104, v96, v97
v_cvt_pk_bf16_f32 v105, v98, v99
v_cvt_pk_bf16_f32 v106, v100, v101
v_cvt_pk_bf16_f32 v107, v102, v103
buffer_store_dwordx4 v[104:107], v61, s[4:7], s38 offen offset:2048 sc1
v_accvgpr_read_b32 v112, a248
v_accvgpr_read_b32 v113, a249
v_accvgpr_read_b32 v114, a250
v_accvgpr_read_b32 v115, a251
v_accvgpr_read_b32 v116, a252
v_accvgpr_read_b32 v117, a253
v_accvgpr_read_b32 v118, a254
v_accvgpr_read_b32 v119, a255
v_cvt_pk_bf16_f32 v120, v112, v113
v_cvt_pk_bf16_f32 v121, v114, v115
v_cvt_pk_bf16_f32 v122, v116, v117
v_cvt_pk_bf16_f32 v123, v118, v119
buffer_store_dwordx4 v[120:123], v61, s[4:7], s38 offen offset:3072 sc1
s_lshl_b32 s36, s28, 11
s_lshl_b32 s37, s29, 7
s_add_u32 s36, s36, s37
s_add_u32 s36, s36, 119578628
v_lshlrev_b32 v7, 7, v1
s_mov_b32 s46, 119545856
s_mov_b32 s47, 119554048
s_cmp_lg_u32 s24, 0
s_cbranch_scc1 TI_53
s_lshl_b32 s26, s20, 8
s_add_u32 s26, s26, 119537664
v_mov_b32 v2, 1
v_mov_b32 v3, 0
buffer_load_dword v5, v7, s[4:7], s46 offen sc1
buffer_load_dword v6, v7, s[4:7], s47 offen sc1
s_mov_b64 exec, 1
buffer_atomic_add v2, v3, s[4:7], s26 offen sc0 sc1
s_mov_b64 exec, -1
TI_53:
v_mov_b32 v4, 163808
s_waitcnt vmcnt(0)
s_cmp_lg_u32 s24, 0
s_cbranch_scc1 TP_54
s_mov_b32 s44, 0
TPL_55:
v_and_b32 v5, v5, v6
v_cmp_eq_u32 vcc, 0, v5
s_cbranch_vccz TPK_56
buffer_load_dword v5, v7, s[4:7], s46 offen sc1
buffer_load_dword v6, v7, s[4:7], s47 offen sc1
s_add_u32 s44, s44, 1
s_waitcnt vmcnt(0)
s_cmp_lt_u32 s44, 40000
s_cbranch_scc1 TPL_55
TPK_56:
s_mov_b64 exec, 1
ds_write_b32 v4, v2
s_mov_b64 exec, -1
s_waitcnt lgkmcnt(0)
TP_54:
s_barrier
ds_read_b32 v2, v4
s_cmp_lg_u32 s24, 0
s_cbranch_scc1 W_TICKET
v_mov_b32 v16, 1
v_mov_b32 v17, 0
s_mov_b64 exec, 1
buffer_store_dword v16, v17, s[4:7], s36 offen sc1
s_mov_b64 exec, -1
s_branch W_TICKET
T_Q:
s_load_dwordx2 s[8:9], s[0:1], 16
s_mov_b32 s10, 8388608
s_mov_b32 s11, 0x20000
s_lshl_b32 s30, s29, 9
s_mul_i32 s31, s28, 524288
s_add_u32 s31, s31, 0
s_lshl_b32 s32, s24, 12
s_add_u32 s33, s32, 65536
s_lshr_b32 s34, s24, 1
s_and_b32 s35, s24, 1
v_lshrrev_b32 v16, 5, v1
v_and_b32 v17, 31, v1
v_lshlrev_b32 v18, 1, v16
v_xor_b32 v17, v17, v18
s_lshl_b32 s36, s24, 3
v_add_u32 v16, s36, v16
s_mov_b32 s36, 8192
v_mul_lo_u32 v16, v16, s36
v_xor_b32 v18, 0, v17
v_lshl_add_u32 v18, v18, 4, v16
v_add_u32 v11, 0, v18
v_xor_b32 v18, 4, v17
v_lshl_add_u32 v18, v18, 4, v16
v_add_u32 v12, 15360, v18
v_xor_b32 v18, 8, v17
v_lshl_add_u32 v18, v18, 4, v16
v_add_u32 v13, 30720, v18
v_xor_b32 v18, 12, v17
v_lshl_add_u32 v18, v18, 4, v16
v_add_u32 v14, 46080, v18
v_lshlrev_b32 v61, 4, v1
v_add_u32 v15, s32, v61
s_lshl_b32 s36, s34, 13
s_add_u32 s36, s36, 65536
v_add_u32 v10, s36, v61
v_lshrrev_b32 v16, 2, v1
v_and_b32 v17, 7, v16
v_lshlrev_b32 v17, 1, v17
v_lshlrev_b32 v16, 9, v16
v_and_b32 v18, 3, v1
v_lshl_add_u32 v16, v18, 3, v16
s_lshl_b32 s36, s35, 8
v_add_u32 v16, s36, v16
v_xor_b32 v18, 0, v17
v_lshl_add_u32 v2, v18, 4, v16
v_xor_b32 v18, 2, v17
v_lshl_add_u32 v3, v18, 4, v16
v_xor_b32 v18, 4, v17
v_lshl_add_u32 v4, v18, 4, v16
v_xor_b32 v18, 6, v17
v_lshl_add_u32 v5, v18, 4, v16
v_xor_b32 v18, 8, v17
v_lshl_add_u32 v6, v18, 4, v16
v_xor_b32 v18, 10, v17
v_lshl_add_u32 v7, v18, 4, v16
v_xor_b32 v18, 12, v17
v_lshl_add_u32 v8, v18, 4, v16
v_xor_b32 v18, 14, v17
v_lshl_add_u32 v9, v18, 4, v16
s_waitcnt lgkmcnt(0)
v_mov_b32 v16, 0
v_mov_b32 v17, 0
v_mov_b32 v18, 0
v_mov_b32 v19, 0
v_mov_b32 v20, 0
v_mov_b32 v21, 0
v_mov_b32 v22, 0
v_mov_b32 v23, 0
v_mov_b32 v24, 0
v_mov_b32 v25, 0
v_mov_b32 v26, 0
v_mov_b32 v27, 0
v_mov_b32 v28, 0
v_mov_b32 v29, 0
v_mov_b32 v30, 0
v_mov_b32 v31, 0
v_mov_b32 v32, 0
v_mov_b32 v33, 0
v_mov_b32 v34, 0
v_mov_b32 v35, 0
v_mov_b32 v36, 0
v_mov_b32 v37, 0
v_mov_b32 v38, 0
v_mov_b32 v39, 0
v_mov_b32 v40, 0
v_mov_b32 v41, 0
v_mov_b32 v42, 0
v_mov_b32 v43, 0
v_mov_b32 v44, 0
v_mov_b32 v45, 0
v_mov_b32 v46, 0
v_mov_b32 v47, 0
v_mov_b32 v48, 0
v_mov_b32 v49, 0
v_mov_b32 v50, 0
v_mov_b32 v51, 0
v_mov_b32 v52, 0
v_mov_b32 v53, 0
v_mov_b32 v54, 0
v_mov_b32 v55, 0
s_add_u32 m0, s32, 0
s_nop 0
buffer_load_dwordx4 v11, s[8:11], s30 offen offset:0 lds
buffer_load_dwordx4 v12, s[8:11], s30 offen offset:1024 lds
buffer_load_dwordx4 v13, s[8:11], s30 offen offset:2048 lds
buffer_load_dwordx4 v14, s[8:11], s30 offen offset:3072 lds
s_add_u32 m0, s33, 0
s_nop 0
buffer_load_dwordx4 v15, s[4:7], s31 offen offset:0 sc1 lds
buffer_load_dwordx4 v15, s[4:7], s31 offen offset:1024 sc1 lds
buffer_load_dwordx4 v15, s[4:7], s31 offen offset:2048 sc1 lds
buffer_load_dwordx4 v15, s[4:7], s31 offen offset:3072 sc1 lds
s_add_u32 s30, s30, 262144
s_add_u32 s31, s31, 16384
s_add_u32 m0, s32, 16384
s_nop 0
buffer_load_dwordx4 v11, s[8:11], s30 offen offset:0 lds
buffer_load_dwordx4 v12, s[8:11], s30 offen offset:1024 lds
buffer_load_dwordx4 v13, s[8:11], s30 offen offset:2048 lds
buffer_load_dwordx4 v14, s[8:11], s30 offen offset:3072 lds
s_add_u32 m0, s33, 16384
s_nop 0
buffer_load_dwordx4 v15, s[4:7], s31 offen offset:0 sc1 lds
buffer_load_dwordx4 v15, s[4:7], s31 offen offset:1024 sc1 lds
buffer_load_dwordx4 v15, s[4:7], s31 offen offset:2048 sc1 lds
buffer_load_dwordx4 v15, s[4:7], s31 offen offset:3072 sc1 lds
s_add_u32 s30, s30, 262144
s_add_u32 s31, s31, 16384
s_add_u32 m0, s32, 32768
s_nop 0
buffer_load_dwordx4 v11, s[8:11], s30 offen offset:0 lds
buffer_load_dwordx4 v12, s[8:11], s30 offen offset:1024 lds
buffer_load_dwordx4 v13, s[8:11], s30 offen offset:2048 lds
buffer_load_dwordx4 v14, s[8:11], s30 offen offset:3072 lds
s_add_u32 m0, s33, 32768
s_nop 0
buffer_load_dwordx4 v15, s[4:7], s31 offen offset:0 sc1 lds
buffer_load_dwordx4 v15, s[4:7], s31 offen offset:1024 sc1 lds
buffer_load_dwordx4 v15, s[4:7], s31 offen offset:2048 sc1 lds
buffer_load_dwordx4 v15, s[4:7], s31 offen offset:3072 sc1 lds
s_add_u32 s30, s30, 262144
s_add_u32 s31, s31, 16384
v_mfma_f32_16x16x32_bf16 a[0:3], v[16:19], v[48:51], 0
v_mfma_f32_16x16x32_bf16 a[4:7], v[16:19], v[48:51], 0
v_mfma_f32_16x16x32_bf16 a[8:11], v[16:19], v[48:51], 0
v_mfma_f32_16x16x32_bf16 a[12:15], v[16:19], v[48:51], 0
v_mfma_f32_16x16x32_bf16 a[16:19], v[16:19], v[48:51], 0
v_mfma_f32_16x16x32_bf16 a[20:23], v[16:19], v[48:51], 0
v_mfma_f32_16x16x32_bf16 a[24:27], v[16:19], v[48:51], 0
v_mfma_f32_16x16x32_bf16 a[28:31], v[16:19], v[48:51], 0
v_mfma_f32_16x16x32_bf16 a[32:35], v[20:23], v[48:51], 0
v_mfma_f32_16x16x32_bf16 a[36:39], v[20:23], v[48:51], 0
v_mfma_f32_16x16x32_bf16 a[40:43], v[20:23], v[48:51], 0
v_mfma_f32_16x16x32_bf16 a[44:47], v[20:23], v[48:51], 0
v_mfma_f32_16x16x32_bf16 a[48:51], v[20:23], v[48:51], 0
v_mfma_f32_16x16x32_bf16 a[52:55], v[20:23], v[48:51], 0
v_mfma_f32_16x16x32_bf16 a[56:59], v[20:23], v[48:51], 0
v_mfma_f32_16x16x32_bf16 a[60:63], v[20:23], v[48:51], 0
v_mfma_f32_16x16x32_bf16 a[64:67], v[24:27], v[48:51], 0
v_mfma_f32_16x16x32_bf16 a[68:71], v[24:27], v[48:51], 0
v_mfma_f32_16x16x32_bf16 a[72:75], v[24:27], v[48:51], 0
v_mfma_f32_16x16x32_bf16 a[76:79], v[24:27], v[48:51], 0
v_mfma_f32_16x16x32_bf16 a[80:83], v[24:27], v[48:51], 0
v_mfma_f32_16x16x32_bf16 a[84:87], v[24:27], v[48:51], 0
v_mfma_f32_16x16x32_bf16 a[88:91], v[24:27], v[48:51], 0
v_mfma_f32_16x16x32_bf16 a[92:95], v[24:27], v[48:51], 0
v_mfma_f32_16x16x32_bf16 a[96:99], v[28:31], v[48:51], 0
v_mfma_f32_16x16x32_bf16 a[100:103], v[28:31], v[48:51], 0
v_mfma_f32_16x16x32_bf16 a[104:107], v[28:31], v[48:51], 0
v_mfma_f32_16x16x32_bf16 a[108:111], v[28:31], v[48:51], 0
v_mfma_f32_16x16x32_bf16 a[112:115], v[28:31], v[48:51], 0
v_mfma_f32_16x16x32_bf16 a[116:119], v[28:31], v[48:51], 0
v_mfma_f32_16x16x32_bf16 a[120:123], v[28:31], v[48:51], 0
v_mfma_f32_16x16x32_bf16 a[124:127], v[28:31], v[48:51], 0
v_mfma_f32_16x16x32_bf16 a[128:131], v[32:35], v[48:51], 0
v_mfma_f32_16x16x32_bf16 a[132:135], v[32:35], v[48:51], 0
v_mfma_f32_16x16x32_bf16 a[136:139], v[32:35], v[48:51], 0
v_mfma_f32_16x16x32_bf16 a[140:143], v[32:35], v[48:51], 0
v_mfma_f32_16x16x32_bf16 a[144:147], v[32:35], v[48:51], 0
v_mfma_f32_16x16x32_bf16 a[148:151], v[32:35], v[48:51], 0
v_mfma_f32_16x16x32_bf16 a[152:155], v[32:35], v[48:51], 0
v_mfma_f32_16x16x32_bf16 a[156:159], v[32:35], v[48:51], 0
v_mfma_f32_16x16x32_bf16 a[160:163], v[36:39], v[48:51], 0
v_mfma_f32_16x16x32_bf16 a[164:167], v[36:39], v[48:51], 0
v_mfma_f32_16x16x32_bf16 a[168:171], v[36:39], v[48:51], 0
v_mfma_f32_16x16x32_bf16 a[172:175], v[36:39], v[48:51], 0
v_mfma_f32_16x16x32_bf16 a[176:179], v[36:39], v[48:51], 0
v_mfma_f32_16x16x32_bf16 a[180:183], v[36:39], v[48:51], 0
v_mfma_f32_16x16x32_bf16 a[184:187], v[36:39], v[48:51], 0
v_mfma_f32_16x16x32_bf16 a[188:191], v[36:39], v[48:51], 0
v_mfma_f32_16x16x32_bf16 a[192:195], v[40:43], v[48:51], 0
v_mfma_f32_16x16x32_bf16 a[196:199], v[40:43], v[48:51], 0
v_mfma_f32_16x16x32_bf16 a[200:203], v[40:43], v[48:51], 0
v_mfma_f32_16x16x32_bf16 a[204:207], v[40:43], v[48:51], 0
v_mfma_f32_16x16x32_bf16 a[208:211], v[40:43], v[48:51], 0
v_mfma_f32_16x16x32_bf16 a[212:215], v[40:43], v[48:51], 0
v_mfma_f32_16x16x32_bf16 a[216:219], v[40:43], v[48:51], 0
v_mfma_f32_16x16x32_bf16 a[220:223], v[40:43], v[48:51], 0
v_mfma_f32_16x16x32_bf16 a[224:227], v[44:47], v[48:51], 0
v_mfma_f32_16x16x32_bf16 a[228:231], v[44:47], v[48:51], 0
v_mfma_f32_16x16x32_bf16 a[232:235], v[44:47], v[48:51], 0
v_mfma_f32_16x16x32_bf16 a[236:239], v[44:47], v[48:51], 0
v_mfma_f32_16x16x32_bf16 a[240:243], v[44:47], v[48:51], 0
v_mfma_f32_16x16x32_bf16 a[244:247], v[44:47], v[48:51], 0
v_mfma_f32_16x16x32_bf16 a[248:251], v[44:47], v[48:51], 0
v_mfma_f32_16x16x32_bf16 a[252:255], v[44:47], v[48:51], 0
s_waitcnt vmcnt(16)
s_barrier
ds_read_b128 v[96:99], v10 offset:0
ds_read_b128 v[100:103], v10 offset:1024
ds_read_b128 v[104:107], v10 offset:2048
ds_read_b128 v[108:111], v10 offset:3072
ds_read_b128 v[112:115], v10 offset:4096
ds_read_b128 v[116:119], v10 offset:5120
ds_read_b128 v[120:123], v10 offset:6144
ds_read_b128 v[124:127], v10 offset:7168
ds_read_b64_tr_b16 v[64:65], v2 offset:0
ds_read_b64_tr_b16 v[66:67], v2 offset:8192
ds_read_b64_tr_b16 v[68:69], v3 offset:0
ds_read_b64_tr_b16 v[70:71], v3 offset:8192
ds_read_b64_tr_b16 v[72:73], v4 offset:0
ds_read_b64_tr_b16 v[74:75], v4 offset:8192
ds_read_b64_tr_b16 v[76:77], v5 offset:0
ds_read_b64_tr_b16 v[78:79], v5 offset:8192
ds_read_b64_tr_b16 v[80:81], v6 offset:0
ds_read_b64_tr_b16 v[82:83], v6 offset:8192
ds_read_b64_tr_b16 v[84:85], v7 offset:0
ds_read_b64_tr_b16 v[86:87], v7 offset:8192
ds_read_b64_tr_b16 v[88:89], v8 offset:0
ds_read_b64_tr_b16 v[90:91], v8 offset:8192
ds_read_b64_tr_b16 v[92:93], v9 offset:0
ds_read_b64_tr_b16 v[94:95], v9 offset:8192
s_mov_b32 s37, 7
GL_57:
s_waitcnt lgkmcnt(0)
v_mfma_f32_16x16x32_bf16 a[0:3], v[64:67], v[96:99], a[0:3]
v_mfma_f32_16x16x32_bf16 a[4:7], v[64:67], v[100:103], a[4:7]
s_waitcnt vmcnt(8)
s_barrier
v_mfma_f32_16x16x32_bf16 a[8:11], v[64:67], v[104:107], a[8:11]
ds_read_b128 v[160:163], v10 offset:16384
v_mfma_f32_16x16x32_bf16 a[12:15], v[64:67], v[108:111], a[12:15]
ds_read_b128 v[164:167], v10 offset:17408
v_mfma_f32_16x16x32_bf16 a[16:19], v[64:67], v[112:115], a[16:19]
ds_read_b128 v[168:171], v10 offset:18432
v_mfma_f32_16x16x32_bf16 a[20:23], v[64:67], v[116:119], a[20:23]
ds_read_b128 v[172:175], v10 offset:19456
v_mfma_f32_16x16x32_bf16 a[24:27], v[64:67], v[120:123], a[24:27]
ds_read_b128 v[176:179], v10 offset:20480
v_mfma_f32_16x16x32_bf16 a[28:31], v[64:67], v[124:127], a[28:31]
ds_read_b128 v[180:183], v10 offset:21504
v_mfma_f32_16x16x32_bf16 a[32:35], v[68:71], v[96:99], a[32:35]
ds_read_b128 v[184:187], v10 offset:22528
v_mfma_f32_16x16x32_bf16 a[36:39], v[68:71], v[100:103], a[36:39]
ds_read_b128 v[188:191], v10 offset:23552
v_mfma_f32_16x16x32_bf16 a[40:43], v[68:71], v[104:107], a[40:43]
ds_read_b64_tr_b16 v[128:129], v2 offset:16384
v_mfma_f32_16x16x32_bf16 a[44:47], v[68:71], v[108:111], a[44:47]
ds_read_b64_tr_b16 v[130:131], v2 offset:24576
v_mfma_f32_16x16x32_bf16 a[48:51], v[68:71], v[112:115], a[48:51]
ds_read_b64_tr_b16 v[132:133], v3 offset:16384
v_mfma_f32_16x16x32_bf16 a[52:55], v[68:71], v[116:119], a[52:55]
ds_read_b64_tr_b16 v[134:135], v3 offset:24576
v_mfma_f32_16x16x32_bf16 a[56:59], v[68:71], v[120:123], a[56:59]
ds_read_b64_tr_b16 v[136:137], v4 offset:16384
v_mfma_f32_16x16x32_bf16 a[60:63], v[68:71], v[124:127], a[60:63]
ds_read_b64_tr_b16 v[138:139], v4 offset:24576
v_mfma_f32_16x16x32_bf16 a[64:67], v[72:75], v[96:99], a[64:67]
ds_read_b64_tr_b16 v[140:141], v5 offset:16384
v_mfma_f32_16x16x32_bf16 a[68:71], v[72:75], v[100:103], a[68:71]
ds_read_b64_tr_b16 v[142:143], v5 offset:24576
v_mfma_f32_16x16x32_bf16 a[72:75], v[72:75], v[104:107], a[72:75]
ds_read_b64_tr_b16 v[144:145], v6 offset:16384
v_mfma_f32_16x16x32_bf16 a[76:79], v[72:75], v[108:111], a[76:79]
ds_read_b64_tr_b16 v[146:147], v6 offset:24576
v_mfma_f32_16x16x32_bf16 a[80:83], v[72:75], v[112:115], a[80:83]
ds_read_b64_tr_b16 v[148:149], v7 offset:16384
v_mfma_f32_16x16x32_bf16 a[84:87], v[72:75], v[116:119], a[84:87]
ds_read_b64_tr_b16 v[150:151], v7 offset:24576
v_mfma_f32_16x16x32_bf16 a[88:91], v[72:75], v[120:123], a[88:91]
ds_read_b64_tr_b16 v[152:153], v8 offset:16384
v_mfma_f32_16x16x32_bf16 a[92:95], v[72:75], v[124:127], a[92:95]
ds_read_b64_tr_b16 v[154:155], v8 offset:24576
v_mfma_f32_16x16x32_bf16 a[96:99], v[76:79], v[96:99], a[96:99]
ds_read_b64_tr_b16 v[156:157], v9 offset:16384
v_mfma_f32_16x16x32_bf16 a[100:103], v[76:79], v[100:103], a[100:103]
ds_read_b64_tr_b16 v[158:159], v9 offset:24576
v_mfma_f32_16x16x32_bf16 a[104:107], v[76:79], v[104:107], a[104:107]
v_mfma_f32_16x16x32_bf16 a[108:111], v[76:79], v[108:111], a[108:111]
s_add_u32 m0, s32, 49152
v_mfma_f32_16x16x32_bf16 a[112:115], v[76:79], v[112:115], a[112:115]
buffer_load_dwordx4 v11, s[8:11], s30 offen offset:0 lds
v_mfma_f32_16x16x32_bf16 a[116:119], v[76:79], v[116:119], a[116:119]
v_mfma_f32_16x16x32_bf16 a[120:123], v[76:79], v[120:123], a[120:123]
v_mfma_f32_16x16x32_bf16 a[124:127], v[76:79], v[124:127], a[124:127]
v_mfma_f32_16x16x32_bf16 a[128:131], v[80:83], v[96:99], a[128:131]
buffer_load_dwordx4 v12, s[8:11], s30 offen offset:1024 lds
v_mfma_f32_16x16x32_bf16 a[132:135], v[80:83], v[100:103], a[132:135]
v_mfma_f32_16x16x32_bf16 a[136:139], v[80:83], v[104:107], a[136:139]
v_mfma_f32_16x16x32_bf16 a[140:143], v[80:83], v[108:111], a[140:143]
v_mfma_f32_16x16x32_bf16 a[144:147], v[80:83], v[112:115], a[144:147]
buffer_load_dwordx4 v13, s[8:11], s30 offen offset:2048 lds
v_mfma_f32_16x16x32_bf16 a[148:151], v[80:83], v[116:119], a[148:151]
v_mfma_f32_16x16x32_bf16 a[152:155], v[80:83], v[120:123], a[152:155]
v_mfma_f32_16x16x32_bf16 a[156:159], v[80:83], v[124:127], a[156:159]
v_mfma_f32_16x16x32_bf16 a[160:163], v[84:87], v[96:99], a[160:163]
buffer_load_dwordx4 v14, s[8:11], s30 offen offset:3072 lds
v_mfma_f32_16x16x32_bf16 a[164:167], v[84:87], v[100:103], a[164:167]
v_mfma_f32_16x16x32_bf16 a[168:171], v[84:87], v[104:107], a[168:171]
v_mfma_f32_16x16x32_bf16 a[172:175], v[84:87], v[108:111], a[172:175]
s_add_u32 m0, s33, 49152
v_mfma_f32_16x16x32_bf16 a[176:179], v[84:87], v[112:115], a[176:179]
buffer_load_dwordx4 v15, s[4:7], s31 offen offset:0 sc1 lds
v_mfma_f32_16x16x32_bf16 a[180:183], v[84:87], v[116:119], a[180:183]
v_mfma_f32_16x16x32_bf16 a[184:187], v[84:87], v[120:123], a[184:187]
v_mfma_f32_16x16x32_bf16 a[188:191], v[84:87], v[124:127], a[188:191]
v_mfma_f32_16x16x32_bf16 a[192:195], v[88:91], v[96:99], a[192:195]
buffer_load_dwordx4 v15, s[4:7], s31 offen offset:1024 sc1 lds
v_mfma_f32_16x16x32_bf16 a[196:199], v[88:91], v[100:103], a[196:199]
v_mfma_f32_16x16x32_bf16 a[200:203], v[88:91], v[104:107], a[200:203]
v_mfma_f32_16x16x32_bf16 a[204:207], v[88:91], v[108:111], a[204:207]
v_mfma_f32_16x16x32_bf16 a[208:211], v[88:91], v[112:115], a[208:211]
buffer_load_dwordx4 v15, s[4:7], s31 offen offset:2048 sc1 lds
v_mfma_f32_16x16x32_bf16 a[212:215], v[88:91], v[116:119], a[212:215]
v_mfma_f32_16x16x32_bf16 a[216:219], v[88:91], v[120:123], a[216:219]
v_mfma_f32_16x16x32_bf16 a[220:223], v[88:91], v[124:127], a[220:223]
v_mfma_f32_16x16x32_bf16 a[224:227], v[92:95], v[96:99], a[224:227]
buffer_load_dwordx4 v15, s[4:7], s31 offen offset:3072 sc1 lds
v_mfma_f32_16x16x32_bf16 a[228:231], v[92:95], v[100:103], a[228:231]
v_mfma_f32_16x16x32_bf16 a[232:235], v[92:95], v[104:107], a[232:235]
s_add_u32 s30, s30, 262144
v_mfma_f32_16x16x32_bf16 a[236:239], v[92:95], v[108:111], a[236:239]
s_add_u32 s31, s31, 16384
v_mfma_f32_16x16x32_bf16 a[240:243], v[92:95], v[112:115], a[240:243]
v_mfma_f32_16x16x32_bf16 a[244:247], v[92:95], v[116:119], a[244:247]
v_mfma_f32_16x16x32_bf16 a[248:251], v[92:95], v[120:123], a[248:251]
v_mfma_f32_16x16x32_bf16 a[252:255], v[92:95], v[124:127], a[252:255]
s_waitcnt lgkmcnt(0)
v_mfma_f32_16x16x32_bf16 a[0:3], v[128:131], v[160:163], a[0:3]
v_mfma_f32_16x16x32_bf16 a[4:7], v[128:131], v[164:167], a[4:7]
s_waitcnt vmcnt(8)
s_barrier
v_mfma_f32_16x16x32_bf16 a[8:11], v[128:131], v[168:171], a[8:11]
ds_read_b128 v[96:99], v10 offset:32768
v_mfma_f32_16x16x32_bf16 a[12:15], v[128:131], v[172:175], a[12:15]
ds_read_b128 v[100:103], v10 offset:33792
v_mfma_f32_16x16x32_bf16 a[16:19], v[128:131], v[176:179], a[16:19]
ds_read_b128 v[104:107], v10 offset:34816
v_mfma_f32_16x16x32_bf16 a[20:23], v[128:131], v[180:183], a[20:23]
ds_read_b128 v[108:111], v10 offset:35840
v_mfma_f32_16x16x32_bf16 a[24:27], v[128:131], v[184:187], a[24:27]
ds_read_b128 v[112:115], v10 offset:36864
v_mfma_f32_16x16x32_bf16 a[28:31], v[128:131], v[188:191], a[28:31]
ds_read_b128 v[116:119], v10 offset:37888
v_mfma_f32_16x16x32_bf16 a[32:35], v[132:135], v[160:163], a[32:35]
ds_read_b128 v[120:123], v10 offset:38912
v_mfma_f32_16x16x32_bf16 a[36:39], v[132:135], v[164:167], a[36:39]
ds_read_b128 v[124:127], v10 offset:39936
v_mfma_f32_16x16x32_bf16 a[40:43], v[132:135], v[168:171], a[40:43]
ds_read_b64_tr_b16 v[64:65], v2 offset:32768
v_mfma_f32_16x16x32_bf16 a[44:47], v[132:135], v[172:175], a[44:47]
ds_read_b64_tr_b16 v[66:67], v2 offset:40960
v_mfma_f32_16x16x32_bf16 a[48:51], v[132:135], v[176:179], a[48:51]
ds_read_b64_tr_b16 v[68:69], v3 offset:32768
v_mfma_f32_16x16x32_bf16 a[52:55], v[132:135], v[180:183], a[52:55]
ds_read_b64_tr_b16 v[70:71], v3 offset:40960
v_mfma_f32_16x16x32_bf16 a[56:59], v[132:135], v[184:187], a[56:59]
ds_read_b64_tr_b16 v[72:73], v4 offset:32768
v_mfma_f32_16x16x32_bf16 a[60:63], v[132:135], v[188:191], a[60:63]
ds_read_b64_tr_b16 v[74:75], v4 offset:40960
v_mfma_f32_16x16x32_bf16 a[64:67], v[136:139], v[160:163], a[64:67]
ds_read_b64_tr_b16 v[76:77], v5 offset:32768
v_mfma_f32_16x16x32_bf16 a[68:71], v[136:139], v[164:167], a[68:71]
ds_read_b64_tr_b16 v[78:79], v5 offset:40960
v_mfma_f32_16x16x32_bf16 a[72:75], v[136:139], v[168:171], a[72:75]
ds_read_b64_tr_b16 v[80:81], v6 offset:32768
v_mfma_f32_16x16x32_bf16 a[76:79], v[136:139], v[172:175], a[76:79]
ds_read_b64_tr_b16 v[82:83], v6 offset:40960
v_mfma_f32_16x16x32_bf16 a[80:83], v[136:139], v[176:179], a[80:83]
ds_read_b64_tr_b16 v[84:85], v7 offset:32768
v_mfma_f32_16x16x32_bf16 a[84:87], v[136:139], v[180:183], a[84:87]
ds_read_b64_tr_b16 v[86:87], v7 offset:40960
v_mfma_f32_16x16x32_bf16 a[88:91], v[136:139], v[184:187], a[88:91]
ds_read_b64_tr_b16 v[88:89], v8 offset:32768
v_mfma_f32_16x16x32_bf16 a[92:95], v[136:139], v[188:191], a[92:95]
ds_read_b64_tr_b16 v[90:91], v8 offset:40960
v_mfma_f32_16x16x32_bf16 a[96:99], v[140:143], v[160:163], a[96:99]
ds_read_b64_tr_b16 v[92:93], v9 offset:32768
v_mfma_f32_16x16x32_bf16 a[100:103], v[140:143], v[164:167], a[100:103]
ds_read_b64_tr_b16 v[94:95], v9 offset:40960
v_mfma_f32_16x16x32_bf16 a[104:107], v[140:143], v[168:171], a[104:107]
v_mfma_f32_16x16x32_bf16 a[108:111], v[140:143], v[172:175], a[108:111]
s_add_u32 m0, s32, 0
v_mfma_f32_16x16x32_bf16 a[112:115], v[140:143], v[176:179], a[112:115]
buffer_load_dwordx4 v11, s[8:11], s30 offen offset:0 lds
v_mfma_f32_16x16x32_bf16 a[116:119], v[140:143], v[180:183], a[116:119]
v_mfma_f32_16x16x32_bf16 a[120:123], v[140:143], v[184:187], a[120:123]
v_mfma_f32_16x16x32_bf16 a[124:127], v[140:143], v[188:191], a[124:127]
v_mfma_f32_16x16x32_bf16 a[128:131], v[144:147], v[160:163], a[128:131]
buffer_load_dwordx4 v12, s[8:11], s30 offen offset:1024 lds
v_mfma_f32_16x16x32_bf16 a[132:135], v[144:147], v[164:167], a[132:135]
v_mfma_f32_16x16x32_bf16 a[136:139], v[144:147], v[168:171], a[136:139]
v_mfma_f32_16x16x32_bf16 a[140:143], v[144:147], v[172:175], a[140:143]
v_mfma_f32_16x16x32_bf16 a[144:147], v[144:147], v[176:179], a[144:147]
buffer_load_dwordx4 v13, s[8:11], s30 offen offset:2048 lds
v_mfma_f32_16x16x32_bf16 a[148:151], v[144:147], v[180:183], a[148:151]
v_mfma_f32_16x16x32_bf16 a[152:155], v[144:147], v[184:187], a[152:155]
v_mfma_f32_16x16x32_bf16 a[156:159], v[144:147], v[188:191], a[156:159]
v_mfma_f32_16x16x32_bf16 a[160:163], v[148:151], v[160:163], a[160:163]
buffer_load_dwordx4 v14, s[8:11], s30 offen offset:3072 lds
v_mfma_f32_16x16x32_bf16 a[164:167], v[148:151], v[164:167], a[164:167]
v_mfma_f32_16x16x32_bf16 a[168:171], v[148:151], v[168:171], a[168:171]
v_mfma_f32_16x16x32_bf16 a[172:175], v[148:151], v[172:175], a[172:175]
s_add_u32 m0, s33, 0
v_mfma_f32_16x16x32_bf16 a[176:179], v[148:151], v[176:179], a[176:179]
buffer_load_dwordx4 v15, s[4:7], s31 offen offset:0 sc1 lds
v_mfma_f32_16x16x32_bf16 a[180:183], v[148:151], v[180:183], a[180:183]
v_mfma_f32_16x16x32_bf16 a[184:187], v[148:151], v[184:187], a[184:187]
v_mfma_f32_16x16x32_bf16 a[188:191], v[148:151], v[188:191], a[188:191]
v_mfma_f32_16x16x32_bf16 a[192:195], v[152:155], v[160:163], a[192:195]
buffer_load_dwordx4 v15, s[4:7], s31 offen offset:1024 sc1 lds
v_mfma_f32_16x16x32_bf16 a[196:199], v[152:155], v[164:167], a[196:199]
v_mfma_f32_16x16x32_bf16 a[200:203], v[152:155], v[168:171], a[200:203]
v_mfma_f32_16x16x32_bf16 a[204:207], v[152:155], v[172:175], a[204:207]
v_mfma_f32_16x16x32_bf16 a[208:211], v[152:155], v[176:179], a[208:211]
buffer_load_dwordx4 v15, s[4:7], s31 offen offset:2048 sc1 lds
v_mfma_f32_16x16x32_bf16 a[212:215], v[152:155], v[180:183], a[212:215]
v_mfma_f32_16x16x32_bf16 a[216:219], v[152:155], v[184:187], a[216:219]
v_mfma_f32_16x16x32_bf16 a[220:223], v[152:155], v[188:191], a[220:223]
v_mfma_f32_16x16x32_bf16 a[224:227], v[156:159], v[160:163], a[224:227]
buffer_load_dwordx4 v15, s[4:7], s31 offen offset:3072 sc1 lds
v_mfma_f32_16x16x32_bf16 a[228:231], v[156:159], v[164:167], a[228:231]
v_mfma_f32_16x16x32_bf16 a[232:235], v[156:159], v[168:171], a[232:235]
s_add_u32 s30, s30, 262144
v_mfma_f32_16x16x32_bf16 a[236:239], v[156:159], v[172:175], a[236:239]
s_add_u32 s31, s31, 16384
v_mfma_f32_16x16x32_bf16 a[240:243], v[156:159], v[176:179], a[240:243]
v_mfma_f32_16x16x32_bf16 a[244:247], v[156:159], v[180:183], a[244:247]
v_mfma_f32_16x16x32_bf16 a[248:251], v[156:159], v[184:187], a[248:251]
v_mfma_f32_16x16x32_bf16 a[252:255], v[156:159], v[188:191], a[252:255]
s_waitcnt lgkmcnt(0)
v_mfma_f32_16x16x32_bf16 a[0:3], v[64:67], v[96:99], a[0:3]
v_mfma_f32_16x16x32_bf16 a[4:7], v[64:67], v[100:103], a[4:7]
s_waitcnt vmcnt(8)
s_barrier
v_mfma_f32_16x16x32_bf16 a[8:11], v[64:67], v[104:107], a[8:11]
ds_read_b128 v[160:163], v10 offset:49152
v_mfma_f32_16x16x32_bf16 a[12:15], v[64:67], v[108:111], a[12:15]
ds_read_b128 v[164:167], v10 offset:50176
v_mfma_f32_16x16x32_bf16 a[16:19], v[64:67], v[112:115], a[16:19]
ds_read_b128 v[168:171], v10 offset:51200
v_mfma_f32_16x16x32_bf16 a[20:23], v[64:67], v[116:119], a[20:23]
ds_read_b128 v[172:175], v10 offset:52224
v_mfma_f32_16x16x32_bf16 a[24:27], v[64:67], v[120:123], a[24:27]
ds_read_b128 v[176:179], v10 offset:53248
v_mfma_f32_16x16x32_bf16 a[28:31], v[64:67], v[124:127], a[28:31]
ds_read_b128 v[180:183], v10 offset:54272
v_mfma_f32_16x16x32_bf16 a[32:35], v[68:71], v[96:99], a[32:35]
ds_read_b128 v[184:187], v10 offset:55296
v_mfma_f32_16x16x32_bf16 a[36:39], v[68:71], v[100:103], a[36:39]
ds_read_b128 v[188:191], v10 offset:56320
v_mfma_f32_16x16x32_bf16 a[40:43], v[68:71], v[104:107], a[40:43]
ds_read_b64_tr_b16 v[128:129], v2 offset:49152
v_mfma_f32_16x16x32_bf16 a[44:47], v[68:71], v[108:111], a[44:47]
ds_read_b64_tr_b16 v[130:131], v2 offset:57344
v_mfma_f32_16x16x32_bf16 a[48:51], v[68:71], v[112:115], a[48:51]
ds_read_b64_tr_b16 v[132:133], v3 offset:49152
v_mfma_f32_16x16x32_bf16 a[52:55], v[68:71], v[116:119], a[52:55]
ds_read_b64_tr_b16 v[134:135], v3 offset:57344
v_mfma_f32_16x16x32_bf16 a[56:59], v[68:71], v[120:123], a[56:59]
ds_read_b64_tr_b16 v[136:137], v4 offset:49152
v_mfma_f32_16x16x32_bf16 a[60:63], v[68:71], v[124:127], a[60:63]
ds_read_b64_tr_b16 v[138:139], v4 offset:57344
v_mfma_f32_16x16x32_bf16 a[64:67], v[72:75], v[96:99], a[64:67]
ds_read_b64_tr_b16 v[140:141], v5 offset:49152
v_mfma_f32_16x16x32_bf16 a[68:71], v[72:75], v[100:103], a[68:71]
ds_read_b64_tr_b16 v[142:143], v5 offset:57344
v_mfma_f32_16x16x32_bf16 a[72:75], v[72:75], v[104:107], a[72:75]
ds_read_b64_tr_b16 v[144:145], v6 offset:49152
v_mfma_f32_16x16x32_bf16 a[76:79], v[72:75], v[108:111], a[76:79]
ds_read_b64_tr_b16 v[146:147], v6 offset:57344
v_mfma_f32_16x16x32_bf16 a[80:83], v[72:75], v[112:115], a[80:83]
ds_read_b64_tr_b16 v[148:149], v7 offset:49152
v_mfma_f32_16x16x32_bf16 a[84:87], v[72:75], v[116:119], a[84:87]
ds_read_b64_tr_b16 v[150:151], v7 offset:57344
v_mfma_f32_16x16x32_bf16 a[88:91], v[72:75], v[120:123], a[88:91]
ds_read_b64_tr_b16 v[152:153], v8 offset:49152
v_mfma_f32_16x16x32_bf16 a[92:95], v[72:75], v[124:127], a[92:95]
ds_read_b64_tr_b16 v[154:155], v8 offset:57344
v_mfma_f32_16x16x32_bf16 a[96:99], v[76:79], v[96:99], a[96:99]
ds_read_b64_tr_b16 v[156:157], v9 offset:49152
v_mfma_f32_16x16x32_bf16 a[100:103], v[76:79], v[100:103], a[100:103]
ds_read_b64_tr_b16 v[158:159], v9 offset:57344
v_mfma_f32_16x16x32_bf16 a[104:107], v[76:79], v[104:107], a[104:107]
v_mfma_f32_16x16x32_bf16 a[108:111], v[76:79], v[108:111], a[108:111]
s_add_u32 m0, s32, 16384
v_mfma_f32_16x16x32_bf16 a[112:115], v[76:79], v[112:115], a[112:115]
buffer_load_dwordx4 v11, s[8:11], s30 offen offset:0 lds
v_mfma_f32_16x16x32_bf16 a[116:119], v[76:79], v[116:119], a[116:119]
v_mfma_f32_16x16x32_bf16 a[120:123], v[76:79], v[120:123], a[120:123]
v_mfma_f32_16x16x32_bf16 a[124:127], v[76:79], v[124:127], a[124:127]
v_mfma_f32_16x16x32_bf16 a[128:131], v[80:83], v[96:99], a[128:131]
buffer_load_dwordx4 v12, s[8:11], s30 offen offset:1024 lds
v_mfma_f32_16x16x32_bf16 a[132:135], v[80:83], v[100:103], a[132:135]
v_mfma_f32_16x16x32_bf16 a[136:139], v[80:83], v[104:107], a[136:139]
v_mfma_f32_16x16x32_bf16 a[140:143], v[80:83], v[108:111], a[140:143]
v_mfma_f32_16x16x32_bf16 a[144:147], v[80:83], v[112:115], a[144:147]
buffer_load_dwordx4 v13, s[8:11], s30 offen offset:2048 lds
v_mfma_f32_16x16x32_bf16 a[148:151], v[80:83], v[116:119], a[148:151]
v_mfma_f32_16x16x32_bf16 a[152:155], v[80:83], v[120:123], a[152:155]
v_mfma_f32_16x16x32_bf16 a[156:159], v[80:83], v[124:127], a[156:159]
v_mfma_f32_16x16x32_bf16 a[160:163], v[84:87], v[96:99], a[160:163]
buffer_load_dwordx4 v14, s[8:11], s30 offen offset:3072 lds
v_mfma_f32_16x16x32_bf16 a[164:167], v[84:87], v[100:103], a[164:167]
v_mfma_f32_16x16x32_bf16 a[168:171], v[84:87], v[104:107], a[168:171]
v_mfma_f32_16x16x32_bf16 a[172:175], v[84:87], v[108:111], a[172:175]
s_add_u32 m0, s33, 16384
v_mfma_f32_16x16x32_bf16 a[176:179], v[84:87], v[112:115], a[176:179]
buffer_load_dwordx4 v15, s[4:7], s31 offen offset:0 sc1 lds
v_mfma_f32_16x16x32_bf16 a[180:183], v[84:87], v[116:119], a[180:183]
v_mfma_f32_16x16x32_bf16 a[184:187], v[84:87], v[120:123], a[184:187]
v_mfma_f32_16x16x32_bf16 a[188:191], v[84:87], v[124:127], a[188:191]
v_mfma_f32_16x16x32_bf16 a[192:195], v[88:91], v[96:99], a[192:195]
buffer_load_dwordx4 v15, s[4:7], s31 offen offset:1024 sc1 lds
v_mfma_f32_16x16x32_bf16 a[196:199], v[88:91], v[100:103], a[196:199]
v_mfma_f32_16x16x32_bf16 a[200:203], v[88:91], v[104:107], a[200:203]
v_mfma_f32_16x16x32_bf16 a[204:207], v[88:91], v[108:111], a[204:207]
v_mfma_f32_16x16x32_bf16 a[208:211], v[88:91], v[112:115], a[208:211]
buffer_load_dwordx4 v15, s[4:7], s31 offen offset:2048 sc1 lds
v_mfma_f32_16x16x32_bf16 a[212:215], v[88:91], v[116:119], a[212:215]
v_mfma_f32_16x16x32_bf16 a[216:219], v[88:91], v[120:123], a[216:219]
v_mfma_f32_16x16x32_bf16 a[220:223], v[88:91], v[124:127], a[220:223]
v_mfma_f32_16x16x32_bf16 a[224:227], v[92:95], v[96:99], a[224:227]
buffer_load_dwordx4 v15, s[4:7], s31 offen offset:3072 sc1 lds
v_mfma_f32_16x16x32_bf16 a[228:231], v[92:95], v[100:103], a[228:231]
v_mfma_f32_16x16x32_bf16 a[232:235], v[92:95], v[104:107], a[232:235]
s_add_u32 s30, s30, 262144
v_mfma_f32_16x16x32_bf16 a[236:239], v[92:95], v[108:111], a[236:239]
s_add_u32 s31, s31, 16384
v_mfma_f32_16x16x32_bf16 a[240:243], v[92:95], v[112:115], a[240:243]
v_mfma_f32_16x16x32_bf16 a[244:247], v[92:95], v[116:119], a[244:247]
v_mfma_f32_16x16x32_bf16 a[248:251], v[92:95], v[120:123], a[248:251]
v_mfma_f32_16x16x32_bf16 a[252:255], v[92:95], v[124:127], a[252:255]
s_waitcnt lgkmcnt(0)
v_mfma_f32_16x16x32_bf16 a[0:3], v[128:131], v[160:163], a[0:3]
v_mfma_f32_16x16x32_bf16 a[4:7], v[128:131], v[164:167], a[4:7]
s_waitcnt vmcnt(8)
s_barrier
v_mfma_f32_16x16x32_bf16 a[8:11], v[128:131], v[168:171], a[8:11]
ds_read_b128 v[96:99], v10 offset:0
v_mfma_f32_16x16x32_bf16 a[12:15], v[128:131], v[172:175], a[12:15]
ds_read_b128 v[100:103], v10 offset:1024
v_mfma_f32_16x16x32_bf16 a[16:19], v[128:131], v[176:179], a[16:19]
ds_read_b128 v[104:107], v10 offset:2048
v_mfma_f32_16x16x32_bf16 a[20:23], v[128:131], v[180:183], a[20:23]
ds_read_b128 v[108:111], v10 offset:3072
v_mfma_f32_16x16x32_bf16 a[24:27], v[128:131], v[184:187], a[24:27]
ds_read_b128 v[112:115], v10 offset:4096
v_mfma_f32_16x16x32_bf16 a[28:31], v[128:131], v[188:191], a[28:31]
ds_read_b128 v[116:119], v10 offset:5120
v_mfma_f32_16x16x32_bf16 a[32:35], v[132:135], v[160:163], a[32:35]
ds_read_b128 v[120:123], v10 offset:6144
v_mfma_f32_16x16x32_bf16 a[36:39], v[132:135], v[164:167], a[36:39]
ds_read_b128 v[124:127], v10 offset:7168
v_mfma_f32_16x16x32_bf16 a[40:43], v[132:135], v[168:171], a[40:43]
ds_read_b64_tr_b16 v[64:65], v2 offset:0
v_mfma_f32_16x16x32_bf16 a[44:47], v[132:135], v[172:175], a[44:47]
ds_read_b64_tr_b16 v[66:67], v2 offset:8192
v_mfma_f32_16x16x32_bf16 a[48:51], v[132:135], v[176:179], a[48:51]
ds_read_b64_tr_b16 v[68:69], v3 offset:0
v_mfma_f32_16x16x32_bf16 a[52:55], v[132:135], v[180:183], a[52:55]
ds_read_b64_tr_b16 v[70:71], v3 offset:8192
v_mfma_f32_16x16x32_bf16 a[56:59], v[132:135], v[184:187], a[56:59]
ds_read_b64_tr_b16 v[72:73], v4 offset:0
v_mfma_f32_16x16x32_bf16 a[60:63], v[132:135], v[188:191], a[60:63]
ds_read_b64_tr_b16 v[74:75], v4 offset:8192
v_mfma_f32_16x16x32_bf16 a[64:67], v[136:139], v[160:163], a[64:67]
ds_read_b64_tr_b16 v[76:77], v5 offset:0
v_mfma_f32_16x16x32_bf16 a[68:71], v[136:139], v[164:167], a[68:71]
ds_read_b64_tr_b16 v[78:79], v5 offset:8192
v_mfma_f32_16x16x32_bf16 a[72:75], v[136:139], v[168:171], a[72:75]
ds_read_b64_tr_b16 v[80:81], v6 offset:0
v_mfma_f32_16x16x32_bf16 a[76:79], v[136:139], v[172:175], a[76:79]
ds_read_b64_tr_b16 v[82:83], v6 offset:8192
v_mfma_f32_16x16x32_bf16 a[80:83], v[136:139], v[176:179], a[80:83]
ds_read_b64_tr_b16 v[84:85], v7 offset:0
v_mfma_f32_16x16x32_bf16 a[84:87], v[136:139], v[180:183], a[84:87]
ds_read_b64_tr_b16 v[86:87], v7 offset:8192
v_mfma_f32_16x16x32_bf16 a[88:91], v[136:139], v[184:187], a[88:91]
ds_read_b64_tr_b16 v[88:89], v8 offset:0
v_mfma_f32_16x16x32_bf16 a[92:95], v[136:139], v[188:191], a[92:95]
ds_read_b64_tr_b16 v[90:91], v8 offset:8192
v_mfma_f32_16x16x32_bf16 a[96:99], v[140:143], v[160:163], a[96:99]
ds_read_b64_tr_b16 v[92:93], v9 offset:0
v_mfma_f32_16x16x32_bf16 a[100:103], v[140:143], v[164:167], a[100:103]
ds_read_b64_tr_b16 v[94:95], v9 offset:8192
v_mfma_f32_16x16x32_bf16 a[104:107], v[140:143], v[168:171], a[104:107]
v_mfma_f32_16x16x32_bf16 a[108:111], v[140:143], v[172:175], a[108:111]
s_add_u32 m0, s32, 32768
v_mfma_f32_16x16x32_bf16 a[112:115], v[140:143], v[176:179], a[112:115]
buffer_load_dwordx4 v11, s[8:11], s30 offen offset:0 lds
v_mfma_f32_16x16x32_bf16 a[116:119], v[140:143], v[180:183], a[116:119]
v_mfma_f32_16x16x32_bf16 a[120:123], v[140:143], v[184:187], a[120:123]
v_mfma_f32_16x16x32_bf16 a[124:127], v[140:143], v[188:191], a[124:127]
v_mfma_f32_16x16x32_bf16 a[128:131], v[144:147], v[160:163], a[128:131]
buffer_load_dwordx4 v12, s[8:11], s30 offen offset:1024 lds
v_mfma_f32_16x16x32_bf16 a[132:135], v[144:147], v[164:167], a[132:135]
v_mfma_f32_16x16x32_bf16 a[136:139], v[144:147], v[168:171], a[136:139]
v_mfma_f32_16x16x32_bf16 a[140:143], v[144:147], v[172:175], a[140:143]
v_mfma_f32_16x16x32_bf16 a[144:147], v[144:147], v[176:179], a[144:147]
buffer_load_dwordx4 v13, s[8:11], s30 offen offset:2048 lds
v_mfma_f32_16x16x32_bf16 a[148:151], v[144:147], v[180:183], a[148:151]
v_mfma_f32_16x16x32_bf16 a[152:155], v[144:147], v[184:187], a[152:155]
v_mfma_f32_16x16x32_bf16 a[156:159], v[144:147], v[188:191], a[156:159]
v_mfma_f32_16x16x32_bf16 a[160:163], v[148:151], v[160:163], a[160:163]
buffer_load_dwordx4 v14, s[8:11], s30 offen offset:3072 lds
v_mfma_f32_16x16x32_bf16 a[164:167], v[148:151], v[164:167], a[164:167]
v_mfma_f32_16x16x32_bf16 a[168:171], v[148:151], v[168:171], a[168:171]
v_mfma_f32_16x16x32_bf16 a[172:175], v[148:151], v[172:175], a[172:175]
s_add_u32 m0, s33, 32768
v_mfma_f32_16x16x32_bf16 a[176:179], v[148:151], v[176:179], a[176:179]
buffer_load_dwordx4 v15, s[4:7], s31 offen offset:0 sc1 lds
v_mfma_f32_16x16x32_bf16 a[180:183], v[148:151], v[180:183], a[180:183]
v_mfma_f32_16x16x32_bf16 a[184:187], v[148:151], v[184:187], a[184:187]
v_mfma_f32_16x16x32_bf16 a[188:191], v[148:151], v[188:191], a[188:191]
v_mfma_f32_16x16x32_bf16 a[192:195], v[152:155], v[160:163], a[192:195]
buffer_load_dwordx4 v15, s[4:7], s31 offen offset:1024 sc1 lds
v_mfma_f32_16x16x32_bf16 a[196:199], v[152:155], v[164:167], a[196:199]
v_mfma_f32_16x16x32_bf16 a[200:203], v[152:155], v[168:171], a[200:203]
v_mfma_f32_16x16x32_bf16 a[204:207], v[152:155], v[172:175], a[204:207]
v_mfma_f32_16x16x32_bf16 a[208:211], v[152:155], v[176:179], a[208:211]
buffer_load_dwordx4 v15, s[4:7], s31 offen offset:2048 sc1 lds
v_mfma_f32_16x16x32_bf16 a[212:215], v[152:155], v[180:183], a[212:215]
v_mfma_f32_16x16x32_bf16 a[216:219], v[152:155], v[184:187], a[216:219]
v_mfma_f32_16x16x32_bf16 a[220:223], v[152:155], v[188:191], a[220:223]
v_mfma_f32_16x16x32_bf16 a[224:227], v[156:159], v[160:163], a[224:227]
buffer_load_dwordx4 v15, s[4:7], s31 offen offset:3072 sc1 lds
v_mfma_f32_16x16x32_bf16 a[228:231], v[156:159], v[164:167], a[228:231]
v_mfma_f32_16x16x32_bf16 a[232:235], v[156:159], v[168:171], a[232:235]
s_add_u32 s30, s30, 262144
v_mfma_f32_16x16x32_bf16 a[236:239], v[156:159], v[172:175], a[236:239]
s_add_u32 s31, s31, 16384
v_mfma_f32_16x16x32_bf16 a[240:243], v[156:159], v[176:179], a[240:243]
v_mfma_f32_16x16x32_bf16 a[244:247], v[156:159], v[180:183], a[244:247]
v_mfma_f32_16x16x32_bf16 a[248:251], v[156:159], v[184:187], a[248:251]
v_mfma_f32_16x16x32_bf16 a[252:255], v[156:159], v[188:191], a[252:255]
s_sub_u32 s37, s37, 1
s_cmp_lg_u32 s37, 0
s_cbranch_scc1 GL_57
s_waitcnt lgkmcnt(0)
v_mfma_f32_16x16x32_bf16 a[0:3], v[64:67], v[96:99], a[0:3]
v_mfma_f32_16x16x32_bf16 a[4:7], v[64:67], v[100:103], a[4:7]
s_waitcnt vmcnt(8)
s_barrier
v_mfma_f32_16x16x32_bf16 a[8:11], v[64:67], v[104:107], a[8:11]
ds_read_b128 v[160:163], v10 offset:16384
v_mfma_f32_16x16x32_bf16 a[12:15], v[64:67], v[108:111], a[12:15]
ds_read_b128 v[164:167], v10 offset:17408
v_mfma_f32_16x16x32_bf16 a[16:19], v[64:67], v[112:115], a[16:19]
ds_read_b128 v[168:171], v10 offset:18432
v_mfma_f32_16x16x32_bf16 a[20:23], v[64:67], v[116:119], a[20:23]
ds_read_b128 v[172:175], v10 offset:19456
v_mfma_f32_16x16x32_bf16 a[24:27], v[64:67], v[120:123], a[24:27]
ds_read_b128 v[176:179], v10 offset:20480
v_mfma_f32_16x16x32_bf16 a[28:31], v[64:67], v[124:127], a[28:31]
ds_read_b128 v[180:183], v10 offset:21504
v_mfma_f32_16x16x32_bf16 a[32:35], v[68:71], v[96:99], a[32:35]
ds_read_b128 v[184:187], v10 offset:22528
v_mfma_f32_16x16x32_bf16 a[36:39], v[68:71], v[100:103], a[36:39]
ds_read_b128 v[188:191], v10 offset:23552
v_mfma_f32_16x16x32_bf16 a[40:43], v[68:71], v[104:107], a[40:43]
ds_read_b64_tr_b16 v[128:129], v2 offset:16384
v_mfma_f32_16x16x32_bf16 a[44:47], v[68:71], v[108:111], a[44:47]
ds_read_b64_tr_b16 v[130:131], v2 offset:24576
v_mfma_f32_16x16x32_bf16 a[48:51], v[68:71], v[112:115], a[48:51]
ds_read_b64_tr_b16 v[132:133], v3 offset:16384
v_mfma_f32_16x16x32_bf16 a[52:55], v[68:71], v[116:119], a[52:55]
ds_read_b64_tr_b16 v[134:135], v3 offset:24576
v_mfma_f32_16x16x32_bf16 a[56:59], v[68:71], v[120:123], a[56:59]
ds_read_b64_tr_b16 v[136:137], v4 offset:16384
v_mfma_f32_16x16x32_bf16 a[60:63], v[68:71], v[124:127], a[60:63]
ds_read_b64_tr_b16 v[138:139], v4 offset:24576
v_mfma_f32_16x16x32_bf16 a[64:67], v[72:75], v[96:99], a[64:67]
ds_read_b64_tr_b16 v[140:141], v5 offset:16384
v_mfma_f32_16x16x32_bf16 a[68:71], v[72:75], v[100:103], a[68:71]
ds_read_b64_tr_b16 v[142:143], v5 offset:24576
v_mfma_f32_16x16x32_bf16 a[72:75], v[72:75], v[104:107], a[72:75]
ds_read_b64_tr_b16 v[144:145], v6 offset:16384
v_mfma_f32_16x16x32_bf16 a[76:79], v[72:75], v[108:111], a[76:79]
ds_read_b64_tr_b16 v[146:147], v6 offset:24576
v_mfma_f32_16x16x32_bf16 a[80:83], v[72:75], v[112:115], a[80:83]
ds_read_b64_tr_b16 v[148:149], v7 offset:16384
v_mfma_f32_16x16x32_bf16 a[84:87], v[72:75], v[116:119], a[84:87]
ds_read_b64_tr_b16 v[150:151], v7 offset:24576
v_mfma_f32_16x16x32_bf16 a[88:91], v[72:75], v[120:123], a[88:91]
ds_read_b64_tr_b16 v[152:153], v8 offset:16384
v_mfma_f32_16x16x32_bf16 a[92:95], v[72:75], v[124:127], a[92:95]
ds_read_b64_tr_b16 v[154:155], v8 offset:24576
v_mfma_f32_16x16x32_bf16 a[96:99], v[76:79], v[96:99], a[96:99]
ds_read_b64_tr_b16 v[156:157], v9 offset:16384
v_mfma_f32_16x16x32_bf16 a[100:103], v[76:79], v[100:103], a[100:103]
ds_read_b64_tr_b16 v[158:159], v9 offset:24576
v_mfma_f32_16x16x32_bf16 a[104:107], v[76:79], v[104:107], a[104:107]
v_mfma_f32_16x16x32_bf16 a[108:111], v[76:79], v[108:111], a[108:111]
s_add_u32 m0, s32, 49152
v_mfma_f32_16x16x32_bf16 a[112:115], v[76:79], v[112:115], a[112:115]
buffer_load_dwordx4 v11, s[8:11], s30 offen offset:0 lds
v_mfma_f32_16x16x32_bf16 a[116:119], v[76:79], v[116:119], a[116:119]
v_mfma_f32_16x16x32_bf16 a[120:123], v[76:79], v[120:123], a[120:123]
v_mfma_f32_16x16x32_bf16 a[124:127], v[76:79], v[124:127], a[124:127]
v_mfma_f32_16x16x32_bf16 a[128:131], v[80:83], v[96:99], a[128:131]
buffer_load_dwordx4 v12, s[8:11], s30 offen offset:1024 lds
v_mfma_f32_16x16x32_bf16 a[132:135], v[80:83], v[100:103], a[132:135]
v_mfma_f32_16x16x32_bf16 a[136:139], v[80:83], v[104:107], a[136:139]
v_mfma_f32_16x16x32_bf16 a[140:143], v[80:83], v[108:111], a[140:143]
v_mfma_f32_16x16x32_bf16 a[144:147], v[80:83], v[112:115], a[144:147]
buffer_load_dwordx4 v13, s[8:11], s30 offen offset:2048 lds
v_mfma_f32_16x16x32_bf16 a[148:151], v[80:83], v[116:119], a[148:151]
v_mfma_f32_16x16x32_bf16 a[152:155], v[80:83], v[120:123], a[152:155]
v_mfma_f32_16x16x32_bf16 a[156:159], v[80:83], v[124:127], a[156:159]
v_mfma_f32_16x16x32_bf16 a[160:163], v[84:87], v[96:99], a[160:163]
buffer_load_dwordx4 v14, s[8:11], s30 offen offset:3072 lds
v_mfma_f32_16x16x32_bf16 a[164:167], v[84:87], v[100:103], a[164:167]
v_mfma_f32_16x16x32_bf16 a[168:171], v[84:87], v[104:107], a[168:171]
v_mfma_f32_16x16x32_bf16 a[172:175], v[84:87], v[108:111], a[172:175]
s_add_u32 m0, s33, 49152
v_mfma_f32_16x16x32_bf16 a[176:179], v[84:87], v[112:115], a[176:179]
buffer_load_dwordx4 v15, s[4:7], s31 offen offset:0 sc1 lds
v_mfma_f32_16x16x32_bf16 a[180:183], v[84:87], v[116:119], a[180:183]
v_mfma_f32_16x16x32_bf16 a[184:187], v[84:87], v[120:123], a[184:187]
v_mfma_f32_16x16x32_bf16 a[188:191], v[84:87], v[124:127], a[188:191]
v_mfma_f32_16x16x32_bf16 a[192:195], v[88:91], v[96:99], a[192:195]
buffer_load_dwordx4 v15, s[4:7], s31 offen offset:1024 sc1 lds
v_mfma_f32_16x16x32_bf16 a[196:199], v[88:91], v[100:103], a[196:199]
v_mfma_f32_16x16x32_bf16 a[200:203], v[88:91], v[104:107], a[200:203]
v_mfma_f32_16x16x32_bf16 a[204:207], v[88:91], v[108:111], a[204:207]
v_mfma_f32_16x16x32_bf16 a[208:211], v[88:91], v[112:115], a[208:211]
buffer_load_dwordx4 v15, s[4:7], s31 offen offset:2048 sc1 lds
v_mfma_f32_16x16x32_bf16 a[212:215], v[88:91], v[116:119], a[212:215]
v_mfma_f32_16x16x32_bf16 a[216:219], v[88:91], v[120:123], a[216:219]
v_mfma_f32_16x16x32_bf16 a[220:223], v[88:91], v[124:127], a[220:223]
v_mfma_f32_16x16x32_bf16 a[224:227], v[92:95], v[96:99], a[224:227]
buffer_load_dwordx4 v15, s[4:7], s31 offen offset:3072 sc1 lds
v_mfma_f32_16x16x32_bf16 a[228:231], v[92:95], v[100:103], a[228:231]
v_mfma_f32_16x16x32_bf16 a[232:235], v[92:95], v[104:107], a[232:235]
s_add_u32 s30, s30, 262144
v_mfma_f32_16x16x32_bf16 a[236:239], v[92:95], v[108:111], a[236:239]
s_add_u32 s31, s31, 16384
v_mfma_f32_16x16x32_bf16 a[240:243], v[92:95], v[112:115], a[240:243]
v_mfma_f32_16x16x32_bf16 a[244:247], v[92:95], v[116:119], a[244:247]
v_mfma_f32_16x16x32_bf16 a[248:251], v[92:95], v[120:123], a[248:251]
v_mfma_f32_16x16x32_bf16 a[252:255], v[92:95], v[124:127], a[252:255]
s_waitcnt lgkmcnt(0)
v_mfma_f32_16x16x32_bf16 a[0:3], v[128:131], v[160:163], a[0:3]
v_mfma_f32_16x16x32_bf16 a[4:7], v[128:131], v[164:167], a[4:7]
s_waitcnt vmcnt(8)
s_barrier
v_mfma_f32_16x16x32_bf16 a[8:11], v[128:131], v[168:171], a[8:11]
ds_read_b128 v[96:99], v10 offset:32768
v_mfma_f32_16x16x32_bf16 a[12:15], v[128:131], v[172:175], a[12:15]
ds_read_b128 v[100:103], v10 offset:33792
v_mfma_f32_16x16x32_bf16 a[16:19], v[128:131], v[176:179], a[16:19]
ds_read_b128 v[104:107], v10 offset:34816
v_mfma_f32_16x16x32_bf16 a[20:23], v[128:131], v[180:183], a[20:23]
ds_read_b128 v[108:111], v10 offset:35840
v_mfma_f32_16x16x32_bf16 a[24:27], v[128:131], v[184:187], a[24:27]
ds_read_b128 v[112:115], v10 offset:36864
v_mfma_f32_16x16x32_bf16 a[28:31], v[128:131], v[188:191], a[28:31]
ds_read_b128 v[116:119], v10 offset:37888
v_mfma_f32_16x16x32_bf16 a[32:35], v[132:135], v[160:163], a[32:35]
ds_read_b128 v[120:123], v10 offset:38912
v_mfma_f32_16x16x32_bf16 a[36:39], v[132:135], v[164:167], a[36:39]
ds_read_b128 v[124:127], v10 offset:39936
v_mfma_f32_16x16x32_bf16 a[40:43], v[132:135], v[168:171], a[40:43]
ds_read_b64_tr_b16 v[64:65], v2 offset:32768
v_mfma_f32_16x16x32_bf16 a[44:47], v[132:135], v[172:175], a[44:47]
ds_read_b64_tr_b16 v[66:67], v2 offset:40960
v_mfma_f32_16x16x32_bf16 a[48:51], v[132:135], v[176:179], a[48:51]
ds_read_b64_tr_b16 v[68:69], v3 offset:32768
v_mfma_f32_16x16x32_bf16 a[52:55], v[132:135], v[180:183], a[52:55]
ds_read_b64_tr_b16 v[70:71], v3 offset:40960
v_mfma_f32_16x16x32_bf16 a[56:59], v[132:135], v[184:187], a[56:59]
ds_read_b64_tr_b16 v[72:73], v4 offset:32768
v_mfma_f32_16x16x32_bf16 a[60:63], v[132:135], v[188:191], a[60:63]
ds_read_b64_tr_b16 v[74:75], v4 offset:40960
v_mfma_f32_16x16x32_bf16 a[64:67], v[136:139], v[160:163], a[64:67]
ds_read_b64_tr_b16 v[76:77], v5 offset:32768
v_mfma_f32_16x16x32_bf16 a[68:71], v[136:139], v[164:167], a[68:71]
ds_read_b64_tr_b16 v[78:79], v5 offset:40960
v_mfma_f32_16x16x32_bf16 a[72:75], v[136:139], v[168:171], a[72:75]
ds_read_b64_tr_b16 v[80:81], v6 offset:32768
v_mfma_f32_16x16x32_bf16 a[76:79], v[136:139], v[172:175], a[76:79]
ds_read_b64_tr_b16 v[82:83], v6 offset:40960
v_mfma_f32_16x16x32_bf16 a[80:83], v[136:139], v[176:179], a[80:83]
ds_read_b64_tr_b16 v[84:85], v7 offset:32768
v_mfma_f32_16x16x32_bf16 a[84:87], v[136:139], v[180:183], a[84:87]
ds_read_b64_tr_b16 v[86:87], v7 offset:40960
v_mfma_f32_16x16x32_bf16 a[88:91], v[136:139], v[184:187], a[88:91]
ds_read_b64_tr_b16 v[88:89], v8 offset:32768
v_mfma_f32_16x16x32_bf16 a[92:95], v[136:139], v[188:191], a[92:95]
ds_read_b64_tr_b16 v[90:91], v8 offset:40960
v_mfma_f32_16x16x32_bf16 a[96:99], v[140:143], v[160:163], a[96:99]
ds_read_b64_tr_b16 v[92:93], v9 offset:32768
v_mfma_f32_16x16x32_bf16 a[100:103], v[140:143], v[164:167], a[100:103]
ds_read_b64_tr_b16 v[94:95], v9 offset:40960
v_mfma_f32_16x16x32_bf16 a[104:107], v[140:143], v[168:171], a[104:107]
v_mfma_f32_16x16x32_bf16 a[108:111], v[140:143], v[172:175], a[108:111]
v_mfma_f32_16x16x32_bf16 a[112:115], v[140:143], v[176:179], a[112:115]
v_mfma_f32_16x16x32_bf16 a[116:119], v[140:143], v[180:183], a[116:119]
v_mfma_f32_16x16x32_bf16 a[120:123], v[140:143], v[184:187], a[120:123]
v_mfma_f32_16x16x32_bf16 a[124:127], v[140:143], v[188:191], a[124:127]
v_mfma_f32_16x16x32_bf16 a[128:131], v[144:147], v[160:163], a[128:131]
v_mfma_f32_16x16x32_bf16 a[132:135], v[144:147], v[164:167], a[132:135]
v_mfma_f32_16x16x32_bf16 a[136:139], v[144:147], v[168:171], a[136:139]
v_mfma_f32_16x16x32_bf16 a[140:143], v[144:147], v[172:175], a[140:143]
v_mfma_f32_16x16x32_bf16 a[144:147], v[144:147], v[176:179], a[144:147]
v_mfma_f32_16x16x32_bf16 a[148:151], v[144:147], v[180:183], a[148:151]
v_mfma_f32_16x16x32_bf16 a[152:155], v[144:147], v[184:187], a[152:155]
v_mfma_f32_16x16x32_bf16 a[156:159], v[144:147], v[188:191], a[156:159]
v_mfma_f32_16x16x32_bf16 a[160:163], v[148:151], v[160:163], a[160:163]
v_mfma_f32_16x16x32_bf16 a[164:167], v[148:151], v[164:167], a[164:167]
v_mfma_f32_16x16x32_bf16 a[168:171], v[148:151], v[168:171], a[168:171]
v_mfma_f32_16x16x32_bf16 a[172:175], v[148:151], v[172:175], a[172:175]
v_mfma_f32_16x16x32_bf16 a[176:179], v[148:151], v[176:179], a[176:179]
v_mfma_f32_16x16x32_bf16 a[180:183], v[148:151], v[180:183], a[180:183]
v_mfma_f32_16x16x32_bf16 a[184:187], v[148:151], v[184:187], a[184:187]
v_mfma_f32_16x16x32_bf16 a[188:191], v[148:151], v[188:191], a[188:191]
v_mfma_f32_16x16x32_bf16 a[192:195], v[152:155], v[160:163], a[192:195]
v_mfma_f32_16x16x32_bf16 a[196:199], v[152:155], v[164:167], a[196:199]
v_mfma_f32_16x16x32_bf16 a[200:203], v[152:155], v[168:171], a[200:203]
v_mfma_f32_16x16x32_bf16 a[204:207], v[152:155], v[172:175], a[204:207]
v_mfma_f32_16x16x32_bf16 a[208:211], v[152:155], v[176:179], a[208:211]
v_mfma_f32_16x16x32_bf16 a[212:215], v[152:155], v[180:183], a[212:215]
v_mfma_f32_16x16x32_bf16 a[216:219], v[152:155], v[184:187], a[216:219]
v_mfma_f32_16x16x32_bf16 a[220:223], v[152:155], v[188:191], a[220:223]
v_mfma_f32_16x16x32_bf16 a[224:227], v[156:159], v[160:163], a[224:227]
v_mfma_f32_16x16x32_bf16 a[228:231], v[156:159], v[164:167], a[228:231]
v_mfma_f32_16x16x32_bf16 a[232:235], v[156:159], v[168:171], a[232:235]
v_mfma_f32_16x16x32_bf16 a[236:239], v[156:159], v[172:175], a[236:239]
v_mfma_f32_16x16x32_bf16 a[240:243], v[156:159], v[176:179], a[240:243]
v_mfma_f32_16x16x32_bf16 a[244:247], v[156:159], v[180:183], a[244:247]
v_mfma_f32_16x16x32_bf16 a[248:251], v[156:159], v[184:187], a[248:251]
v_mfma_f32_16x16x32_bf16 a[252:255], v[156:159], v[188:191], a[252:255]
s_waitcnt lgkmcnt(0)
v_mfma_f32_16x16x32_bf16 a[0:3], v[64:67], v[96:99], a[0:3]
v_mfma_f32_16x16x32_bf16 a[4:7], v[64:67], v[100:103], a[4:7]
s_waitcnt vmcnt(0)
s_barrier
v_mfma_f32_16x16x32_bf16 a[8:11], v[64:67], v[104:107], a[8:11]
ds_read_b128 v[160:163], v10 offset:49152
v_mfma_f32_16x16x32_bf16 a[12:15], v[64:67], v[108:111], a[12:15]
ds_read_b128 v[164:167], v10 offset:50176
v_mfma_f32_16x16x32_bf16 a[16:19], v[64:67], v[112:115], a[16:19]
ds_read_b128 v[168:171], v10 offset:51200
v_mfma_f32_16x16x32_bf16 a[20:23], v[64:67], v[116:119], a[20:23]
ds_read_b128 v[172:175], v10 offset:52224
v_mfma_f32_16x16x32_bf16 a[24:27], v[64:67], v[120:123], a[24:27]
ds_read_b128 v[176:179], v10 offset:53248
v_mfma_f32_16x16x32_bf16 a[28:31], v[64:67], v[124:127], a[28:31]
ds_read_b128 v[180:183], v10 offset:54272
v_mfma_f32_16x16x32_bf16 a[32:35], v[68:71], v[96:99], a[32:35]
ds_read_b128 v[184:187], v10 offset:55296
v_mfma_f32_16x16x32_bf16 a[36:39], v[68:71], v[100:103], a[36:39]
ds_read_b128 v[188:191], v10 offset:56320
v_mfma_f32_16x16x32_bf16 a[40:43], v[68:71], v[104:107], a[40:43]
ds_read_b64_tr_b16 v[128:129], v2 offset:49152
v_mfma_f32_16x16x32_bf16 a[44:47], v[68:71], v[108:111], a[44:47]
ds_read_b64_tr_b16 v[130:131], v2 offset:57344
v_mfma_f32_16x16x32_bf16 a[48:51], v[68:71], v[112:115], a[48:51]
ds_read_b64_tr_b16 v[132:133], v3 offset:49152
v_mfma_f32_16x16x32_bf16 a[52:55], v[68:71], v[116:119], a[52:55]
ds_read_b64_tr_b16 v[134:135], v3 offset:57344
v_mfma_f32_16x16x32_bf16 a[56:59], v[68:71], v[120:123], a[56:59]
ds_read_b64_tr_b16 v[136:137], v4 offset:49152
v_mfma_f32_16x16x32_bf16 a[60:63], v[68:71], v[124:127], a[60:63]
ds_read_b64_tr_b16 v[138:139], v4 offset:57344
v_mfma_f32_16x16x32_bf16 a[64:67], v[72:75], v[96:99], a[64:67]
ds_read_b64_tr_b16 v[140:141], v5 offset:49152
v_mfma_f32_16x16x32_bf16 a[68:71], v[72:75], v[100:103], a[68:71]
ds_read_b64_tr_b16 v[142:143], v5 offset:57344
v_mfma_f32_16x16x32_bf16 a[72:75], v[72:75], v[104:107], a[72:75]
ds_read_b64_tr_b16 v[144:145], v6 offset:49152
v_mfma_f32_16x16x32_bf16 a[76:79], v[72:75], v[108:111], a[76:79]
ds_read_b64_tr_b16 v[146:147], v6 offset:57344
v_mfma_f32_16x16x32_bf16 a[80:83], v[72:75], v[112:115], a[80:83]
ds_read_b64_tr_b16 v[148:149], v7 offset:49152
v_mfma_f32_16x16x32_bf16 a[84:87], v[72:75], v[116:119], a[84:87]
ds_read_b64_tr_b16 v[150:151], v7 offset:57344
v_mfma_f32_16x16x32_bf16 a[88:91], v[72:75], v[120:123], a[88:91]
ds_read_b64_tr_b16 v[152:153], v8 offset:49152
v_mfma_f32_16x16x32_bf16 a[92:95], v[72:75], v[124:127], a[92:95]
ds_read_b64_tr_b16 v[154:155], v8 offset:57344
v_mfma_f32_16x16x32_bf16 a[96:99], v[76:79], v[96:99], a[96:99]
ds_read_b64_tr_b16 v[156:157], v9 offset:49152
v_mfma_f32_16x16x32_bf16 a[100:103], v[76:79], v[100:103], a[100:103]
ds_read_b64_tr_b16 v[158:159], v9 offset:57344
v_mfma_f32_16x16x32_bf16 a[104:107], v[76:79], v[104:107], a[104:107]
v_mfma_f32_16x16x32_bf16 a[108:111], v[76:79], v[108:111], a[108:111]
v_mfma_f32_16x16x32_bf16 a[112:115], v[76:79], v[112:115], a[112:115]
v_mfma_f32_16x16x32_bf16 a[116:119], v[76:79], v[116:119], a[116:119]
v_mfma_f32_16x16x32_bf16 a[120:123], v[76:79], v[120:123], a[120:123]
v_mfma_f32_16x16x32_bf16 a[124:127], v[76:79], v[124:127], a[124:127]
v_mfma_f32_16x16x32_bf16 a[128:131], v[80:83], v[96:99], a[128:131]
v_mfma_f32_16x16x32_bf16 a[132:135], v[80:83], v[100:103], a[132:135]
v_mfma_f32_16x16x32_bf16 a[136:139], v[80:83], v[104:107], a[136:139]
v_mfma_f32_16x16x32_bf16 a[140:143], v[80:83], v[108:111], a[140:143]
v_mfma_f32_16x16x32_bf16 a[144:147], v[80:83], v[112:115], a[144:147]
v_mfma_f32_16x16x32_bf16 a[148:151], v[80:83], v[116:119], a[148:151]
v_mfma_f32_16x16x32_bf16 a[152:155], v[80:83], v[120:123], a[152:155]
v_mfma_f32_16x16x32_bf16 a[156:159], v[80:83], v[124:127], a[156:159]
v_mfma_f32_16x16x32_bf16 a[160:163], v[84:87], v[96:99], a[160:163]
v_mfma_f32_16x16x32_bf16 a[164:167], v[84:87], v[100:103], a[164:167]
v_mfma_f32_16x16x32_bf16 a[168:171], v[84:87], v[104:107], a[168:171]
v_mfma_f32_16x16x32_bf16 a[172:175], v[84:87], v[108:111], a[172:175]
v_mfma_f32_16x16x32_bf16 a[176:179], v[84:87], v[112:115], a[176:179]
v_mfma_f32_16x16x32_bf16 a[180:183], v[84:87], v[116:119], a[180:183]
v_mfma_f32_16x16x32_bf16 a[184:187], v[84:87], v[120:123], a[184:187]
v_mfma_f32_16x16x32_bf16 a[188:191], v[84:87], v[124:127], a[188:191]
v_mfma_f32_16x16x32_bf16 a[192:195], v[88:91], v[96:99], a[192:195]
v_mfma_f32_16x16x32_bf16 a[196:199], v[88:91], v[100:103], a[196:199]
v_mfma_f32_16x16x32_bf16 a[200:203], v[88:91], v[104:107], a[200:203]
v_mfma_f32_16x16x32_bf16 a[204:207], v[88:91], v[108:111], a[204:207]
v_mfma_f32_16x16x32_bf16 a[208:211], v[88:91], v[112:115], a[208:211]
v_mfma_f32_16x16x32_bf16 a[212:215], v[88:91], v[116:119], a[212:215]
v_mfma_f32_16x16x32_bf16 a[216:219], v[88:91], v[120:123], a[216:219]
v_mfma_f32_16x16x32_bf16 a[220:223], v[88:91], v[124:127], a[220:223]
v_mfma_f32_16x16x32_bf16 a[224:227], v[92:95], v[96:99], a[224:227]
v_mfma_f32_16x16x32_bf16 a[228:231], v[92:95], v[100:103], a[228:231]
v_mfma_f32_16x16x32_bf16 a[232:235], v[92:95], v[104:107], a[232:235]
v_mfma_f32_16x16x32_bf16 a[236:239], v[92:95], v[108:111], a[236:239]
v_mfma_f32_16x16x32_bf16 a[240:243], v[92:95], v[112:115], a[240:243]
v_mfma_f32_16x16x32_bf16 a[244:247], v[92:95], v[116:119], a[244:247]
v_mfma_f32_16x16x32_bf16 a[248:251], v[92:95], v[120:123], a[248:251]
v_mfma_f32_16x16x32_bf16 a[252:255], v[92:95], v[124:127], a[252:255]
s_waitcnt lgkmcnt(0)
v_mfma_f32_16x16x32_bf16 a[0:3], v[128:131], v[160:163], a[0:3]
v_mfma_f32_16x16x32_bf16 a[4:7], v[128:131], v[164:167], a[4:7]
v_mfma_f32_16x16x32_bf16 a[8:11], v[128:131], v[168:171], a[8:11]
v_mfma_f32_16x16x32_bf16 a[12:15], v[128:131], v[172:175], a[12:15]
v_mfma_f32_16x16x32_bf16 a[16:19], v[128:131], v[176:179], a[16:19]
v_mfma_f32_16x16x32_bf16 a[20:23], v[128:131], v[180:183], a[20:23]
v_mfma_f32_16x16x32_bf16 a[24:27], v[128:131], v[184:187], a[24:27]
v_mfma_f32_16x16x32_bf16 a[28:31], v[128:131], v[188:191], a[28:31]
v_mfma_f32_16x16x32_bf16 a[32:35], v[132:135], v[160:163], a[32:35]
v_mfma_f32_16x16x32_bf16 a[36:39], v[132:135], v[164:167], a[36:39]
v_mfma_f32_16x16x32_bf16 a[40:43], v[132:135], v[168:171], a[40:43]
v_mfma_f32_16x16x32_bf16 a[44:47], v[132:135], v[172:175], a[44:47]
v_mfma_f32_16x16x32_bf16 a[48:51], v[132:135], v[176:179], a[48:51]
v_mfma_f32_16x16x32_bf16 a[52:55], v[132:135], v[180:183], a[52:55]
v_mfma_f32_16x16x32_bf16 a[56:59], v[132:135], v[184:187], a[56:59]
v_mfma_f32_16x16x32_bf16 a[60:63], v[132:135], v[188:191], a[60:63]
v_mfma_f32_16x16x32_bf16 a[64:67], v[136:139], v[160:163], a[64:67]
v_mfma_f32_16x16x32_bf16 a[68:71], v[136:139], v[164:167], a[68:71]
v_mfma_f32_16x16x32_bf16 a[72:75], v[136:139], v[168:171], a[72:75]
v_mfma_f32_16x16x32_bf16 a[76:79], v[136:139], v[172:175], a[76:79]
v_mfma_f32_16x16x32_bf16 a[80:83], v[136:139], v[176:179], a[80:83]
v_mfma_f32_16x16x32_bf16 a[84:87], v[136:139], v[180:183], a[84:87]
v_mfma_f32_16x16x32_bf16 a[88:91], v[136:139], v[184:187], a[88:91]
v_mfma_f32_16x16x32_bf16 a[92:95], v[136:139], v[188:191], a[92:95]
v_mfma_f32_16x16x32_bf16 a[96:99], v[140:143], v[160:163], a[96:99]
v_mfma_f32_16x16x32_bf16 a[100:103], v[140:143], v[164:167], a[100:103]
v_mfma_f32_16x16x32_bf16 a[104:107], v[140:143], v[168:171], a[104:107]
v_mfma_f32_16x16x32_bf16 a[108:111], v[140:143], v[172:175], a[108:111]
v_mfma_f32_16x16x32_bf16 a[112:115], v[140:143], v[176:179], a[112:115]
v_mfma_f32_16x16x32_bf16 a[116:119], v[140:143], v[180:183], a[116:119]
v_mfma_f32_16x16x32_bf16 a[120:123], v[140:143], v[184:187], a[120:123]
v_mfma_f32_16x16x32_bf16 a[124:127], v[140:143], v[188:191], a[124:127]
v_mfma_f32_16x16x32_bf16 a[128:131], v[144:147], v[160:163], a[128:131]
v_mfma_f32_16x16x32_bf16 a[132:135], v[144:147], v[164:167], a[132:135]
v_mfma_f32_16x16x32_bf16 a[136:139], v[144:147], v[168:171], a[136:139]
v_mfma_f32_16x16x32_bf16 a[140:143], v[144:147], v[172:175], a[140:143]
v_mfma_f32_16x16x32_bf16 a[144:147], v[144:147], v[176:179], a[144:147]
v_mfma_f32_16x16x32_bf16 a[148:151], v[144:147], v[180:183], a[148:151]
v_mfma_f32_16x16x32_bf16 a[152:155], v[144:147], v[184:187], a[152:155]
v_mfma_f32_16x16x32_bf16 a[156:159], v[144:147], v[188:191], a[156:159]
v_mfma_f32_16x16x32_bf16 a[160:163], v[148:151], v[160:163], a[160:163]
v_mfma_f32_16x16x32_bf16 a[164:167], v[148:151], v[164:167], a[164:167]
v_mfma_f32_16x16x32_bf16 a[168:171], v[148:151], v[168:171], a[168:171]
v_mfma_f32_16x16x32_bf16 a[172:175], v[148:151], v[172:175], a[172:175]
v_mfma_f32_16x16x32_bf16 a[176:179], v[148:151], v[176:179], a[176:179]
v_mfma_f32_16x16x32_bf16 a[180:183], v[148:151], v[180:183], a[180:183]
v_mfma_f32_16x16x32_bf16 a[184:187], v[148:151], v[184:187], a[184:187]
v_mfma_f32_16x16x32_bf16 a[188:191], v[148:151], v[188:191], a[188:191]
v_mfma_f32_16x16x32_bf16 a[192:195], v[152:155], v[160:163], a[192:195]
v_mfma_f32_16x16x32_bf16 a[196:199], v[152:155], v[164:167], a[196:199]
v_mfma_f32_16x16x32_bf16 a[200:203], v[152:155], v[168:171], a[200:203]
v_mfma_f32_16x16x32_bf16 a[204:207], v[152:155], v[172:175], a[204:207]
v_mfma_f32_16x16x32_bf16 a[208:211], v[152:155], v[176:179], a[208:211]
v_mfma_f32_16x16x32_bf16 a[212:215], v[152:155], v[180:183], a[212:215]
v_mfma_f32_16x16x32_bf16 a[216:219], v[152:155], v[184:187], a[216:219]
v_mfma_f32_16x16x32_bf16 a[220:223], v[152:155], v[188:191], a[220:223]
v_mfma_f32_16x16x32_bf16 a[224:227], v[156:159], v[160:163], a[224:227]
v_mfma_f32_16x16x32_bf16 a[228:231], v[156:159], v[164:167], a[228:231]
v_mfma_f32_16x16x32_bf16 a[232:235], v[156:159], v[168:171], a[232:235]
v_mfma_f32_16x16x32_bf16 a[236:239], v[156:159], v[172:175], a[236:239]
v_mfma_f32_16x16x32_bf16 a[240:243], v[156:159], v[176:179], a[240:243]
v_mfma_f32_16x16x32_bf16 a[244:247], v[156:159], v[180:183], a[244:247]
v_mfma_f32_16x16x32_bf16 a[248:251], v[156:159], v[184:187], a[248:251]
v_mfma_f32_16x16x32_bf16 a[252:255], v[156:159], v[188:191], a[252:255]
s_nop 7
s_mov_b32 s42, 1.0
s_lshl_b32 s36, s28, 21
s_lshl_b32 s37, s34, 20
s_add_u32 s36, s36, s37
s_lshl_b32 s37, s29, 14
s_add_u32 s36, s36, s37
s_lshl_b32 s37, s35, 13
s_add_u32 s36, s36, s37
s_add_u32 s36, s36, 25165824
s_add_u32 s38, s36, 0
v_accvgpr_read_b32 v64, a0
v_accvgpr_read_b32 v65, a1
v_accvgpr_read_b32 v66, a2
v_accvgpr_read_b32 v67, a3
v_accvgpr_read_b32 v68, a32
v_accvgpr_read_b32 v69, a33
v_accvgpr_read_b32 v70, a34
v_accvgpr_read_b32 v71, a35
v_cvt_pk_bf16_f32 v72, v64, v65
v_cvt_pk_bf16_f32 v73, v66, v67
v_cvt_pk_bf16_f32 v74, v68, v69
v_cvt_pk_bf16_f32 v75, v70, v71
buffer_store_dwordx4 v[72:75], v61, s[4:7], s38 offen offset:0 sc1
v_accvgpr_read_b32 v80, a64
v_accvgpr_read_b32 v81, a65
v_accvgpr_read_b32 v82, a66
v_accvgpr_read_b32 v83, a67
v_accvgpr_read_b32 v84, a96
v_accvgpr_read_b32 v85, a97
v_accvgpr_read_b32 v86, a98
v_accvgpr_read_b32 v87, a99
v_cvt_pk_bf16_f32 v88, v80, v81
v_cvt_pk_bf16_f32 v89, v82, v83
v_cvt_pk_bf16_f32 v90, v84, v85
v_cvt_pk_bf16_f32 v91, v86, v87
buffer_store_dwordx4 v[88:91], v61, s[4:7], s38 offen offset:1024 sc1
v_accvgpr_read_b32 v96, a128
v_accvgpr_read_b32 v97, a129
v_accvgpr_read_b32 v98, a130
v_accvgpr_read_b32 v99, a131
v_accvgpr_read_b32 v100, a160
v_accvgpr_read_b32 v101, a161
v_accvgpr_read_b32 v102, a162
v_accvgpr_read_b32 v103, a163
v_cvt_pk_bf16_f32 v104, v96, v97
v_cvt_pk_bf16_f32 v105, v98, v99
v_cvt_pk_bf16_f32 v106, v100, v101
v_cvt_pk_bf16_f32 v107, v102, v103
buffer_store_dwordx4 v[104:107], v61, s[4:7], s38 offen offset:2048 sc1
v_accvgpr_read_b32 v112, a192
v_accvgpr_read_b32 v113, a193
v_accvgpr_read_b32 v114, a194
v_accvgpr_read_b32 v115, a195
v_accvgpr_read_b32 v116, a224
v_accvgpr_read_b32 v117, a225
v_accvgpr_read_b32 v118, a226
v_accvgpr_read_b32 v119, a227
v_cvt_pk_bf16_f32 v120, v112, v113
v_cvt_pk_bf16_f32 v121, v114, v115
v_cvt_pk_bf16_f32 v122, v116, v117
v_cvt_pk_bf16_f32 v123, v118, v119
buffer_store_dwordx4 v[120:123], v61, s[4:7], s38 offen offset:3072 sc1
s_add_u32 s38, s36, 4096
v_accvgpr_read_b32 v64, a4
v_accvgpr_read_b32 v65, a5
v_accvgpr_read_b32 v66, a6
v_accvgpr_read_b32 v67, a7
v_accvgpr_read_b32 v68, a36
v_accvgpr_read_b32 v69, a37
v_accvgpr_read_b32 v70, a38
v_accvgpr_read_b32 v71, a39
v_cvt_pk_bf16_f32 v72, v64, v65
v_cvt_pk_bf16_f32 v73, v66, v67
v_cvt_pk_bf16_f32 v74, v68, v69
v_cvt_pk_bf16_f32 v75, v70, v71
buffer_store_dwordx4 v[72:75], v61, s[4:7], s38 offen offset:0 sc1
v_accvgpr_read_b32 v80, a68
v_accvgpr_read_b32 v81, a69
v_accvgpr_read_b32 v82, a70
v_accvgpr_read_b32 v83, a71
v_accvgpr_read_b32 v84, a100
v_accvgpr_read_b32 v85, a101
v_accvgpr_read_b32 v86, a102
v_accvgpr_read_b32 v87, a103
v_cvt_pk_bf16_f32 v88, v80, v81
v_cvt_pk_bf16_f32 v89, v82, v83
v_cvt_pk_bf16_f32 v90, v84, v85
v_cvt_pk_bf16_f32 v91, v86, v87
buffer_store_dwordx4 v[88:91], v61, s[4:7], s38 offen offset:1024 sc1
v_accvgpr_read_b32 v96, a132
v_accvgpr_read_b32 v97, a133
v_accvgpr_read_b32 v98, a134
v_accvgpr_read_b32 v99, a135
v_accvgpr_read_b32 v100, a164
v_accvgpr_read_b32 v101, a165
v_accvgpr_read_b32 v102, a166
v_accvgpr_read_b32 v103, a167
v_cvt_pk_bf16_f32 v104, v96, v97
v_cvt_pk_bf16_f32 v105, v98, v99
v_cvt_pk_bf16_f32 v106, v100, v101
v_cvt_pk_bf16_f32 v107, v102, v103
buffer_store_dwordx4 v[104:107], v61, s[4:7], s38 offen offset:2048 sc1
v_accvgpr_read_b32 v112, a196
v_accvgpr_read_b32 v113, a197
v_accvgpr_read_b32 v114, a198
v_accvgpr_read_b32 v115, a199
v_accvgpr_read_b32 v116, a228
v_accvgpr_read_b32 v117, a229
v_accvgpr_read_b32 v118, a230
v_accvgpr_read_b32 v119, a231
v_cvt_pk_bf16_f32 v120, v112, v113
v_cvt_pk_bf16_f32 v121, v114, v115
v_cvt_pk_bf16_f32 v122, v116, v117
v_cvt_pk_bf16_f32 v123, v118, v119
buffer_store_dwordx4 v[120:123], v61, s[4:7], s38 offen offset:3072 sc1
s_add_u32 s38, s36, 262144
v_accvgpr_read_b32 v64, a8
v_accvgpr_read_b32 v65, a9
v_accvgpr_read_b32 v66, a10
v_accvgpr_read_b32 v67, a11
v_accvgpr_read_b32 v68, a40
v_accvgpr_read_b32 v69, a41
v_accvgpr_read_b32 v70, a42
v_accvgpr_read_b32 v71, a43
v_cvt_pk_bf16_f32 v72, v64, v65
v_cvt_pk_bf16_f32 v73, v66, v67
v_cvt_pk_bf16_f32 v74, v68, v69
v_cvt_pk_bf16_f32 v75, v70, v71
buffer_store_dwordx4 v[72:75], v61, s[4:7], s38 offen offset:0 sc1
v_accvgpr_read_b32 v80, a72
v_accvgpr_read_b32 v81, a73
v_accvgpr_read_b32 v82, a74
v_accvgpr_read_b32 v83, a75
v_accvgpr_read_b32 v84, a104
v_accvgpr_read_b32 v85, a105
v_accvgpr_read_b32 v86, a106
v_accvgpr_read_b32 v87, a107
v_cvt_pk_bf16_f32 v88, v80, v81
v_cvt_pk_bf16_f32 v89, v82, v83
v_cvt_pk_bf16_f32 v90, v84, v85
v_cvt_pk_bf16_f32 v91, v86, v87
buffer_store_dwordx4 v[88:91], v61, s[4:7], s38 offen offset:1024 sc1
v_accvgpr_read_b32 v96, a136
v_accvgpr_read_b32 v97, a137
v_accvgpr_read_b32 v98, a138
v_accvgpr_read_b32 v99, a139
v_accvgpr_read_b32 v100, a168
v_accvgpr_read_b32 v101, a169
v_accvgpr_read_b32 v102, a170
v_accvgpr_read_b32 v103, a171
v_cvt_pk_bf16_f32 v104, v96, v97
v_cvt_pk_bf16_f32 v105, v98, v99
v_cvt_pk_bf16_f32 v106, v100, v101
v_cvt_pk_bf16_f32 v107, v102, v103
buffer_store_dwordx4 v[104:107], v61, s[4:7], s38 offen offset:2048 sc1
v_accvgpr_read_b32 v112, a200
v_accvgpr_read_b32 v113, a201
v_accvgpr_read_b32 v114, a202
v_accvgpr_read_b32 v115, a203
v_accvgpr_read_b32 v116, a232
v_accvgpr_read_b32 v117, a233
v_accvgpr_read_b32 v118, a234
v_accvgpr_read_b32 v119, a235
v_cvt_pk_bf16_f32 v120, v112, v113
v_cvt_pk_bf16_f32 v121, v114, v115
v_cvt_pk_bf16_f32 v122, v116, v117
v_cvt_pk_bf16_f32 v123, v118, v119
buffer_store_dwordx4 v[120:123], v61, s[4:7], s38 offen offset:3072 sc1
s_add_u32 s38, s36, 266240
v_accvgpr_read_b32 v64, a12
v_accvgpr_read_b32 v65, a13
v_accvgpr_read_b32 v66, a14
v_accvgpr_read_b32 v67, a15
v_accvgpr_read_b32 v68, a44
v_accvgpr_read_b32 v69, a45
v_accvgpr_read_b32 v70, a46
v_accvgpr_read_b32 v71, a47
v_cvt_pk_bf16_f32 v72, v64, v65
v_cvt_pk_bf16_f32 v73, v66, v67
v_cvt_pk_bf16_f32 v74, v68, v69
v_cvt_pk_bf16_f32 v75, v70, v71
buffer_store_dwordx4 v[72:75], v61, s[4:7], s38 offen offset:0 sc1
v_accvgpr_read_b32 v80, a76
v_accvgpr_read_b32 v81, a77
v_accvgpr_read_b32 v82, a78
v_accvgpr_read_b32 v83, a79
v_accvgpr_read_b32 v84, a108
v_accvgpr_read_b32 v85, a109
v_accvgpr_read_b32 v86, a110
v_accvgpr_read_b32 v87, a111
v_cvt_pk_bf16_f32 v88, v80, v81
v_cvt_pk_bf16_f32 v89, v82, v83
v_cvt_pk_bf16_f32 v90, v84, v85
v_cvt_pk_bf16_f32 v91, v86, v87
buffer_store_dwordx4 v[88:91], v61, s[4:7], s38 offen offset:1024 sc1
v_accvgpr_read_b32 v96, a140
v_accvgpr_read_b32 v97, a141
v_accvgpr_read_b32 v98, a142
v_accvgpr_read_b32 v99, a143
v_accvgpr_read_b32 v100, a172
v_accvgpr_read_b32 v101, a173
v_accvgpr_read_b32 v102, a174
v_accvgpr_read_b32 v103, a175
v_cvt_pk_bf16_f32 v104, v96, v97
v_cvt_pk_bf16_f32 v105, v98, v99
v_cvt_pk_bf16_f32 v106, v100, v101
v_cvt_pk_bf16_f32 v107, v102, v103
buffer_store_dwordx4 v[104:107], v61, s[4:7], s38 offen offset:2048 sc1
v_accvgpr_read_b32 v112, a204
v_accvgpr_read_b32 v113, a205
v_accvgpr_read_b32 v114, a206
v_accvgpr_read_b32 v115, a207
v_accvgpr_read_b32 v116, a236
v_accvgpr_read_b32 v117, a237
v_accvgpr_read_b32 v118, a238
v_accvgpr_read_b32 v119, a239
v_cvt_pk_bf16_f32 v120, v112, v113
v_cvt_pk_bf16_f32 v121, v114, v115
v_cvt_pk_bf16_f32 v122, v116, v117
v_cvt_pk_bf16_f32 v123, v118, v119
buffer_store_dwordx4 v[120:123], v61, s[4:7], s38 offen offset:3072 sc1
s_add_u32 s38, s36, 524288
v_accvgpr_read_b32 v64, a16
v_accvgpr_read_b32 v65, a17
v_accvgpr_read_b32 v66, a18
v_accvgpr_read_b32 v67, a19
v_accvgpr_read_b32 v68, a48
v_accvgpr_read_b32 v69, a49
v_accvgpr_read_b32 v70, a50
v_accvgpr_read_b32 v71, a51
v_cvt_pk_bf16_f32 v72, v64, v65
v_cvt_pk_bf16_f32 v73, v66, v67
v_cvt_pk_bf16_f32 v74, v68, v69
v_cvt_pk_bf16_f32 v75, v70, v71
buffer_store_dwordx4 v[72:75], v61, s[4:7], s38 offen offset:0 sc1
v_accvgpr_read_b32 v80, a80
v_accvgpr_read_b32 v81, a81
v_accvgpr_read_b32 v82, a82
v_accvgpr_read_b32 v83, a83
v_accvgpr_read_b32 v84, a112
v_accvgpr_read_b32 v85, a113
v_accvgpr_read_b32 v86, a114
v_accvgpr_read_b32 v87, a115
v_cvt_pk_bf16_f32 v88, v80, v81
v_cvt_pk_bf16_f32 v89, v82, v83
v_cvt_pk_bf16_f32 v90, v84, v85
v_cvt_pk_bf16_f32 v91, v86, v87
buffer_store_dwordx4 v[88:91], v61, s[4:7], s38 offen offset:1024 sc1
v_accvgpr_read_b32 v96, a144
v_accvgpr_read_b32 v97, a145
v_accvgpr_read_b32 v98, a146
v_accvgpr_read_b32 v99, a147
v_accvgpr_read_b32 v100, a176
v_accvgpr_read_b32 v101, a177
v_accvgpr_read_b32 v102, a178
v_accvgpr_read_b32 v103, a179
v_cvt_pk_bf16_f32 v104, v96, v97
v_cvt_pk_bf16_f32 v105, v98, v99
v_cvt_pk_bf16_f32 v106, v100, v101
v_cvt_pk_bf16_f32 v107, v102, v103
buffer_store_dwordx4 v[104:107], v61, s[4:7], s38 offen offset:2048 sc1
v_accvgpr_read_b32 v112, a208
v_accvgpr_read_b32 v113, a209
v_accvgpr_read_b32 v114, a210
v_accvgpr_read_b32 v115, a211
v_accvgpr_read_b32 v116, a240
v_accvgpr_read_b32 v117, a241
v_accvgpr_read_b32 v118, a242
v_accvgpr_read_b32 v119, a243
v_cvt_pk_bf16_f32 v120, v112, v113
v_cvt_pk_bf16_f32 v121, v114, v115
v_cvt_pk_bf16_f32 v122, v116, v117
v_cvt_pk_bf16_f32 v123, v118, v119
buffer_store_dwordx4 v[120:123], v61, s[4:7], s38 offen offset:3072 sc1
s_add_u32 s38, s36, 528384
v_accvgpr_read_b32 v64, a20
v_accvgpr_read_b32 v65, a21
v_accvgpr_read_b32 v66, a22
v_accvgpr_read_b32 v67, a23
v_accvgpr_read_b32 v68, a52
v_accvgpr_read_b32 v69, a53
v_accvgpr_read_b32 v70, a54
v_accvgpr_read_b32 v71, a55
v_cvt_pk_bf16_f32 v72, v64, v65
v_cvt_pk_bf16_f32 v73, v66, v67
v_cvt_pk_bf16_f32 v74, v68, v69
v_cvt_pk_bf16_f32 v75, v70, v71
buffer_store_dwordx4 v[72:75], v61, s[4:7], s38 offen offset:0 sc1
v_accvgpr_read_b32 v80, a84
v_accvgpr_read_b32 v81, a85
v_accvgpr_read_b32 v82, a86
v_accvgpr_read_b32 v83, a87
v_accvgpr_read_b32 v84, a116
v_accvgpr_read_b32 v85, a117
v_accvgpr_read_b32 v86, a118
v_accvgpr_read_b32 v87, a119
v_cvt_pk_bf16_f32 v88, v80, v81
v_cvt_pk_bf16_f32 v89, v82, v83
v_cvt_pk_bf16_f32 v90, v84, v85
v_cvt_pk_bf16_f32 v91, v86, v87
buffer_store_dwordx4 v[88:91], v61, s[4:7], s38 offen offset:1024 sc1
v_accvgpr_read_b32 v96, a148
v_accvgpr_read_b32 v97, a149
v_accvgpr_read_b32 v98, a150
v_accvgpr_read_b32 v99, a151
v_accvgpr_read_b32 v100, a180
v_accvgpr_read_b32 v101, a181
v_accvgpr_read_b32 v102, a182
v_accvgpr_read_b32 v103, a183
v_cvt_pk_bf16_f32 v104, v96, v97
v_cvt_pk_bf16_f32 v105, v98, v99
v_cvt_pk_bf16_f32 v106, v100, v101
v_cvt_pk_bf16_f32 v107, v102, v103
buffer_store_dwordx4 v[104:107], v61, s[4:7], s38 offen offset:2048 sc1
v_accvgpr_read_b32 v112, a212
v_accvgpr_read_b32 v113, a213
v_accvgpr_read_b32 v114, a214
v_accvgpr_read_b32 v115, a215
v_accvgpr_read_b32 v116, a244
v_accvgpr_read_b32 v117, a245
v_accvgpr_read_b32 v118, a246
v_accvgpr_read_b32 v119, a247
v_cvt_pk_bf16_f32 v120, v112, v113
v_cvt_pk_bf16_f32 v121, v114, v115
v_cvt_pk_bf16_f32 v122, v116, v117
v_cvt_pk_bf16_f32 v123, v118, v119
buffer_store_dwordx4 v[120:123], v61, s[4:7], s38 offen offset:3072 sc1
s_add_u32 s38, s36, 786432
v_accvgpr_read_b32 v64, a24
v_accvgpr_read_b32 v65, a25
v_accvgpr_read_b32 v66, a26
v_accvgpr_read_b32 v67, a27
v_accvgpr_read_b32 v68, a56
v_accvgpr_read_b32 v69, a57
v_accvgpr_read_b32 v70, a58
v_accvgpr_read_b32 v71, a59
v_cvt_pk_bf16_f32 v72, v64, v65
v_cvt_pk_bf16_f32 v73, v66, v67
v_cvt_pk_bf16_f32 v74, v68, v69
v_cvt_pk_bf16_f32 v75, v70, v71
buffer_store_dwordx4 v[72:75], v61, s[4:7], s38 offen offset:0 sc1
v_accvgpr_read_b32 v80, a88
v_accvgpr_read_b32 v81, a89
v_accvgpr_read_b32 v82, a90
v_accvgpr_read_b32 v83, a91
v_accvgpr_read_b32 v84, a120
v_accvgpr_read_b32 v85, a121
v_accvgpr_read_b32 v86, a122
v_accvgpr_read_b32 v87, a123
v_cvt_pk_bf16_f32 v88, v80, v81
v_cvt_pk_bf16_f32 v89, v82, v83
v_cvt_pk_bf16_f32 v90, v84, v85
v_cvt_pk_bf16_f32 v91, v86, v87
buffer_store_dwordx4 v[88:91], v61, s[4:7], s38 offen offset:1024 sc1
v_accvgpr_read_b32 v96, a152
v_accvgpr_read_b32 v97, a153
v_accvgpr_read_b32 v98, a154
v_accvgpr_read_b32 v99, a155
v_accvgpr_read_b32 v100, a184
v_accvgpr_read_b32 v101, a185
v_accvgpr_read_b32 v102, a186
v_accvgpr_read_b32 v103, a187
v_cvt_pk_bf16_f32 v104, v96, v97
v_cvt_pk_bf16_f32 v105, v98, v99
v_cvt_pk_bf16_f32 v106, v100, v101
v_cvt_pk_bf16_f32 v107, v102, v103
buffer_store_dwordx4 v[104:107], v61, s[4:7], s38 offen offset:2048 sc1
v_accvgpr_read_b32 v112, a216
v_accvgpr_read_b32 v113, a217
v_accvgpr_read_b32 v114, a218
v_accvgpr_read_b32 v115, a219
v_accvgpr_read_b32 v116, a248
v_accvgpr_read_b32 v117, a249
v_accvgpr_read_b32 v118, a250
v_accvgpr_read_b32 v119, a251
v_cvt_pk_bf16_f32 v120, v112, v113
v_cvt_pk_bf16_f32 v121, v114, v115
v_cvt_pk_bf16_f32 v122, v116, v117
v_cvt_pk_bf16_f32 v123, v118, v119
buffer_store_dwordx4 v[120:123], v61, s[4:7], s38 offen offset:3072 sc1
s_add_u32 s38, s36, 790528
v_accvgpr_read_b32 v64, a28
v_accvgpr_read_b32 v65, a29
v_accvgpr_read_b32 v66, a30
v_accvgpr_read_b32 v67, a31
v_accvgpr_read_b32 v68, a60
v_accvgpr_read_b32 v69, a61
v_accvgpr_read_b32 v70, a62
v_accvgpr_read_b32 v71, a63
v_cvt_pk_bf16_f32 v72, v64, v65
v_cvt_pk_bf16_f32 v73, v66, v67
v_cvt_pk_bf16_f32 v74, v68, v69
v_cvt_pk_bf16_f32 v75, v70, v71
buffer_store_dwordx4 v[72:75], v61, s[4:7], s38 offen offset:0 sc1
v_accvgpr_read_b32 v80, a92
v_accvgpr_read_b32 v81, a93
v_accvgpr_read_b32 v82, a94
v_accvgpr_read_b32 v83, a95
v_accvgpr_read_b32 v84, a124
v_accvgpr_read_b32 v85, a125
v_accvgpr_read_b32 v86, a126
v_accvgpr_read_b32 v87, a127
v_cvt_pk_bf16_f32 v88, v80, v81
v_cvt_pk_bf16_f32 v89, v82, v83
v_cvt_pk_bf16_f32 v90, v84, v85
v_cvt_pk_bf16_f32 v91, v86, v87
buffer_store_dwordx4 v[88:91], v61, s[4:7], s38 offen offset:1024 sc1
v_accvgpr_read_b32 v96, a156
v_accvgpr_read_b32 v97, a157
v_accvgpr_read_b32 v98, a158
v_accvgpr_read_b32 v99, a159
v_accvgpr_read_b32 v100, a188
v_accvgpr_read_b32 v101, a189
v_accvgpr_read_b32 v102, a190
v_accvgpr_read_b32 v103, a191
v_cvt_pk_bf16_f32 v104, v96, v97
v_cvt_pk_bf16_f32 v105, v98, v99
v_cvt_pk_bf16_f32 v106, v100, v101
v_cvt_pk_bf16_f32 v107, v102, v103
buffer_store_dwordx4 v[104:107], v61, s[4:7], s38 offen offset:2048 sc1
v_accvgpr_read_b32 v112, a220
v_accvgpr_read_b32 v113, a221
v_accvgpr_read_b32 v114, a222
v_accvgpr_read_b32 v115, a223
v_accvgpr_read_b32 v116, a252
v_accvgpr_read_b32 v117, a253
v_accvgpr_read_b32 v118, a254
v_accvgpr_read_b32 v119, a255
v_cvt_pk_bf16_f32 v120, v112, v113
v_cvt_pk_bf16_f32 v121, v114, v115
v_cvt_pk_bf16_f32 v122, v116, v117
v_cvt_pk_bf16_f32 v123, v118, v119
buffer_store_dwordx4 v[120:123], v61, s[4:7], s38 offen offset:3072 sc1
s_lshl_b32 s36, s28, 11
s_lshl_b32 s37, s29, 7
s_add_u32 s36, s36, s37
s_add_u32 s36, s36, 119578632
v_lshlrev_b32 v7, 7, v1
s_mov_b32 s46, 119545856
s_mov_b32 s47, 119554048
s_cmp_lg_u32 s24, 0
s_cbranch_scc1 TI_58
s_lshl_b32 s26, s20, 8
s_add_u32 s26, s26, 119537664
v_mov_b32 v2, 1
v_mov_b32 v3, 0
buffer_load_dword v5, v7, s[4:7], s46 offen sc1
buffer_load_dword v6, v7, s[4:7], s47 offen sc1
s_mov_b64 exec, 1
buffer_atomic_add v2, v3, s[4:7], s26 offen sc0 sc1
s_mov_b64 exec, -1
TI_58:
v_mov_b32 v4, 163808
s_waitcnt vmcnt(0)
s_cmp_lg_u32 s24, 0
s_cbranch_scc1 TP_59
s_mov_b32 s44, 0
TPL_60:
v_and_b32 v5, v5, v6
v_cmp_eq_u32 vcc, 0, v5
s_cbranch_vccz TPK_61
buffer_load_dword v5, v7, s[4:7], s46 offen sc1
buffer_load_dword v6, v7, s[4:7], s47 offen sc1
s_add_u32 s44, s44, 1
s_waitcnt vmcnt(0)
s_cmp_lt_u32 s44, 40000
s_cbranch_scc1 TPL_60
TPK_61:
s_mov_b64 exec, 1
ds_write_b32 v4, v2
s_mov_b64 exec, -1
s_waitcnt lgkmcnt(0)
TP_59:
s_barrier
ds_read_b32 v2, v4
s_cmp_lg_u32 s24, 0
s_cbranch_scc1 W_TICKET
v_mov_b32 v16, 1
v_mov_b32 v17, 0
s_mov_b64 exec, 1
buffer_store_dword v16, v17, s[4:7], s36 offen sc1
s_mov_b64 exec, -1
s_branch W_TICKET
T_F1:
s_load_dwordx2 s[8:9], s[0:1], 64
s_mov_b32 s10, 7340032
s_mov_b32 s11, 0x20000
s_load_dwordx2 s[12:13], s[0:1], 72
s_mov_b32 s14, 7168
s_mov_b32 s15, 0x20000
s_lshl_b32 s30, s29, 9
s_mul_i32 s31, s28, 524288
s_add_u32 s31, s31, 0
s_lshl_b32 s32, s24, 12
s_add_u32 s33, s32, 65536
s_lshr_b32 s34, s24, 1
s_and_b32 s35, s24, 1
v_lshrrev_b32 v16, 5, v1
v_and_b32 v17, 31, v1
v_lshlrev_b32 v18, 1, v16
v_xor_b32 v17, v17, v18
s_lshl_b32 s36, s24, 3
v_add_u32 v16, s36, v16
s_mov_b32 s36, 7168
v_mul_lo_u32 v16, v16, s36
v_xor_b32 v18, 0, v17
v_lshl_add_u32 v18, v18, 4, v16
v_add_u32 v11, 0, v18
v_xor_b32 v18, 4, v17
v_lshl_add_u32 v18, v18, 4, v16
v_add_u32 v12, 13312, v18
v_xor_b32 v18, 8, v17
v_lshl_add_u32 v18, v18, 4, v16
v_add_u32 v13, 26624, v18
v_xor_b32 v18, 12, v17
v_lshl_add_u32 v18, v18, 4, v16
v_add_u32 v14, 39936, v18
v_lshlrev_b32 v61, 4, v1
v_add_u32 v15, s32, v61
s_lshl_b32 s36, s34, 13
s_add_u32 s36, s36, 65536
v_add_u32 v10, s36, v61
v_lshrrev_b32 v16, 2, v1
v_and_b32 v17, 7, v16
v_lshlrev_b32 v17, 1, v17
v_lshlrev_b32 v16, 9, v16
v_and_b32 v18, 3, v1
v_lshl_add_u32 v16, v18, 3, v16
s_lshl_b32 s36, s35, 8
v_add_u32 v16, s36, v16
v_xor_b32 v18, 0, v17
v_lshl_add_u32 v2, v18, 4, v16
v_xor_b32 v18, 2, v17
v_lshl_add_u32 v3, v18, 4, v16
v_xor_b32 v18, 4, v17
v_lshl_add_u32 v4, v18, 4, v16
v_xor_b32 v18, 6, v17
v_lshl_add_u32 v5, v18, 4, v16
v_xor_b32 v18, 8, v17
v_lshl_add_u32 v6, v18, 4, v16
v_xor_b32 v18, 10, v17
v_lshl_add_u32 v7, v18, 4, v16
v_xor_b32 v18, 12, v17
v_lshl_add_u32 v8, v18, 4, v16
v_xor_b32 v18, 14, v17
v_lshl_add_u32 v9, v18, 4, v16
s_waitcnt lgkmcnt(0)
v_mov_b32 v16, 0
v_mov_b32 v17, 0
v_mov_b32 v18, 0
v_mov_b32 v19, 0
v_mov_b32 v20, 0
v_mov_b32 v21, 0
v_mov_b32 v22, 0
v_mov_b32 v23, 0
v_mov_b32 v24, 0
v_mov_b32 v25, 0
v_mov_b32 v26, 0
v_mov_b32 v27, 0
v_mov_b32 v28, 0
v_mov_b32 v29, 0
v_mov_b32 v30, 0
v_mov_b32 v31, 0
v_mov_b32 v32, 0
v_mov_b32 v33, 0
v_mov_b32 v34, 0
v_mov_b32 v35, 0
v_mov_b32 v36, 0
v_mov_b32 v37, 0
v_mov_b32 v38, 0
v_mov_b32 v39, 0
v_mov_b32 v40, 0
v_mov_b32 v41, 0
v_mov_b32 v42, 0
v_mov_b32 v43, 0
v_mov_b32 v44, 0
v_mov_b32 v45, 0
v_mov_b32 v46, 0
v_mov_b32 v47, 0
v_mov_b32 v48, 0
v_mov_b32 v49, 0
v_mov_b32 v50, 0
v_mov_b32 v51, 0
v_mov_b32 v52, 0
v_mov_b32 v53, 0
v_mov_b32 v54, 0
v_mov_b32 v55, 0
v_and_b32 v56, 15, v1
v_lshlrev_b32 v56, 1, v56
s_lshl_b32 s36, s35, 8
v_add_u32 v56, s36, v56
v_mov_b32 v57, 2147483648
v_cmp_gt_u32 vcc, 16, v1
v_mov_b32 v48, 0x3f803f80
s_nop 0
v_cndmask_b32 v56, v57, v56, vcc
buffer_load_ushort v16, v56, s[12:15], s30 offen offset:0
buffer_load_ushort v20, v56, s[12:15], s30 offen offset:32
buffer_load_ushort v24, v56, s[12:15], s30 offen offset:64
buffer_load_ushort v28, v56, s[12:15], s30 offen offset:96
buffer_load_ushort v32, v56, s[12:15], s30 offen offset:128
buffer_load_ushort v36, v56, s[12:15], s30 offen offset:160
buffer_load_ushort v40, v56, s[12:15], s30 offen offset:192
buffer_load_ushort v44, v56, s[12:15], s30 offen offset:224
s_add_u32 m0, s32, 0
s_nop 0
buffer_load_dwordx4 v11, s[8:11], s30 offen offset:0 lds
buffer_load_dwordx4 v12, s[8:11], s30 offen offset:1024 lds
buffer_load_dwordx4 v13, s[8:11], s30 offen offset:2048 lds
buffer_load_dwordx4 v14, s[8:11], s30 offen offset:3072 lds
s_add_u32 m0, s33, 0
s_nop 0
buffer_load_dwordx4 v15, s[4:7], s31 offen offset:0 sc1 lds
buffer_load_dwordx4 v15, s[4:7], s31 offen offset:1024 sc1 lds
buffer_load_dwordx4 v15, s[4:7], s31 offen offset:2048 sc1 lds
buffer_load_dwordx4 v15, s[4:7], s31 offen offset:3072 sc1 lds
s_add_u32 s30, s30, 229376
s_add_u32 s31, s31, 16384
s_add_u32 m0, s32, 16384
s_nop 0
buffer_load_dwordx4 v11, s[8:11], s30 offen offset:0 lds
buffer_load_dwordx4 v12, s[8:11], s30 offen offset:1024 lds
buffer_load_dwordx4 v13, s[8:11], s30 offen offset:2048 lds
buffer_load_dwordx4 v14, s[8:11], s30 offen offset:3072 lds
s_add_u32 m0, s33, 16384
s_nop 0
buffer_load_dwordx4 v15, s[4:7], s31 offen offset:0 sc1 lds
buffer_load_dwordx4 v15, s[4:7], s31 offen offset:1024 sc1 lds
buffer_load_dwordx4 v15, s[4:7], s31 offen offset:2048 sc1 lds
buffer_load_dwordx4 v15, s[4:7], s31 offen offset:3072 sc1 lds
s_add_u32 s30, s30, 229376
s_add_u32 s31, s31, 16384
s_add_u32 m0, s32, 32768
s_nop 0
buffer_load_dwordx4 v11, s[8:11], s30 offen offset:0 lds
buffer_load_dwordx4 v12, s[8:11], s30 offen offset:1024 lds
buffer_load_dwordx4 v13, s[8:11], s30 offen offset:2048 lds
buffer_load_dwordx4 v14, s[8:11], s30 offen offset:3072 lds
s_add_u32 m0, s33, 32768
s_nop 0
buffer_load_dwordx4 v15, s[4:7], s31 offen offset:0 sc1 lds
buffer_load_dwordx4 v15, s[4:7], s31 offen offset:1024 sc1 lds
buffer_load_dwordx4 v15, s[4:7], s31 offen offset:2048 sc1 lds
buffer_load_dwordx4 v15, s[4:7], s31 offen offset:3072 sc1 lds
s_add_u32 s30, s30, 229376
s_add_u32 s31, s31, 16384
s_waitcnt vmcnt(24)
v_mfma_f32_16x16x32_bf16 a[0:3], v[16:19], v[48:51], 0
v_mfma_f32_16x16x32_bf16 a[4:7], v[16:19], v[48:51], 0
v_mfma_f32_16x16x32_bf16 a[8:11], v[16:19], v[48:51], 0
v_mfma_f32_16x16x32_bf16 a[12:15], v[16:19], v[48:51], 0
v_mfma_f32_16x16x32_bf16 a[16:19], v[16:19], v[48:51], 0
v_mfma_f32_16x16x32_bf16 a[20:23], v[16:19], v[48:51], 0
v_mfma_f32_16x16x32_bf16 a[24:27], v[16:19], v[48:51], 0
v_mfma_f32_16x16x32_bf16 a[28:31], v[16:19], v[48:51], 0
v_mfma_f32_16x16x32_bf16 a[32:35], v[20:23], v[48:51], 0
v_mfma_f32_16x16x32_bf16 a[36:39], v[20:23], v[48:51], 0
v_mfma_f32_16x16x32_bf16 a[40:43], v[20:23], v[48:51], 0
v_mfma_f32_16x16x32_bf16 a[44:47], v[20:23], v[48:51], 0
v_mfma_f32_16x16x32_bf16 a[48:51], v[20:23], v[48:51], 0
v_mfma_f32_16x16x32_bf16 a[52:55], v[20:23], v[48:51], 0
v_mfma_f32_16x16x32_bf16 a[56:59], v[20:23], v[48:51], 0
v_mfma_f32_16x16x32_bf16 a[60:63], v[20:23], v[48:51], 0
v_mfma_f32_16x16x32_bf16 a[64:67], v[24:27], v[48:51], 0
v_mfma_f32_16x16x32_bf16 a[68:71], v[24:27], v[48:51], 0
v_mfma_f32_16x16x32_bf16 a[72:75], v[24:27], v[48:51], 0
v_mfma_f32_16x16x32_bf16 a[76:79], v[24:27], v[48:51], 0
v_mfma_f32_16x16x32_bf16 a[80:83], v[24:27], v[48:51], 0
v_mfma_f32_16x16x32_bf16 a[84:87], v[24:27], v[48:51], 0
v_mfma_f32_16x16x32_bf16 a[88:91], v[24:27], v[48:51], 0
v_mfma_f32_16x16x32_bf16 a[92:95], v[24:27], v[48:51], 0
v_mfma_f32_16x16x32_bf16 a[96:99], v[28:31], v[48:51], 0
v_mfma_f32_16x16x32_bf16 a[100:103], v[28:31], v[48:51], 0
v_mfma_f32_16x16x32_bf16 a[104:107], v[28:31], v[48:51], 0
v_mfma_f32_16x16x32_bf16 a[108:111], v[28:31], v[48:51], 0
v_mfma_f32_16x16x32_bf16 a[112:115], v[28:31], v[48:51], 0
v_mfma_f32_16x16x32_bf16 a[116:119], v[28:31], v[48:51], 0
v_mfma_f32_16x16x32_bf16 a[120:123], v[28:31], v[48:51], 0
v_mfma_f32_16x16x32_bf16 a[124:127], v[28:31], v[48:51], 0
v_mfma_f32_16x16x32_bf16 a[128:131], v[32:35], v[48:51], 0
v_mfma_f32_16x16x32_bf16 a[132:135], v[32:35], v[48:51], 0
v_mfma_f32_16x16x32_bf16 a[136:139], v[32:35], v[48:51], 0
v_mfma_f32_16x16x32_bf16 a[140:143], v[32:35], v[48:51], 0
v_mfma_f32_16x16x32_bf16 a[144:147], v[32:35], v[48:51], 0
v_mfma_f32_16x16x32_bf16 a[148:151], v[32:35], v[48:51], 0
v_mfma_f32_16x16x32_bf16 a[152:155], v[32:35], v[48:51], 0
v_mfma_f32_16x16x32_bf16 a[156:159], v[32:35], v[48:51], 0
v_mfma_f32_16x16x32_bf16 a[160:163], v[36:39], v[48:51], 0
v_mfma_f32_16x16x32_bf16 a[164:167], v[36:39], v[48:51], 0
v_mfma_f32_16x16x32_bf16 a[168:171], v[36:39], v[48:51], 0
v_mfma_f32_16x16x32_bf16 a[172:175], v[36:39], v[48:51], 0
v_mfma_f32_16x16x32_bf16 a[176:179], v[36:39], v[48:51], 0
v_mfma_f32_16x16x32_bf16 a[180:183], v[36:39], v[48:51], 0
v_mfma_f32_16x16x32_bf16 a[184:187], v[36:39], v[48:51], 0
v_mfma_f32_16x16x32_bf16 a[188:191], v[36:39], v[48:51], 0
v_mfma_f32_16x16x32_bf16 a[192:195], v[40:43], v[48:51], 0
v_mfma_f32_16x16x32_bf16 a[196:199], v[40:43], v[48:51], 0
v_mfma_f32_16x16x32_bf16 a[200:203], v[40:43], v[48:51], 0
v_mfma_f32_16x16x32_bf16 a[204:207], v[40:43], v[48:51], 0
v_mfma_f32_16x16x32_bf16 a[208:211], v[40:43], v[48:51], 0
v_mfma_f32_16x16x32_bf16 a[212:215], v[40:43], v[48:51], 0
v_mfma_f32_16x16x32_bf16 a[216:219], v[40:43], v[48:51], 0
v_mfma_f32_16x16x32_bf16 a[220:223], v[40:43], v[48:51], 0
v_mfma_f32_16x16x32_bf16 a[224:227], v[44:47], v[48:51], 0
v_mfma_f32_16x16x32_bf16 a[228:231], v[44:47], v[48:51], 0
v_mfma_f32_16x16x32_bf16 a[232:235], v[44:47], v[48:51], 0
v_mfma_f32_16x16x32_bf16 a[236:239], v[44:47], v[48:51], 0
v_mfma_f32_16x16x32_bf16 a[240:243], v[44:47], v[48:51], 0
v_mfma_f32_16x16x32_bf16 a[244:247], v[44:47], v[48:51], 0
v_mfma_f32_16x16x32_bf16 a[248:251], v[44:47], v[48:51], 0
v_mfma_f32_16x16x32_bf16 a[252:255], v[44:47], v[48:51], 0
s_waitcnt vmcnt(16)
s_barrier
ds_read_b128 v[96:99], v10 offset:0
ds_read_b128 v[100:103], v10 offset:1024
ds_read_b128 v[104:107], v10 offset:2048
ds_read_b128 v[108:111], v10 offset:3072
ds_read_b128 v[112:115], v10 offset:4096
ds_read_b128 v[116:119], v10 offset:5120
ds_read_b128 v[120:123], v10 offset:6144
ds_read_b128 v[124:127], v10 offset:7168
ds_read_b64_tr_b16 v[64:65], v2 offset:0
ds_read_b64_tr_b16 v[66:67], v2 offset:8192
ds_read_b64_tr_b16 v[68:69], v3 offset:0
ds_read_b64_tr_b16 v[70:71], v3 offset:8192
ds_read_b64_tr_b16 v[72:73], v4 offset:0
ds_read_b64_tr_b16 v[74:75], v4 offset:8192
ds_read_b64_tr_b16 v[76:77], v5 offset:0
ds_read_b64_tr_b16 v[78:79], v5 offset:8192
ds_read_b64_tr_b16 v[80:81], v6 offset:0
ds_read_b64_tr_b16 v[82:83], v6 offset:8192
ds_read_b64_tr_b16 v[84:85], v7 offset:0
ds_read_b64_tr_b16 v[86:87], v7 offset:8192
ds_read_b64_tr_b16 v[88:89], v8 offset:0
ds_read_b64_tr_b16 v[90:91], v8 offset:8192
ds_read_b64_tr_b16 v[92:93], v9 offset:0
ds_read_b64_tr_b16 v[94:95], v9 offset:8192
s_mov_b32 s37, 7
GL_62:
s_waitcnt lgkmcnt(0)
v_mfma_f32_16x16x32_bf16 a[0:3], v[64:67], v[96:99], a[0:3]
v_mfma_f32_16x16x32_bf16 a[4:7], v[64:67], v[100:103], a[4:7]
s_waitcnt vmcnt(8)
s_barrier
v_mfma_f32_16x16x32_bf16 a[8:11], v[64:67], v[104:107], a[8:11]
ds_read_b128 v[160:163], v10 offset:16384
v_mfma_f32_16x16x32_bf16 a[12:15], v[64:67], v[108:111], a[12:15]
ds_read_b128 v[164:167], v10 offset:17408
v_mfma_f32_16x16x32_bf16 a[16:19], v[64:67], v[112:115], a[16:19]
ds_read_b128 v[168:171], v10 offset:18432
v_mfma_f32_16x16x32_bf16 a[20:23], v[64:67], v[116:119], a[20:23]
ds_read_b128 v[172:175], v10 offset:19456
v_mfma_f32_16x16x32_bf16 a[24:27], v[64:67], v[120:123], a[24:27]
ds_read_b128 v[176:179], v10 offset:20480
v_mfma_f32_16x16x32_bf16 a[28:31], v[64:67], v[124:127], a[28:31]
ds_read_b128 v[180:183], v10 offset:21504
v_mfma_f32_16x16x32_bf16 a[32:35], v[68:71], v[96:99], a[32:35]
ds_read_b128 v[184:187], v10 offset:22528
v_mfma_f32_16x16x32_bf16 a[36:39], v[68:71], v[100:103], a[36:39]
ds_read_b128 v[188:191], v10 offset:23552
v_mfma_f32_16x16x32_bf16 a[40:43], v[68:71], v[104:107], a[40:43]
ds_read_b64_tr_b16 v[128:129], v2 offset:16384
v_mfma_f32_16x16x32_bf16 a[44:47], v[68:71], v[108:111], a[44:47]
ds_read_b64_tr_b16 v[130:131], v2 offset:24576
v_mfma_f32_16x16x32_bf16 a[48:51], v[68:71], v[112:115], a[48:51]
ds_read_b64_tr_b16 v[132:133], v3 offset:16384
v_mfma_f32_16x16x32_bf16 a[52:55], v[68:71], v[116:119], a[52:55]
ds_read_b64_tr_b16 v[134:135], v3 offset:24576
v_mfma_f32_16x16x32_bf16 a[56:59], v[68:71], v[120:123], a[56:59]
ds_read_b64_tr_b16 v[136:137], v4 offset:16384
v_mfma_f32_16x16x32_bf16 a[60:63], v[68:71], v[124:127], a[60:63]
ds_read_b64_tr_b16 v[138:139], v4 offset:24576
v_mfma_f32_16x16x32_bf16 a[64:67], v[72:75], v[96:99], a[64:67]
ds_read_b64_tr_b16 v[140:141], v5 offset:16384
v_mfma_f32_16x16x32_bf16 a[68:71], v[72:75], v[100:103], a[68:71]
ds_read_b64_tr_b16 v[142:143], v5 offset:24576
v_mfma_f32_16x16x32_bf16 a[72:75], v[72:75], v[104:107], a[72:75]
ds_read_b64_tr_b16 v[144:145], v6 offset:16384
v_mfma_f32_16x16x32_bf16 a[76:79], v[72:75], v[108:111], a[76:79]
ds_read_b64_tr_b16 v[146:147], v6 offset:24576
v_mfma_f32_16x16x32_bf16 a[80:83], v[72:75], v[112:115], a[80:83]
ds_read_b64_tr_b16 v[148:149], v7 offset:16384
v_mfma_f32_16x16x32_bf16 a[84:87], v[72:75], v[116:119], a[84:87]
ds_read_b64_tr_b16 v[150:151], v7 offset:24576
v_mfma_f32_16x16x32_bf16 a[88:91], v[72:75], v[120:123], a[88:91]
ds_read_b64_tr_b16 v[152:153], v8 offset:16384
v_mfma_f32_16x16x32_bf16 a[92:95], v[72:75], v[124:127], a[92:95]
ds_read_b64_tr_b16 v[154:155], v8 offset:24576
v_mfma_f32_16x16x32_bf16 a[96:99], v[76:79], v[96:99], a[96:99]
ds_read_b64_tr_b16 v[156:157], v9 offset:16384
v_mfma_f32_16x16x32_bf16 a[100:103], v[76:79], v[100:103], a[100:103]
ds_read_b64_tr_b16 v[158:159], v9 offset:24576
v_mfma_f32_16x16x32_bf16 a[104:107], v[76:79], v[104:107], a[104:107]
v_mfma_f32_16x16x32_bf16 a[108:111], v[76:79], v[108:111], a[108:111]
s_add_u32 m0, s32, 49152
v_mfma_f32_16x16x32_bf16 a[112:115], v[76:79], v[112:115], a[112:115]
buffer_load_dwordx4 v11, s[8:11], s30 offen offset:0 lds
v_mfma_f32_16x16x32_bf16 a[116:119], v[76:79], v[116:119], a[116:119]
v_mfma_f32_16x16x32_bf16 a[120:123], v[76:79], v[120:123], a[120:123]
v_mfma_f32_16x16x32_bf16 a[124:127], v[76:79], v[124:127], a[124:127]
v_mfma_f32_16x16x32_bf16 a[128:131], v[80:83], v[96:99], a[128:131]
buffer_load_dwordx4 v12, s[8:11], s30 offen offset:1024 lds
v_mfma_f32_16x16x32_bf16 a[132:135], v[80:83], v[100:103], a[132:135]
v_mfma_f32_16x16x32_bf16 a[136:139], v[80:83], v[104:107], a[136:139]
v_mfma_f32_16x16x32_bf16 a[140:143], v[80:83], v[108:111], a[140:143]
v_mfma_f32_16x16x32_bf16 a[144:147], v[80:83], v[112:115], a[144:147]
buffer_load_dwordx4 v13, s[8:11], s30 offen offset:2048 lds
v_mfma_f32_16x16x32_bf16 a[148:151], v[80:83], v[116:119], a[148:151]
v_mfma_f32_16x16x32_bf16 a[152:155], v[80:83], v[120:123], a[152:155]
v_mfma_f32_16x16x32_bf16 a[156:159], v[80:83], v[124:127], a[156:159]
v_mfma_f32_16x16x32_bf16 a[160:163], v[84:87], v[96:99], a[160:163]
buffer_load_dwordx4 v14, s[8:11], s30 offen offset:3072 lds
v_mfma_f32_16x16x32_bf16 a[164:167], v[84:87], v[100:103], a[164:167]
v_mfma_f32_16x16x32_bf16 a[168:171], v[84:87], v[104:107], a[168:171]
v_mfma_f32_16x16x32_bf16 a[172:175], v[84:87], v[108:111], a[172:175]
s_add_u32 m0, s33, 49152
v_mfma_f32_16x16x32_bf16 a[176:179], v[84:87], v[112:115], a[176:179]
buffer_load_dwordx4 v15, s[4:7], s31 offen offset:0 sc1 lds
v_mfma_f32_16x16x32_bf16 a[180:183], v[84:87], v[116:119], a[180:183]
v_mfma_f32_16x16x32_bf16 a[184:187], v[84:87], v[120:123], a[184:187]
v_mfma_f32_16x16x32_bf16 a[188:191], v[84:87], v[124:127], a[188:191]
v_mfma_f32_16x16x32_bf16 a[192:195], v[88:91], v[96:99], a[192:195]
buffer_load_dwordx4 v15, s[4:7], s31 offen offset:1024 sc1 lds
v_mfma_f32_16x16x32_bf16 a[196:199], v[88:91], v[100:103], a[196:199]
v_mfma_f32_16x16x32_bf16 a[200:203], v[88:91], v[104:107], a[200:203]
v_mfma_f32_16x16x32_bf16 a[204:207], v[88:91], v[108:111], a[204:207]
v_mfma_f32_16x16x32_bf16 a[208:211], v[88:91], v[112:115], a[208:211]
buffer_load_dwordx4 v15, s[4:7], s31 offen offset:2048 sc1 lds
v_mfma_f32_16x16x32_bf16 a[212:215], v[88:91], v[116:119], a[212:215]
v_mfma_f32_16x16x32_bf16 a[216:219], v[88:91], v[120:123], a[216:219]
v_mfma_f32_16x16x32_bf16 a[220:223], v[88:91], v[124:127], a[220:223]
v_mfma_f32_16x16x32_bf16 a[224:227], v[92:95], v[96:99], a[224:227]
buffer_load_dwordx4 v15, s[4:7], s31 offen offset:3072 sc1 lds
v_mfma_f32_16x16x32_bf16 a[228:231], v[92:95], v[100:103], a[228:231]
v_mfma_f32_16x16x32_bf16 a[232:235], v[92:95], v[104:107], a[232:235]
s_add_u32 s30, s30, 229376
v_mfma_f32_16x16x32_bf16 a[236:239], v[92:95], v[108:111], a[236:239]
s_add_u32 s31, s31, 16384
v_mfma_f32_16x16x32_bf16 a[240:243], v[92:95], v[112:115], a[240:243]
v_mfma_f32_16x16x32_bf16 a[244:247], v[92:95], v[116:119], a[244:247]
v_mfma_f32_16x16x32_bf16 a[248:251], v[92:95], v[120:123], a[248:251]
v_mfma_f32_16x16x32_bf16 a[252:255], v[92:95], v[124:127], a[252:255]
s_waitcnt lgkmcnt(0)
v_mfma_f32_16x16x32_bf16 a[0:3], v[128:131], v[160:163], a[0:3]
v_mfma_f32_16x16x32_bf16 a[4:7], v[128:131], v[164:167], a[4:7]
s_waitcnt vmcnt(8)
s_barrier
v_mfma_f32_16x16x32_bf16 a[8:11], v[128:131], v[168:171], a[8:11]
ds_read_b128 v[96:99], v10 offset:32768
v_mfma_f32_16x16x32_bf16 a[12:15], v[128:131], v[172:175], a[12:15]
ds_read_b128 v[100:103], v10 offset:33792
v_mfma_f32_16x16x32_bf16 a[16:19], v[128:131], v[176:179], a[16:19]
ds_read_b128 v[104:107], v10 offset:34816
v_mfma_f32_16x16x32_bf16 a[20:23], v[128:131], v[180:183], a[20:23]
ds_read_b128 v[108:111], v10 offset:35840
v_mfma_f32_16x16x32_bf16 a[24:27], v[128:131], v[184:187], a[24:27]
ds_read_b128 v[112:115], v10 offset:36864
v_mfma_f32_16x16x32_bf16 a[28:31], v[128:131], v[188:191], a[28:31]
ds_read_b128 v[116:119], v10 offset:37888
v_mfma_f32_16x16x32_bf16 a[32:35], v[132:135], v[160:163], a[32:35]
ds_read_b128 v[120:123], v10 offset:38912
v_mfma_f32_16x16x32_bf16 a[36:39], v[132:135], v[164:167], a[36:39]
ds_read_b128 v[124:127], v10 offset:39936
v_mfma_f32_16x16x32_bf16 a[40:43], v[132:135], v[168:171], a[40:43]
ds_read_b64_tr_b16 v[64:65], v2 offset:32768
v_mfma_f32_16x16x32_bf16 a[44:47], v[132:135], v[172:175], a[44:47]
ds_read_b64_tr_b16 v[66:67], v2 offset:40960
v_mfma_f32_16x16x32_bf16 a[48:51], v[132:135], v[176:179], a[48:51]
ds_read_b64_tr_b16 v[68:69], v3 offset:32768
v_mfma_f32_16x16x32_bf16 a[52:55], v[132:135], v[180:183], a[52:55]
ds_read_b64_tr_b16 v[70:71], v3 offset:40960
v_mfma_f32_16x16x32_bf16 a[56:59], v[132:135], v[184:187], a[56:59]
ds_read_b64_tr_b16 v[72:73], v4 offset:32768
v_mfma_f32_16x16x32_bf16 a[60:63], v[132:135], v[188:191], a[60:63]
ds_read_b64_tr_b16 v[74:75], v4 offset:40960
v_mfma_f32_16x16x32_bf16 a[64:67], v[136:139], v[160:163], a[64:67]
ds_read_b64_tr_b16 v[76:77], v5 offset:32768
v_mfma_f32_16x16x32_bf16 a[68:71], v[136:139], v[164:167], a[68:71]
ds_read_b64_tr_b16 v[78:79], v5 offset:40960
v_mfma_f32_16x16x32_bf16 a[72:75], v[136:139], v[168:171], a[72:75]
ds_read_b64_tr_b16 v[80:81], v6 offset:32768
v_mfma_f32_16x16x32_bf16 a[76:79], v[136:139], v[172:175], a[76:79]
ds_read_b64_tr_b16 v[82:83], v6 offset:40960
v_mfma_f32_16x16x32_bf16 a[80:83], v[136:139], v[176:179], a[80:83]
ds_read_b64_tr_b16 v[84:85], v7 offset:32768
v_mfma_f32_16x16x32_bf16 a[84:87], v[136:139], v[180:183], a[84:87]
ds_read_b64_tr_b16 v[86:87], v7 offset:40960
v_mfma_f32_16x16x32_bf16 a[88:91], v[136:139], v[184:187], a[88:91]
ds_read_b64_tr_b16 v[88:89], v8 offset:32768
v_mfma_f32_16x16x32_bf16 a[92:95], v[136:139], v[188:191], a[92:95]
ds_read_b64_tr_b16 v[90:91], v8 offset:40960
v_mfma_f32_16x16x32_bf16 a[96:99], v[140:143], v[160:163], a[96:99]
ds_read_b64_tr_b16 v[92:93], v9 offset:32768
v_mfma_f32_16x16x32_bf16 a[100:103], v[140:143], v[164:167], a[100:103]
ds_read_b64_tr_b16 v[94:95], v9 offset:40960
v_mfma_f32_16x16x32_bf16 a[104:107], v[140:143], v[168:171], a[104:107]
v_mfma_f32_16x16x32_bf16 a[108:111], v[140:143], v[172:175], a[108:111]
s_add_u32 m0, s32, 0
v_mfma_f32_16x16x32_bf16 a[112:115], v[140:143], v[176:179], a[112:115]
buffer_load_dwordx4 v11, s[8:11], s30 offen offset:0 lds
v_mfma_f32_16x16x32_bf16 a[116:119], v[140:143], v[180:183], a[116:119]
v_mfma_f32_16x16x32_bf16 a[120:123], v[140:143], v[184:187], a[120:123]
v_mfma_f32_16x16x32_bf16 a[124:127], v[140:143], v[188:191], a[124:127]
v_mfma_f32_16x16x32_bf16 a[128:131], v[144:147], v[160:163], a[128:131]
buffer_load_dwordx4 v12, s[8:11], s30 offen offset:1024 lds
v_mfma_f32_16x16x32_bf16 a[132:135], v[144:147], v[164:167], a[132:135]
v_mfma_f32_16x16x32_bf16 a[136:139], v[144:147], v[168:171], a[136:139]
v_mfma_f32_16x16x32_bf16 a[140:143], v[144:147], v[172:175], a[140:143]
v_mfma_f32_16x16x32_bf16 a[144:147], v[144:147], v[176:179], a[144:147]
buffer_load_dwordx4 v13, s[8:11], s30 offen offset:2048 lds
v_mfma_f32_16x16x32_bf16 a[148:151], v[144:147], v[180:183], a[148:151]
v_mfma_f32_16x16x32_bf16 a[152:155], v[144:147], v[184:187], a[152:155]
v_mfma_f32_16x16x32_bf16 a[156:159], v[144:147], v[188:191], a[156:159]
v_mfma_f32_16x16x32_bf16 a[160:163], v[148:151], v[160:163], a[160:163]
buffer_load_dwordx4 v14, s[8:11], s30 offen offset:3072 lds
v_mfma_f32_16x16x32_bf16 a[164:167], v[148:151], v[164:167], a[164:167]
v_mfma_f32_16x16x32_bf16 a[168:171], v[148:151], v[168:171], a[168:171]
v_mfma_f32_16x16x32_bf16 a[172:175], v[148:151], v[172:175], a[172:175]
s_add_u32 m0, s33, 0
v_mfma_f32_16x16x32_bf16 a[176:179], v[148:151], v[176:179], a[176:179]
buffer_load_dwordx4 v15, s[4:7], s31 offen offset:0 sc1 lds
v_mfma_f32_16x16x32_bf16 a[180:183], v[148:151], v[180:183], a[180:183]
v_mfma_f32_16x16x32_bf16 a[184:187], v[148:151], v[184:187], a[184:187]
v_mfma_f32_16x16x32_bf16 a[188:191], v[148:151], v[188:191], a[188:191]
v_mfma_f32_16x16x32_bf16 a[192:195], v[152:155], v[160:163], a[192:195]
buffer_load_dwordx4 v15, s[4:7], s31 offen offset:1024 sc1 lds
v_mfma_f32_16x16x32_bf16 a[196:199], v[152:155], v[164:167], a[196:199]
v_mfma_f32_16x16x32_bf16 a[200:203], v[152:155], v[168:171], a[200:203]
v_mfma_f32_16x16x32_bf16 a[204:207], v[152:155], v[172:175], a[204:207]
v_mfma_f32_16x16x32_bf16 a[208:211], v[152:155], v[176:179], a[208:211]
buffer_load_dwordx4 v15, s[4:7], s31 offen offset:2048 sc1 lds
v_mfma_f32_16x16x32_bf16 a[212:215], v[152:155], v[180:183], a[212:215]
v_mfma_f32_16x16x32_bf16 a[216:219], v[152:155], v[184:187], a[216:219]
v_mfma_f32_16x16x32_bf16 a[220:223], v[152:155], v[188:191], a[220:223]
v_mfma_f32_16x16x32_bf16 a[224:227], v[156:159], v[160:163], a[224:227]
buffer_load_dwordx4 v15, s[4:7], s31 offen offset:3072 sc1 lds
v_mfma_f32_16x16x32_bf16 a[228:231], v[156:159], v[164:167], a[228:231]
v_mfma_f32_16x16x32_bf16 a[232:235], v[156:159], v[168:171], a[232:235]
s_add_u32 s30, s30, 229376
v_mfma_f32_16x16x32_bf16 a[236:239], v[156:159], v[172:175], a[236:239]
s_add_u32 s31, s31, 16384
v_mfma_f32_16x16x32_bf16 a[240:243], v[156:159], v[176:179], a[240:243]
v_mfma_f32_16x16x32_bf16 a[244:247], v[156:159], v[180:183], a[244:247]
v_mfma_f32_16x16x32_bf16 a[248:251], v[156:159], v[184:187], a[248:251]
v_mfma_f32_16x16x32_bf16 a[252:255], v[156:159], v[188:191], a[252:255]
s_waitcnt lgkmcnt(0)
v_mfma_f32_16x16x32_bf16 a[0:3], v[64:67], v[96:99], a[0:3]
v_mfma_f32_16x16x32_bf16 a[4:7], v[64:67], v[100:103], a[4:7]
s_waitcnt vmcnt(8)
s_barrier
v_mfma_f32_16x16x32_bf16 a[8:11], v[64:67], v[104:107], a[8:11]
ds_read_b128 v[160:163], v10 offset:49152
v_mfma_f32_16x16x32_bf16 a[12:15], v[64:67], v[108:111], a[12:15]
ds_read_b128 v[164:167], v10 offset:50176
v_mfma_f32_16x16x32_bf16 a[16:19], v[64:67], v[112:115], a[16:19]
ds_read_b128 v[168:171], v10 offset:51200
v_mfma_f32_16x16x32_bf16 a[20:23], v[64:67], v[116:119], a[20:23]
ds_read_b128 v[172:175], v10 offset:52224
v_mfma_f32_16x16x32_bf16 a[24:27], v[64:67], v[120:123], a[24:27]
ds_read_b128 v[176:179], v10 offset:53248
v_mfma_f32_16x16x32_bf16 a[28:31], v[64:67], v[124:127], a[28:31]
ds_read_b128 v[180:183], v10 offset:54272
v_mfma_f32_16x16x32_bf16 a[32:35], v[68:71], v[96:99], a[32:35]
ds_read_b128 v[184:187], v10 offset:55296
v_mfma_f32_16x16x32_bf16 a[36:39], v[68:71], v[100:103], a[36:39]
ds_read_b128 v[188:191], v10 offset:56320
v_mfma_f32_16x16x32_bf16 a[40:43], v[68:71], v[104:107], a[40:43]
ds_read_b64_tr_b16 v[128:129], v2 offset:49152
v_mfma_f32_16x16x32_bf16 a[44:47], v[68:71], v[108:111], a[44:47]
ds_read_b64_tr_b16 v[130:131], v2 offset:57344
v_mfma_f32_16x16x32_bf16 a[48:51], v[68:71], v[112:115], a[48:51]
ds_read_b64_tr_b16 v[132:133], v3 offset:49152
v_mfma_f32_16x16x32_bf16 a[52:55], v[68:71], v[116:119], a[52:55]
ds_read_b64_tr_b16 v[134:135], v3 offset:57344
v_mfma_f32_16x16x32_bf16 a[56:59], v[68:71], v[120:123], a[56:59]
ds_read_b64_tr_b16 v[136:137], v4 offset:49152
v_mfma_f32_16x16x32_bf16 a[60:63], v[68:71], v[124:127], a[60:63]
ds_read_b64_tr_b16 v[138:139], v4 offset:57344
v_mfma_f32_16x16x32_bf16 a[64:67], v[72:75], v[96:99], a[64:67]
ds_read_b64_tr_b16 v[140:141], v5 offset:49152
v_mfma_f32_16x16x32_bf16 a[68:71], v[72:75], v[100:103], a[68:71]
ds_read_b64_tr_b16 v[142:143], v5 offset:57344
v_mfma_f32_16x16x32_bf16 a[72:75], v[72:75], v[104:107], a[72:75]
ds_read_b64_tr_b16 v[144:145], v6 offset:49152
v_mfma_f32_16x16x32_bf16 a[76:79], v[72:75], v[108:111], a[76:79]
ds_read_b64_tr_b16 v[146:147], v6 offset:57344
v_mfma_f32_16x16x32_bf16 a[80:83], v[72:75], v[112:115], a[80:83]
ds_read_b64_tr_b16 v[148:149], v7 offset:49152
v_mfma_f32_16x16x32_bf16 a[84:87], v[72:75], v[116:119], a[84:87]
ds_read_b64_tr_b16 v[150:151], v7 offset:57344
v_mfma_f32_16x16x32_bf16 a[88:91], v[72:75], v[120:123], a[88:91]
ds_read_b64_tr_b16 v[152:153], v8 offset:49152
v_mfma_f32_16x16x32_bf16 a[92:95], v[72:75], v[124:127], a[92:95]
ds_read_b64_tr_b16 v[154:155], v8 offset:57344
v_mfma_f32_16x16x32_bf16 a[96:99], v[76:79], v[96:99], a[96:99]
ds_read_b64_tr_b16 v[156:157], v9 offset:49152
v_mfma_f32_16x16x32_bf16 a[100:103], v[76:79], v[100:103], a[100:103]
ds_read_b64_tr_b16 v[158:159], v9 offset:57344
v_mfma_f32_16x16x32_bf16 a[104:107], v[76:79], v[104:107], a[104:107]
v_mfma_f32_16x16x32_bf16 a[108:111], v[76:79], v[108:111], a[108:111]
s_add_u32 m0, s32, 16384
v_mfma_f32_16x16x32_bf16 a[112:115], v[76:79], v[112:115], a[112:115]
buffer_load_dwordx4 v11, s[8:11], s30 offen offset:0 lds
v_mfma_f32_16x16x32_bf16 a[116:119], v[76:79], v[116:119], a[116:119]
v_mfma_f32_16x16x32_bf16 a[120:123], v[76:79], v[120:123], a[120:123]
v_mfma_f32_16x16x32_bf16 a[124:127], v[76:79], v[124:127], a[124:127]
v_mfma_f32_16x16x32_bf16 a[128:131], v[80:83], v[96:99], a[128:131]
buffer_load_dwordx4 v12, s[8:11], s30 offen offset:1024 lds
v_mfma_f32_16x16x32_bf16 a[132:135], v[80:83], v[100:103], a[132:135]
v_mfma_f32_16x16x32_bf16 a[136:139], v[80:83], v[104:107], a[136:139]
v_mfma_f32_16x16x32_bf16 a[140:143], v[80:83], v[108:111], a[140:143]
v_mfma_f32_16x16x32_bf16 a[144:147], v[80:83], v[112:115], a[144:147]
buffer_load_dwordx4 v13, s[8:11], s30 offen offset:2048 lds
v_mfma_f32_16x16x32_bf16 a[148:151], v[80:83], v[116:119], a[148:151]
v_mfma_f32_16x16x32_bf16 a[152:155], v[80:83], v[120:123], a[152:155]
v_mfma_f32_16x16x32_bf16 a[156:159], v[80:83], v[124:127], a[156:159]
v_mfma_f32_16x16x32_bf16 a[160:163], v[84:87], v[96:99], a[160:163]
buffer_load_dwordx4 v14, s[8:11], s30 offen offset:3072 lds
v_mfma_f32_16x16x32_bf16 a[164:167], v[84:87], v[100:103], a[164:167]
v_mfma_f32_16x16x32_bf16 a[168:171], v[84:87], v[104:107], a[168:171]
v_mfma_f32_16x16x32_bf16 a[172:175], v[84:87], v[108:111], a[172:175]
s_add_u32 m0, s33, 16384
v_mfma_f32_16x16x32_bf16 a[176:179], v[84:87], v[112:115], a[176:179]
buffer_load_dwordx4 v15, s[4:7], s31 offen offset:0 sc1 lds
v_mfma_f32_16x16x32_bf16 a[180:183], v[84:87], v[116:119], a[180:183]
v_mfma_f32_16x16x32_bf16 a[184:187], v[84:87], v[120:123], a[184:187]
v_mfma_f32_16x16x32_bf16 a[188:191], v[84:87], v[124:127], a[188:191]
v_mfma_f32_16x16x32_bf16 a[192:195], v[88:91], v[96:99], a[192:195]
buffer_load_dwordx4 v15, s[4:7], s31 offen offset:1024 sc1 lds
v_mfma_f32_16x16x32_bf16 a[196:199], v[88:91], v[100:103], a[196:199]
v_mfma_f32_16x16x32_bf16 a[200:203], v[88:91], v[104:107], a[200:203]
v_mfma_f32_16x16x32_bf16 a[204:207], v[88:91], v[108:111], a[204:207]
v_mfma_f32_16x16x32_bf16 a[208:211], v[88:91], v[112:115], a[208:211]
buffer_load_dwordx4 v15, s[4:7], s31 offen offset:2048 sc1 lds
v_mfma_f32_16x16x32_bf16 a[212:215], v[88:91], v[116:119], a[212:215]
v_mfma_f32_16x16x32_bf16 a[216:219], v[88:91], v[120:123], a[216:219]
v_mfma_f32_16x16x32_bf16 a[220:223], v[88:91], v[124:127], a[220:223]
v_mfma_f32_16x16x32_bf16 a[224:227], v[92:95], v[96:99], a[224:227]
buffer_load_dwordx4 v15, s[4:7], s31 offen offset:3072 sc1 lds
v_mfma_f32_16x16x32_bf16 a[228:231], v[92:95], v[100:103], a[228:231]
v_mfma_f32_16x16x32_bf16 a[232:235], v[92:95], v[104:107], a[232:235]
s_add_u32 s30, s30, 229376
v_mfma_f32_16x16x32_bf16 a[236:239], v[92:95], v[108:111], a[236:239]
s_add_u32 s31, s31, 16384
v_mfma_f32_16x16x32_bf16 a[240:243], v[92:95], v[112:115], a[240:243]
v_mfma_f32_16x16x32_bf16 a[244:247], v[92:95], v[116:119], a[244:247]
v_mfma_f32_16x16x32_bf16 a[248:251], v[92:95], v[120:123], a[248:251]
v_mfma_f32_16x16x32_bf16 a[252:255], v[92:95], v[124:127], a[252:255]
s_waitcnt lgkmcnt(0)
v_mfma_f32_16x16x32_bf16 a[0:3], v[128:131], v[160:163], a[0:3]
v_mfma_f32_16x16x32_bf16 a[4:7], v[128:131], v[164:167], a[4:7]
s_waitcnt vmcnt(8)
s_barrier
v_mfma_f32_16x16x32_bf16 a[8:11], v[128:131], v[168:171], a[8:11]
ds_read_b128 v[96:99], v10 offset:0
v_mfma_f32_16x16x32_bf16 a[12:15], v[128:131], v[172:175], a[12:15]
ds_read_b128 v[100:103], v10 offset:1024
v_mfma_f32_16x16x32_bf16 a[16:19], v[128:131], v[176:179], a[16:19]
ds_read_b128 v[104:107], v10 offset:2048
v_mfma_f32_16x16x32_bf16 a[20:23], v[128:131], v[180:183], a[20:23]
ds_read_b128 v[108:111], v10 offset:3072
v_mfma_f32_16x16x32_bf16 a[24:27], v[128:131], v[184:187], a[24:27]
ds_read_b128 v[112:115], v10 offset:4096
v_mfma_f32_16x16x32_bf16 a[28:31], v[128:131], v[188:191], a[28:31]
ds_read_b128 v[116:119], v10 offset:5120
v_mfma_f32_16x16x32_bf16 a[32:35], v[132:135], v[160:163], a[32:35]
ds_read_b128 v[120:123], v10 offset:6144
v_mfma_f32_16x16x32_bf16 a[36:39], v[132:135], v[164:167], a[36:39]
ds_read_b128 v[124:127], v10 offset:7168
v_mfma_f32_16x16x32_bf16 a[40:43], v[132:135], v[168:171], a[40:43]
ds_read_b64_tr_b16 v[64:65], v2 offset:0
v_mfma_f32_16x16x32_bf16 a[44:47], v[132:135], v[172:175], a[44:47]
ds_read_b64_tr_b16 v[66:67], v2 offset:8192
v_mfma_f32_16x16x32_bf16 a[48:51], v[132:135], v[176:179], a[48:51]
ds_read_b64_tr_b16 v[68:69], v3 offset:0
v_mfma_f32_16x16x32_bf16 a[52:55], v[132:135], v[180:183], a[52:55]
ds_read_b64_tr_b16 v[70:71], v3 offset:8192
v_mfma_f32_16x16x32_bf16 a[56:59], v[132:135], v[184:187], a[56:59]
ds_read_b64_tr_b16 v[72:73], v4 offset:0
v_mfma_f32_16x16x32_bf16 a[60:63], v[132:135], v[188:191], a[60:63]
ds_read_b64_tr_b16 v[74:75], v4 offset:8192
v_mfma_f32_16x16x32_bf16 a[64:67], v[136:139], v[160:163], a[64:67]
ds_read_b64_tr_b16 v[76:77], v5 offset:0
v_mfma_f32_16x16x32_bf16 a[68:71], v[136:139], v[164:167], a[68:71]
ds_read_b64_tr_b16 v[78:79], v5 offset:8192
v_mfma_f32_16x16x32_bf16 a[72:75], v[136:139], v[168:171], a[72:75]
ds_read_b64_tr_b16 v[80:81], v6 offset:0
v_mfma_f32_16x16x32_bf16 a[76:79], v[136:139], v[172:175], a[76:79]
ds_read_b64_tr_b16 v[82:83], v6 offset:8192
v_mfma_f32_16x16x32_bf16 a[80:83], v[136:139], v[176:179], a[80:83]
ds_read_b64_tr_b16 v[84:85], v7 offset:0
v_mfma_f32_16x16x32_bf16 a[84:87], v[136:139], v[180:183], a[84:87]
ds_read_b64_tr_b16 v[86:87], v7 offset:8192
v_mfma_f32_16x16x32_bf16 a[88:91], v[136:139], v[184:187], a[88:91]
ds_read_b64_tr_b16 v[88:89], v8 offset:0
v_mfma_f32_16x16x32_bf16 a[92:95], v[136:139], v[188:191], a[92:95]
ds_read_b64_tr_b16 v[90:91], v8 offset:8192
v_mfma_f32_16x16x32_bf16 a[96:99], v[140:143], v[160:163], a[96:99]
ds_read_b64_tr_b16 v[92:93], v9 offset:0
v_mfma_f32_16x16x32_bf16 a[100:103], v[140:143], v[164:167], a[100:103]
ds_read_b64_tr_b16 v[94:95], v9 offset:8192
v_mfma_f32_16x16x32_bf16 a[104:107], v[140:143], v[168:171], a[104:107]
v_mfma_f32_16x16x32_bf16 a[108:111], v[140:143], v[172:175], a[108:111]
s_add_u32 m0, s32, 32768
v_mfma_f32_16x16x32_bf16 a[112:115], v[140:143], v[176:179], a[112:115]
buffer_load_dwordx4 v11, s[8:11], s30 offen offset:0 lds
v_mfma_f32_16x16x32_bf16 a[116:119], v[140:143], v[180:183], a[116:119]
v_mfma_f32_16x16x32_bf16 a[120:123], v[140:143], v[184:187], a[120:123]
v_mfma_f32_16x16x32_bf16 a[124:127], v[140:143], v[188:191], a[124:127]
v_mfma_f32_16x16x32_bf16 a[128:131], v[144:147], v[160:163], a[128:131]
buffer_load_dwordx4 v12, s[8:11], s30 offen offset:1024 lds
v_mfma_f32_16x16x32_bf16 a[132:135], v[144:147], v[164:167], a[132:135]
v_mfma_f32_16x16x32_bf16 a[136:139], v[144:147], v[168:171], a[136:139]
v_mfma_f32_16x16x32_bf16 a[140:143], v[144:147], v[172:175], a[140:143]
v_mfma_f32_16x16x32_bf16 a[144:147], v[144:147], v[176:179], a[144:147]
buffer_load_dwordx4 v13, s[8:11], s30 offen offset:2048 lds
v_mfma_f32_16x16x32_bf16 a[148:151], v[144:147], v[180:183], a[148:151]
v_mfma_f32_16x16x32_bf16 a[152:155], v[144:147], v[184:187], a[152:155]
v_mfma_f32_16x16x32_bf16 a[156:159], v[144:147], v[188:191], a[156:159]
v_mfma_f32_16x16x32_bf16 a[160:163], v[148:151], v[160:163], a[160:163]
buffer_load_dwordx4 v14, s[8:11], s30 offen offset:3072 lds
v_mfma_f32_16x16x32_bf16 a[164:167], v[148:151], v[164:167], a[164:167]
v_mfma_f32_16x16x32_bf16 a[168:171], v[148:151], v[168:171], a[168:171]
v_mfma_f32_16x16x32_bf16 a[172:175], v[148:151], v[172:175], a[172:175]
s_add_u32 m0, s33, 32768
v_mfma_f32_16x16x32_bf16 a[176:179], v[148:151], v[176:179], a[176:179]
buffer_load_dwordx4 v15, s[4:7], s31 offen offset:0 sc1 lds
v_mfma_f32_16x16x32_bf16 a[180:183], v[148:151], v[180:183], a[180:183]
v_mfma_f32_16x16x32_bf16 a[184:187], v[148:151], v[184:187], a[184:187]
v_mfma_f32_16x16x32_bf16 a[188:191], v[148:151], v[188:191], a[188:191]
v_mfma_f32_16x16x32_bf16 a[192:195], v[152:155], v[160:163], a[192:195]
buffer_load_dwordx4 v15, s[4:7], s31 offen offset:1024 sc1 lds
v_mfma_f32_16x16x32_bf16 a[196:199], v[152:155], v[164:167], a[196:199]
v_mfma_f32_16x16x32_bf16 a[200:203], v[152:155], v[168:171], a[200:203]
v_mfma_f32_16x16x32_bf16 a[204:207], v[152:155], v[172:175], a[204:207]
v_mfma_f32_16x16x32_bf16 a[208:211], v[152:155], v[176:179], a[208:211]
buffer_load_dwordx4 v15, s[4:7], s31 offen offset:2048 sc1 lds
v_mfma_f32_16x16x32_bf16 a[212:215], v[152:155], v[180:183], a[212:215]
v_mfma_f32_16x16x32_bf16 a[216:219], v[152:155], v[184:187], a[216:219]
v_mfma_f32_16x16x32_bf16 a[220:223], v[152:155], v[188:191], a[220:223]
v_mfma_f32_16x16x32_bf16 a[224:227], v[156:159], v[160:163], a[224:227]
buffer_load_dwordx4 v15, s[4:7], s31 offen offset:3072 sc1 lds
v_mfma_f32_16x16x32_bf16 a[228:231], v[156:159], v[164:167], a[228:231]
v_mfma_f32_16x16x32_bf16 a[232:235], v[156:159], v[168:171], a[232:235]
s_add_u32 s30, s30, 229376
v_mfma_f32_16x16x32_bf16 a[236:239], v[156:159], v[172:175], a[236:239]
s_add_u32 s31, s31, 16384
v_mfma_f32_16x16x32_bf16 a[240:243], v[156:159], v[176:179], a[240:243]
v_mfma_f32_16x16x32_bf16 a[244:247], v[156:159], v[180:183], a[244:247]
v_mfma_f32_16x16x32_bf16 a[248:251], v[156:159], v[184:187], a[248:251]
v_mfma_f32_16x16x32_bf16 a[252:255], v[156:159], v[188:191], a[252:255]
s_sub_u32 s37, s37, 1
s_cmp_lg_u32 s37, 0
s_cbranch_scc1 GL_62
s_waitcnt lgkmcnt(0)
v_mfma_f32_16x16x32_bf16 a[0:3], v[64:67], v[96:99], a[0:3]
v_mfma_f32_16x16x32_bf16 a[4:7], v[64:67], v[100:103], a[4:7]
s_waitcnt vmcnt(8)
s_barrier
v_mfma_f32_16x16x32_bf16 a[8:11], v[64:67], v[104:107], a[8:11]
ds_read_b128 v[160:163], v10 offset:16384
v_mfma_f32_16x16x32_bf16 a[12:15], v[64:67], v[108:111], a[12:15]
ds_read_b128 v[164:167], v10 offset:17408
v_mfma_f32_16x16x32_bf16 a[16:19], v[64:67], v[112:115], a[16:19]
ds_read_b128 v[168:171], v10 offset:18432
v_mfma_f32_16x16x32_bf16 a[20:23], v[64:67], v[116:119], a[20:23]
ds_read_b128 v[172:175], v10 offset:19456
v_mfma_f32_16x16x32_bf16 a[24:27], v[64:67], v[120:123], a[24:27]
ds_read_b128 v[176:179], v10 offset:20480
v_mfma_f32_16x16x32_bf16 a[28:31], v[64:67], v[124:127], a[28:31]
ds_read_b128 v[180:183], v10 offset:21504
v_mfma_f32_16x16x32_bf16 a[32:35], v[68:71], v[96:99], a[32:35]
ds_read_b128 v[184:187], v10 offset:22528
v_mfma_f32_16x16x32_bf16 a[36:39], v[68:71], v[100:103], a[36:39]
ds_read_b128 v[188:191], v10 offset:23552
v_mfma_f32_16x16x32_bf16 a[40:43], v[68:71], v[104:107], a[40:43]
ds_read_b64_tr_b16 v[128:129], v2 offset:16384
v_mfma_f32_16x16x32_bf16 a[44:47], v[68:71], v[108:111], a[44:47]
ds_read_b64_tr_b16 v[130:131], v2 offset:24576
v_mfma_f32_16x16x32_bf16 a[48:51], v[68:71], v[112:115], a[48:51]
ds_read_b64_tr_b16 v[132:133], v3 offset:16384
v_mfma_f32_16x16x32_bf16 a[52:55], v[68:71], v[116:119], a[52:55]
ds_read_b64_tr_b16 v[134:135], v3 offset:24576
v_mfma_f32_16x16x32_bf16 a[56:59], v[68:71], v[120:123], a[56:59]
ds_read_b64_tr_b16 v[136:137], v4 offset:16384
v_mfma_f32_16x16x32_bf16 a[60:63], v[68:71], v[124:127], a[60:63]
ds_read_b64_tr_b16 v[138:139], v4 offset:24576
v_mfma_f32_16x16x32_bf16 a[64:67], v[72:75], v[96:99], a[64:67]
ds_read_b64_tr_b16 v[140:141], v5 offset:16384
v_mfma_f32_16x16x32_bf16 a[68:71], v[72:75], v[100:103], a[68:71]
ds_read_b64_tr_b16 v[142:143], v5 offset:24576
v_mfma_f32_16x16x32_bf16 a[72:75], v[72:75], v[104:107], a[72:75]
ds_read_b64_tr_b16 v[144:145], v6 offset:16384
v_mfma_f32_16x16x32_bf16 a[76:79], v[72:75], v[108:111], a[76:79]
ds_read_b64_tr_b16 v[146:147], v6 offset:24576
v_mfma_f32_16x16x32_bf16 a[80:83], v[72:75], v[112:115], a[80:83]
ds_read_b64_tr_b16 v[148:149], v7 offset:16384
v_mfma_f32_16x16x32_bf16 a[84:87], v[72:75], v[116:119], a[84:87]
ds_read_b64_tr_b16 v[150:151], v7 offset:24576
v_mfma_f32_16x16x32_bf16 a[88:91], v[72:75], v[120:123], a[88:91]
ds_read_b64_tr_b16 v[152:153], v8 offset:16384
v_mfma_f32_16x16x32_bf16 a[92:95], v[72:75], v[124:127], a[92:95]
ds_read_b64_tr_b16 v[154:155], v8 offset:24576
v_mfma_f32_16x16x32_bf16 a[96:99], v[76:79], v[96:99], a[96:99]
ds_read_b64_tr_b16 v[156:157], v9 offset:16384
v_mfma_f32_16x16x32_bf16 a[100:103], v[76:79], v[100:103], a[100:103]
ds_read_b64_tr_b16 v[158:159], v9 offset:24576
v_mfma_f32_16x16x32_bf16 a[104:107], v[76:79], v[104:107], a[104:107]
v_mfma_f32_16x16x32_bf16 a[108:111], v[76:79], v[108:111], a[108:111]
s_add_u32 m0, s32, 49152
v_mfma_f32_16x16x32_bf16 a[112:115], v[76:79], v[112:115], a[112:115]
buffer_load_dwordx4 v11, s[8:11], s30 offen offset:0 lds
v_mfma_f32_16x16x32_bf16 a[116:119], v[76:79], v[116:119], a[116:119]
v_mfma_f32_16x16x32_bf16 a[120:123], v[76:79], v[120:123], a[120:123]
v_mfma_f32_16x16x32_bf16 a[124:127], v[76:79], v[124:127], a[124:127]
v_mfma_f32_16x16x32_bf16 a[128:131], v[80:83], v[96:99], a[128:131]
buffer_load_dwordx4 v12, s[8:11], s30 offen offset:1024 lds
v_mfma_f32_16x16x32_bf16 a[132:135], v[80:83], v[100:103], a[132:135]
v_mfma_f32_16x16x32_bf16 a[136:139], v[80:83], v[104:107], a[136:139]
v_mfma_f32_16x16x32_bf16 a[140:143], v[80:83], v[108:111], a[140:143]
v_mfma_f32_16x16x32_bf16 a[144:147], v[80:83], v[112:115], a[144:147]
buffer_load_dwordx4 v13, s[8:11], s30 offen offset:2048 lds
v_mfma_f32_16x16x32_bf16 a[148:151], v[80:83], v[116:119], a[148:151]
v_mfma_f32_16x16x32_bf16 a[152:155], v[80:83], v[120:123], a[152:155]
v_mfma_f32_16x16x32_bf16 a[156:159], v[80:83], v[124:127], a[156:159]
v_mfma_f32_16x16x32_bf16 a[160:163], v[84:87], v[96:99], a[160:163]
buffer_load_dwordx4 v14, s[8:11], s30 offen offset:3072 lds
v_mfma_f32_16x16x32_bf16 a[164:167], v[84:87], v[100:103], a[164:167]
v_mfma_f32_16x16x32_bf16 a[168:171], v[84:87], v[104:107], a[168:171]
v_mfma_f32_16x16x32_bf16 a[172:175], v[84:87], v[108:111], a[172:175]
s_add_u32 m0, s33, 49152
v_mfma_f32_16x16x32_bf16 a[176:179], v[84:87], v[112:115], a[176:179]
buffer_load_dwordx4 v15, s[4:7], s31 offen offset:0 sc1 lds
v_mfma_f32_16x16x32_bf16 a[180:183], v[84:87], v[116:119], a[180:183]
v_mfma_f32_16x16x32_bf16 a[184:187], v[84:87], v[120:123], a[184:187]
v_mfma_f32_16x16x32_bf16 a[188:191], v[84:87], v[124:127], a[188:191]
v_mfma_f32_16x16x32_bf16 a[192:195], v[88:91], v[96:99], a[192:195]
buffer_load_dwordx4 v15, s[4:7], s31 offen offset:1024 sc1 lds
v_mfma_f32_16x16x32_bf16 a[196:199], v[88:91], v[100:103], a[196:199]
v_mfma_f32_16x16x32_bf16 a[200:203], v[88:91], v[104:107], a[200:203]
v_mfma_f32_16x16x32_bf16 a[204:207], v[88:91], v[108:111], a[204:207]
v_mfma_f32_16x16x32_bf16 a[208:211], v[88:91], v[112:115], a[208:211]
buffer_load_dwordx4 v15, s[4:7], s31 offen offset:2048 sc1 lds
v_mfma_f32_16x16x32_bf16 a[212:215], v[88:91], v[116:119], a[212:215]
v_mfma_f32_16x16x32_bf16 a[216:219], v[88:91], v[120:123], a[216:219]
v_mfma_f32_16x16x32_bf16 a[220:223], v[88:91], v[124:127], a[220:223]
v_mfma_f32_16x16x32_bf16 a[224:227], v[92:95], v[96:99], a[224:227]
buffer_load_dwordx4 v15, s[4:7], s31 offen offset:3072 sc1 lds
v_mfma_f32_16x16x32_bf16 a[228:231], v[92:95], v[100:103], a[228:231]
v_mfma_f32_16x16x32_bf16 a[232:235], v[92:95], v[104:107], a[232:235]
s_add_u32 s30, s30, 229376
v_mfma_f32_16x16x32_bf16 a[236:239], v[92:95], v[108:111], a[236:239]
s_add_u32 s31, s31, 16384
v_mfma_f32_16x16x32_bf16 a[240:243], v[92:95], v[112:115], a[240:243]
v_mfma_f32_16x16x32_bf16 a[244:247], v[92:95], v[116:119], a[244:247]
v_mfma_f32_16x16x32_bf16 a[248:251], v[92:95], v[120:123], a[248:251]
v_mfma_f32_16x16x32_bf16 a[252:255], v[92:95], v[124:127], a[252:255]
s_waitcnt lgkmcnt(0)
v_mfma_f32_16x16x32_bf16 a[0:3], v[128:131], v[160:163], a[0:3]
v_mfma_f32_16x16x32_bf16 a[4:7], v[128:131], v[164:167], a[4:7]
s_waitcnt vmcnt(8)
s_barrier
v_mfma_f32_16x16x32_bf16 a[8:11], v[128:131], v[168:171], a[8:11]
ds_read_b128 v[96:99], v10 offset:32768
v_mfma_f32_16x16x32_bf16 a[12:15], v[128:131], v[172:175], a[12:15]
ds_read_b128 v[100:103], v10 offset:33792
v_mfma_f32_16x16x32_bf16 a[16:19], v[128:131], v[176:179], a[16:19]
ds_read_b128 v[104:107], v10 offset:34816
v_mfma_f32_16x16x32_bf16 a[20:23], v[128:131], v[180:183], a[20:23]
ds_read_b128 v[108:111], v10 offset:35840
v_mfma_f32_16x16x32_bf16 a[24:27], v[128:131], v[184:187], a[24:27]
ds_read_b128 v[112:115], v10 offset:36864
v_mfma_f32_16x16x32_bf16 a[28:31], v[128:131], v[188:191], a[28:31]
ds_read_b128 v[116:119], v10 offset:37888
v_mfma_f32_16x16x32_bf16 a[32:35], v[132:135], v[160:163], a[32:35]
ds_read_b128 v[120:123], v10 offset:38912
v_mfma_f32_16x16x32_bf16 a[36:39], v[132:135], v[164:167], a[36:39]
ds_read_b128 v[124:127], v10 offset:39936
v_mfma_f32_16x16x32_bf16 a[40:43], v[132:135], v[168:171], a[40:43]
ds_read_b64_tr_b16 v[64:65], v2 offset:32768
v_mfma_f32_16x16x32_bf16 a[44:47], v[132:135], v[172:175], a[44:47]
ds_read_b64_tr_b16 v[66:67], v2 offset:40960
v_mfma_f32_16x16x32_bf16 a[48:51], v[132:135], v[176:179], a[48:51]
ds_read_b64_tr_b16 v[68:69], v3 offset:32768
v_mfma_f32_16x16x32_bf16 a[52:55], v[132:135], v[180:183], a[52:55]
ds_read_b64_tr_b16 v[70:71], v3 offset:40960
v_mfma_f32_16x16x32_bf16 a[56:59], v[132:135], v[184:187], a[56:59]
ds_read_b64_tr_b16 v[72:73], v4 offset:32768
v_mfma_f32_16x16x32_bf16 a[60:63], v[132:135], v[188:191], a[60:63]
ds_read_b64_tr_b16 v[74:75], v4 offset:40960
v_mfma_f32_16x16x32_bf16 a[64:67], v[136:139], v[160:163], a[64:67]
ds_read_b64_tr_b16 v[76:77], v5 offset:32768
v_mfma_f32_16x16x32_bf16 a[68:71], v[136:139], v[164:167], a[68:71]
ds_read_b64_tr_b16 v[78:79], v5 offset:40960
v_mfma_f32_16x16x32_bf16 a[72:75], v[136:139], v[168:171], a[72:75]
ds_read_b64_tr_b16 v[80:81], v6 offset:32768
v_mfma_f32_16x16x32_bf16 a[76:79], v[136:139], v[172:175], a[76:79]
ds_read_b64_tr_b16 v[82:83], v6 offset:40960
v_mfma_f32_16x16x32_bf16 a[80:83], v[136:139], v[176:179], a[80:83]
ds_read_b64_tr_b16 v[84:85], v7 offset:32768
v_mfma_f32_16x16x32_bf16 a[84:87], v[136:139], v[180:183], a[84:87]
ds_read_b64_tr_b16 v[86:87], v7 offset:40960
v_mfma_f32_16x16x32_bf16 a[88:91], v[136:139], v[184:187], a[88:91]
ds_read_b64_tr_b16 v[88:89], v8 offset:32768
v_mfma_f32_16x16x32_bf16 a[92:95], v[136:139], v[188:191], a[92:95]
ds_read_b64_tr_b16 v[90:91], v8 offset:40960
v_mfma_f32_16x16x32_bf16 a[96:99], v[140:143], v[160:163], a[96:99]
ds_read_b64_tr_b16 v[92:93], v9 offset:32768
v_mfma_f32_16x16x32_bf16 a[100:103], v[140:143], v[164:167], a[100:103]
ds_read_b64_tr_b16 v[94:95], v9 offset:40960
v_mfma_f32_16x16x32_bf16 a[104:107], v[140:143], v[168:171], a[104:107]
v_mfma_f32_16x16x32_bf16 a[108:111], v[140:143], v[172:175], a[108:111]
v_mfma_f32_16x16x32_bf16 a[112:115], v[140:143], v[176:179], a[112:115]
v_mfma_f32_16x16x32_bf16 a[116:119], v[140:143], v[180:183], a[116:119]
v_mfma_f32_16x16x32_bf16 a[120:123], v[140:143], v[184:187], a[120:123]
v_mfma_f32_16x16x32_bf16 a[124:127], v[140:143], v[188:191], a[124:127]
v_mfma_f32_16x16x32_bf16 a[128:131], v[144:147], v[160:163], a[128:131]
v_mfma_f32_16x16x32_bf16 a[132:135], v[144:147], v[164:167], a[132:135]
v_mfma_f32_16x16x32_bf16 a[136:139], v[144:147], v[168:171], a[136:139]
v_mfma_f32_16x16x32_bf16 a[140:143], v[144:147], v[172:175], a[140:143]
v_mfma_f32_16x16x32_bf16 a[144:147], v[144:147], v[176:179], a[144:147]
v_mfma_f32_16x16x32_bf16 a[148:151], v[144:147], v[180:183], a[148:151]
v_mfma_f32_16x16x32_bf16 a[152:155], v[144:147], v[184:187], a[152:155]
v_mfma_f32_16x16x32_bf16 a[156:159], v[144:147], v[188:191], a[156:159]
v_mfma_f32_16x16x32_bf16 a[160:163], v[148:151], v[160:163], a[160:163]
v_mfma_f32_16x16x32_bf16 a[164:167], v[148:151], v[164:167], a[164:167]
v_mfma_f32_16x16x32_bf16 a[168:171], v[148:151], v[168:171], a[168:171]
v_mfma_f32_16x16x32_bf16 a[172:175], v[148:151], v[172:175], a[172:175]
v_mfma_f32_16x16x32_bf16 a[176:179], v[148:151], v[176:179], a[176:179]
v_mfma_f32_16x16x32_bf16 a[180:183], v[148:151], v[180:183], a[180:183]
v_mfma_f32_16x16x32_bf16 a[184:187], v[148:151], v[184:187], a[184:187]
v_mfma_f32_16x16x32_bf16 a[188:191], v[148:151], v[188:191], a[188:191]
v_mfma_f32_16x16x32_bf16 a[192:195], v[152:155], v[160:163], a[192:195]
v_mfma_f32_16x16x32_bf16 a[196:199], v[152:155], v[164:167], a[196:199]
v_mfma_f32_16x16x32_bf16 a[200:203], v[152:155], v[168:171], a[200:203]
v_mfma_f32_16x16x32_bf16 a[204:207], v[152:155], v[172:175], a[204:207]
v_mfma_f32_16x16x32_bf16 a[208:211], v[152:155], v[176:179], a[208:211]
v_mfma_f32_16x16x32_bf16 a[212:215], v[152:155], v[180:183], a[212:215]
v_mfma_f32_16x16x32_bf16 a[216:219], v[152:155], v[184:187], a[216:219]
v_mfma_f32_16x16x32_bf16 a[220:223], v[152:155], v[188:191], a[220:223]
v_mfma_f32_16x16x32_bf16 a[224:227], v[156:159], v[160:163], a[224:227]
v_mfma_f32_16x16x32_bf16 a[228:231], v[156:159], v[164:167], a[228:231]
v_mfma_f32_16x16x32_bf16 a[232:235], v[156:159], v[168:171], a[232:235]
v_mfma_f32_16x16x32_bf16 a[236:239], v[156:159], v[172:175], a[236:239]
v_mfma_f32_16x16x32_bf16 a[240:243], v[156:159], v[176:179], a[240:243]
v_mfma_f32_16x16x32_bf16 a[244:247], v[156:159], v[180:183], a[244:247]
v_mfma_f32_16x16x32_bf16 a[248:251], v[156:159], v[184:187], a[248:251]
v_mfma_f32_16x16x32_bf16 a[252:255], v[156:159], v[188:191], a[252:255]
s_waitcnt lgkmcnt(0)
v_mfma_f32_16x16x32_bf16 a[0:3], v[64:67], v[96:99], a[0:3]
v_mfma_f32_16x16x32_bf16 a[4:7], v[64:67], v[100:103], a[4:7]
s_waitcnt vmcnt(0)
s_barrier
v_mfma_f32_16x16x32_bf16 a[8:11], v[64:67], v[104:107], a[8:11]
ds_read_b128 v[160:163], v10 offset:49152
v_mfma_f32_16x16x32_bf16 a[12:15], v[64:67], v[108:111], a[12:15]
ds_read_b128 v[164:167], v10 offset:50176
v_mfma_f32_16x16x32_bf16 a[16:19], v[64:67], v[112:115], a[16:19]
ds_read_b128 v[168:171], v10 offset:51200
v_mfma_f32_16x16x32_bf16 a[20:23], v[64:67], v[116:119], a[20:23]
ds_read_b128 v[172:175], v10 offset:52224
v_mfma_f32_16x16x32_bf16 a[24:27], v[64:67], v[120:123], a[24:27]
ds_read_b128 v[176:179], v10 offset:53248
v_mfma_f32_16x16x32_bf16 a[28:31], v[64:67], v[124:127], a[28:31]
ds_read_b128 v[180:183], v10 offset:54272
v_mfma_f32_16x16x32_bf16 a[32:35], v[68:71], v[96:99], a[32:35]
ds_read_b128 v[184:187], v10 offset:55296
v_mfma_f32_16x16x32_bf16 a[36:39], v[68:71], v[100:103], a[36:39]
ds_read_b128 v[188:191], v10 offset:56320
v_mfma_f32_16x16x32_bf16 a[40:43], v[68:71], v[104:107], a[40:43]
ds_read_b64_tr_b16 v[128:129], v2 offset:49152
v_mfma_f32_16x16x32_bf16 a[44:47], v[68:71], v[108:111], a[44:47]
ds_read_b64_tr_b16 v[130:131], v2 offset:57344
v_mfma_f32_16x16x32_bf16 a[48:51], v[68:71], v[112:115], a[48:51]
ds_read_b64_tr_b16 v[132:133], v3 offset:49152
v_mfma_f32_16x16x32_bf16 a[52:55], v[68:71], v[116:119], a[52:55]
ds_read_b64_tr_b16 v[134:135], v3 offset:57344
v_mfma_f32_16x16x32_bf16 a[56:59], v[68:71], v[120:123], a[56:59]
ds_read_b64_tr_b16 v[136:137], v4 offset:49152
v_mfma_f32_16x16x32_bf16 a[60:63], v[68:71], v[124:127], a[60:63]
ds_read_b64_tr_b16 v[138:139], v4 offset:57344
v_mfma_f32_16x16x32_bf16 a[64:67], v[72:75], v[96:99], a[64:67]
ds_read_b64_tr_b16 v[140:141], v5 offset:49152
v_mfma_f32_16x16x32_bf16 a[68:71], v[72:75], v[100:103], a[68:71]
ds_read_b64_tr_b16 v[142:143], v5 offset:57344
v_mfma_f32_16x16x32_bf16 a[72:75], v[72:75], v[104:107], a[72:75]
ds_read_b64_tr_b16 v[144:145], v6 offset:49152
v_mfma_f32_16x16x32_bf16 a[76:79], v[72:75], v[108:111], a[76:79]
ds_read_b64_tr_b16 v[146:147], v6 offset:57344
v_mfma_f32_16x16x32_bf16 a[80:83], v[72:75], v[112:115], a[80:83]
ds_read_b64_tr_b16 v[148:149], v7 offset:49152
v_mfma_f32_16x16x32_bf16 a[84:87], v[72:75], v[116:119], a[84:87]
ds_read_b64_tr_b16 v[150:151], v7 offset:57344
v_mfma_f32_16x16x32_bf16 a[88:91], v[72:75], v[120:123], a[88:91]
ds_read_b64_tr_b16 v[152:153], v8 offset:49152
v_mfma_f32_16x16x32_bf16 a[92:95], v[72:75], v[124:127], a[92:95]
ds_read_b64_tr_b16 v[154:155], v8 offset:57344
v_mfma_f32_16x16x32_bf16 a[96:99], v[76:79], v[96:99], a[96:99]
ds_read_b64_tr_b16 v[156:157], v9 offset:49152
v_mfma_f32_16x16x32_bf16 a[100:103], v[76:79], v[100:103], a[100:103]
ds_read_b64_tr_b16 v[158:159], v9 offset:57344
v_mfma_f32_16x16x32_bf16 a[104:107], v[76:79], v[104:107], a[104:107]
v_mfma_f32_16x16x32_bf16 a[108:111], v[76:79], v[108:111], a[108:111]
v_mfma_f32_16x16x32_bf16 a[112:115], v[76:79], v[112:115], a[112:115]
v_mfma_f32_16x16x32_bf16 a[116:119], v[76:79], v[116:119], a[116:119]
v_mfma_f32_16x16x32_bf16 a[120:123], v[76:79], v[120:123], a[120:123]
v_mfma_f32_16x16x32_bf16 a[124:127], v[76:79], v[124:127], a[124:127]
v_mfma_f32_16x16x32_bf16 a[128:131], v[80:83], v[96:99], a[128:131]
v_mfma_f32_16x16x32_bf16 a[132:135], v[80:83], v[100:103], a[132:135]
v_mfma_f32_16x16x32_bf16 a[136:139], v[80:83], v[104:107], a[136:139]
v_mfma_f32_16x16x32_bf16 a[140:143], v[80:83], v[108:111], a[140:143]
v_mfma_f32_16x16x32_bf16 a[144:147], v[80:83], v[112:115], a[144:147]
v_mfma_f32_16x16x32_bf16 a[148:151], v[80:83], v[116:119], a[148:151]
v_mfma_f32_16x16x32_bf16 a[152:155], v[80:83], v[120:123], a[152:155]
v_mfma_f32_16x16x32_bf16 a[156:159], v[80:83], v[124:127], a[156:159]
v_mfma_f32_16x16x32_bf16 a[160:163], v[84:87], v[96:99], a[160:163]
v_mfma_f32_16x16x32_bf16 a[164:167], v[84:87], v[100:103], a[164:167]
v_mfma_f32_16x16x32_bf16 a[168:171], v[84:87], v[104:107], a[168:171]
v_mfma_f32_16x16x32_bf16 a[172:175], v[84:87], v[108:111], a[172:175]
v_mfma_f32_16x16x32_bf16 a[176:179], v[84:87], v[112:115], a[176:179]
v_mfma_f32_16x16x32_bf16 a[180:183], v[84:87], v[116:119], a[180:183]
v_mfma_f32_16x16x32_bf16 a[184:187], v[84:87], v[120:123], a[184:187]
v_mfma_f32_16x16x32_bf16 a[188:191], v[84:87], v[124:127], a[188:191]
v_mfma_f32_16x16x32_bf16 a[192:195], v[88:91], v[96:99], a[192:195]
v_mfma_f32_16x16x32_bf16 a[196:199], v[88:91], v[100:103], a[196:199]
v_mfma_f32_16x16x32_bf16 a[200:203], v[88:91], v[104:107], a[200:203]
v_mfma_f32_16x16x32_bf16 a[204:207], v[88:91], v[108:111], a[204:207]
v_mfma_f32_16x16x32_bf16 a[208:211], v[88:91], v[112:115], a[208:211]
v_mfma_f32_16x16x32_bf16 a[212:215], v[88:91], v[116:119], a[212:215]
v_mfma_f32_16x16x32_bf16 a[216:219], v[88:91], v[120:123], a[216:219]
v_mfma_f32_16x16x32_bf16 a[220:223], v[88:91], v[124:127], a[220:223]
v_mfma_f32_16x16x32_bf16 a[224:227], v[92:95], v[96:99], a[224:227]
v_mfma_f32_16x16x32_bf16 a[228:231], v[92:95], v[100:103], a[228:231]
v_mfma_f32_16x16x32_bf16 a[232:235], v[92:95], v[104:107], a[232:235]
v_mfma_f32_16x16x32_bf16 a[236:239], v[92:95], v[108:111], a[236:239]
v_mfma_f32_16x16x32_bf16 a[240:243], v[92:95], v[112:115], a[240:243]
v_mfma_f32_16x16x32_bf16 a[244:247], v[92:95], v[116:119], a[244:247]
v_mfma_f32_16x16x32_bf16 a[248:251], v[92:95], v[120:123], a[248:251]
v_mfma_f32_16x16x32_bf16 a[252:255], v[92:95], v[124:127], a[252:255]
s_waitcnt lgkmcnt(0)
v_mfma_f32_16x16x32_bf16 a[0:3], v[128:131], v[160:163], a[0:3]
v_mfma_f32_16x16x32_bf16 a[4:7], v[128:131], v[164:167], a[4:7]
v_mfma_f32_16x16x32_bf16 a[8:11], v[128:131], v[168:171], a[8:11]
v_mfma_f32_16x16x32_bf16 a[12:15], v[128:131], v[172:175], a[12:15]
v_mfma_f32_16x16x32_bf16 a[16:19], v[128:131], v[176:179], a[16:19]
v_mfma_f32_16x16x32_bf16 a[20:23], v[128:131], v[180:183], a[20:23]
v_mfma_f32_16x16x32_bf16 a[24:27], v[128:131], v[184:187], a[24:27]
v_mfma_f32_16x16x32_bf16 a[28:31], v[128:131], v[188:191], a[28:31]
v_mfma_f32_16x16x32_bf16 a[32:35], v[132:135], v[160:163], a[32:35]
v_mfma_f32_16x16x32_bf16 a[36:39], v[132:135], v[164:167], a[36:39]
v_mfma_f32_16x16x32_bf16 a[40:43], v[132:135], v[168:171], a[40:43]
v_mfma_f32_16x16x32_bf16 a[44:47], v[132:135], v[172:175], a[44:47]
v_mfma_f32_16x16x32_bf16 a[48:51], v[132:135], v[176:179], a[48:51]
v_mfma_f32_16x16x32_bf16 a[52:55], v[132:135], v[180:183], a[52:55]
v_mfma_f32_16x16x32_bf16 a[56:59], v[132:135], v[184:187], a[56:59]
v_mfma_f32_16x16x32_bf16 a[60:63], v[132:135], v[188:191], a[60:63]
v_mfma_f32_16x16x32_bf16 a[64:67], v[136:139], v[160:163], a[64:67]
v_mfma_f32_16x16x32_bf16 a[68:71], v[136:139], v[164:167], a[68:71]
v_mfma_f32_16x16x32_bf16 a[72:75], v[136:139], v[168:171], a[72:75]
v_mfma_f32_16x16x32_bf16 a[76:79], v[136:139], v[172:175], a[76:79]
v_mfma_f32_16x16x32_bf16 a[80:83], v[136:139], v[176:179], a[80:83]
v_mfma_f32_16x16x32_bf16 a[84:87], v[136:139], v[180:183], a[84:87]
v_mfma_f32_16x16x32_bf16 a[88:91], v[136:139], v[184:187], a[88:91]
v_mfma_f32_16x16x32_bf16 a[92:95], v[136:139], v[188:191], a[92:95]
v_mfma_f32_16x16x32_bf16 a[96:99], v[140:143], v[160:163], a[96:99]
v_mfma_f32_16x16x32_bf16 a[100:103], v[140:143], v[164:167], a[100:103]
v_mfma_f32_16x16x32_bf16 a[104:107], v[140:143], v[168:171], a[104:107]
v_mfma_f32_16x16x32_bf16 a[108:111], v[140:143], v[172:175], a[108:111]
v_mfma_f32_16x16x32_bf16 a[112:115], v[140:143], v[176:179], a[112:115]
v_mfma_f32_16x16x32_bf16 a[116:119], v[140:143], v[180:183], a[116:119]
v_mfma_f32_16x16x32_bf16 a[120:123], v[140:143], v[184:187], a[120:123]
v_mfma_f32_16x16x32_bf16 a[124:127], v[140:143], v[188:191], a[124:127]
v_mfma_f32_16x16x32_bf16 a[128:131], v[144:147], v[160:163], a[128:131]
v_mfma_f32_16x16x32_bf16 a[132:135], v[144:147], v[164:167], a[132:135]
v_mfma_f32_16x16x32_bf16 a[136:139], v[144:147], v[168:171], a[136:139]
v_mfma_f32_16x16x32_bf16 a[140:143], v[144:147], v[172:175], a[140:143]
v_mfma_f32_16x16x32_bf16 a[144:147], v[144:147], v[176:179], a[144:147]
v_mfma_f32_16x16x32_bf16 a[148:151], v[144:147], v[180:183], a[148:151]
v_mfma_f32_16x16x32_bf16 a[152:155], v[144:147], v[184:187], a[152:155]
v_mfma_f32_16x16x32_bf16 a[156:159], v[144:147], v[188:191], a[156:159]
v_mfma_f32_16x16x32_bf16 a[160:163], v[148:151], v[160:163], a[160:163]
v_mfma_f32_16x16x32_bf16 a[164:167], v[148:151], v[164:167], a[164:167]
v_mfma_f32_16x16x32_bf16 a[168:171], v[148:151], v[168:171], a[168:171]
v_mfma_f32_16x16x32_bf16 a[172:175], v[148:151], v[172:175], a[172:175]
v_mfma_f32_16x16x32_bf16 a[176:179], v[148:151], v[176:179], a[176:179]
v_mfma_f32_16x16x32_bf16 a[180:183], v[148:151], v[180:183], a[180:183]
v_mfma_f32_16x16x32_bf16 a[184:187], v[148:151], v[184:187], a[184:187]
v_mfma_f32_16x16x32_bf16 a[188:191], v[148:151], v[188:191], a[188:191]
v_mfma_f32_16x16x32_bf16 a[192:195], v[152:155], v[160:163], a[192:195]
v_mfma_f32_16x16x32_bf16 a[196:199], v[152:155], v[164:167], a[196:199]
v_mfma_f32_16x16x32_bf16 a[200:203], v[152:155], v[168:171], a[200:203]
v_mfma_f32_16x16x32_bf16 a[204:207], v[152:155], v[172:175], a[204:207]
v_mfma_f32_16x16x32_bf16 a[208:211], v[152:155], v[176:179], a[208:211]
v_mfma_f32_16x16x32_bf16 a[212:215], v[152:155], v[180:183], a[212:215]
v_mfma_f32_16x16x32_bf16 a[216:219], v[152:155], v[184:187], a[216:219]
v_mfma_f32_16x16x32_bf16 a[220:223], v[152:155], v[188:191], a[220:223]
v_mfma_f32_16x16x32_bf16 a[224:227], v[156:159], v[160:163], a[224:227]
v_mfma_f32_16x16x32_bf16 a[228:231], v[156:159], v[164:167], a[228:231]
v_mfma_f32_16x16x32_bf16 a[232:235], v[156:159], v[168:171], a[232:235]
v_mfma_f32_16x16x32_bf16 a[236:239], v[156:159], v[172:175], a[236:239]
v_mfma_f32_16x16x32_bf16 a[240:243], v[156:159], v[176:179], a[240:243]
v_mfma_f32_16x16x32_bf16 a[244:247], v[156:159], v[180:183], a[244:247]
v_mfma_f32_16x16x32_bf16 a[248:251], v[156:159], v[184:187], a[248:251]
v_mfma_f32_16x16x32_bf16 a[252:255], v[156:159], v[188:191], a[252:255]
s_nop 7
s_mov_b32 s42, 1.0
s_mov_b32 s40, 0xbdd2d3e8
v_mov_b32 v60, 0xc0135761
s_mul_i32 s36, s28, 112
s_lshl_b32 s37, s29, 3
s_add_u32 s36, s36, s37
s_lshl_b32 s37, s35, 2
s_add_u32 s36, s36, s37
s_lshl_b32 s36, s36, 14
s_lshl_b32 s37, s34, 13
s_add_u32 s36, s36, s37
s_add_u32 s36, s36, 4194304
s_add_u32 s38, s36, 0
v_accvgpr_read_b32 v64, a0
v_accvgpr_read_b32 v65, a1
v_accvgpr_read_b32 v66, a2
v_accvgpr_read_b32 v67, a3
v_accvgpr_read_b32 v68, a32
v_accvgpr_read_b32 v69, a33
v_accvgpr_read_b32 v70, a34
v_accvgpr_read_b32 v71, a35
v_pk_mul_f32 v[224:225], v[64:65], v[64:65]
v_pk_mul_f32 v[226:227], v[66:67], v[66:67]
v_pk_mul_f32 v[228:229], v[68:69], v[68:69]
v_pk_mul_f32 v[230:231], v[70:71], v[70:71]
v_pk_fma_f32 v[224:225], v[224:225], s[40:41], v[60:61] op_sel_hi:[1,0,0]
v_pk_fma_f32 v[226:227], v[226:227], s[40:41], v[60:61] op_sel_hi:[1,0,0]
v_pk_fma_f32 v[228:229], v[228:229], s[40:41], v[60:61] op_sel_hi:[1,0,0]
v_pk_fma_f32 v[230:231], v[230:231], s[40:41], v[60:61] op_sel_hi:[1,0,0]
v_pk_mul_f32 v[224:225], v[224:225], v[64:65]
v_pk_mul_f32 v[226:227], v[226:227], v[66:67]
v_pk_mul_f32 v[228:229], v[228:229], v[68:69]
v_pk_mul_f32 v[230:231], v[230:231], v[70:71]
v_exp_f32 v224, v224
v_exp_f32 v225, v225
v_exp_f32 v226, v226
v_exp_f32 v227, v227
v_exp_f32 v228, v228
v_exp_f32 v229, v229
v_exp_f32 v230, v230
v_exp_f32 v231, v231
v_pk_add_f32 v[224:225], v[224:225], s[42:43] op_sel_hi:[1,0]
v_pk_add_f32 v[226:227], v[226:227], s[42:43] op_sel_hi:[1,0]
v_pk_add_f32 v[228:229], v[228:229], s[42:43] op_sel_hi:[1,0]
v_pk_add_f32 v[230:231], v[230:231], s[42:43] op_sel_hi:[1,0]
v_rcp_f32 v224, v224
v_rcp_f32 v225, v225
v_rcp_f32 v226, v226
v_rcp_f32 v227, v227
v_rcp_f32 v228, v228
v_rcp_f32 v229, v229
v_rcp_f32 v230, v230
v_rcp_f32 v231, v231
v_pk_mul_f32 v[64:65], v[64:65], v[224:225]
v_pk_mul_f32 v[66:67], v[66:67], v[226:227]
v_pk_mul_f32 v[68:69], v[68:69], v[228:229]
v_pk_mul_f32 v[70:71], v[70:71], v[230:231]
v_cvt_pk_bf16_f32 v72, v64, v65
v_cvt_pk_bf16_f32 v73, v66, v67
v_cvt_pk_bf16_f32 v74, v68, v69
v_cvt_pk_bf16_f32 v75, v70, v71
buffer_store_dwordx4 v[72:75], v61, s[4:7], s38 offen offset:0 sc1
v_accvgpr_read_b32 v80, a4
v_accvgpr_read_b32 v81, a5
v_accvgpr_read_b32 v82, a6
v_accvgpr_read_b32 v83, a7
v_accvgpr_read_b32 v84, a36
v_accvgpr_read_b32 v85, a37
v_accvgpr_read_b32 v86, a38
v_accvgpr_read_b32 v87, a39
v_pk_mul_f32 v[224:225], v[80:81], v[80:81]
v_pk_mul_f32 v[226:227], v[82:83], v[82:83]
v_pk_mul_f32 v[228:229], v[84:85], v[84:85]
v_pk_mul_f32 v[230:231], v[86:87], v[86:87]
v_pk_fma_f32 v[224:225], v[224:225], s[40:41], v[60:61] op_sel_hi:[1,0,0]
v_pk_fma_f32 v[226:227], v[226:227], s[40:41], v[60:61] op_sel_hi:[1,0,0]
v_pk_fma_f32 v[228:229], v[228:229], s[40:41], v[60:61] op_sel_hi:[1,0,0]
v_pk_fma_f32 v[230:231], v[230:231], s[40:41], v[60:61] op_sel_hi:[1,0,0]
v_pk_mul_f32 v[224:225], v[224:225], v[80:81]
v_pk_mul_f32 v[226:227], v[226:227], v[82:83]
v_pk_mul_f32 v[228:229], v[228:229], v[84:85]
v_pk_mul_f32 v[230:231], v[230:231], v[86:87]
v_exp_f32 v224, v224
v_exp_f32 v225, v225
v_exp_f32 v226, v226
v_exp_f32 v227, v227
v_exp_f32 v228, v228
v_exp_f32 v229, v229
v_exp_f32 v230, v230
v_exp_f32 v231, v231
v_pk_add_f32 v[224:225], v[224:225], s[42:43] op_sel_hi:[1,0]
v_pk_add_f32 v[226:227], v[226:227], s[42:43] op_sel_hi:[1,0]
v_pk_add_f32 v[228:229], v[228:229], s[42:43] op_sel_hi:[1,0]
v_pk_add_f32 v[230:231], v[230:231], s[42:43] op_sel_hi:[1,0]
v_rcp_f32 v224, v224
v_rcp_f32 v225, v225
v_rcp_f32 v226, v226
v_rcp_f32 v227, v227
v_rcp_f32 v228, v228
v_rcp_f32 v229, v229
v_rcp_f32 v230, v230
v_rcp_f32 v231, v231
v_pk_mul_f32 v[80:81], v[80:81], v[224:225]
v_pk_mul_f32 v[82:83], v[82:83], v[226:227]
v_pk_mul_f32 v[84:85], v[84:85], v[228:229]
v_pk_mul_f32 v[86:87], v[86:87], v[230:231]
v_cvt_pk_bf16_f32 v88, v80, v81
v_cvt_pk_bf16_f32 v89, v82, v83
v_cvt_pk_bf16_f32 v90, v84, v85
v_cvt_pk_bf16_f32 v91, v86, v87
buffer_store_dwordx4 v[88:91], v61, s[4:7], s38 offen offset:1024 sc1
v_accvgpr_read_b32 v96, a8
v_accvgpr_read_b32 v97, a9
v_accvgpr_read_b32 v98, a10
v_accvgpr_read_b32 v99, a11
v_accvgpr_read_b32 v100, a40
v_accvgpr_read_b32 v101, a41
v_accvgpr_read_b32 v102, a42
v_accvgpr_read_b32 v103, a43
v_pk_mul_f32 v[224:225], v[96:97], v[96:97]
v_pk_mul_f32 v[226:227], v[98:99], v[98:99]
v_pk_mul_f32 v[228:229], v[100:101], v[100:101]
v_pk_mul_f32 v[230:231], v[102:103], v[102:103]
v_pk_fma_f32 v[224:225], v[224:225], s[40:41], v[60:61] op_sel_hi:[1,0,0]
v_pk_fma_f32 v[226:227], v[226:227], s[40:41], v[60:61] op_sel_hi:[1,0,0]
v_pk_fma_f32 v[228:229], v[228:229], s[40:41], v[60:61] op_sel_hi:[1,0,0]
v_pk_fma_f32 v[230:231], v[230:231], s[40:41], v[60:61] op_sel_hi:[1,0,0]
v_pk_mul_f32 v[224:225], v[224:225], v[96:97]
v_pk_mul_f32 v[226:227], v[226:227], v[98:99]
v_pk_mul_f32 v[228:229], v[228:229], v[100:101]
v_pk_mul_f32 v[230:231], v[230:231], v[102:103]
v_exp_f32 v224, v224
v_exp_f32 v225, v225
v_exp_f32 v226, v226
v_exp_f32 v227, v227
v_exp_f32 v228, v228
v_exp_f32 v229, v229
v_exp_f32 v230, v230
v_exp_f32 v231, v231
v_pk_add_f32 v[224:225], v[224:225], s[42:43] op_sel_hi:[1,0]
v_pk_add_f32 v[226:227], v[226:227], s[42:43] op_sel_hi:[1,0]
v_pk_add_f32 v[228:229], v[228:229], s[42:43] op_sel_hi:[1,0]
v_pk_add_f32 v[230:231], v[230:231], s[42:43] op_sel_hi:[1,0]
v_rcp_f32 v224, v224
v_rcp_f32 v225, v225
v_rcp_f32 v226, v226
v_rcp_f32 v227, v227
v_rcp_f32 v228, v228
v_rcp_f32 v229, v229
v_rcp_f32 v230, v230
v_rcp_f32 v231, v231
v_pk_mul_f32 v[96:97], v[96:97], v[224:225]
v_pk_mul_f32 v[98:99], v[98:99], v[226:227]
v_pk_mul_f32 v[100:101], v[100:101], v[228:229]
v_pk_mul_f32 v[102:103], v[102:103], v[230:231]
v_cvt_pk_bf16_f32 v104, v96, v97
v_cvt_pk_bf16_f32 v105, v98, v99
v_cvt_pk_bf16_f32 v106, v100, v101
v_cvt_pk_bf16_f32 v107, v102, v103
buffer_store_dwordx4 v[104:107], v61, s[4:7], s38 offen offset:2048 sc1
v_accvgpr_read_b32 v112, a12
v_accvgpr_read_b32 v113, a13
v_accvgpr_read_b32 v114, a14
v_accvgpr_read_b32 v115, a15
v_accvgpr_read_b32 v116, a44
v_accvgpr_read_b32 v117, a45
v_accvgpr_read_b32 v118, a46
v_accvgpr_read_b32 v119, a47
v_pk_mul_f32 v[224:225], v[112:113], v[112:113]
v_pk_mul_f32 v[226:227], v[114:115], v[114:115]
v_pk_mul_f32 v[228:229], v[116:117], v[116:117]
v_pk_mul_f32 v[230:231], v[118:119], v[118:119]
v_pk_fma_f32 v[224:225], v[224:225], s[40:41], v[60:61] op_sel_hi:[1,0,0]
v_pk_fma_f32 v[226:227], v[226:227], s[40:41], v[60:61] op_sel_hi:[1,0,0]
v_pk_fma_f32 v[228:229], v[228:229], s[40:41], v[60:61] op_sel_hi:[1,0,0]
v_pk_fma_f32 v[230:231], v[230:231], s[40:41], v[60:61] op_sel_hi:[1,0,0]
v_pk_mul_f32 v[224:225], v[224:225], v[112:113]
v_pk_mul_f32 v[226:227], v[226:227], v[114:115]
v_pk_mul_f32 v[228:229], v[228:229], v[116:117]
v_pk_mul_f32 v[230:231], v[230:231], v[118:119]
v_exp_f32 v224, v224
v_exp_f32 v225, v225
v_exp_f32 v226, v226
v_exp_f32 v227, v227
v_exp_f32 v228, v228
v_exp_f32 v229, v229
v_exp_f32 v230, v230
v_exp_f32 v231, v231
v_pk_add_f32 v[224:225], v[224:225], s[42:43] op_sel_hi:[1,0]
v_pk_add_f32 v[226:227], v[226:227], s[42:43] op_sel_hi:[1,0]
v_pk_add_f32 v[228:229], v[228:229], s[42:43] op_sel_hi:[1,0]
v_pk_add_f32 v[230:231], v[230:231], s[42:43] op_sel_hi:[1,0]
v_rcp_f32 v224, v224
v_rcp_f32 v225, v225
v_rcp_f32 v226, v226
v_rcp_f32 v227, v227
v_rcp_f32 v228, v228
v_rcp_f32 v229, v229
v_rcp_f32 v230, v230
v_rcp_f32 v231, v231
v_pk_mul_f32 v[112:113], v[112:113], v[224:225]
v_pk_mul_f32 v[114:115], v[114:115], v[226:227]
v_pk_mul_f32 v[116:117], v[116:117], v[228:229]
v_pk_mul_f32 v[118:119], v[118:119], v[230:231]
v_cvt_pk_bf16_f32 v120, v112, v113
v_cvt_pk_bf16_f32 v121, v114, v115
v_cvt_pk_bf16_f32 v122, v116, v117
v_cvt_pk_bf16_f32 v123, v118, v119
buffer_store_dwordx4 v[120:123], v61, s[4:7], s38 offen offset:3072 sc1
s_add_u32 s38, s36, 4096
v_accvgpr_read_b32 v64, a16
v_accvgpr_read_b32 v65, a17
v_accvgpr_read_b32 v66, a18
v_accvgpr_read_b32 v67, a19
v_accvgpr_read_b32 v68, a48
v_accvgpr_read_b32 v69, a49
v_accvgpr_read_b32 v70, a50
v_accvgpr_read_b32 v71, a51
v_pk_mul_f32 v[224:225], v[64:65], v[64:65]
v_pk_mul_f32 v[226:227], v[66:67], v[66:67]
v_pk_mul_f32 v[228:229], v[68:69], v[68:69]
v_pk_mul_f32 v[230:231], v[70:71], v[70:71]
v_pk_fma_f32 v[224:225], v[224:225], s[40:41], v[60:61] op_sel_hi:[1,0,0]
v_pk_fma_f32 v[226:227], v[226:227], s[40:41], v[60:61] op_sel_hi:[1,0,0]
v_pk_fma_f32 v[228:229], v[228:229], s[40:41], v[60:61] op_sel_hi:[1,0,0]
v_pk_fma_f32 v[230:231], v[230:231], s[40:41], v[60:61] op_sel_hi:[1,0,0]
v_pk_mul_f32 v[224:225], v[224:225], v[64:65]
v_pk_mul_f32 v[226:227], v[226:227], v[66:67]
v_pk_mul_f32 v[228:229], v[228:229], v[68:69]
v_pk_mul_f32 v[230:231], v[230:231], v[70:71]
v_exp_f32 v224, v224
v_exp_f32 v225, v225
v_exp_f32 v226, v226
v_exp_f32 v227, v227
v_exp_f32 v228, v228
v_exp_f32 v229, v229
v_exp_f32 v230, v230
v_exp_f32 v231, v231
v_pk_add_f32 v[224:225], v[224:225], s[42:43] op_sel_hi:[1,0]
v_pk_add_f32 v[226:227], v[226:227], s[42:43] op_sel_hi:[1,0]
v_pk_add_f32 v[228:229], v[228:229], s[42:43] op_sel_hi:[1,0]
v_pk_add_f32 v[230:231], v[230:231], s[42:43] op_sel_hi:[1,0]
v_rcp_f32 v224, v224
v_rcp_f32 v225, v225
v_rcp_f32 v226, v226
v_rcp_f32 v227, v227
v_rcp_f32 v228, v228
v_rcp_f32 v229, v229
v_rcp_f32 v230, v230
v_rcp_f32 v231, v231
v_pk_mul_f32 v[64:65], v[64:65], v[224:225]
v_pk_mul_f32 v[66:67], v[66:67], v[226:227]
v_pk_mul_f32 v[68:69], v[68:69], v[228:229]
v_pk_mul_f32 v[70:71], v[70:71], v[230:231]
v_cvt_pk_bf16_f32 v72, v64, v65
v_cvt_pk_bf16_f32 v73, v66, v67
v_cvt_pk_bf16_f32 v74, v68, v69
v_cvt_pk_bf16_f32 v75, v70, v71
buffer_store_dwordx4 v[72:75], v61, s[4:7], s38 offen offset:0 sc1
v_accvgpr_read_b32 v80, a20
v_accvgpr_read_b32 v81, a21
v_accvgpr_read_b32 v82, a22
v_accvgpr_read_b32 v83, a23
v_accvgpr_read_b32 v84, a52
v_accvgpr_read_b32 v85, a53
v_accvgpr_read_b32 v86, a54
v_accvgpr_read_b32 v87, a55
v_pk_mul_f32 v[224:225], v[80:81], v[80:81]
v_pk_mul_f32 v[226:227], v[82:83], v[82:83]
v_pk_mul_f32 v[228:229], v[84:85], v[84:85]
v_pk_mul_f32 v[230:231], v[86:87], v[86:87]
v_pk_fma_f32 v[224:225], v[224:225], s[40:41], v[60:61] op_sel_hi:[1,0,0]
v_pk_fma_f32 v[226:227], v[226:227], s[40:41], v[60:61] op_sel_hi:[1,0,0]
v_pk_fma_f32 v[228:229], v[228:229], s[40:41], v[60:61] op_sel_hi:[1,0,0]
v_pk_fma_f32 v[230:231], v[230:231], s[40:41], v[60:61] op_sel_hi:[1,0,0]
v_pk_mul_f32 v[224:225], v[224:225], v[80:81]
v_pk_mul_f32 v[226:227], v[226:227], v[82:83]
v_pk_mul_f32 v[228:229], v[228:229], v[84:85]
v_pk_mul_f32 v[230:231], v[230:231], v[86:87]
v_exp_f32 v224, v224
v_exp_f32 v225, v225
v_exp_f32 v226, v226
v_exp_f32 v227, v227
v_exp_f32 v228, v228
v_exp_f32 v229, v229
v_exp_f32 v230, v230
v_exp_f32 v231, v231
v_pk_add_f32 v[224:225], v[224:225], s[42:43] op_sel_hi:[1,0]
v_pk_add_f32 v[226:227], v[226:227], s[42:43] op_sel_hi:[1,0]
v_pk_add_f32 v[228:229], v[228:229], s[42:43] op_sel_hi:[1,0]
v_pk_add_f32 v[230:231], v[230:231], s[42:43] op_sel_hi:[1,0]
v_rcp_f32 v224, v224
v_rcp_f32 v225, v225
v_rcp_f32 v226, v226
v_rcp_f32 v227, v227
v_rcp_f32 v228, v228
v_rcp_f32 v229, v229
v_rcp_f32 v230, v230
v_rcp_f32 v231, v231
v_pk_mul_f32 v[80:81], v[80:81], v[224:225]
v_pk_mul_f32 v[82:83], v[82:83], v[226:227]
v_pk_mul_f32 v[84:85], v[84:85], v[228:229]
v_pk_mul_f32 v[86:87], v[86:87], v[230:231]
v_cvt_pk_bf16_f32 v88, v80, v81
v_cvt_pk_bf16_f32 v89, v82, v83
v_cvt_pk_bf16_f32 v90, v84, v85
v_cvt_pk_bf16_f32 v91, v86, v87
buffer_store_dwordx4 v[88:91], v61, s[4:7], s38 offen offset:1024 sc1
v_accvgpr_read_b32 v96, a24
v_accvgpr_read_b32 v97, a25
v_accvgpr_read_b32 v98, a26
v_accvgpr_read_b32 v99, a27
v_accvgpr_read_b32 v100, a56
v_accvgpr_read_b32 v101, a57
v_accvgpr_read_b32 v102, a58
v_accvgpr_read_b32 v103, a59
v_pk_mul_f32 v[224:225], v[96:97], v[96:97]
v_pk_mul_f32 v[226:227], v[98:99], v[98:99]
v_pk_mul_f32 v[228:229], v[100:101], v[100:101]
v_pk_mul_f32 v[230:231], v[102:103], v[102:103]
v_pk_fma_f32 v[224:225], v[224:225], s[40:41], v[60:61] op_sel_hi:[1,0,0]
v_pk_fma_f32 v[226:227], v[226:227], s[40:41], v[60:61] op_sel_hi:[1,0,0]
v_pk_fma_f32 v[228:229], v[228:229], s[40:41], v[60:61] op_sel_hi:[1,0,0]
v_pk_fma_f32 v[230:231], v[230:231], s[40:41], v[60:61] op_sel_hi:[1,0,0]
v_pk_mul_f32 v[224:225], v[224:225], v[96:97]
v_pk_mul_f32 v[226:227], v[226:227], v[98:99]
v_pk_mul_f32 v[228:229], v[228:229], v[100:101]
v_pk_mul_f32 v[230:231], v[230:231], v[102:103]
v_exp_f32 v224, v224
v_exp_f32 v225, v225
v_exp_f32 v226, v226
v_exp_f32 v227, v227
v_exp_f32 v228, v228
v_exp_f32 v229, v229
v_exp_f32 v230, v230
v_exp_f32 v231, v231
v_pk_add_f32 v[224:225], v[224:225], s[42:43] op_sel_hi:[1,0]
v_pk_add_f32 v[226:227], v[226:227], s[42:43] op_sel_hi:[1,0]
v_pk_add_f32 v[228:229], v[228:229], s[42:43] op_sel_hi:[1,0]
v_pk_add_f32 v[230:231], v[230:231], s[42:43] op_sel_hi:[1,0]
v_rcp_f32 v224, v224
v_rcp_f32 v225, v225
v_rcp_f32 v226, v226
v_rcp_f32 v227, v227
v_rcp_f32 v228, v228
v_rcp_f32 v229, v229
v_rcp_f32 v230, v230
v_rcp_f32 v231, v231
v_pk_mul_f32 v[96:97], v[96:97], v[224:225]
v_pk_mul_f32 v[98:99], v[98:99], v[226:227]
v_pk_mul_f32 v[100:101], v[100:101], v[228:229]
v_pk_mul_f32 v[102:103], v[102:103], v[230:231]
v_cvt_pk_bf16_f32 v104, v96, v97
v_cvt_pk_bf16_f32 v105, v98, v99
v_cvt_pk_bf16_f32 v106, v100, v101
v_cvt_pk_bf16_f32 v107, v102, v103
buffer_store_dwordx4 v[104:107], v61, s[4:7], s38 offen offset:2048 sc1
v_accvgpr_read_b32 v112, a28
v_accvgpr_read_b32 v113, a29
v_accvgpr_read_b32 v114, a30
v_accvgpr_read_b32 v115, a31
v_accvgpr_read_b32 v116, a60
v_accvgpr_read_b32 v117, a61
v_accvgpr_read_b32 v118, a62
v_accvgpr_read_b32 v119, a63
v_pk_mul_f32 v[224:225], v[112:113], v[112:113]
v_pk_mul_f32 v[226:227], v[114:115], v[114:115]
v_pk_mul_f32 v[228:229], v[116:117], v[116:117]
v_pk_mul_f32 v[230:231], v[118:119], v[118:119]
v_pk_fma_f32 v[224:225], v[224:225], s[40:41], v[60:61] op_sel_hi:[1,0,0]
v_pk_fma_f32 v[226:227], v[226:227], s[40:41], v[60:61] op_sel_hi:[1,0,0]
v_pk_fma_f32 v[228:229], v[228:229], s[40:41], v[60:61] op_sel_hi:[1,0,0]
v_pk_fma_f32 v[230:231], v[230:231], s[40:41], v[60:61] op_sel_hi:[1,0,0]
v_pk_mul_f32 v[224:225], v[224:225], v[112:113]
v_pk_mul_f32 v[226:227], v[226:227], v[114:115]
v_pk_mul_f32 v[228:229], v[228:229], v[116:117]
v_pk_mul_f32 v[230:231], v[230:231], v[118:119]
v_exp_f32 v224, v224
v_exp_f32 v225, v225
v_exp_f32 v226, v226
v_exp_f32 v227, v227
v_exp_f32 v228, v228
v_exp_f32 v229, v229
v_exp_f32 v230, v230
v_exp_f32 v231, v231
v_pk_add_f32 v[224:225], v[224:225], s[42:43] op_sel_hi:[1,0]
v_pk_add_f32 v[226:227], v[226:227], s[42:43] op_sel_hi:[1,0]
v_pk_add_f32 v[228:229], v[228:229], s[42:43] op_sel_hi:[1,0]
v_pk_add_f32 v[230:231], v[230:231], s[42:43] op_sel_hi:[1,0]
v_rcp_f32 v224, v224
v_rcp_f32 v225, v225
v_rcp_f32 v226, v226
v_rcp_f32 v227, v227
v_rcp_f32 v228, v228
v_rcp_f32 v229, v229
v_rcp_f32 v230, v230
v_rcp_f32 v231, v231
v_pk_mul_f32 v[112:113], v[112:113], v[224:225]
v_pk_mul_f32 v[114:115], v[114:115], v[226:227]
v_pk_mul_f32 v[116:117], v[116:117], v[228:229]
v_pk_mul_f32 v[118:119], v[118:119], v[230:231]
v_cvt_pk_bf16_f32 v120, v112, v113
v_cvt_pk_bf16_f32 v121, v114, v115
v_cvt_pk_bf16_f32 v122, v116, v117
v_cvt_pk_bf16_f32 v123, v118, v119
buffer_store_dwordx4 v[120:123], v61, s[4:7], s38 offen offset:3072 sc1
s_add_u32 s38, s36, 16384
v_accvgpr_read_b32 v64, a64
v_accvgpr_read_b32 v65, a65
v_accvgpr_read_b32 v66, a66
v_accvgpr_read_b32 v67, a67
v_accvgpr_read_b32 v68, a96
v_accvgpr_read_b32 v69, a97
v_accvgpr_read_b32 v70, a98
v_accvgpr_read_b32 v71, a99
v_pk_mul_f32 v[224:225], v[64:65], v[64:65]
v_pk_mul_f32 v[226:227], v[66:67], v[66:67]
v_pk_mul_f32 v[228:229], v[68:69], v[68:69]
v_pk_mul_f32 v[230:231], v[70:71], v[70:71]
v_pk_fma_f32 v[224:225], v[224:225], s[40:41], v[60:61] op_sel_hi:[1,0,0]
v_pk_fma_f32 v[226:227], v[226:227], s[40:41], v[60:61] op_sel_hi:[1,0,0]
v_pk_fma_f32 v[228:229], v[228:229], s[40:41], v[60:61] op_sel_hi:[1,0,0]
v_pk_fma_f32 v[230:231], v[230:231], s[40:41], v[60:61] op_sel_hi:[1,0,0]
v_pk_mul_f32 v[224:225], v[224:225], v[64:65]
v_pk_mul_f32 v[226:227], v[226:227], v[66:67]
v_pk_mul_f32 v[228:229], v[228:229], v[68:69]
v_pk_mul_f32 v[230:231], v[230:231], v[70:71]
v_exp_f32 v224, v224
v_exp_f32 v225, v225
v_exp_f32 v226, v226
v_exp_f32 v227, v227
v_exp_f32 v228, v228
v_exp_f32 v229, v229
v_exp_f32 v230, v230
v_exp_f32 v231, v231
v_pk_add_f32 v[224:225], v[224:225], s[42:43] op_sel_hi:[1,0]
v_pk_add_f32 v[226:227], v[226:227], s[42:43] op_sel_hi:[1,0]
v_pk_add_f32 v[228:229], v[228:229], s[42:43] op_sel_hi:[1,0]
v_pk_add_f32 v[230:231], v[230:231], s[42:43] op_sel_hi:[1,0]
v_rcp_f32 v224, v224
v_rcp_f32 v225, v225
v_rcp_f32 v226, v226
v_rcp_f32 v227, v227
v_rcp_f32 v228, v228
v_rcp_f32 v229, v229
v_rcp_f32 v230, v230
v_rcp_f32 v231, v231
v_pk_mul_f32 v[64:65], v[64:65], v[224:225]
v_pk_mul_f32 v[66:67], v[66:67], v[226:227]
v_pk_mul_f32 v[68:69], v[68:69], v[228:229]
v_pk_mul_f32 v[70:71], v[70:71], v[230:231]
v_cvt_pk_bf16_f32 v72, v64, v65
v_cvt_pk_bf16_f32 v73, v66, v67
v_cvt_pk_bf16_f32 v74, v68, v69
v_cvt_pk_bf16_f32 v75, v70, v71
buffer_store_dwordx4 v[72:75], v61, s[4:7], s38 offen offset:0 sc1
v_accvgpr_read_b32 v80, a68
v_accvgpr_read_b32 v81, a69
v_accvgpr_read_b32 v82, a70
v_accvgpr_read_b32 v83, a71
v_accvgpr_read_b32 v84, a100
v_accvgpr_read_b32 v85, a101
v_accvgpr_read_b32 v86, a102
v_accvgpr_read_b32 v87, a103
v_pk_mul_f32 v[224:225], v[80:81], v[80:81]
v_pk_mul_f32 v[226:227], v[82:83], v[82:83]
v_pk_mul_f32 v[228:229], v[84:85], v[84:85]
v_pk_mul_f32 v[230:231], v[86:87], v[86:87]
v_pk_fma_f32 v[224:225], v[224:225], s[40:41], v[60:61] op_sel_hi:[1,0,0]
v_pk_fma_f32 v[226:227], v[226:227], s[40:41], v[60:61] op_sel_hi:[1,0,0]
v_pk_fma_f32 v[228:229], v[228:229], s[40:41], v[60:61] op_sel_hi:[1,0,0]
v_pk_fma_f32 v[230:231], v[230:231], s[40:41], v[60:61] op_sel_hi:[1,0,0]
v_pk_mul_f32 v[224:225], v[224:225], v[80:81]
v_pk_mul_f32 v[226:227], v[226:227], v[82:83]
v_pk_mul_f32 v[228:229], v[228:229], v[84:85]
v_pk_mul_f32 v[230:231], v[230:231], v[86:87]
v_exp_f32 v224, v224
v_exp_f32 v225, v225
v_exp_f32 v226, v226
v_exp_f32 v227, v227
v_exp_f32 v228, v228
v_exp_f32 v229, v229
v_exp_f32 v230, v230
v_exp_f32 v231, v231
v_pk_add_f32 v[224:225], v[224:225], s[42:43] op_sel_hi:[1,0]
v_pk_add_f32 v[226:227], v[226:227], s[42:43] op_sel_hi:[1,0]
v_pk_add_f32 v[228:229], v[228:229], s[42:43] op_sel_hi:[1,0]
v_pk_add_f32 v[230:231], v[230:231], s[42:43] op_sel_hi:[1,0]
v_rcp_f32 v224, v224
v_rcp_f32 v225, v225
v_rcp_f32 v226, v226
v_rcp_f32 v227, v227
v_rcp_f32 v228, v228
v_rcp_f32 v229, v229
v_rcp_f32 v230, v230
v_rcp_f32 v231, v231
v_pk_mul_f32 v[80:81], v[80:81], v[224:225]
v_pk_mul_f32 v[82:83], v[82:83], v[226:227]
v_pk_mul_f32 v[84:85], v[84:85], v[228:229]
v_pk_mul_f32 v[86:87], v[86:87], v[230:231]
v_cvt_pk_bf16_f32 v88, v80, v81
v_cvt_pk_bf16_f32 v89, v82, v83
v_cvt_pk_bf16_f32 v90, v84, v85
v_cvt_pk_bf16_f32 v91, v86, v87
buffer_store_dwordx4 v[88:91], v61, s[4:7], s38 offen offset:1024 sc1
v_accvgpr_read_b32 v96, a72
v_accvgpr_read_b32 v97, a73
v_accvgpr_read_b32 v98, a74
v_accvgpr_read_b32 v99, a75
v_accvgpr_read_b32 v100, a104
v_accvgpr_read_b32 v101, a105
v_accvgpr_read_b32 v102, a106
v_accvgpr_read_b32 v103, a107
v_pk_mul_f32 v[224:225], v[96:97], v[96:97]
v_pk_mul_f32 v[226:227], v[98:99], v[98:99]
v_pk_mul_f32 v[228:229], v[100:101], v[100:101]
v_pk_mul_f32 v[230:231], v[102:103], v[102:103]
v_pk_fma_f32 v[224:225], v[224:225], s[40:41], v[60:61] op_sel_hi:[1,0,0]
v_pk_fma_f32 v[226:227], v[226:227], s[40:41], v[60:61] op_sel_hi:[1,0,0]
v_pk_fma_f32 v[228:229], v[228:229], s[40:41], v[60:61] op_sel_hi:[1,0,0]
v_pk_fma_f32 v[230:231], v[230:231], s[40:41], v[60:61] op_sel_hi:[1,0,0]
v_pk_mul_f32 v[224:225], v[224:225], v[96:97]
v_pk_mul_f32 v[226:227], v[226:227], v[98:99]
v_pk_mul_f32 v[228:229], v[228:229], v[100:101]
v_pk_mul_f32 v[230:231], v[230:231], v[102:103]
v_exp_f32 v224, v224
v_exp_f32 v225, v225
v_exp_f32 v226, v226
v_exp_f32 v227, v227
v_exp_f32 v228, v228
v_exp_f32 v229, v229
v_exp_f32 v230, v230
v_exp_f32 v231, v231
v_pk_add_f32 v[224:225], v[224:225], s[42:43] op_sel_hi:[1,0]
v_pk_add_f32 v[226:227], v[226:227], s[42:43] op_sel_hi:[1,0]
v_pk_add_f32 v[228:229], v[228:229], s[42:43] op_sel_hi:[1,0]
v_pk_add_f32 v[230:231], v[230:231], s[42:43] op_sel_hi:[1,0]
v_rcp_f32 v224, v224
v_rcp_f32 v225, v225
v_rcp_f32 v226, v226
v_rcp_f32 v227, v227
v_rcp_f32 v228, v228
v_rcp_f32 v229, v229
v_rcp_f32 v230, v230
v_rcp_f32 v231, v231
v_pk_mul_f32 v[96:97], v[96:97], v[224:225]
v_pk_mul_f32 v[98:99], v[98:99], v[226:227]
v_pk_mul_f32 v[100:101], v[100:101], v[228:229]
v_pk_mul_f32 v[102:103], v[102:103], v[230:231]
v_cvt_pk_bf16_f32 v104, v96, v97
v_cvt_pk_bf16_f32 v105, v98, v99
v_cvt_pk_bf16_f32 v106, v100, v101
v_cvt_pk_bf16_f32 v107, v102, v103
buffer_store_dwordx4 v[104:107], v61, s[4:7], s38 offen offset:2048 sc1
v_accvgpr_read_b32 v112, a76
v_accvgpr_read_b32 v113, a77
v_accvgpr_read_b32 v114, a78
v_accvgpr_read_b32 v115, a79
v_accvgpr_read_b32 v116, a108
v_accvgpr_read_b32 v117, a109
v_accvgpr_read_b32 v118, a110
v_accvgpr_read_b32 v119, a111
v_pk_mul_f32 v[224:225], v[112:113], v[112:113]
v_pk_mul_f32 v[226:227], v[114:115], v[114:115]
v_pk_mul_f32 v[228:229], v[116:117], v[116:117]
v_pk_mul_f32 v[230:231], v[118:119], v[118:119]
v_pk_fma_f32 v[224:225], v[224:225], s[40:41], v[60:61] op_sel_hi:[1,0,0]
v_pk_fma_f32 v[226:227], v[226:227], s[40:41], v[60:61] op_sel_hi:[1,0,0]
v_pk_fma_f32 v[228:229], v[228:229], s[40:41], v[60:61] op_sel_hi:[1,0,0]
v_pk_fma_f32 v[230:231], v[230:231], s[40:41], v[60:61] op_sel_hi:[1,0,0]
v_pk_mul_f32 v[224:225], v[224:225], v[112:113]
v_pk_mul_f32 v[226:227], v[226:227], v[114:115]
v_pk_mul_f32 v[228:229], v[228:229], v[116:117]
v_pk_mul_f32 v[230:231], v[230:231], v[118:119]
v_exp_f32 v224, v224
v_exp_f32 v225, v225
v_exp_f32 v226, v226
v_exp_f32 v227, v227
v_exp_f32 v228, v228
v_exp_f32 v229, v229
v_exp_f32 v230, v230
v_exp_f32 v231, v231
v_pk_add_f32 v[224:225], v[224:225], s[42:43] op_sel_hi:[1,0]
v_pk_add_f32 v[226:227], v[226:227], s[42:43] op_sel_hi:[1,0]
v_pk_add_f32 v[228:229], v[228:229], s[42:43] op_sel_hi:[1,0]
v_pk_add_f32 v[230:231], v[230:231], s[42:43] op_sel_hi:[1,0]
v_rcp_f32 v224, v224
v_rcp_f32 v225, v225
v_rcp_f32 v226, v226
v_rcp_f32 v227, v227
v_rcp_f32 v228, v228
v_rcp_f32 v229, v229
v_rcp_f32 v230, v230
v_rcp_f32 v231, v231
v_pk_mul_f32 v[112:113], v[112:113], v[224:225]
v_pk_mul_f32 v[114:115], v[114:115], v[226:227]
v_pk_mul_f32 v[116:117], v[116:117], v[228:229]
v_pk_mul_f32 v[118:119], v[118:119], v[230:231]
v_cvt_pk_bf16_f32 v120, v112, v113
v_cvt_pk_bf16_f32 v121, v114, v115
v_cvt_pk_bf16_f32 v122, v116, v117
v_cvt_pk_bf16_f32 v123, v118, v119
buffer_store_dwordx4 v[120:123], v61, s[4:7], s38 offen offset:3072 sc1
s_add_u32 s38, s36, 20480
v_accvgpr_read_b32 v64, a80
v_accvgpr_read_b32 v65, a81
v_accvgpr_read_b32 v66, a82
v_accvgpr_read_b32 v67, a83
v_accvgpr_read_b32 v68, a112
v_accvgpr_read_b32 v69, a113
v_accvgpr_read_b32 v70, a114
v_accvgpr_read_b32 v71, a115
v_pk_mul_f32 v[224:225], v[64:65], v[64:65]
v_pk_mul_f32 v[226:227], v[66:67], v[66:67]
v_pk_mul_f32 v[228:229], v[68:69], v[68:69]
v_pk_mul_f32 v[230:231], v[70:71], v[70:71]
v_pk_fma_f32 v[224:225], v[224:225], s[40:41], v[60:61] op_sel_hi:[1,0,0]
v_pk_fma_f32 v[226:227], v[226:227], s[40:41], v[60:61] op_sel_hi:[1,0,0]
v_pk_fma_f32 v[228:229], v[228:229], s[40:41], v[60:61] op_sel_hi:[1,0,0]
v_pk_fma_f32 v[230:231], v[230:231], s[40:41], v[60:61] op_sel_hi:[1,0,0]
v_pk_mul_f32 v[224:225], v[224:225], v[64:65]
v_pk_mul_f32 v[226:227], v[226:227], v[66:67]
v_pk_mul_f32 v[228:229], v[228:229], v[68:69]
v_pk_mul_f32 v[230:231], v[230:231], v[70:71]
v_exp_f32 v224, v224
v_exp_f32 v225, v225
v_exp_f32 v226, v226
v_exp_f32 v227, v227
v_exp_f32 v228, v228
v_exp_f32 v229, v229
v_exp_f32 v230, v230
v_exp_f32 v231, v231
v_pk_add_f32 v[224:225], v[224:225], s[42:43] op_sel_hi:[1,0]
v_pk_add_f32 v[226:227], v[226:227], s[42:43] op_sel_hi:[1,0]
v_pk_add_f32 v[228:229], v[228:229], s[42:43] op_sel_hi:[1,0]
v_pk_add_f32 v[230:231], v[230:231], s[42:43] op_sel_hi:[1,0]
v_rcp_f32 v224, v224
v_rcp_f32 v225, v225
v_rcp_f32 v226, v226
v_rcp_f32 v227, v227
v_rcp_f32 v228, v228
v_rcp_f32 v229, v229
v_rcp_f32 v230, v230
v_rcp_f32 v231, v231
v_pk_mul_f32 v[64:65], v[64:65], v[224:225]
v_pk_mul_f32 v[66:67], v[66:67], v[226:227]
v_pk_mul_f32 v[68:69], v[68:69], v[228:229]
v_pk_mul_f32 v[70:71], v[70:71], v[230:231]
v_cvt_pk_bf16_f32 v72, v64, v65
v_cvt_pk_bf16_f32 v73, v66, v67
v_cvt_pk_bf16_f32 v74, v68, v69
v_cvt_pk_bf16_f32 v75, v70, v71
buffer_store_dwordx4 v[72:75], v61, s[4:7], s38 offen offset:0 sc1
v_accvgpr_read_b32 v80, a84
v_accvgpr_read_b32 v81, a85
v_accvgpr_read_b32 v82, a86
v_accvgpr_read_b32 v83, a87
v_accvgpr_read_b32 v84, a116
v_accvgpr_read_b32 v85, a117
v_accvgpr_read_b32 v86, a118
v_accvgpr_read_b32 v87, a119
v_pk_mul_f32 v[224:225], v[80:81], v[80:81]
v_pk_mul_f32 v[226:227], v[82:83], v[82:83]
v_pk_mul_f32 v[228:229], v[84:85], v[84:85]
v_pk_mul_f32 v[230:231], v[86:87], v[86:87]
v_pk_fma_f32 v[224:225], v[224:225], s[40:41], v[60:61] op_sel_hi:[1,0,0]
v_pk_fma_f32 v[226:227], v[226:227], s[40:41], v[60:61] op_sel_hi:[1,0,0]
v_pk_fma_f32 v[228:229], v[228:229], s[40:41], v[60:61] op_sel_hi:[1,0,0]
v_pk_fma_f32 v[230:231], v[230:231], s[40:41], v[60:61] op_sel_hi:[1,0,0]
v_pk_mul_f32 v[224:225], v[224:225], v[80:81]
v_pk_mul_f32 v[226:227], v[226:227], v[82:83]
v_pk_mul_f32 v[228:229], v[228:229], v[84:85]
v_pk_mul_f32 v[230:231], v[230:231], v[86:87]
v_exp_f32 v224, v224
v_exp_f32 v225, v225
v_exp_f32 v226, v226
v_exp_f32 v227, v227
v_exp_f32 v228, v228
v_exp_f32 v229, v229
v_exp_f32 v230, v230
v_exp_f32 v231, v231
v_pk_add_f32 v[224:225], v[224:225], s[42:43] op_sel_hi:[1,0]
v_pk_add_f32 v[226:227], v[226:227], s[42:43] op_sel_hi:[1,0]
v_pk_add_f32 v[228:229], v[228:229], s[42:43] op_sel_hi:[1,0]
v_pk_add_f32 v[230:231], v[230:231], s[42:43] op_sel_hi:[1,0]
v_rcp_f32 v224, v224
v_rcp_f32 v225, v225
v_rcp_f32 v226, v226
v_rcp_f32 v227, v227
v_rcp_f32 v228, v228
v_rcp_f32 v229, v229
v_rcp_f32 v230, v230
v_rcp_f32 v231, v231
v_pk_mul_f32 v[80:81], v[80:81], v[224:225]
v_pk_mul_f32 v[82:83], v[82:83], v[226:227]
v_pk_mul_f32 v[84:85], v[84:85], v[228:229]
v_pk_mul_f32 v[86:87], v[86:87], v[230:231]
v_cvt_pk_bf16_f32 v88, v80, v81
v_cvt_pk_bf16_f32 v89, v82, v83
v_cvt_pk_bf16_f32 v90, v84, v85
v_cvt_pk_bf16_f32 v91, v86, v87
buffer_store_dwordx4 v[88:91], v61, s[4:7], s38 offen offset:1024 sc1
v_accvgpr_read_b32 v96, a88
v_accvgpr_read_b32 v97, a89
v_accvgpr_read_b32 v98, a90
v_accvgpr_read_b32 v99, a91
v_accvgpr_read_b32 v100, a120
v_accvgpr_read_b32 v101, a121
v_accvgpr_read_b32 v102, a122
v_accvgpr_read_b32 v103, a123
v_pk_mul_f32 v[224:225], v[96:97], v[96:97]
v_pk_mul_f32 v[226:227], v[98:99], v[98:99]
v_pk_mul_f32 v[228:229], v[100:101], v[100:101]
v_pk_mul_f32 v[230:231], v[102:103], v[102:103]
v_pk_fma_f32 v[224:225], v[224:225], s[40:41], v[60:61] op_sel_hi:[1,0,0]
v_pk_fma_f32 v[226:227], v[226:227], s[40:41], v[60:61] op_sel_hi:[1,0,0]
v_pk_fma_f32 v[228:229], v[228:229], s[40:41], v[60:61] op_sel_hi:[1,0,0]
v_pk_fma_f32 v[230:231], v[230:231], s[40:41], v[60:61] op_sel_hi:[1,0,0]
v_pk_mul_f32 v[224:225], v[224:225], v[96:97]
v_pk_mul_f32 v[226:227], v[226:227], v[98:99]
v_pk_mul_f32 v[228:229], v[228:229], v[100:101]
v_pk_mul_f32 v[230:231], v[230:231], v[102:103]
v_exp_f32 v224, v224
v_exp_f32 v225, v225
v_exp_f32 v226, v226
v_exp_f32 v227, v227
v_exp_f32 v228, v228
v_exp_f32 v229, v229
v_exp_f32 v230, v230
v_exp_f32 v231, v231
v_pk_add_f32 v[224:225], v[224:225], s[42:43] op_sel_hi:[1,0]
v_pk_add_f32 v[226:227], v[226:227], s[42:43] op_sel_hi:[1,0]
v_pk_add_f32 v[228:229], v[228:229], s[42:43] op_sel_hi:[1,0]
v_pk_add_f32 v[230:231], v[230:231], s[42:43] op_sel_hi:[1,0]
v_rcp_f32 v224, v224
v_rcp_f32 v225, v225
v_rcp_f32 v226, v226
v_rcp_f32 v227, v227
v_rcp_f32 v228, v228
v_rcp_f32 v229, v229
v_rcp_f32 v230, v230
v_rcp_f32 v231, v231
v_pk_mul_f32 v[96:97], v[96:97], v[224:225]
v_pk_mul_f32 v[98:99], v[98:99], v[226:227]
v_pk_mul_f32 v[100:101], v[100:101], v[228:229]
v_pk_mul_f32 v[102:103], v[102:103], v[230:231]
v_cvt_pk_bf16_f32 v104, v96, v97
v_cvt_pk_bf16_f32 v105, v98, v99
v_cvt_pk_bf16_f32 v106, v100, v101
v_cvt_pk_bf16_f32 v107, v102, v103
buffer_store_dwordx4 v[104:107], v61, s[4:7], s38 offen offset:2048 sc1
v_accvgpr_read_b32 v112, a92
v_accvgpr_read_b32 v113, a93
v_accvgpr_read_b32 v114, a94
v_accvgpr_read_b32 v115, a95
v_accvgpr_read_b32 v116, a124
v_accvgpr_read_b32 v117, a125
v_accvgpr_read_b32 v118, a126
v_accvgpr_read_b32 v119, a127
v_pk_mul_f32 v[224:225], v[112:113], v[112:113]
v_pk_mul_f32 v[226:227], v[114:115], v[114:115]
v_pk_mul_f32 v[228:229], v[116:117], v[116:117]
v_pk_mul_f32 v[230:231], v[118:119], v[118:119]
v_pk_fma_f32 v[224:225], v[224:225], s[40:41], v[60:61] op_sel_hi:[1,0,0]
v_pk_fma_f32 v[226:227], v[226:227], s[40:41], v[60:61] op_sel_hi:[1,0,0]
v_pk_fma_f32 v[228:229], v[228:229], s[40:41], v[60:61] op_sel_hi:[1,0,0]
v_pk_fma_f32 v[230:231], v[230:231], s[40:41], v[60:61] op_sel_hi:[1,0,0]
v_pk_mul_f32 v[224:225], v[224:225], v[112:113]
v_pk_mul_f32 v[226:227], v[226:227], v[114:115]
v_pk_mul_f32 v[228:229], v[228:229], v[116:117]
v_pk_mul_f32 v[230:231], v[230:231], v[118:119]
v_exp_f32 v224, v224
v_exp_f32 v225, v225
v_exp_f32 v226, v226
v_exp_f32 v227, v227
v_exp_f32 v228, v228
v_exp_f32 v229, v229
v_exp_f32 v230, v230
v_exp_f32 v231, v231
v_pk_add_f32 v[224:225], v[224:225], s[42:43] op_sel_hi:[1,0]
v_pk_add_f32 v[226:227], v[226:227], s[42:43] op_sel_hi:[1,0]
v_pk_add_f32 v[228:229], v[228:229], s[42:43] op_sel_hi:[1,0]
v_pk_add_f32 v[230:231], v[230:231], s[42:43] op_sel_hi:[1,0]
v_rcp_f32 v224, v224
v_rcp_f32 v225, v225
v_rcp_f32 v226, v226
v_rcp_f32 v227, v227
v_rcp_f32 v228, v228
v_rcp_f32 v229, v229
v_rcp_f32 v230, v230
v_rcp_f32 v231, v231
v_pk_mul_f32 v[112:113], v[112:113], v[224:225]
v_pk_mul_f32 v[114:115], v[114:115], v[226:227]
v_pk_mul_f32 v[116:117], v[116:117], v[228:229]
v_pk_mul_f32 v[118:119], v[118:119], v[230:231]
v_cvt_pk_bf16_f32 v120, v112, v113
v_cvt_pk_bf16_f32 v121, v114, v115
v_cvt_pk_bf16_f32 v122, v116, v117
v_cvt_pk_bf16_f32 v123, v118, v119
buffer_store_dwordx4 v[120:123], v61, s[4:7], s38 offen offset:3072 sc1
s_add_u32 s38, s36, 32768
v_accvgpr_read_b32 v64, a128
v_accvgpr_read_b32 v65, a129
v_accvgpr_read_b32 v66, a130
v_accvgpr_read_b32 v67, a131
v_accvgpr_read_b32 v68, a160
v_accvgpr_read_b32 v69, a161
v_accvgpr_read_b32 v70, a162
v_accvgpr_read_b32 v71, a163
v_pk_mul_f32 v[224:225], v[64:65], v[64:65]
v_pk_mul_f32 v[226:227], v[66:67], v[66:67]
v_pk_mul_f32 v[228:229], v[68:69], v[68:69]
v_pk_mul_f32 v[230:231], v[70:71], v[70:71]
v_pk_fma_f32 v[224:225], v[224:225], s[40:41], v[60:61] op_sel_hi:[1,0,0]
v_pk_fma_f32 v[226:227], v[226:227], s[40:41], v[60:61] op_sel_hi:[1,0,0]
v_pk_fma_f32 v[228:229], v[228:229], s[40:41], v[60:61] op_sel_hi:[1,0,0]
v_pk_fma_f32 v[230:231], v[230:231], s[40:41], v[60:61] op_sel_hi:[1,0,0]
v_pk_mul_f32 v[224:225], v[224:225], v[64:65]
v_pk_mul_f32 v[226:227], v[226:227], v[66:67]
v_pk_mul_f32 v[228:229], v[228:229], v[68:69]
v_pk_mul_f32 v[230:231], v[230:231], v[70:71]
v_exp_f32 v224, v224
v_exp_f32 v225, v225
v_exp_f32 v226, v226
v_exp_f32 v227, v227
v_exp_f32 v228, v228
v_exp_f32 v229, v229
v_exp_f32 v230, v230
v_exp_f32 v231, v231
v_pk_add_f32 v[224:225], v[224:225], s[42:43] op_sel_hi:[1,0]
v_pk_add_f32 v[226:227], v[226:227], s[42:43] op_sel_hi:[1,0]
v_pk_add_f32 v[228:229], v[228:229], s[42:43] op_sel_hi:[1,0]
v_pk_add_f32 v[230:231], v[230:231], s[42:43] op_sel_hi:[1,0]
v_rcp_f32 v224, v224
v_rcp_f32 v225, v225
v_rcp_f32 v226, v226
v_rcp_f32 v227, v227
v_rcp_f32 v228, v228
v_rcp_f32 v229, v229
v_rcp_f32 v230, v230
v_rcp_f32 v231, v231
v_pk_mul_f32 v[64:65], v[64:65], v[224:225]
v_pk_mul_f32 v[66:67], v[66:67], v[226:227]
v_pk_mul_f32 v[68:69], v[68:69], v[228:229]
v_pk_mul_f32 v[70:71], v[70:71], v[230:231]
v_cvt_pk_bf16_f32 v72, v64, v65
v_cvt_pk_bf16_f32 v73, v66, v67
v_cvt_pk_bf16_f32 v74, v68, v69
v_cvt_pk_bf16_f32 v75, v70, v71
buffer_store_dwordx4 v[72:75], v61, s[4:7], s38 offen offset:0 sc1
v_accvgpr_read_b32 v80, a132
v_accvgpr_read_b32 v81, a133
v_accvgpr_read_b32 v82, a134
v_accvgpr_read_b32 v83, a135
v_accvgpr_read_b32 v84, a164
v_accvgpr_read_b32 v85, a165
v_accvgpr_read_b32 v86, a166
v_accvgpr_read_b32 v87, a167
v_pk_mul_f32 v[224:225], v[80:81], v[80:81]
v_pk_mul_f32 v[226:227], v[82:83], v[82:83]
v_pk_mul_f32 v[228:229], v[84:85], v[84:85]
v_pk_mul_f32 v[230:231], v[86:87], v[86:87]
v_pk_fma_f32 v[224:225], v[224:225], s[40:41], v[60:61] op_sel_hi:[1,0,0]
v_pk_fma_f32 v[226:227], v[226:227], s[40:41], v[60:61] op_sel_hi:[1,0,0]
v_pk_fma_f32 v[228:229], v[228:229], s[40:41], v[60:61] op_sel_hi:[1,0,0]
v_pk_fma_f32 v[230:231], v[230:231], s[40:41], v[60:61] op_sel_hi:[1,0,0]
v_pk_mul_f32 v[224:225], v[224:225], v[80:81]
v_pk_mul_f32 v[226:227], v[226:227], v[82:83]
v_pk_mul_f32 v[228:229], v[228:229], v[84:85]
v_pk_mul_f32 v[230:231], v[230:231], v[86:87]
v_exp_f32 v224, v224
v_exp_f32 v225, v225
v_exp_f32 v226, v226
v_exp_f32 v227, v227
v_exp_f32 v228, v228
v_exp_f32 v229, v229
v_exp_f32 v230, v230
v_exp_f32 v231, v231
v_pk_add_f32 v[224:225], v[224:225], s[42:43] op_sel_hi:[1,0]
v_pk_add_f32 v[226:227], v[226:227], s[42:43] op_sel_hi:[1,0]
v_pk_add_f32 v[228:229], v[228:229], s[42:43] op_sel_hi:[1,0]
v_pk_add_f32 v[230:231], v[230:231], s[42:43] op_sel_hi:[1,0]
v_rcp_f32 v224, v224
v_rcp_f32 v225, v225
v_rcp_f32 v226, v226
v_rcp_f32 v227, v227
v_rcp_f32 v228, v228
v_rcp_f32 v229, v229
v_rcp_f32 v230, v230
v_rcp_f32 v231, v231
v_pk_mul_f32 v[80:81], v[80:81], v[224:225]
v_pk_mul_f32 v[82:83], v[82:83], v[226:227]
v_pk_mul_f32 v[84:85], v[84:85], v[228:229]
v_pk_mul_f32 v[86:87], v[86:87], v[230:231]
v_cvt_pk_bf16_f32 v88, v80, v81
v_cvt_pk_bf16_f32 v89, v82, v83
v_cvt_pk_bf16_f32 v90, v84, v85
v_cvt_pk_bf16_f32 v91, v86, v87
buffer_store_dwordx4 v[88:91], v61, s[4:7], s38 offen offset:1024 sc1
v_accvgpr_read_b32 v96, a136
v_accvgpr_read_b32 v97, a137
v_accvgpr_read_b32 v98, a138
v_accvgpr_read_b32 v99, a139
v_accvgpr_read_b32 v100, a168
v_accvgpr_read_b32 v101, a169
v_accvgpr_read_b32 v102, a170
v_accvgpr_read_b32 v103, a171
v_pk_mul_f32 v[224:225], v[96:97], v[96:97]
v_pk_mul_f32 v[226:227], v[98:99], v[98:99]
v_pk_mul_f32 v[228:229], v[100:101], v[100:101]
v_pk_mul_f32 v[230:231], v[102:103], v[102:103]
v_pk_fma_f32 v[224:225], v[224:225], s[40:41], v[60:61] op_sel_hi:[1,0,0]
v_pk_fma_f32 v[226:227], v[226:227], s[40:41], v[60:61] op_sel_hi:[1,0,0]
v_pk_fma_f32 v[228:229], v[228:229], s[40:41], v[60:61] op_sel_hi:[1,0,0]
v_pk_fma_f32 v[230:231], v[230:231], s[40:41], v[60:61] op_sel_hi:[1,0,0]
v_pk_mul_f32 v[224:225], v[224:225], v[96:97]
v_pk_mul_f32 v[226:227], v[226:227], v[98:99]
v_pk_mul_f32 v[228:229], v[228:229], v[100:101]
v_pk_mul_f32 v[230:231], v[230:231], v[102:103]
v_exp_f32 v224, v224
v_exp_f32 v225, v225
v_exp_f32 v226, v226
v_exp_f32 v227, v227
v_exp_f32 v228, v228
v_exp_f32 v229, v229
v_exp_f32 v230, v230
v_exp_f32 v231, v231
v_pk_add_f32 v[224:225], v[224:225], s[42:43] op_sel_hi:[1,0]
v_pk_add_f32 v[226:227], v[226:227], s[42:43] op_sel_hi:[1,0]
v_pk_add_f32 v[228:229], v[228:229], s[42:43] op_sel_hi:[1,0]
v_pk_add_f32 v[230:231], v[230:231], s[42:43] op_sel_hi:[1,0]
v_rcp_f32 v224, v224
v_rcp_f32 v225, v225
v_rcp_f32 v226, v226
v_rcp_f32 v227, v227
v_rcp_f32 v228, v228
v_rcp_f32 v229, v229
v_rcp_f32 v230, v230
v_rcp_f32 v231, v231
v_pk_mul_f32 v[96:97], v[96:97], v[224:225]
v_pk_mul_f32 v[98:99], v[98:99], v[226:227]
v_pk_mul_f32 v[100:101], v[100:101], v[228:229]
v_pk_mul_f32 v[102:103], v[102:103], v[230:231]
v_cvt_pk_bf16_f32 v104, v96, v97
v_cvt_pk_bf16_f32 v105, v98, v99
v_cvt_pk_bf16_f32 v106, v100, v101
v_cvt_pk_bf16_f32 v107, v102, v103
buffer_store_dwordx4 v[104:107], v61, s[4:7], s38 offen offset:2048 sc1
v_accvgpr_read_b32 v112, a140
v_accvgpr_read_b32 v113, a141
v_accvgpr_read_b32 v114, a142
v_accvgpr_read_b32 v115, a143
v_accvgpr_read_b32 v116, a172
v_accvgpr_read_b32 v117, a173
v_accvgpr_read_b32 v118, a174
v_accvgpr_read_b32 v119, a175
v_pk_mul_f32 v[224:225], v[112:113], v[112:113]
v_pk_mul_f32 v[226:227], v[114:115], v[114:115]
v_pk_mul_f32 v[228:229], v[116:117], v[116:117]
v_pk_mul_f32 v[230:231], v[118:119], v[118:119]
v_pk_fma_f32 v[224:225], v[224:225], s[40:41], v[60:61] op_sel_hi:[1,0,0]
v_pk_fma_f32 v[226:227], v[226:227], s[40:41], v[60:61] op_sel_hi:[1,0,0]
v_pk_fma_f32 v[228:229], v[228:229], s[40:41], v[60:61] op_sel_hi:[1,0,0]
v_pk_fma_f32 v[230:231], v[230:231], s[40:41], v[60:61] op_sel_hi:[1,0,0]
v_pk_mul_f32 v[224:225], v[224:225], v[112:113]
v_pk_mul_f32 v[226:227], v[226:227], v[114:115]
v_pk_mul_f32 v[228:229], v[228:229], v[116:117]
v_pk_mul_f32 v[230:231], v[230:231], v[118:119]
v_exp_f32 v224, v224
v_exp_f32 v225, v225
v_exp_f32 v226, v226
v_exp_f32 v227, v227
v_exp_f32 v228, v228
v_exp_f32 v229, v229
v_exp_f32 v230, v230
v_exp_f32 v231, v231
v_pk_add_f32 v[224:225], v[224:225], s[42:43] op_sel_hi:[1,0]
v_pk_add_f32 v[226:227], v[226:227], s[42:43] op_sel_hi:[1,0]
v_pk_add_f32 v[228:229], v[228:229], s[42:43] op_sel_hi:[1,0]
v_pk_add_f32 v[230:231], v[230:231], s[42:43] op_sel_hi:[1,0]
v_rcp_f32 v224, v224
v_rcp_f32 v225, v225
v_rcp_f32 v226, v226
v_rcp_f32 v227, v227
v_rcp_f32 v228, v228
v_rcp_f32 v229, v229
v_rcp_f32 v230, v230
v_rcp_f32 v231, v231
v_pk_mul_f32 v[112:113], v[112:113], v[224:225]
v_pk_mul_f32 v[114:115], v[114:115], v[226:227]
v_pk_mul_f32 v[116:117], v[116:117], v[228:229]
v_pk_mul_f32 v[118:119], v[118:119], v[230:231]
v_cvt_pk_bf16_f32 v120, v112, v113
v_cvt_pk_bf16_f32 v121, v114, v115
v_cvt_pk_bf16_f32 v122, v116, v117
v_cvt_pk_bf16_f32 v123, v118, v119
buffer_store_dwordx4 v[120:123], v61, s[4:7], s38 offen offset:3072 sc1
s_add_u32 s38, s36, 36864
v_accvgpr_read_b32 v64, a144
v_accvgpr_read_b32 v65, a145
v_accvgpr_read_b32 v66, a146
v_accvgpr_read_b32 v67, a147
v_accvgpr_read_b32 v68, a176
v_accvgpr_read_b32 v69, a177
v_accvgpr_read_b32 v70, a178
v_accvgpr_read_b32 v71, a179
v_pk_mul_f32 v[224:225], v[64:65], v[64:65]
v_pk_mul_f32 v[226:227], v[66:67], v[66:67]
v_pk_mul_f32 v[228:229], v[68:69], v[68:69]
v_pk_mul_f32 v[230:231], v[70:71], v[70:71]
v_pk_fma_f32 v[224:225], v[224:225], s[40:41], v[60:61] op_sel_hi:[1,0,0]
v_pk_fma_f32 v[226:227], v[226:227], s[40:41], v[60:61] op_sel_hi:[1,0,0]
v_pk_fma_f32 v[228:229], v[228:229], s[40:41], v[60:61] op_sel_hi:[1,0,0]
v_pk_fma_f32 v[230:231], v[230:231], s[40:41], v[60:61] op_sel_hi:[1,0,0]
v_pk_mul_f32 v[224:225], v[224:225], v[64:65]
v_pk_mul_f32 v[226:227], v[226:227], v[66:67]
v_pk_mul_f32 v[228:229], v[228:229], v[68:69]
v_pk_mul_f32 v[230:231], v[230:231], v[70:71]
v_exp_f32 v224, v224
v_exp_f32 v225, v225
v_exp_f32 v226, v226
v_exp_f32 v227, v227
v_exp_f32 v228, v228
v_exp_f32 v229, v229
v_exp_f32 v230, v230
v_exp_f32 v231, v231
v_pk_add_f32 v[224:225], v[224:225], s[42:43] op_sel_hi:[1,0]
v_pk_add_f32 v[226:227], v[226:227], s[42:43] op_sel_hi:[1,0]
v_pk_add_f32 v[228:229], v[228:229], s[42:43] op_sel_hi:[1,0]
v_pk_add_f32 v[230:231], v[230:231], s[42:43] op_sel_hi:[1,0]
v_rcp_f32 v224, v224
v_rcp_f32 v225, v225
v_rcp_f32 v226, v226
v_rcp_f32 v227, v227
v_rcp_f32 v228, v228
v_rcp_f32 v229, v229
v_rcp_f32 v230, v230
v_rcp_f32 v231, v231
v_pk_mul_f32 v[64:65], v[64:65], v[224:225]
v_pk_mul_f32 v[66:67], v[66:67], v[226:227]
v_pk_mul_f32 v[68:69], v[68:69], v[228:229]
v_pk_mul_f32 v[70:71], v[70:71], v[230:231]
v_cvt_pk_bf16_f32 v72, v64, v65
v_cvt_pk_bf16_f32 v73, v66, v67
v_cvt_pk_bf16_f32 v74, v68, v69
v_cvt_pk_bf16_f32 v75, v70, v71
buffer_store_dwordx4 v[72:75], v61, s[4:7], s38 offen offset:0 sc1
v_accvgpr_read_b32 v80, a148
v_accvgpr_read_b32 v81, a149
v_accvgpr_read_b32 v82, a150
v_accvgpr_read_b32 v83, a151
v_accvgpr_read_b32 v84, a180
v_accvgpr_read_b32 v85, a181
v_accvgpr_read_b32 v86, a182
v_accvgpr_read_b32 v87, a183
v_pk_mul_f32 v[224:225], v[80:81], v[80:81]
v_pk_mul_f32 v[226:227], v[82:83], v[82:83]
v_pk_mul_f32 v[228:229], v[84:85], v[84:85]
v_pk_mul_f32 v[230:231], v[86:87], v[86:87]
v_pk_fma_f32 v[224:225], v[224:225], s[40:41], v[60:61] op_sel_hi:[1,0,0]
v_pk_fma_f32 v[226:227], v[226:227], s[40:41], v[60:61] op_sel_hi:[1,0,0]
v_pk_fma_f32 v[228:229], v[228:229], s[40:41], v[60:61] op_sel_hi:[1,0,0]
v_pk_fma_f32 v[230:231], v[230:231], s[40:41], v[60:61] op_sel_hi:[1,0,0]
v_pk_mul_f32 v[224:225], v[224:225], v[80:81]
v_pk_mul_f32 v[226:227], v[226:227], v[82:83]
v_pk_mul_f32 v[228:229], v[228:229], v[84:85]
v_pk_mul_f32 v[230:231], v[230:231], v[86:87]
v_exp_f32 v224, v224
v_exp_f32 v225, v225
v_exp_f32 v226, v226
v_exp_f32 v227, v227
v_exp_f32 v228, v228
v_exp_f32 v229, v229
v_exp_f32 v230, v230
v_exp_f32 v231, v231
v_pk_add_f32 v[224:225], v[224:225], s[42:43] op_sel_hi:[1,0]
v_pk_add_f32 v[226:227], v[226:227], s[42:43] op_sel_hi:[1,0]
v_pk_add_f32 v[228:229], v[228:229], s[42:43] op_sel_hi:[1,0]
v_pk_add_f32 v[230:231], v[230:231], s[42:43] op_sel_hi:[1,0]
v_rcp_f32 v224, v224
v_rcp_f32 v225, v225
v_rcp_f32 v226, v226
v_rcp_f32 v227, v227
v_rcp_f32 v228, v228
v_rcp_f32 v229, v229
v_rcp_f32 v230, v230
v_rcp_f32 v231, v231
v_pk_mul_f32 v[80:81], v[80:81], v[224:225]
v_pk_mul_f32 v[82:83], v[82:83], v[226:227]
v_pk_mul_f32 v[84:85], v[84:85], v[228:229]
v_pk_mul_f32 v[86:87], v[86:87], v[230:231]
v_cvt_pk_bf16_f32 v88, v80, v81
v_cvt_pk_bf16_f32 v89, v82, v83
v_cvt_pk_bf16_f32 v90, v84, v85
v_cvt_pk_bf16_f32 v91, v86, v87
buffer_store_dwordx4 v[88:91], v61, s[4:7], s38 offen offset:1024 sc1
v_accvgpr_read_b32 v96, a152
v_accvgpr_read_b32 v97, a153
v_accvgpr_read_b32 v98, a154
v_accvgpr_read_b32 v99, a155
v_accvgpr_read_b32 v100, a184
v_accvgpr_read_b32 v101, a185
v_accvgpr_read_b32 v102, a186
v_accvgpr_read_b32 v103, a187
v_pk_mul_f32 v[224:225], v[96:97], v[96:97]
v_pk_mul_f32 v[226:227], v[98:99], v[98:99]
v_pk_mul_f32 v[228:229], v[100:101], v[100:101]
v_pk_mul_f32 v[230:231], v[102:103], v[102:103]
v_pk_fma_f32 v[224:225], v[224:225], s[40:41], v[60:61] op_sel_hi:[1,0,0]
v_pk_fma_f32 v[226:227], v[226:227], s[40:41], v[60:61] op_sel_hi:[1,0,0]
v_pk_fma_f32 v[228:229], v[228:229], s[40:41], v[60:61] op_sel_hi:[1,0,0]
v_pk_fma_f32 v[230:231], v[230:231], s[40:41], v[60:61] op_sel_hi:[1,0,0]
v_pk_mul_f32 v[224:225], v[224:225], v[96:97]
v_pk_mul_f32 v[226:227], v[226:227], v[98:99]
v_pk_mul_f32 v[228:229], v[228:229], v[100:101]
v_pk_mul_f32 v[230:231], v[230:231], v[102:103]
v_exp_f32 v224, v224
v_exp_f32 v225, v225
v_exp_f32 v226, v226
v_exp_f32 v227, v227
v_exp_f32 v228, v228
v_exp_f32 v229, v229
v_exp_f32 v230, v230
v_exp_f32 v231, v231
v_pk_add_f32 v[224:225], v[224:225], s[42:43] op_sel_hi:[1,0]
v_pk_add_f32 v[226:227], v[226:227], s[42:43] op_sel_hi:[1,0]
v_pk_add_f32 v[228:229], v[228:229], s[42:43] op_sel_hi:[1,0]
v_pk_add_f32 v[230:231], v[230:231], s[42:43] op_sel_hi:[1,0]
v_rcp_f32 v224, v224
v_rcp_f32 v225, v225
v_rcp_f32 v226, v226
v_rcp_f32 v227, v227
v_rcp_f32 v228, v228
v_rcp_f32 v229, v229
v_rcp_f32 v230, v230
v_rcp_f32 v231, v231
v_pk_mul_f32 v[96:97], v[96:97], v[224:225]
v_pk_mul_f32 v[98:99], v[98:99], v[226:227]
v_pk_mul_f32 v[100:101], v[100:101], v[228:229]
v_pk_mul_f32 v[102:103], v[102:103], v[230:231]
v_cvt_pk_bf16_f32 v104, v96, v97
v_cvt_pk_bf16_f32 v105, v98, v99
v_cvt_pk_bf16_f32 v106, v100, v101
v_cvt_pk_bf16_f32 v107, v102, v103
buffer_store_dwordx4 v[104:107], v61, s[4:7], s38 offen offset:2048 sc1
v_accvgpr_read_b32 v112, a156
v_accvgpr_read_b32 v113, a157
v_accvgpr_read_b32 v114, a158
v_accvgpr_read_b32 v115, a159
v_accvgpr_read_b32 v116, a188
v_accvgpr_read_b32 v117, a189
v_accvgpr_read_b32 v118, a190
v_accvgpr_read_b32 v119, a191
v_pk_mul_f32 v[224:225], v[112:113], v[112:113]
v_pk_mul_f32 v[226:227], v[114:115], v[114:115]
v_pk_mul_f32 v[228:229], v[116:117], v[116:117]
v_pk_mul_f32 v[230:231], v[118:119], v[118:119]
v_pk_fma_f32 v[224:225], v[224:225], s[40:41], v[60:61] op_sel_hi:[1,0,0]
v_pk_fma_f32 v[226:227], v[226:227], s[40:41], v[60:61] op_sel_hi:[1,0,0]
v_pk_fma_f32 v[228:229], v[228:229], s[40:41], v[60:61] op_sel_hi:[1,0,0]
v_pk_fma_f32 v[230:231], v[230:231], s[40:41], v[60:61] op_sel_hi:[1,0,0]
v_pk_mul_f32 v[224:225], v[224:225], v[112:113]
v_pk_mul_f32 v[226:227], v[226:227], v[114:115]
v_pk_mul_f32 v[228:229], v[228:229], v[116:117]
v_pk_mul_f32 v[230:231], v[230:231], v[118:119]
v_exp_f32 v224, v224
v_exp_f32 v225, v225
v_exp_f32 v226, v226
v_exp_f32 v227, v227
v_exp_f32 v228, v228
v_exp_f32 v229, v229
v_exp_f32 v230, v230
v_exp_f32 v231, v231
v_pk_add_f32 v[224:225], v[224:225], s[42:43] op_sel_hi:[1,0]
v_pk_add_f32 v[226:227], v[226:227], s[42:43] op_sel_hi:[1,0]
v_pk_add_f32 v[228:229], v[228:229], s[42:43] op_sel_hi:[1,0]
v_pk_add_f32 v[230:231], v[230:231], s[42:43] op_sel_hi:[1,0]
v_rcp_f32 v224, v224
v_rcp_f32 v225, v225
v_rcp_f32 v226, v226
v_rcp_f32 v227, v227
v_rcp_f32 v228, v228
v_rcp_f32 v229, v229
v_rcp_f32 v230, v230
v_rcp_f32 v231, v231
v_pk_mul_f32 v[112:113], v[112:113], v[224:225]
v_pk_mul_f32 v[114:115], v[114:115], v[226:227]
v_pk_mul_f32 v[116:117], v[116:117], v[228:229]
v_pk_mul_f32 v[118:119], v[118:119], v[230:231]
v_cvt_pk_bf16_f32 v120, v112, v113
v_cvt_pk_bf16_f32 v121, v114, v115
v_cvt_pk_bf16_f32 v122, v116, v117
v_cvt_pk_bf16_f32 v123, v118, v119
buffer_store_dwordx4 v[120:123], v61, s[4:7], s38 offen offset:3072 sc1
s_add_u32 s38, s36, 49152
v_accvgpr_read_b32 v64, a192
v_accvgpr_read_b32 v65, a193
v_accvgpr_read_b32 v66, a194
v_accvgpr_read_b32 v67, a195
v_accvgpr_read_b32 v68, a224
v_accvgpr_read_b32 v69, a225
v_accvgpr_read_b32 v70, a226
v_accvgpr_read_b32 v71, a227
v_pk_mul_f32 v[224:225], v[64:65], v[64:65]
v_pk_mul_f32 v[226:227], v[66:67], v[66:67]
v_pk_mul_f32 v[228:229], v[68:69], v[68:69]
v_pk_mul_f32 v[230:231], v[70:71], v[70:71]
v_pk_fma_f32 v[224:225], v[224:225], s[40:41], v[60:61] op_sel_hi:[1,0,0]
v_pk_fma_f32 v[226:227], v[226:227], s[40:41], v[60:61] op_sel_hi:[1,0,0]
v_pk_fma_f32 v[228:229], v[228:229], s[40:41], v[60:61] op_sel_hi:[1,0,0]
v_pk_fma_f32 v[230:231], v[230:231], s[40:41], v[60:61] op_sel_hi:[1,0,0]
v_pk_mul_f32 v[224:225], v[224:225], v[64:65]
v_pk_mul_f32 v[226:227], v[226:227], v[66:67]
v_pk_mul_f32 v[228:229], v[228:229], v[68:69]
v_pk_mul_f32 v[230:231], v[230:231], v[70:71]
v_exp_f32 v224, v224
v_exp_f32 v225, v225
v_exp_f32 v226, v226
v_exp_f32 v227, v227
v_exp_f32 v228, v228
v_exp_f32 v229, v229
v_exp_f32 v230, v230
v_exp_f32 v231, v231
v_pk_add_f32 v[224:225], v[224:225], s[42:43] op_sel_hi:[1,0]
v_pk_add_f32 v[226:227], v[226:227], s[42:43] op_sel_hi:[1,0]
v_pk_add_f32 v[228:229], v[228:229], s[42:43] op_sel_hi:[1,0]
v_pk_add_f32 v[230:231], v[230:231], s[42:43] op_sel_hi:[1,0]
v_rcp_f32 v224, v224
v_rcp_f32 v225, v225
v_rcp_f32 v226, v226
v_rcp_f32 v227, v227
v_rcp_f32 v228, v228
v_rcp_f32 v229, v229
v_rcp_f32 v230, v230
v_rcp_f32 v231, v231
v_pk_mul_f32 v[64:65], v[64:65], v[224:225]
v_pk_mul_f32 v[66:67], v[66:67], v[226:227]
v_pk_mul_f32 v[68:69], v[68:69], v[228:229]
v_pk_mul_f32 v[70:71], v[70:71], v[230:231]
v_cvt_pk_bf16_f32 v72, v64, v65
v_cvt_pk_bf16_f32 v73, v66, v67
v_cvt_pk_bf16_f32 v74, v68, v69
v_cvt_pk_bf16_f32 v75, v70, v71
buffer_store_dwordx4 v[72:75], v61, s[4:7], s38 offen offset:0 sc1
v_accvgpr_read_b32 v80, a196
v_accvgpr_read_b32 v81, a197
v_accvgpr_read_b32 v82, a198
v_accvgpr_read_b32 v83, a199
v_accvgpr_read_b32 v84, a228
v_accvgpr_read_b32 v85, a229
v_accvgpr_read_b32 v86, a230
v_accvgpr_read_b32 v87, a231
v_pk_mul_f32 v[224:225], v[80:81], v[80:81]
v_pk_mul_f32 v[226:227], v[82:83], v[82:83]
v_pk_mul_f32 v[228:229], v[84:85], v[84:85]
v_pk_mul_f32 v[230:231], v[86:87], v[86:87]
v_pk_fma_f32 v[224:225], v[224:225], s[40:41], v[60:61] op_sel_hi:[1,0,0]
v_pk_fma_f32 v[226:227], v[226:227], s[40:41], v[60:61] op_sel_hi:[1,0,0]
v_pk_fma_f32 v[228:229], v[228:229], s[40:41], v[60:61] op_sel_hi:[1,0,0]
v_pk_fma_f32 v[230:231], v[230:231], s[40:41], v[60:61] op_sel_hi:[1,0,0]
v_pk_mul_f32 v[224:225], v[224:225], v[80:81]
v_pk_mul_f32 v[226:227], v[226:227], v[82:83]
v_pk_mul_f32 v[228:229], v[228:229], v[84:85]
v_pk_mul_f32 v[230:231], v[230:231], v[86:87]
v_exp_f32 v224, v224
v_exp_f32 v225, v225
v_exp_f32 v226, v226
v_exp_f32 v227, v227
v_exp_f32 v228, v228
v_exp_f32 v229, v229
v_exp_f32 v230, v230
v_exp_f32 v231, v231
v_pk_add_f32 v[224:225], v[224:225], s[42:43] op_sel_hi:[1,0]
v_pk_add_f32 v[226:227], v[226:227], s[42:43] op_sel_hi:[1,0]
v_pk_add_f32 v[228:229], v[228:229], s[42:43] op_sel_hi:[1,0]
v_pk_add_f32 v[230:231], v[230:231], s[42:43] op_sel_hi:[1,0]
v_rcp_f32 v224, v224
v_rcp_f32 v225, v225
v_rcp_f32 v226, v226
v_rcp_f32 v227, v227
v_rcp_f32 v228, v228
v_rcp_f32 v229, v229
v_rcp_f32 v230, v230
v_rcp_f32 v231, v231
v_pk_mul_f32 v[80:81], v[80:81], v[224:225]
v_pk_mul_f32 v[82:83], v[82:83], v[226:227]
v_pk_mul_f32 v[84:85], v[84:85], v[228:229]
v_pk_mul_f32 v[86:87], v[86:87], v[230:231]
v_cvt_pk_bf16_f32 v88, v80, v81
v_cvt_pk_bf16_f32 v89, v82, v83
v_cvt_pk_bf16_f32 v90, v84, v85
v_cvt_pk_bf16_f32 v91, v86, v87
buffer_store_dwordx4 v[88:91], v61, s[4:7], s38 offen offset:1024 sc1
v_accvgpr_read_b32 v96, a200
v_accvgpr_read_b32 v97, a201
v_accvgpr_read_b32 v98, a202
v_accvgpr_read_b32 v99, a203
v_accvgpr_read_b32 v100, a232
v_accvgpr_read_b32 v101, a233
v_accvgpr_read_b32 v102, a234
v_accvgpr_read_b32 v103, a235
v_pk_mul_f32 v[224:225], v[96:97], v[96:97]
v_pk_mul_f32 v[226:227], v[98:99], v[98:99]
v_pk_mul_f32 v[228:229], v[100:101], v[100:101]
v_pk_mul_f32 v[230:231], v[102:103], v[102:103]
v_pk_fma_f32 v[224:225], v[224:225], s[40:41], v[60:61] op_sel_hi:[1,0,0]
v_pk_fma_f32 v[226:227], v[226:227], s[40:41], v[60:61] op_sel_hi:[1,0,0]
v_pk_fma_f32 v[228:229], v[228:229], s[40:41], v[60:61] op_sel_hi:[1,0,0]
v_pk_fma_f32 v[230:231], v[230:231], s[40:41], v[60:61] op_sel_hi:[1,0,0]
v_pk_mul_f32 v[224:225], v[224:225], v[96:97]
v_pk_mul_f32 v[226:227], v[226:227], v[98:99]
v_pk_mul_f32 v[228:229], v[228:229], v[100:101]
v_pk_mul_f32 v[230:231], v[230:231], v[102:103]
v_exp_f32 v224, v224
v_exp_f32 v225, v225
v_exp_f32 v226, v226
v_exp_f32 v227, v227
v_exp_f32 v228, v228
v_exp_f32 v229, v229
v_exp_f32 v230, v230
v_exp_f32 v231, v231
v_pk_add_f32 v[224:225], v[224:225], s[42:43] op_sel_hi:[1,0]
v_pk_add_f32 v[226:227], v[226:227], s[42:43] op_sel_hi:[1,0]
v_pk_add_f32 v[228:229], v[228:229], s[42:43] op_sel_hi:[1,0]
v_pk_add_f32 v[230:231], v[230:231], s[42:43] op_sel_hi:[1,0]
v_rcp_f32 v224, v224
v_rcp_f32 v225, v225
v_rcp_f32 v226, v226
v_rcp_f32 v227, v227
v_rcp_f32 v228, v228
v_rcp_f32 v229, v229
v_rcp_f32 v230, v230
v_rcp_f32 v231, v231
v_pk_mul_f32 v[96:97], v[96:97], v[224:225]
v_pk_mul_f32 v[98:99], v[98:99], v[226:227]
v_pk_mul_f32 v[100:101], v[100:101], v[228:229]
v_pk_mul_f32 v[102:103], v[102:103], v[230:231]
v_cvt_pk_bf16_f32 v104, v96, v97
v_cvt_pk_bf16_f32 v105, v98, v99
v_cvt_pk_bf16_f32 v106, v100, v101
v_cvt_pk_bf16_f32 v107, v102, v103
buffer_store_dwordx4 v[104:107], v61, s[4:7], s38 offen offset:2048 sc1
v_accvgpr_read_b32 v112, a204
v_accvgpr_read_b32 v113, a205
v_accvgpr_read_b32 v114, a206
v_accvgpr_read_b32 v115, a207
v_accvgpr_read_b32 v116, a236
v_accvgpr_read_b32 v117, a237
v_accvgpr_read_b32 v118, a238
v_accvgpr_read_b32 v119, a239
v_pk_mul_f32 v[224:225], v[112:113], v[112:113]
v_pk_mul_f32 v[226:227], v[114:115], v[114:115]
v_pk_mul_f32 v[228:229], v[116:117], v[116:117]
v_pk_mul_f32 v[230:231], v[118:119], v[118:119]
v_pk_fma_f32 v[224:225], v[224:225], s[40:41], v[60:61] op_sel_hi:[1,0,0]
v_pk_fma_f32 v[226:227], v[226:227], s[40:41], v[60:61] op_sel_hi:[1,0,0]
v_pk_fma_f32 v[228:229], v[228:229], s[40:41], v[60:61] op_sel_hi:[1,0,0]
v_pk_fma_f32 v[230:231], v[230:231], s[40:41], v[60:61] op_sel_hi:[1,0,0]
v_pk_mul_f32 v[224:225], v[224:225], v[112:113]
v_pk_mul_f32 v[226:227], v[226:227], v[114:115]
v_pk_mul_f32 v[228:229], v[228:229], v[116:117]
v_pk_mul_f32 v[230:231], v[230:231], v[118:119]
v_exp_f32 v224, v224
v_exp_f32 v225, v225
v_exp_f32 v226, v226
v_exp_f32 v227, v227
v_exp_f32 v228, v228
v_exp_f32 v229, v229
v_exp_f32 v230, v230
v_exp_f32 v231, v231
v_pk_add_f32 v[224:225], v[224:225], s[42:43] op_sel_hi:[1,0]
v_pk_add_f32 v[226:227], v[226:227], s[42:43] op_sel_hi:[1,0]
v_pk_add_f32 v[228:229], v[228:229], s[42:43] op_sel_hi:[1,0]
v_pk_add_f32 v[230:231], v[230:231], s[42:43] op_sel_hi:[1,0]
v_rcp_f32 v224, v224
v_rcp_f32 v225, v225
v_rcp_f32 v226, v226
v_rcp_f32 v227, v227
v_rcp_f32 v228, v228
v_rcp_f32 v229, v229
v_rcp_f32 v230, v230
v_rcp_f32 v231, v231
v_pk_mul_f32 v[112:113], v[112:113], v[224:225]
v_pk_mul_f32 v[114:115], v[114:115], v[226:227]
v_pk_mul_f32 v[116:117], v[116:117], v[228:229]
v_pk_mul_f32 v[118:119], v[118:119], v[230:231]
v_cvt_pk_bf16_f32 v120, v112, v113
v_cvt_pk_bf16_f32 v121, v114, v115
v_cvt_pk_bf16_f32 v122, v116, v117
v_cvt_pk_bf16_f32 v123, v118, v119
buffer_store_dwordx4 v[120:123], v61, s[4:7], s38 offen offset:3072 sc1
s_add_u32 s38, s36, 53248
v_accvgpr_read_b32 v64, a208
v_accvgpr_read_b32 v65, a209
v_accvgpr_read_b32 v66, a210
v_accvgpr_read_b32 v67, a211
v_accvgpr_read_b32 v68, a240
v_accvgpr_read_b32 v69, a241
v_accvgpr_read_b32 v70, a242
v_accvgpr_read_b32 v71, a243
v_pk_mul_f32 v[224:225], v[64:65], v[64:65]
v_pk_mul_f32 v[226:227], v[66:67], v[66:67]
v_pk_mul_f32 v[228:229], v[68:69], v[68:69]
v_pk_mul_f32 v[230:231], v[70:71], v[70:71]
v_pk_fma_f32 v[224:225], v[224:225], s[40:41], v[60:61] op_sel_hi:[1,0,0]
v_pk_fma_f32 v[226:227], v[226:227], s[40:41], v[60:61] op_sel_hi:[1,0,0]
v_pk_fma_f32 v[228:229], v[228:229], s[40:41], v[60:61] op_sel_hi:[1,0,0]
v_pk_fma_f32 v[230:231], v[230:231], s[40:41], v[60:61] op_sel_hi:[1,0,0]
v_pk_mul_f32 v[224:225], v[224:225], v[64:65]
v_pk_mul_f32 v[226:227], v[226:227], v[66:67]
v_pk_mul_f32 v[228:229], v[228:229], v[68:69]
v_pk_mul_f32 v[230:231], v[230:231], v[70:71]
v_exp_f32 v224, v224
v_exp_f32 v225, v225
v_exp_f32 v226, v226
v_exp_f32 v227, v227
v_exp_f32 v228, v228
v_exp_f32 v229, v229
v_exp_f32 v230, v230
v_exp_f32 v231, v231
v_pk_add_f32 v[224:225], v[224:225], s[42:43] op_sel_hi:[1,0]
v_pk_add_f32 v[226:227], v[226:227], s[42:43] op_sel_hi:[1,0]
v_pk_add_f32 v[228:229], v[228:229], s[42:43] op_sel_hi:[1,0]
v_pk_add_f32 v[230:231], v[230:231], s[42:43] op_sel_hi:[1,0]
v_rcp_f32 v224, v224
v_rcp_f32 v225, v225
v_rcp_f32 v226, v226
v_rcp_f32 v227, v227
v_rcp_f32 v228, v228
v_rcp_f32 v229, v229
v_rcp_f32 v230, v230
v_rcp_f32 v231, v231
v_pk_mul_f32 v[64:65], v[64:65], v[224:225]
v_pk_mul_f32 v[66:67], v[66:67], v[226:227]
v_pk_mul_f32 v[68:69], v[68:69], v[228:229]
v_pk_mul_f32 v[70:71], v[70:71], v[230:231]
v_cvt_pk_bf16_f32 v72, v64, v65
v_cvt_pk_bf16_f32 v73, v66, v67
v_cvt_pk_bf16_f32 v74, v68, v69
v_cvt_pk_bf16_f32 v75, v70, v71
buffer_store_dwordx4 v[72:75], v61, s[4:7], s38 offen offset:0 sc1
v_accvgpr_read_b32 v80, a212
v_accvgpr_read_b32 v81, a213
v_accvgpr_read_b32 v82, a214
v_accvgpr_read_b32 v83, a215
v_accvgpr_read_b32 v84, a244
v_accvgpr_read_b32 v85, a245
v_accvgpr_read_b32 v86, a246
v_accvgpr_read_b32 v87, a247
v_pk_mul_f32 v[224:225], v[80:81], v[80:81]
v_pk_mul_f32 v[226:227], v[82:83], v[82:83]
v_pk_mul_f32 v[228:229], v[84:85], v[84:85]
v_pk_mul_f32 v[230:231], v[86:87], v[86:87]
v_pk_fma_f32 v[224:225], v[224:225], s[40:41], v[60:61] op_sel_hi:[1,0,0]
v_pk_fma_f32 v[226:227], v[226:227], s[40:41], v[60:61] op_sel_hi:[1,0,0]
v_pk_fma_f32 v[228:229], v[228:229], s[40:41], v[60:61] op_sel_hi:[1,0,0]
v_pk_fma_f32 v[230:231], v[230:231], s[40:41], v[60:61] op_sel_hi:[1,0,0]
v_pk_mul_f32 v[224:225], v[224:225], v[80:81]
v_pk_mul_f32 v[226:227], v[226:227], v[82:83]
v_pk_mul_f32 v[228:229], v[228:229], v[84:85]
v_pk_mul_f32 v[230:231], v[230:231], v[86:87]
v_exp_f32 v224, v224
v_exp_f32 v225, v225
v_exp_f32 v226, v226
v_exp_f32 v227, v227
v_exp_f32 v228, v228
v_exp_f32 v229, v229
v_exp_f32 v230, v230
v_exp_f32 v231, v231
v_pk_add_f32 v[224:225], v[224:225], s[42:43] op_sel_hi:[1,0]
v_pk_add_f32 v[226:227], v[226:227], s[42:43] op_sel_hi:[1,0]
v_pk_add_f32 v[228:229], v[228:229], s[42:43] op_sel_hi:[1,0]
v_pk_add_f32 v[230:231], v[230:231], s[42:43] op_sel_hi:[1,0]
v_rcp_f32 v224, v224
v_rcp_f32 v225, v225
v_rcp_f32 v226, v226
v_rcp_f32 v227, v227
v_rcp_f32 v228, v228
v_rcp_f32 v229, v229
v_rcp_f32 v230, v230
v_rcp_f32 v231, v231
v_pk_mul_f32 v[80:81], v[80:81], v[224:225]
v_pk_mul_f32 v[82:83], v[82:83], v[226:227]
v_pk_mul_f32 v[84:85], v[84:85], v[228:229]
v_pk_mul_f32 v[86:87], v[86:87], v[230:231]
v_cvt_pk_bf16_f32 v88, v80, v81
v_cvt_pk_bf16_f32 v89, v82, v83
v_cvt_pk_bf16_f32 v90, v84, v85
v_cvt_pk_bf16_f32 v91, v86, v87
buffer_store_dwordx4 v[88:91], v61, s[4:7], s38 offen offset:1024 sc1
v_accvgpr_read_b32 v96, a216
v_accvgpr_read_b32 v97, a217
v_accvgpr_read_b32 v98, a218
v_accvgpr_read_b32 v99, a219
v_accvgpr_read_b32 v100, a248
v_accvgpr_read_b32 v101, a249
v_accvgpr_read_b32 v102, a250
v_accvgpr_read_b32 v103, a251
v_pk_mul_f32 v[224:225], v[96:97], v[96:97]
v_pk_mul_f32 v[226:227], v[98:99], v[98:99]
v_pk_mul_f32 v[228:229], v[100:101], v[100:101]
v_pk_mul_f32 v[230:231], v[102:103], v[102:103]
v_pk_fma_f32 v[224:225], v[224:225], s[40:41], v[60:61] op_sel_hi:[1,0,0]
v_pk_fma_f32 v[226:227], v[226:227], s[40:41], v[60:61] op_sel_hi:[1,0,0]
v_pk_fma_f32 v[228:229], v[228:229], s[40:41], v[60:61] op_sel_hi:[1,0,0]
v_pk_fma_f32 v[230:231], v[230:231], s[40:41], v[60:61] op_sel_hi:[1,0,0]
v_pk_mul_f32 v[224:225], v[224:225], v[96:97]
v_pk_mul_f32 v[226:227], v[226:227], v[98:99]
v_pk_mul_f32 v[228:229], v[228:229], v[100:101]
v_pk_mul_f32 v[230:231], v[230:231], v[102:103]
v_exp_f32 v224, v224
v_exp_f32 v225, v225
v_exp_f32 v226, v226
v_exp_f32 v227, v227
v_exp_f32 v228, v228
v_exp_f32 v229, v229
v_exp_f32 v230, v230
v_exp_f32 v231, v231
v_pk_add_f32 v[224:225], v[224:225], s[42:43] op_sel_hi:[1,0]
v_pk_add_f32 v[226:227], v[226:227], s[42:43] op_sel_hi:[1,0]
v_pk_add_f32 v[228:229], v[228:229], s[42:43] op_sel_hi:[1,0]
v_pk_add_f32 v[230:231], v[230:231], s[42:43] op_sel_hi:[1,0]
v_rcp_f32 v224, v224
v_rcp_f32 v225, v225
v_rcp_f32 v226, v226
v_rcp_f32 v227, v227
v_rcp_f32 v228, v228
v_rcp_f32 v229, v229
v_rcp_f32 v230, v230
v_rcp_f32 v231, v231
v_pk_mul_f32 v[96:97], v[96:97], v[224:225]
v_pk_mul_f32 v[98:99], v[98:99], v[226:227]
v_pk_mul_f32 v[100:101], v[100:101], v[228:229]
v_pk_mul_f32 v[102:103], v[102:103], v[230:231]
v_cvt_pk_bf16_f32 v104, v96, v97
v_cvt_pk_bf16_f32 v105, v98, v99
v_cvt_pk_bf16_f32 v106, v100, v101
v_cvt_pk_bf16_f32 v107, v102, v103
buffer_store_dwordx4 v[104:107], v61, s[4:7], s38 offen offset:2048 sc1
v_accvgpr_read_b32 v112, a220
v_accvgpr_read_b32 v113, a221
v_accvgpr_read_b32 v114, a222
v_accvgpr_read_b32 v115, a223
v_accvgpr_read_b32 v116, a252
v_accvgpr_read_b32 v117, a253
v_accvgpr_read_b32 v118, a254
v_accvgpr_read_b32 v119, a255
v_pk_mul_f32 v[224:225], v[112:113], v[112:113]
v_pk_mul_f32 v[226:227], v[114:115], v[114:115]
v_pk_mul_f32 v[228:229], v[116:117], v[116:117]
v_pk_mul_f32 v[230:231], v[118:119], v[118:119]
v_pk_fma_f32 v[224:225], v[224:225], s[40:41], v[60:61] op_sel_hi:[1,0,0]
v_pk_fma_f32 v[226:227], v[226:227], s[40:41], v[60:61] op_sel_hi:[1,0,0]
v_pk_fma_f32 v[228:229], v[228:229], s[40:41], v[60:61] op_sel_hi:[1,0,0]
v_pk_fma_f32 v[230:231], v[230:231], s[40:41], v[60:61] op_sel_hi:[1,0,0]
v_pk_mul_f32 v[224:225], v[224:225], v[112:113]
v_pk_mul_f32 v[226:227], v[226:227], v[114:115]
v_pk_mul_f32 v[228:229], v[228:229], v[116:117]
v_pk_mul_f32 v[230:231], v[230:231], v[118:119]
v_exp_f32 v224, v224
v_exp_f32 v225, v225
v_exp_f32 v226, v226
v_exp_f32 v227, v227
v_exp_f32 v228, v228
v_exp_f32 v229, v229
v_exp_f32 v230, v230
v_exp_f32 v231, v231
v_pk_add_f32 v[224:225], v[224:225], s[42:43] op_sel_hi:[1,0]
v_pk_add_f32 v[226:227], v[226:227], s[42:43] op_sel_hi:[1,0]
v_pk_add_f32 v[228:229], v[228:229], s[42:43] op_sel_hi:[1,0]
v_pk_add_f32 v[230:231], v[230:231], s[42:43] op_sel_hi:[1,0]
v_rcp_f32 v224, v224
v_rcp_f32 v225, v225
v_rcp_f32 v226, v226
v_rcp_f32 v227, v227
v_rcp_f32 v228, v228
v_rcp_f32 v229, v229
v_rcp_f32 v230, v230
v_rcp_f32 v231, v231
v_pk_mul_f32 v[112:113], v[112:113], v[224:225]
v_pk_mul_f32 v[114:115], v[114:115], v[226:227]
v_pk_mul_f32 v[116:117], v[116:117], v[228:229]
v_pk_mul_f32 v[118:119], v[118:119], v[230:231]
v_cvt_pk_bf16_f32 v120, v112, v113
v_cvt_pk_bf16_f32 v121, v114, v115
v_cvt_pk_bf16_f32 v122, v116, v117
v_cvt_pk_bf16_f32 v123, v118, v119
buffer_store_dwordx4 v[120:123], v61, s[4:7], s38 offen offset:3072 sc1
s_lshl_b32 s36, s28, 11
s_lshl_b32 s37, s29, 7
s_add_u32 s36, s36, s37
s_add_u32 s36, s36, 119562240
v_lshlrev_b32 v7, 7, v1
s_mov_b32 s46, 119545856
s_mov_b32 s47, 119554048
s_cmp_lg_u32 s24, 0
s_cbranch_scc1 TI_63
s_lshl_b32 s26, s20, 8
s_add_u32 s26, s26, 119537664
v_mov_b32 v2, 1
v_mov_b32 v3, 0
buffer_load_dword v5, v7, s[4:7], s46 offen sc1
buffer_load_dword v6, v7, s[4:7], s47 offen sc1
s_mov_b64 exec, 1
buffer_atomic_add v2, v3, s[4:7], s26 offen sc0 sc1
s_mov_b64 exec, -1
TI_63:
v_mov_b32 v4, 163808
s_waitcnt vmcnt(0)
s_cmp_lg_u32 s24, 0
s_cbranch_scc1 TP_64
s_mov_b32 s44, 0
TPL_65:
v_and_b32 v5, v5, v6
v_cmp_eq_u32 vcc, 0, v5
s_cbranch_vccz TPK_66
buffer_load_dword v5, v7, s[4:7], s46 offen sc1
buffer_load_dword v6, v7, s[4:7], s47 offen sc1
s_add_u32 s44, s44, 1
s_waitcnt vmcnt(0)
s_cmp_lt_u32 s44, 40000
s_cbranch_scc1 TPL_65
TPK_66:
s_mov_b64 exec, 1
ds_write_b32 v4, v2
s_mov_b64 exec, -1
s_waitcnt lgkmcnt(0)
TP_64:
s_barrier
ds_read_b32 v2, v4
s_cmp_lg_u32 s24, 0
s_cbranch_scc1 W_TICKET
v_mov_b32 v16, 1
v_mov_b32 v17, 0
s_mov_b64 exec, 1
buffer_store_dword v16, v17, s[4:7], s36 offen sc1
s_mov_b64 exec, -1
s_branch W_TICKET
T_F2:
s_load_dwordx2 s[8:9], s[0:1], 80
s_mov_b32 s10, 7340032
s_mov_b32 s11, 0x20000
s_load_dwordx2 s[12:13], s[0:1], 88
s_mov_b32 s14, 2048
s_mov_b32 s15, 0x20000
s_lshl_b32 s30, s29, 9
s_lshr_b32 s36, s28, 1
s_mul_i32 s31, s36, 1835008
s_and_b32 s37, s28, 1
s_lshl_b32 s37, s37, 13
s_add_u32 s31, s31, s37
s_add_u32 s31, s31, 4194304
s_lshl_b32 s32, s24, 12
s_lshl_b32 s38, s24, 11
s_add_u32 s33, s38, 98304
s_lshr_b32 s34, s24, 1
s_and_b32 s35, s24, 1
v_lshrrev_b32 v16, 5, v1
v_and_b32 v17, 31, v1
v_lshlrev_b32 v18, 1, v16
v_xor_b32 v17, v17, v18
s_lshl_b32 s37, s24, 3
v_add_u32 v16, s37, v16
v_lshlrev_b32 v16, 11, v16
v_xor_b32 v18, 0, v17
v_lshl_add_u32 v18, v18, 4, v16
v_add_u32 v11, 0, v18
v_xor_b32 v18, 4, v17
v_lshl_add_u32 v18, v18, 4, v16
v_add_u32 v12, 3072, v18
v_xor_b32 v18, 8, v17
v_lshl_add_u32 v18, v18, 4, v16
v_add_u32 v13, 6144, v18
v_xor_b32 v18, 12, v17
v_lshl_add_u32 v18, v18, 4, v16
v_add_u32 v14, 9216, v18
v_lshlrev_b32 v61, 4, v1
v_add_u32 v15, s38, v61
s_lshl_b32 s37, s34, 12
s_mov_b32 s37, 0
s_add_u32 s37, s37, 98304
v_add_u32 v10, s37, v61
v_lshrrev_b32 v16, 2, v1
v_and_b32 v17, 7, v16
v_lshlrev_b32 v17, 1, v17
v_lshlrev_b32 v16, 9, v16
v_and_b32 v18, 3, v1
v_lshl_add_u32 v16, v18, 3, v16
s_lshl_b32 s37, s34, 8
v_add_u32 v16, s37, v16
s_lshl_b32 s37, s35, 3
v_xor_b32 v17, s37, v17
v_xor_b32 v18, 0, v17
v_lshl_add_u32 v2, v18, 4, v16
v_add_u32 v192, 0x10000, v2
v_xor_b32 v18, 2, v17
v_lshl_add_u32 v3, v18, 4, v16
v_add_u32 v193, 0x10000, v3
v_xor_b32 v18, 4, v17
v_lshl_add_u32 v4, v18, 4, v16
v_add_u32 v194, 0x10000, v4
v_xor_b32 v18, 6, v17
v_lshl_add_u32 v5, v18, 4, v16
v_add_u32 v195, 0x10000, v5
s_lshl_b32 s36, s36, 11
s_add_u32 s36, s36, 119562240
v_lshlrev_b32 v62, 7, v1
v_cmp_gt_u32 vcc, 14, v1
v_mov_b32 v63, 2147483648
s_nop 0
v_cndmask_b32 v62, v63, v62, vcc
s_mov_b64 s[42:43], vcc
s_mov_b32 s44, 0
PF_67:
buffer_load_dword v63, v62, s[4:7], s36 offen sc1
s_waitcnt vmcnt(0)
v_cmp_ne_u32 vcc, 0, v63
s_cmp_eq_u64 vcc, s[42:43]
s_cbranch_scc1 PFOK_68
s_sleep 8
s_add_u32 s44, s44, 1
s_cmp_lt_u32 s44, 40000
s_cbranch_scc1 PF_67
s_branch M_END
PFOK_68:
s_waitcnt lgkmcnt(0)
v_mov_b32 v16, 0
v_mov_b32 v17, 0
v_mov_b32 v18, 0
v_mov_b32 v19, 0
v_mov_b32 v20, 0
v_mov_b32 v21, 0
v_mov_b32 v22, 0
v_mov_b32 v23, 0
v_mov_b32 v24, 0
v_mov_b32 v25, 0
v_mov_b32 v26, 0
v_mov_b32 v27, 0
v_mov_b32 v28, 0
v_mov_b32 v29, 0
v_mov_b32 v30, 0
v_mov_b32 v31, 0
v_mov_b32 v32, 0
v_mov_b32 v33, 0
v_mov_b32 v34, 0
v_mov_b32 v35, 0
v_mov_b32 v36, 0
v_mov_b32 v37, 0
v_mov_b32 v38, 0
v_mov_b32 v39, 0
v_mov_b32 v40, 0
v_mov_b32 v41, 0
v_mov_b32 v42, 0
v_mov_b32 v43, 0
v_mov_b32 v44, 0
v_mov_b32 v45, 0
v_mov_b32 v46, 0
v_mov_b32 v47, 0
v_mov_b32 v48, 0
v_mov_b32 v49, 0
v_mov_b32 v50, 0
v_mov_b32 v51, 0
v_mov_b32 v52, 0
v_mov_b32 v53, 0
v_mov_b32 v54, 0
v_mov_b32 v55, 0
v_and_b32 v56, 15, v1
v_lshlrev_b32 v56, 1, v56
s_lshl_b32 s36, s24, 7
v_add_u32 v56, s36, v56
v_mov_b32 v57, 2147483648
v_cmp_gt_u32 vcc, 16, v1
v_mov_b32 v48, 0x3f803f80
s_nop 0
v_cndmask_b32 v56, v57, v56, vcc
buffer_load_ushort v16, v56, s[12:15], s30 offen offset:0
buffer_load_ushort v20, v56, s[12:15], s30 offen offset:32
buffer_load_ushort v24, v56, s[12:15], s30 offen offset:64
buffer_load_ushort v28, v56, s[12:15], s30 offen offset:96
s_add_u32 m0, s32, 0
s_nop 0
buffer_load_dwordx4 v11, s[8:11], s30 offen offset:0 lds
buffer_load_dwordx4 v12, s[8:11], s30 offen offset:1024 lds
buffer_load_dwordx4 v13, s[8:11], s30 offen offset:2048 lds
buffer_load_dwordx4 v14, s[8:11], s30 offen offset:3072 lds
s_add_u32 m0, s33, 0
s_nop 0
buffer_load_dwordx4 v15, s[4:7], s31 offen offset:0 sc1 lds
buffer_load_dwordx4 v15, s[4:7], s31 offen offset:1024 sc1 lds
s_add_u32 s30, s30, 65536
s_add_u32 s31, s31, 16384
s_add_u32 m0, s32, 16384
s_nop 0
buffer_load_dwordx4 v11, s[8:11], s30 offen offset:0 lds
buffer_load_dwordx4 v12, s[8:11], s30 offen offset:1024 lds
buffer_load_dwordx4 v13, s[8:11], s30 offen offset:2048 lds
buffer_load_dwordx4 v14, s[8:11], s30 offen offset:3072 lds
s_add_u32 m0, s33, 8192
s_nop 0
buffer_load_dwordx4 v15, s[4:7], s31 offen offset:0 sc1 lds
buffer_load_dwordx4 v15, s[4:7], s31 offen offset:1024 sc1 lds
s_add_u32 s30, s30, 65536
s_add_u32 s31, s31, 16384
s_add_u32 m0, s32, 32768
s_nop 0
buffer_load_dwordx4 v11, s[8:11], s30 offen offset:0 lds
buffer_load_dwordx4 v12, s[8:11], s30 offen offset:1024 lds
buffer_load_dwordx4 v13, s[8:11], s30 offen offset:2048 lds
buffer_load_dwordx4 v14, s[8:11], s30 offen offset:3072 lds
s_add_u32 m0, s33, 16384
s_nop 0
buffer_load_dwordx4 v15, s[4:7], s31 offen offset:0 sc1 lds
buffer_load_dwordx4 v15, s[4:7], s31 offen offset:1024 sc1 lds
s_add_u32 s30, s30, 65536
s_add_u32 s31, s31, 16384
s_add_u32 m0, s32, 49152
s_nop 0
buffer_load_dwordx4 v11, s[8:11], s30 offen offset:0 lds
buffer_load_dwordx4 v12, s[8:11], s30 offen offset:1024 lds
buffer_load_dwordx4 v13, s[8:11], s30 offen offset:2048 lds
buffer_load_dwordx4 v14, s[8:11], s30 offen offset:3072 lds
s_add_u32 m0, s33, 24576
s_nop 0
buffer_load_dwordx4 v15, s[4:7], s31 offen offset:0 sc1 lds
buffer_load_dwordx4 v15, s[4:7], s31 offen offset:1024 sc1 lds
s_add_u32 s30, s30, 65536
s_add_u32 s31, s31, 16384
s_add_u32 m0, s32, 65536
s_nop 0
buffer_load_dwordx4 v11, s[8:11], s30 offen offset:0 lds
buffer_load_dwordx4 v12, s[8:11], s30 offen offset:1024 lds
buffer_load_dwordx4 v13, s[8:11], s30 offen offset:2048 lds
buffer_load_dwordx4 v14, s[8:11], s30 offen offset:3072 lds
s_add_u32 m0, s33, 32768
s_nop 0
buffer_load_dwordx4 v15, s[4:7], s31 offen offset:0 sc1 lds
buffer_load_dwordx4 v15, s[4:7], s31 offen offset:1024 sc1 lds
s_add_u32 s30, s30, 65536
s_add_u32 s31, s31, 16384
s_waitcnt vmcnt(30)
v_mfma_f32_16x16x32_bf16 a[0:3], v[16:19], v[48:51], 0
v_mfma_f32_16x16x32_bf16 a[4:7], v[16:19], v[48:51], 0
v_mfma_f32_16x16x32_bf16 a[8:11], v[16:19], v[48:51], 0
v_mfma_f32_16x16x32_bf16 a[12:15], v[16:19], v[48:51], 0
v_mfma_f32_16x16x32_bf16 a[16:19], v[16:19], v[48:51], 0
v_mfma_f32_16x16x32_bf16 a[20:23], v[16:19], v[48:51], 0
v_mfma_f32_16x16x32_bf16 a[24:27], v[16:19], v[48:51], 0
v_mfma_f32_16x16x32_bf16 a[28:31], v[16:19], v[48:51], 0
v_mfma_f32_16x16x32_bf16 a[32:35], v[20:23], v[48:51], 0
v_mfma_f32_16x16x32_bf16 a[36:39], v[20:23], v[48:51], 0
v_mfma_f32_16x16x32_bf16 a[40:43], v[20:23], v[48:51], 0
v_mfma_f32_16x16x32_bf16 a[44:47], v[20:23], v[48:51], 0
v_mfma_f32_16x16x32_bf16 a[48:51], v[20:23], v[48:51], 0
v_mfma_f32_16x16x32_bf16 a[52:55], v[20:23], v[48:51], 0
v_mfma_f32_16x16x32_bf16 a[56:59], v[20:23], v[48:51], 0
v_mfma_f32_16x16x32_bf16 a[60:63], v[20:23], v[48:51], 0
v_mfma_f32_16x16x32_bf16 a[64:67], v[24:27], v[48:51], 0
v_mfma_f32_16x16x32_bf16 a[68:71], v[24:27], v[48:51], 0
v_mfma_f32_16x16x32_bf16 a[72:75], v[24:27], v[48:51], 0
v_mfma_f32_16x16x32_bf16 a[76:79], v[24:27], v[48:51], 0
v_mfma_f32_16x16x32_bf16 a[80:83], v[24:27], v[48:51], 0
v_mfma_f32_16x16x32_bf16 a[84:87], v[24:27], v[48:51], 0
v_mfma_f32_16x16x32_bf16 a[88:91], v[24:27], v[48:51], 0
v_mfma_f32_16x16x32_bf16 a[92:95], v[24:27], v[48:51], 0
v_mfma_f32_16x16x32_bf16 a[96:99], v[28:31], v[48:51], 0
v_mfma_f32_16x16x32_bf16 a[100:103], v[28:31], v[48:51], 0
v_mfma_f32_16x16x32_bf16 a[104:107], v[28:31], v[48:51], 0
v_mfma_f32_16x16x32_bf16 a[108:111], v[28:31], v[48:51], 0
v_mfma_f32_16x16x32_bf16 a[112:115], v[28:31], v[48:51], 0
v_mfma_f32_16x16x32_bf16 a[116:119], v[28:31], v[48:51], 0
v_mfma_f32_16x16x32_bf16 a[120:123], v[28:31], v[48:51], 0
v_mfma_f32_16x16x32_bf16 a[124:127], v[28:31], v[48:51], 0
s_waitcnt vmcnt(24)
s_barrier
ds_read_b128 v[96:99], v10 offset:0
ds_read_b128 v[100:103], v10 offset:1024
ds_read_b128 v[104:107], v10 offset:2048
ds_read_b128 v[108:111], v10 offset:3072
ds_read_b128 v[112:115], v10 offset:4096
ds_read_b128 v[116:119], v10 offset:5120
ds_read_b128 v[120:123], v10 offset:6144
ds_read_b128 v[124:127], v10 offset:7168
ds_read_b64_tr_b16 v[64:65], v2 offset:0
ds_read_b64_tr_b16 v[66:67], v2 offset:8192
ds_read_b64_tr_b16 v[68:69], v3 offset:0
ds_read_b64_tr_b16 v[70:71], v3 offset:8192
ds_read_b64_tr_b16 v[72:73], v4 offset:0
ds_read_b64_tr_b16 v[74:75], v4 offset:8192
ds_read_b64_tr_b16 v[76:77], v5 offset:0
ds_read_b64_tr_b16 v[78:79], v5 offset:8192
s_mov_b32 s37, 17
GL_69:
s_waitcnt lgkmcnt(0)
v_mfma_f32_16x16x32_bf16 a[0:3], v[64:67], v[96:99], a[0:3]
v_mfma_f32_16x16x32_bf16 a[4:7], v[64:67], v[100:103], a[4:7]
s_waitcnt vmcnt(18)
s_barrier
v_mfma_f32_16x16x32_bf16 a[8:11], v[64:67], v[104:107], a[8:11]
ds_read_b128 v[160:163], v10 offset:8192
v_mfma_f32_16x16x32_bf16 a[12:15], v[64:67], v[108:111], a[12:15]
ds_read_b128 v[164:167], v10 offset:9216
s_add_u32 m0, s32, 81920
v_mfma_f32_16x16x32_bf16 a[16:19], v[64:67], v[112:115], a[16:19]
ds_read_b128 v[168:171], v10 offset:10240
buffer_load_dwordx4 v11, s[8:11], s30 offen offset:0 lds
v_mfma_f32_16x16x32_bf16 a[20:23], v[64:67], v[116:119], a[20:23]
ds_read_b128 v[172:175], v10 offset:11264
v_mfma_f32_16x16x32_bf16 a[24:27], v[64:67], v[120:123], a[24:27]
ds_read_b128 v[176:179], v10 offset:12288
v_mfma_f32_16x16x32_bf16 a[28:31], v[64:67], v[124:127], a[28:31]
ds_read_b128 v[180:183], v10 offset:13312
v_mfma_f32_16x16x32_bf16 a[32:35], v[68:71], v[96:99], a[32:35]
ds_read_b128 v[184:187], v10 offset:14336
buffer_load_dwordx4 v12, s[8:11], s30 offen offset:1024 lds
v_mfma_f32_16x16x32_bf16 a[36:39], v[68:71], v[100:103], a[36:39]
ds_read_b128 v[188:191], v10 offset:15360
v_mfma_f32_16x16x32_bf16 a[40:43], v[68:71], v[104:107], a[40:43]
ds_read_b64_tr_b16 v[128:129], v2 offset:16384
v_mfma_f32_16x16x32_bf16 a[44:47], v[68:71], v[108:111], a[44:47]
ds_read_b64_tr_b16 v[130:131], v2 offset:24576
v_mfma_f32_16x16x32_bf16 a[48:51], v[68:71], v[112:115], a[48:51]
ds_read_b64_tr_b16 v[132:133], v3 offset:16384
buffer_load_dwordx4 v13, s[8:11], s30 offen offset:2048 lds
v_mfma_f32_16x16x32_bf16 a[52:55], v[68:71], v[116:119], a[52:55]
ds_read_b64_tr_b16 v[134:135], v3 offset:24576
v_mfma_f32_16x16x32_bf16 a[56:59], v[68:71], v[120:123], a[56:59]
ds_read_b64_tr_b16 v[136:137], v4 offset:16384
v_mfma_f32_16x16x32_bf16 a[60:63], v[68:71], v[124:127], a[60:63]
ds_read_b64_tr_b16 v[138:139], v4 offset:24576
v_mfma_f32_16x16x32_bf16 a[64:67], v[72:75], v[96:99], a[64:67]
ds_read_b64_tr_b16 v[140:141], v5 offset:16384
buffer_load_dwordx4 v14, s[8:11], s30 offen offset:3072 lds
v_mfma_f32_16x16x32_bf16 a[68:71], v[72:75], v[100:103], a[68:71]
ds_read_b64_tr_b16 v[142:143], v5 offset:24576
v_mfma_f32_16x16x32_bf16 a[72:75], v[72:75], v[104:107], a[72:75]
v_mfma_f32_16x16x32_bf16 a[76:79], v[72:75], v[108:111], a[76:79]
s_add_u32 m0, s33, 40960
v_mfma_f32_16x16x32_bf16 a[80:83], v[72:75], v[112:115], a[80:83]
buffer_load_dwordx4 v15, s[4:7], s31 offen offset:0 sc1 lds
v_mfma_f32_16x16x32_bf16 a[84:87], v[72:75], v[116:119], a[84:87]
v_mfma_f32_16x16x32_bf16 a[88:91], v[72:75], v[120:123], a[88:91]
v_mfma_f32_16x16x32_bf16 a[92:95], v[72:75], v[124:127], a[92:95]
v_mfma_f32_16x16x32_bf16 a[96:99], v[76:79], v[96:99], a[96:99]
buffer_load_dwordx4 v15, s[4:7], s31 offen offset:1024 sc1 lds
v_mfma_f32_16x16x32_bf16 a[100:103], v[76:79], v[100:103], a[100:103]
v_mfma_f32_16x16x32_bf16 a[104:107], v[76:79], v[104:107], a[104:107]
v_mfma_f32_16x16x32_bf16 a[108:111], v[76:79], v[108:111], a[108:111]
s_add_u32 s30, s30, 65536
v_mfma_f32_16x16x32_bf16 a[112:115], v[76:79], v[112:115], a[112:115]
s_add_u32 s31, s31, 16384
v_mfma_f32_16x16x32_bf16 a[116:119], v[76:79], v[116:119], a[116:119]
v_mfma_f32_16x16x32_bf16 a[120:123], v[76:79], v[120:123], a[120:123]
v_mfma_f32_16x16x32_bf16 a[124:127], v[76:79], v[124:127], a[124:127]
s_waitcnt lgkmcnt(0)
v_mfma_f32_16x16x32_bf16 a[0:3], v[128:131], v[160:163], a[0:3]
v_mfma_f32_16x16x32_bf16 a[4:7], v[128:131], v[164:167], a[4:7]
s_waitcnt vmcnt(18)
s_barrier
v_mfma_f32_16x16x32_bf16 a[8:11], v[128:131], v[168:171], a[8:11]
ds_read_b128 v[96:99], v10 offset:16384
v_mfma_f32_16x16x32_bf16 a[12:15], v[128:131], v[172:175], a[12:15]
ds_read_b128 v[100:103], v10 offset:17408
s_add_u32 m0, s32, 0
v_mfma_f32_16x16x32_bf16 a[16:19], v[128:131], v[176:179], a[16:19]
ds_read_b128 v[104:107], v10 offset:18432
buffer_load_dwordx4 v11, s[8:11], s30 offen offset:0 lds
v_mfma_f32_16x16x32_bf16 a[20:23], v[128:131], v[180:183], a[20:23]
ds_read_b128 v[108:111], v10 offset:19456
v_mfma_f32_16x16x32_bf16 a[24:27], v[128:131], v[184:187], a[24:27]
ds_read_b128 v[112:115], v10 offset:20480
v_mfma_f32_16x16x32_bf16 a[28:31], v[128:131], v[188:191], a[28:31]
ds_read_b128 v[116:119], v10 offset:21504
v_mfma_f32_16x16x32_bf16 a[32:35], v[132:135], v[160:163], a[32:35]
ds_read_b128 v[120:123], v10 offset:22528
buffer_load_dwordx4 v12, s[8:11], s30 offen offset:1024 lds
v_mfma_f32_16x16x32_bf16 a[36:39], v[132:135], v[164:167], a[36:39]
ds_read_b128 v[124:127], v10 offset:23552
v_mfma_f32_16x16x32_bf16 a[40:43], v[132:135], v[168:171], a[40:43]
ds_read_b64_tr_b16 v[64:65], v2 offset:32768
v_mfma_f32_16x16x32_bf16 a[44:47], v[132:135], v[172:175], a[44:47]
ds_read_b64_tr_b16 v[66:67], v2 offset:40960
v_mfma_f32_16x16x32_bf16 a[48:51], v[132:135], v[176:179], a[48:51]
ds_read_b64_tr_b16 v[68:69], v3 offset:32768
buffer_load_dwordx4 v13, s[8:11], s30 offen offset:2048 lds
v_mfma_f32_16x16x32_bf16 a[52:55], v[132:135], v[180:183], a[52:55]
ds_read_b64_tr_b16 v[70:71], v3 offset:40960
v_mfma_f32_16x16x32_bf16 a[56:59], v[132:135], v[184:187], a[56:59]
ds_read_b64_tr_b16 v[72:73], v4 offset:32768
v_mfma_f32_16x16x32_bf16 a[60:63], v[132:135], v[188:191], a[60:63]
ds_read_b64_tr_b16 v[74:75], v4 offset:40960
v_mfma_f32_16x16x32_bf16 a[64:67], v[136:139], v[160:163], a[64:67]
ds_read_b64_tr_b16 v[76:77], v5 offset:32768
buffer_load_dwordx4 v14, s[8:11], s30 offen offset:3072 lds
v_mfma_f32_16x16x32_bf16 a[68:71], v[136:139], v[164:167], a[68:71]
ds_read_b64_tr_b16 v[78:79], v5 offset:40960
v_mfma_f32_16x16x32_bf16 a[72:75], v[136:139], v[168:171], a[72:75]
v_mfma_f32_16x16x32_bf16 a[76:79], v[136:139], v[172:175], a[76:79]
s_add_u32 m0, s33, 0
v_mfma_f32_16x16x32_bf16 a[80:83], v[136:139], v[176:179], a[80:83]
buffer_load_dwordx4 v15, s[4:7], s31 offen offset:0 sc1 lds
v_mfma_f32_16x16x32_bf16 a[84:87], v[136:139], v[180:183], a[84:87]
v_mfma_f32_16x16x32_bf16 a[88:91], v[136:139], v[184:187], a[88:91]
v_mfma_f32_16x16x32_bf16 a[92:95], v[136:139], v[188:191], a[92:95]
v_mfma_f32_16x16x32_bf16 a[96:99], v[140:143], v[160:163], a[96:99]
buffer_load_dwordx4 v15, s[4:7], s31 offen offset:1024 sc1 lds
v_mfma_f32_16x16x32_bf16 a[100:103], v[140:143], v[164:167], a[100:103]
v_mfma_f32_16x16x32_bf16 a[104:107], v[140:143], v[168:171], a[104:107]
v_mfma_f32_16x16x32_bf16 a[108:111], v[140:143], v[172:175], a[108:111]
s_add_u32 s30, s30, 65536
v_mfma_f32_16x16x32_bf16 a[112:115], v[140:143], v[176:179], a[112:115]
s_add_u32 s31, s31, 16384
v_mfma_f32_16x16x32_bf16 a[116:119], v[140:143], v[180:183], a[116:119]
v_mfma_f32_16x16x32_bf16 a[120:123], v[140:143], v[184:187], a[120:123]
v_mfma_f32_16x16x32_bf16 a[124:127], v[140:143], v[188:191], a[124:127]
s_waitcnt lgkmcnt(0)
v_mfma_f32_16x16x32_bf16 a[0:3], v[64:67], v[96:99], a[0:3]
v_mfma_f32_16x16x32_bf16 a[4:7], v[64:67], v[100:103], a[4:7]
s_waitcnt vmcnt(18)
s_barrier
v_mfma_f32_16x16x32_bf16 a[8:11], v[64:67], v[104:107], a[8:11]
ds_read_b128 v[160:163], v10 offset:24576
v_mfma_f32_16x16x32_bf16 a[12:15], v[64:67], v[108:111], a[12:15]
ds_read_b128 v[164:167], v10 offset:25600
s_add_u32 m0, s32, 16384
v_mfma_f32_16x16x32_bf16 a[16:19], v[64:67], v[112:115], a[16:19]
ds_read_b128 v[168:171], v10 offset:26624
buffer_load_dwordx4 v11, s[8:11], s30 offen offset:0 lds
v_mfma_f32_16x16x32_bf16 a[20:23], v[64:67], v[116:119], a[20:23]
ds_read_b128 v[172:175], v10 offset:27648
v_mfma_f32_16x16x32_bf16 a[24:27], v[64:67], v[120:123], a[24:27]
ds_read_b128 v[176:179], v10 offset:28672
v_mfma_f32_16x16x32_bf16 a[28:31], v[64:67], v[124:127], a[28:31]
ds_read_b128 v[180:183], v10 offset:29696
v_mfma_f32_16x16x32_bf16 a[32:35], v[68:71], v[96:99], a[32:35]
ds_read_b128 v[184:187], v10 offset:30720
buffer_load_dwordx4 v12, s[8:11], s30 offen offset:1024 lds
v_mfma_f32_16x16x32_bf16 a[36:39], v[68:71], v[100:103], a[36:39]
ds_read_b128 v[188:191], v10 offset:31744
v_mfma_f32_16x16x32_bf16 a[40:43], v[68:71], v[104:107], a[40:43]
ds_read_b64_tr_b16 v[128:129], v2 offset:49152
v_mfma_f32_16x16x32_bf16 a[44:47], v[68:71], v[108:111], a[44:47]
ds_read_b64_tr_b16 v[130:131], v2 offset:57344
v_mfma_f32_16x16x32_bf16 a[48:51], v[68:71], v[112:115], a[48:51]
ds_read_b64_tr_b16 v[132:133], v3 offset:49152
buffer_load_dwordx4 v13, s[8:11], s30 offen offset:2048 lds
v_mfma_f32_16x16x32_bf16 a[52:55], v[68:71], v[116:119], a[52:55]
ds_read_b64_tr_b16 v[134:135], v3 offset:57344
v_mfma_f32_16x16x32_bf16 a[56:59], v[68:71], v[120:123], a[56:59]
ds_read_b64_tr_b16 v[136:137], v4 offset:49152
v_mfma_f32_16x16x32_bf16 a[60:63], v[68:71], v[124:127], a[60:63]
ds_read_b64_tr_b16 v[138:139], v4 offset:57344
v_mfma_f32_16x16x32_bf16 a[64:67], v[72:75], v[96:99], a[64:67]
ds_read_b64_tr_b16 v[140:141], v5 offset:49152
buffer_load_dwordx4 v14, s[8:11], s30 offen offset:3072 lds
v_mfma_f32_16x16x32_bf16 a[68:71], v[72:75], v[100:103], a[68:71]
ds_read_b64_tr_b16 v[142:143], v5 offset:57344
v_mfma_f32_16x16x32_bf16 a[72:75], v[72:75], v[104:107], a[72:75]
v_mfma_f32_16x16x32_bf16 a[76:79], v[72:75], v[108:111], a[76:79]
s_add_u32 m0, s33, 8192
v_mfma_f32_16x16x32_bf16 a[80:83], v[72:75], v[112:115], a[80:83]
buffer_load_dwordx4 v15, s[4:7], s31 offen offset:0 sc1 lds
v_mfma_f32_16x16x32_bf16 a[84:87], v[72:75], v[116:119], a[84:87]
v_mfma_f32_16x16x32_bf16 a[88:91], v[72:75], v[120:123], a[88:91]
v_mfma_f32_16x16x32_bf16 a[92:95], v[72:75], v[124:127], a[92:95]
v_mfma_f32_16x16x32_bf16 a[96:99], v[76:79], v[96:99], a[96:99]
buffer_load_dwordx4 v15, s[4:7], s31 offen offset:1024 sc1 lds
v_mfma_f32_16x16x32_bf16 a[100:103], v[76:79], v[100:103], a[100:103]
v_mfma_f32_16x16x32_bf16 a[104:107], v[76:79], v[104:107], a[104:107]
v_mfma_f32_16x16x32_bf16 a[108:111], v[76:79], v[108:111], a[108:111]
s_add_u32 s30, s30, 65536
v_mfma_f32_16x16x32_bf16 a[112:115], v[76:79], v[112:115], a[112:115]
s_add_u32 s31, s31, 16384
v_mfma_f32_16x16x32_bf16 a[116:119], v[76:79], v[116:119], a[116:119]
v_mfma_f32_16x16x32_bf16 a[120:123], v[76:79], v[120:123], a[120:123]
v_mfma_f32_16x16x32_bf16 a[124:127], v[76:79], v[124:127], a[124:127]
s_waitcnt lgkmcnt(0)
v_mfma_f32_16x16x32_bf16 a[0:3], v[128:131], v[160:163], a[0:3]
v_mfma_f32_16x16x32_bf16 a[4:7], v[128:131], v[164:167], a[4:7]
s_waitcnt vmcnt(18)
s_barrier
v_mfma_f32_16x16x32_bf16 a[8:11], v[128:131], v[168:171], a[8:11]
ds_read_b128 v[96:99], v10 offset:32768
v_mfma_f32_16x16x32_bf16 a[12:15], v[128:131], v[172:175], a[12:15]
ds_read_b128 v[100:103], v10 offset:33792
s_add_u32 m0, s32, 32768
v_mfma_f32_16x16x32_bf16 a[16:19], v[128:131], v[176:179], a[16:19]
ds_read_b128 v[104:107], v10 offset:34816
buffer_load_dwordx4 v11, s[8:11], s30 offen offset:0 lds
v_mfma_f32_16x16x32_bf16 a[20:23], v[128:131], v[180:183], a[20:23]
ds_read_b128 v[108:111], v10 offset:35840
v_mfma_f32_16x16x32_bf16 a[24:27], v[128:131], v[184:187], a[24:27]
ds_read_b128 v[112:115], v10 offset:36864
v_mfma_f32_16x16x32_bf16 a[28:31], v[128:131], v[188:191], a[28:31]
ds_read_b128 v[116:119], v10 offset:37888
v_mfma_f32_16x16x32_bf16 a[32:35], v[132:135], v[160:163], a[32:35]
ds_read_b128 v[120:123], v10 offset:38912
buffer_load_dwordx4 v12, s[8:11], s30 offen offset:1024 lds
v_mfma_f32_16x16x32_bf16 a[36:39], v[132:135], v[164:167], a[36:39]
ds_read_b128 v[124:127], v10 offset:39936
v_mfma_f32_16x16x32_bf16 a[40:43], v[132:135], v[168:171], a[40:43]
ds_read_b64_tr_b16 v[64:65], v192 offset:0
v_mfma_f32_16x16x32_bf16 a[44:47], v[132:135], v[172:175], a[44:47]
ds_read_b64_tr_b16 v[66:67], v192 offset:8192
v_mfma_f32_16x16x32_bf16 a[48:51], v[132:135], v[176:179], a[48:51]
ds_read_b64_tr_b16 v[68:69], v193 offset:0
buffer_load_dwordx4 v13, s[8:11], s30 offen offset:2048 lds
v_mfma_f32_16x16x32_bf16 a[52:55], v[132:135], v[180:183], a[52:55]
ds_read_b64_tr_b16 v[70:71], v193 offset:8192
v_mfma_f32_16x16x32_bf16 a[56:59], v[132:135], v[184:187], a[56:59]
ds_read_b64_tr_b16 v[72:73], v194 offset:0
v_mfma_f32_16x16x32_bf16 a[60:63], v[132:135], v[188:191], a[60:63]
ds_read_b64_tr_b16 v[74:75], v194 offset:8192
v_mfma_f32_16x16x32_bf16 a[64:67], v[136:139], v[160:163], a[64:67]
ds_read_b64_tr_b16 v[76:77], v195 offset:0
buffer_load_dwordx4 v14, s[8:11], s30 offen offset:3072 lds
v_mfma_f32_16x16x32_bf16 a[68:71], v[136:139], v[164:167], a[68:71]
ds_read_b64_tr_b16 v[78:79], v195 offset:8192
v_mfma_f32_16x16x32_bf16 a[72:75], v[136:139], v[168:171], a[72:75]
v_mfma_f32_16x16x32_bf16 a[76:79], v[136:139], v[172:175], a[76:79]
s_add_u32 m0, s33, 16384
v_mfma_f32_16x16x32_bf16 a[80:83], v[136:139], v[176:179], a[80:83]
buffer_load_dwordx4 v15, s[4:7], s31 offen offset:0 sc1 lds
v_mfma_f32_16x16x32_bf16 a[84:87], v[136:139], v[180:183], a[84:87]
v_mfma_f32_16x16x32_bf16 a[88:91], v[136:139], v[184:187], a[88:91]
v_mfma_f32_16x16x32_bf16 a[92:95], v[136:139], v[188:191], a[92:95]
v_mfma_f32_16x16x32_bf16 a[96:99], v[140:143], v[160:163], a[96:99]
buffer_load_dwordx4 v15, s[4:7], s31 offen offset:1024 sc1 lds
v_mfma_f32_16x16x32_bf16 a[100:103], v[140:143], v[164:167], a[100:103]
v_mfma_f32_16x16x32_bf16 a[104:107], v[140:143], v[168:171], a[104:107]
v_mfma_f32_16x16x32_bf16 a[108:111], v[140:143], v[172:175], a[108:111]
s_add_u32 s30, s30, 65536
v_mfma_f32_16x16x32_bf16 a[112:115], v[140:143], v[176:179], a[112:115]
s_add_u32 s31, s31, 16384
v_mfma_f32_16x16x32_bf16 a[116:119], v[140:143], v[180:183], a[116:119]
v_mfma_f32_16x16x32_bf16 a[120:123], v[140:143], v[184:187], a[120:123]
v_mfma_f32_16x16x32_bf16 a[124:127], v[140:143], v[188:191], a[124:127]
s_waitcnt lgkmcnt(0)
v_mfma_f32_16x16x32_bf16 a[0:3], v[64:67], v[96:99], a[0:3]
v_mfma_f32_16x16x32_bf16 a[4:7], v[64:67], v[100:103], a[4:7]
s_waitcnt vmcnt(18)
s_barrier
v_mfma_f32_16x16x32_bf16 a[8:11], v[64:67], v[104:107], a[8:11]
ds_read_b128 v[160:163], v10 offset:40960
v_mfma_f32_16x16x32_bf16 a[12:15], v[64:67], v[108:111], a[12:15]
ds_read_b128 v[164:167], v10 offset:41984
s_add_u32 m0, s32, 49152
v_mfma_f32_16x16x32_bf16 a[16:19], v[64:67], v[112:115], a[16:19]
ds_read_b128 v[168:171], v10 offset:43008
buffer_load_dwordx4 v11, s[8:11], s30 offen offset:0 lds
v_mfma_f32_16x16x32_bf16 a[20:23], v[64:67], v[116:119], a[20:23]
ds_read_b128 v[172:175], v10 offset:44032
v_mfma_f32_16x16x32_bf16 a[24:27], v[64:67], v[120:123], a[24:27]
ds_read_b128 v[176:179], v10 offset:45056
v_mfma_f32_16x16x32_bf16 a[28:31], v[64:67], v[124:127], a[28:31]
ds_read_b128 v[180:183], v10 offset:46080
v_mfma_f32_16x16x32_bf16 a[32:35], v[68:71], v[96:99], a[32:35]
ds_read_b128 v[184:187], v10 offset:47104
buffer_load_dwordx4 v12, s[8:11], s30 offen offset:1024 lds
v_mfma_f32_16x16x32_bf16 a[36:39], v[68:71], v[100:103], a[36:39]
ds_read_b128 v[188:191], v10 offset:48128
v_mfma_f32_16x16x32_bf16 a[40:43], v[68:71], v[104:107], a[40:43]
ds_read_b64_tr_b16 v[128:129], v192 offset:16384
v_mfma_f32_16x16x32_bf16 a[44:47], v[68:71], v[108:111], a[44:47]
ds_read_b64_tr_b16 v[130:131], v192 offset:24576
v_mfma_f32_16x16x32_bf16 a[48:51], v[68:71], v[112:115], a[48:51]
ds_read_b64_tr_b16 v[132:133], v193 offset:16384
buffer_load_dwordx4 v13, s[8:11], s30 offen offset:2048 lds
v_mfma_f32_16x16x32_bf16 a[52:55], v[68:71], v[116:119], a[52:55]
ds_read_b64_tr_b16 v[134:135], v193 offset:24576
v_mfma_f32_16x16x32_bf16 a[56:59], v[68:71], v[120:123], a[56:59]
ds_read_b64_tr_b16 v[136:137], v194 offset:16384
v_mfma_f32_16x16x32_bf16 a[60:63], v[68:71], v[124:127], a[60:63]
ds_read_b64_tr_b16 v[138:139], v194 offset:24576
v_mfma_f32_16x16x32_bf16 a[64:67], v[72:75], v[96:99], a[64:67]
ds_read_b64_tr_b16 v[140:141], v195 offset:16384
buffer_load_dwordx4 v14, s[8:11], s30 offen offset:3072 lds
v_mfma_f32_16x16x32_bf16 a[68:71], v[72:75], v[100:103], a[68:71]
ds_read_b64_tr_b16 v[142:143], v195 offset:24576
v_mfma_f32_16x16x32_bf16 a[72:75], v[72:75], v[104:107], a[72:75]
v_mfma_f32_16x16x32_bf16 a[76:79], v[72:75], v[108:111], a[76:79]
s_add_u32 m0, s33, 24576
v_mfma_f32_16x16x32_bf16 a[80:83], v[72:75], v[112:115], a[80:83]
buffer_load_dwordx4 v15, s[4:7], s31 offen offset:0 sc1 lds
v_mfma_f32_16x16x32_bf16 a[84:87], v[72:75], v[116:119], a[84:87]
v_mfma_f32_16x16x32_bf16 a[88:91], v[72:75], v[120:123], a[88:91]
v_mfma_f32_16x16x32_bf16 a[92:95], v[72:75], v[124:127], a[92:95]
v_mfma_f32_16x16x32_bf16 a[96:99], v[76:79], v[96:99], a[96:99]
buffer_load_dwordx4 v15, s[4:7], s31 offen offset:1024 sc1 lds
v_mfma_f32_16x16x32_bf16 a[100:103], v[76:79], v[100:103], a[100:103]
v_mfma_f32_16x16x32_bf16 a[104:107], v[76:79], v[104:107], a[104:107]
v_mfma_f32_16x16x32_bf16 a[108:111], v[76:79], v[108:111], a[108:111]
s_add_u32 s30, s30, 65536
v_mfma_f32_16x16x32_bf16 a[112:115], v[76:79], v[112:115], a[112:115]
s_add_u32 s31, s31, 16384
v_mfma_f32_16x16x32_bf16 a[116:119], v[76:79], v[116:119], a[116:119]
v_mfma_f32_16x16x32_bf16 a[120:123], v[76:79], v[120:123], a[120:123]
v_mfma_f32_16x16x32_bf16 a[124:127], v[76:79], v[124:127], a[124:127]
s_waitcnt lgkmcnt(0)
v_mfma_f32_16x16x32_bf16 a[0:3], v[128:131], v[160:163], a[0:3]
v_mfma_f32_16x16x32_bf16 a[4:7], v[128:131], v[164:167], a[4:7]
s_waitcnt vmcnt(18)
s_barrier
v_mfma_f32_16x16x32_bf16 a[8:11], v[128:131], v[168:171], a[8:11]
ds_read_b128 v[96:99], v10 offset:0
v_mfma_f32_16x16x32_bf16 a[12:15], v[128:131], v[172:175], a[12:15]
ds_read_b128 v[100:103], v10 offset:1024
s_add_u32 m0, s32, 65536
v_mfma_f32_16x16x32_bf16 a[16:19], v[128:131], v[176:179], a[16:19]
ds_read_b128 v[104:107], v10 offset:2048
buffer_load_dwordx4 v11, s[8:11], s30 offen offset:0 lds
v_mfma_f32_16x16x32_bf16 a[20:23], v[128:131], v[180:183], a[20:23]
ds_read_b128 v[108:111], v10 offset:3072
v_mfma_f32_16x16x32_bf16 a[24:27], v[128:131], v[184:187], a[24:27]
ds_read_b128 v[112:115], v10 offset:4096
v_mfma_f32_16x16x32_bf16 a[28:31], v[128:131], v[188:191], a[28:31]
ds_read_b128 v[116:119], v10 offset:5120
v_mfma_f32_16x16x32_bf16 a[32:35], v[132:135], v[160:163], a[32:35]
ds_read_b128 v[120:123], v10 offset:6144
buffer_load_dwordx4 v12, s[8:11], s30 offen offset:1024 lds
v_mfma_f32_16x16x32_bf16 a[36:39], v[132:135], v[164:167], a[36:39]
ds_read_b128 v[124:127], v10 offset:7168
v_mfma_f32_16x16x32_bf16 a[40:43], v[132:135], v[168:171], a[40:43]
ds_read_b64_tr_b16 v[64:65], v2 offset:0
v_mfma_f32_16x16x32_bf16 a[44:47], v[132:135], v[172:175], a[44:47]
ds_read_b64_tr_b16 v[66:67], v2 offset:8192
v_mfma_f32_16x16x32_bf16 a[48:51], v[132:135], v[176:179], a[48:51]
ds_read_b64_tr_b16 v[68:69], v3 offset:0
buffer_load_dwordx4 v13, s[8:11], s30 offen offset:2048 lds
v_mfma_f32_16x16x32_bf16 a[52:55], v[132:135], v[180:183], a[52:55]
ds_read_b64_tr_b16 v[70:71], v3 offset:8192
v_mfma_f32_16x16x32_bf16 a[56:59], v[132:135], v[184:187], a[56:59]
ds_read_b64_tr_b16 v[72:73], v4 offset:0
v_mfma_f32_16x16x32_bf16 a[60:63], v[132:135], v[188:191], a[60:63]
ds_read_b64_tr_b16 v[74:75], v4 offset:8192
v_mfma_f32_16x16x32_bf16 a[64:67], v[136:139], v[160:163], a[64:67]
ds_read_b64_tr_b16 v[76:77], v5 offset:0
buffer_load_dwordx4 v14, s[8:11], s30 offen offset:3072 lds
v_mfma_f32_16x16x32_bf16 a[68:71], v[136:139], v[164:167], a[68:71]
ds_read_b64_tr_b16 v[78:79], v5 offset:8192
v_mfma_f32_16x16x32_bf16 a[72:75], v[136:139], v[168:171], a[72:75]
v_mfma_f32_16x16x32_bf16 a[76:79], v[136:139], v[172:175], a[76:79]
s_add_u32 m0, s33, 32768
v_mfma_f32_16x16x32_bf16 a[80:83], v[136:139], v[176:179], a[80:83]
buffer_load_dwordx4 v15, s[4:7], s31 offen offset:0 sc1 lds
v_mfma_f32_16x16x32_bf16 a[84:87], v[136:139], v[180:183], a[84:87]
v_mfma_f32_16x16x32_bf16 a[88:91], v[136:139], v[184:187], a[88:91]
v_mfma_f32_16x16x32_bf16 a[92:95], v[136:139], v[188:191], a[92:95]
v_mfma_f32_16x16x32_bf16 a[96:99], v[140:143], v[160:163], a[96:99]
buffer_load_dwordx4 v15, s[4:7], s31 offen offset:1024 sc1 lds
v_mfma_f32_16x16x32_bf16 a[100:103], v[140:143], v[164:167], a[100:103]
v_mfma_f32_16x16x32_bf16 a[104:107], v[140:143], v[168:171], a[104:107]
v_mfma_f32_16x16x32_bf16 a[108:111], v[140:143], v[172:175], a[108:111]
s_add_u32 s30, s30, 65536
v_mfma_f32_16x16x32_bf16 a[112:115], v[140:143], v[176:179], a[112:115]
s_add_u32 s31, s31, 16384
v_mfma_f32_16x16x32_bf16 a[116:119], v[140:143], v[180:183], a[116:119]
v_mfma_f32_16x16x32_bf16 a[120:123], v[140:143], v[184:187], a[120:123]
v_mfma_f32_16x16x32_bf16 a[124:127], v[140:143], v[188:191], a[124:127]
s_sub_u32 s37, s37, 1
s_cmp_lg_u32 s37, 0
s_cbranch_scc1 GL_69
s_waitcnt lgkmcnt(0)
v_mfma_f32_16x16x32_bf16 a[0:3], v[64:67], v[96:99], a[0:3]
v_mfma_f32_16x16x32_bf16 a[4:7], v[64:67], v[100:103], a[4:7]
s_waitcnt vmcnt(18)
s_barrier
v_mfma_f32_16x16x32_bf16 a[8:11], v[64:67], v[104:107], a[8:11]
ds_read_b128 v[160:163], v10 offset:8192
v_mfma_f32_16x16x32_bf16 a[12:15], v[64:67], v[108:111], a[12:15]
ds_read_b128 v[164:167], v10 offset:9216
s_add_u32 m0, s32, 81920
v_mfma_f32_16x16x32_bf16 a[16:19], v[64:67], v[112:115], a[16:19]
ds_read_b128 v[168:171], v10 offset:10240
buffer_load_dwordx4 v11, s[8:11], s30 offen offset:0 lds
v_mfma_f32_16x16x32_bf16 a[20:23], v[64:67], v[116:119], a[20:23]
ds_read_b128 v[172:175], v10 offset:11264
v_mfma_f32_16x16x32_bf16 a[24:27], v[64:67], v[120:123], a[24:27]
ds_read_b128 v[176:179], v10 offset:12288
v_mfma_f32_16x16x32_bf16 a[28:31], v[64:67], v[124:127], a[28:31]
ds_read_b128 v[180:183], v10 offset:13312
v_mfma_f32_16x16x32_bf16 a[32:35], v[68:71], v[96:99], a[32:35]
ds_read_b128 v[184:187], v10 offset:14336
buffer_load_dwordx4 v12, s[8:11], s30 offen offset:1024 lds
v_mfma_f32_16x16x32_bf16 a[36:39], v[68:71], v[100:103], a[36:39]
ds_read_b128 v[188:191], v10 offset:15360
v_mfma_f32_16x16x32_bf16 a[40:43], v[68:71], v[104:107], a[40:43]
ds_read_b64_tr_b16 v[128:129], v2 offset:16384
v_mfma_f32_16x16x32_bf16 a[44:47], v[68:71], v[108:111], a[44:47]
ds_read_b64_tr_b16 v[130:131], v2 offset:24576
v_mfma_f32_16x16x32_bf16 a[48:51], v[68:71], v[112:115], a[48:51]
ds_read_b64_tr_b16 v[132:133], v3 offset:16384
buffer_load_dwordx4 v13, s[8:11], s30 offen offset:2048 lds
v_mfma_f32_16x16x32_bf16 a[52:55], v[68:71], v[116:119], a[52:55]
ds_read_b64_tr_b16 v[134:135], v3 offset:24576
v_mfma_f32_16x16x32_bf16 a[56:59], v[68:71], v[120:123], a[56:59]
ds_read_b64_tr_b16 v[136:137], v4 offset:16384
v_mfma_f32_16x16x32_bf16 a[60:63], v[68:71], v[124:127], a[60:63]
ds_read_b64_tr_b16 v[138:139], v4 offset:24576
v_mfma_f32_16x16x32_bf16 a[64:67], v[72:75], v[96:99], a[64:67]
ds_read_b64_tr_b16 v[140:141], v5 offset:16384
buffer_load_dwordx4 v14, s[8:11], s30 offen offset:3072 lds
v_mfma_f32_16x16x32_bf16 a[68:71], v[72:75], v[100:103], a[68:71]
ds_read_b64_tr_b16 v[142:143], v5 offset:24576
v_mfma_f32_16x16x32_bf16 a[72:75], v[72:75], v[104:107], a[72:75]
v_mfma_f32_16x16x32_bf16 a[76:79], v[72:75], v[108:111], a[76:79]
s_add_u32 m0, s33, 40960
v_mfma_f32_16x16x32_bf16 a[80:83], v[72:75], v[112:115], a[80:83]
buffer_load_dwordx4 v15, s[4:7], s31 offen offset:0 sc1 lds
v_mfma_f32_16x16x32_bf16 a[84:87], v[72:75], v[116:119], a[84:87]
v_mfma_f32_16x16x32_bf16 a[88:91], v[72:75], v[120:123], a[88:91]
v_mfma_f32_16x16x32_bf16 a[92:95], v[72:75], v[124:127], a[92:95]
v_mfma_f32_16x16x32_bf16 a[96:99], v[76:79], v[96:99], a[96:99]
buffer_load_dwordx4 v15, s[4:7], s31 offen offset:1024 sc1 lds
v_mfma_f32_16x16x32_bf16 a[100:103], v[76:79], v[100:103], a[100:103]
v_mfma_f32_16x16x32_bf16 a[104:107], v[76:79], v[104:107], a[104:107]
v_mfma_f32_16x16x32_bf16 a[108:111], v[76:79], v[108:111], a[108:111]
s_add_u32 s30, s30, 65536
v_mfma_f32_16x16x32_bf16 a[112:115], v[76:79], v[112:115], a[112:115]
s_add_u32 s31, s31, 16384
v_mfma_f32_16x16x32_bf16 a[116:119], v[76:79], v[116:119], a[116:119]
v_mfma_f32_16x16x32_bf16 a[120:123], v[76:79], v[120:123], a[120:123]
v_mfma_f32_16x16x32_bf16 a[124:127], v[76:79], v[124:127], a[124:127]
s_waitcnt lgkmcnt(0)
v_mfma_f32_16x16x32_bf16 a[0:3], v[128:131], v[160:163], a[0:3]
v_mfma_f32_16x16x32_bf16 a[4:7], v[128:131], v[164:167], a[4:7]
s_waitcnt vmcnt(18)
s_barrier
v_mfma_f32_16x16x32_bf16 a[8:11], v[128:131], v[168:171], a[8:11]
ds_read_b128 v[96:99], v10 offset:16384
v_mfma_f32_16x16x32_bf16 a[12:15], v[128:131], v[172:175], a[12:15]
ds_read_b128 v[100:103], v10 offset:17408
s_add_u32 m0, s32, 0
v_mfma_f32_16x16x32_bf16 a[16:19], v[128:131], v[176:179], a[16:19]
ds_read_b128 v[104:107], v10 offset:18432
buffer_load_dwordx4 v11, s[8:11], s30 offen offset:0 lds
v_mfma_f32_16x16x32_bf16 a[20:23], v[128:131], v[180:183], a[20:23]
ds_read_b128 v[108:111], v10 offset:19456
v_mfma_f32_16x16x32_bf16 a[24:27], v[128:131], v[184:187], a[24:27]
ds_read_b128 v[112:115], v10 offset:20480
v_mfma_f32_16x16x32_bf16 a[28:31], v[128:131], v[188:191], a[28:31]
ds_read_b128 v[116:119], v10 offset:21504
v_mfma_f32_16x16x32_bf16 a[32:35], v[132:135], v[160:163], a[32:35]
ds_read_b128 v[120:123], v10 offset:22528
buffer_load_dwordx4 v12, s[8:11], s30 offen offset:1024 lds
v_mfma_f32_16x16x32_bf16 a[36:39], v[132:135], v[164:167], a[36:39]
ds_read_b128 v[124:127], v10 offset:23552
v_mfma_f32_16x16x32_bf16 a[40:43], v[132:135], v[168:171], a[40:43]
ds_read_b64_tr_b16 v[64:65], v2 offset:32768
v_mfma_f32_16x16x32_bf16 a[44:47], v[132:135], v[172:175], a[44:47]
ds_read_b64_tr_b16 v[66:67], v2 offset:40960
v_mfma_f32_16x16x32_bf16 a[48:51], v[132:135], v[176:179], a[48:51]
ds_read_b64_tr_b16 v[68:69], v3 offset:32768
buffer_load_dwordx4 v13, s[8:11], s30 offen offset:2048 lds
v_mfma_f32_16x16x32_bf16 a[52:55], v[132:135], v[180:183], a[52:55]
ds_read_b64_tr_b16 v[70:71], v3 offset:40960
v_mfma_f32_16x16x32_bf16 a[56:59], v[132:135], v[184:187], a[56:59]
ds_read_b64_tr_b16 v[72:73], v4 offset:32768
v_mfma_f32_16x16x32_bf16 a[60:63], v[132:135], v[188:191], a[60:63]
ds_read_b64_tr_b16 v[74:75], v4 offset:40960
v_mfma_f32_16x16x32_bf16 a[64:67], v[136:139], v[160:163], a[64:67]
ds_read_b64_tr_b16 v[76:77], v5 offset:32768
buffer_load_dwordx4 v14, s[8:11], s30 offen offset:3072 lds
v_mfma_f32_16x16x32_bf16 a[68:71], v[136:139], v[164:167], a[68:71]
ds_read_b64_tr_b16 v[78:79], v5 offset:40960
v_mfma_f32_16x16x32_bf16 a[72:75], v[136:139], v[168:171], a[72:75]
v_mfma_f32_16x16x32_bf16 a[76:79], v[136:139], v[172:175], a[76:79]
s_add_u32 m0, s33, 0
v_mfma_f32_16x16x32_bf16 a[80:83], v[136:139], v[176:179], a[80:83]
buffer_load_dwordx4 v15, s[4:7], s31 offen offset:0 sc1 lds
v_mfma_f32_16x16x32_bf16 a[84:87], v[136:139], v[180:183], a[84:87]
v_mfma_f32_16x16x32_bf16 a[88:91], v[136:139], v[184:187], a[88:91]
v_mfma_f32_16x16x32_bf16 a[92:95], v[136:139], v[188:191], a[92:95]
v_mfma_f32_16x16x32_bf16 a[96:99], v[140:143], v[160:163], a[96:99]
buffer_load_dwordx4 v15, s[4:7], s31 offen offset:1024 sc1 lds
v_mfma_f32_16x16x32_bf16 a[100:103], v[140:143], v[164:167], a[100:103]
v_mfma_f32_16x16x32_bf16 a[104:107], v[140:143], v[168:171], a[104:107]
v_mfma_f32_16x16x32_bf16 a[108:111], v[140:143], v[172:175], a[108:111]
s_add_u32 s30, s30, 65536
v_mfma_f32_16x16x32_bf16 a[112:115], v[140:143], v[176:179], a[112:115]
s_add_u32 s31, s31, 16384
v_mfma_f32_16x16x32_bf16 a[116:119], v[140:143], v[180:183], a[116:119]
v_mfma_f32_16x16x32_bf16 a[120:123], v[140:143], v[184:187], a[120:123]
v_mfma_f32_16x16x32_bf16 a[124:127], v[140:143], v[188:191], a[124:127]
s_waitcnt lgkmcnt(0)
v_mfma_f32_16x16x32_bf16 a[0:3], v[64:67], v[96:99], a[0:3]
v_mfma_f32_16x16x32_bf16 a[4:7], v[64:67], v[100:103], a[4:7]
s_waitcnt vmcnt(18)
s_barrier
v_mfma_f32_16x16x32_bf16 a[8:11], v[64:67], v[104:107], a[8:11]
ds_read_b128 v[160:163], v10 offset:24576
v_mfma_f32_16x16x32_bf16 a[12:15], v[64:67], v[108:111], a[12:15]
ds_read_b128 v[164:167], v10 offset:25600
s_add_u32 m0, s32, 16384
v_mfma_f32_16x16x32_bf16 a[16:19], v[64:67], v[112:115], a[16:19]
ds_read_b128 v[168:171], v10 offset:26624
buffer_load_dwordx4 v11, s[8:11], s30 offen offset:0 lds
v_mfma_f32_16x16x32_bf16 a[20:23], v[64:67], v[116:119], a[20:23]
ds_read_b128 v[172:175], v10 offset:27648
v_mfma_f32_16x16x32_bf16 a[24:27], v[64:67], v[120:123], a[24:27]
ds_read_b128 v[176:179], v10 offset:28672
v_mfma_f32_16x16x32_bf16 a[28:31], v[64:67], v[124:127], a[28:31]
ds_read_b128 v[180:183], v10 offset:29696
v_mfma_f32_16x16x32_bf16 a[32:35], v[68:71], v[96:99], a[32:35]
ds_read_b128 v[184:187], v10 offset:30720
buffer_load_dwordx4 v12, s[8:11], s30 offen offset:1024 lds
v_mfma_f32_16x16x32_bf16 a[36:39], v[68:71], v[100:103], a[36:39]
ds_read_b128 v[188:191], v10 offset:31744
v_mfma_f32_16x16x32_bf16 a[40:43], v[68:71], v[104:107], a[40:43]
ds_read_b64_tr_b16 v[128:129], v2 offset:49152
v_mfma_f32_16x16x32_bf16 a[44:47], v[68:71], v[108:111], a[44:47]
ds_read_b64_tr_b16 v[130:131], v2 offset:57344
v_mfma_f32_16x16x32_bf16 a[48:51], v[68:71], v[112:115], a[48:51]
ds_read_b64_tr_b16 v[132:133], v3 offset:49152
buffer_load_dwordx4 v13, s[8:11], s30 offen offset:2048 lds
v_mfma_f32_16x16x32_bf16 a[52:55], v[68:71], v[116:119], a[52:55]
ds_read_b64_tr_b16 v[134:135], v3 offset:57344
v_mfma_f32_16x16x32_bf16 a[56:59], v[68:71], v[120:123], a[56:59]
ds_read_b64_tr_b16 v[136:137], v4 offset:49152
v_mfma_f32_16x16x32_bf16 a[60:63], v[68:71], v[124:127], a[60:63]
ds_read_b64_tr_b16 v[138:139], v4 offset:57344
v_mfma_f32_16x16x32_bf16 a[64:67], v[72:75], v[96:99], a[64:67]
ds_read_b64_tr_b16 v[140:141], v5 offset:49152
buffer_load_dwordx4 v14, s[8:11], s30 offen offset:3072 lds
v_mfma_f32_16x16x32_bf16 a[68:71], v[72:75], v[100:103], a[68:71]
ds_read_b64_tr_b16 v[142:143], v5 offset:57344
v_mfma_f32_16x16x32_bf16 a[72:75], v[72:75], v[104:107], a[72:75]
v_mfma_f32_16x16x32_bf16 a[76:79], v[72:75], v[108:111], a[76:79]
s_add_u32 m0, s33, 8192
v_mfma_f32_16x16x32_bf16 a[80:83], v[72:75], v[112:115], a[80:83]
buffer_load_dwordx4 v15, s[4:7], s31 offen offset:0 sc1 lds
v_mfma_f32_16x16x32_bf16 a[84:87], v[72:75], v[116:119], a[84:87]
v_mfma_f32_16x16x32_bf16 a[88:91], v[72:75], v[120:123], a[88:91]
v_mfma_f32_16x16x32_bf16 a[92:95], v[72:75], v[124:127], a[92:95]
v_mfma_f32_16x16x32_bf16 a[96:99], v[76:79], v[96:99], a[96:99]
buffer_load_dwordx4 v15, s[4:7], s31 offen offset:1024 sc1 lds
v_mfma_f32_16x16x32_bf16 a[100:103], v[76:79], v[100:103], a[100:103]
v_mfma_f32_16x16x32_bf16 a[104:107], v[76:79], v[104:107], a[104:107]
v_mfma_f32_16x16x32_bf16 a[108:111], v[76:79], v[108:111], a[108:111]
s_add_u32 s30, s30, 65536
v_mfma_f32_16x16x32_bf16 a[112:115], v[76:79], v[112:115], a[112:115]
s_add_u32 s31, s31, 16384
v_mfma_f32_16x16x32_bf16 a[116:119], v[76:79], v[116:119], a[116:119]
v_mfma_f32_16x16x32_bf16 a[120:123], v[76:79], v[120:123], a[120:123]
v_mfma_f32_16x16x32_bf16 a[124:127], v[76:79], v[124:127], a[124:127]
s_waitcnt lgkmcnt(0)
v_mfma_f32_16x16x32_bf16 a[0:3], v[128:131], v[160:163], a[0:3]
v_mfma_f32_16x16x32_bf16 a[4:7], v[128:131], v[164:167], a[4:7]
s_waitcnt vmcnt(18)
s_barrier
v_mfma_f32_16x16x32_bf16 a[8:11], v[128:131], v[168:171], a[8:11]
ds_read_b128 v[96:99], v10 offset:32768
v_mfma_f32_16x16x32_bf16 a[12:15], v[128:131], v[172:175], a[12:15]
ds_read_b128 v[100:103], v10 offset:33792
s_add_u32 m0, s32, 32768
v_mfma_f32_16x16x32_bf16 a[16:19], v[128:131], v[176:179], a[16:19]
ds_read_b128 v[104:107], v10 offset:34816
buffer_load_dwordx4 v11, s[8:11], s30 offen offset:0 lds
v_mfma_f32_16x16x32_bf16 a[20:23], v[128:131], v[180:183], a[20:23]
ds_read_b128 v[108:111], v10 offset:35840
v_mfma_f32_16x16x32_bf16 a[24:27], v[128:131], v[184:187], a[24:27]
ds_read_b128 v[112:115], v10 offset:36864
v_mfma_f32_16x16x32_bf16 a[28:31], v[128:131], v[188:191], a[28:31]
ds_read_b128 v[116:119], v10 offset:37888
v_mfma_f32_16x16x32_bf16 a[32:35], v[132:135], v[160:163], a[32:35]
ds_read_b128 v[120:123], v10 offset:38912
buffer_load_dwordx4 v12, s[8:11], s30 offen offset:1024 lds
v_mfma_f32_16x16x32_bf16 a[36:39], v[132:135], v[164:167], a[36:39]
ds_read_b128 v[124:127], v10 offset:39936
v_mfma_f32_16x16x32_bf16 a[40:43], v[132:135], v[168:171], a[40:43]
ds_read_b64_tr_b16 v[64:65], v192 offset:0
v_mfma_f32_16x16x32_bf16 a[44:47], v[132:135], v[172:175], a[44:47]
ds_read_b64_tr_b16 v[66:67], v192 offset:8192
v_mfma_f32_16x16x32_bf16 a[48:51], v[132:135], v[176:179], a[48:51]
ds_read_b64_tr_b16 v[68:69], v193 offset:0
buffer_load_dwordx4 v13, s[8:11], s30 offen offset:2048 lds
v_mfma_f32_16x16x32_bf16 a[52:55], v[132:135], v[180:183], a[52:55]
ds_read_b64_tr_b16 v[70:71], v193 offset:8192
v_mfma_f32_16x16x32_bf16 a[56:59], v[132:135], v[184:187], a[56:59]
ds_read_b64_tr_b16 v[72:73], v194 offset:0
v_mfma_f32_16x16x32_bf16 a[60:63], v[132:135], v[188:191], a[60:63]
ds_read_b64_tr_b16 v[74:75], v194 offset:8192
v_mfma_f32_16x16x32_bf16 a[64:67], v[136:139], v[160:163], a[64:67]
ds_read_b64_tr_b16 v[76:77], v195 offset:0
buffer_load_dwordx4 v14, s[8:11], s30 offen offset:3072 lds
v_mfma_f32_16x16x32_bf16 a[68:71], v[136:139], v[164:167], a[68:71]
ds_read_b64_tr_b16 v[78:79], v195 offset:8192
v_mfma_f32_16x16x32_bf16 a[72:75], v[136:139], v[168:171], a[72:75]
v_mfma_f32_16x16x32_bf16 a[76:79], v[136:139], v[172:175], a[76:79]
s_add_u32 m0, s33, 16384
v_mfma_f32_16x16x32_bf16 a[80:83], v[136:139], v[176:179], a[80:83]
buffer_load_dwordx4 v15, s[4:7], s31 offen offset:0 sc1 lds
v_mfma_f32_16x16x32_bf16 a[84:87], v[136:139], v[180:183], a[84:87]
v_mfma_f32_16x16x32_bf16 a[88:91], v[136:139], v[184:187], a[88:91]
v_mfma_f32_16x16x32_bf16 a[92:95], v[136:139], v[188:191], a[92:95]
v_mfma_f32_16x16x32_bf16 a[96:99], v[140:143], v[160:163], a[96:99]
buffer_load_dwordx4 v15, s[4:7], s31 offen offset:1024 sc1 lds
v_mfma_f32_16x16x32_bf16 a[100:103], v[140:143], v[164:167], a[100:103]
v_mfma_f32_16x16x32_bf16 a[104:107], v[140:143], v[168:171], a[104:107]
v_mfma_f32_16x16x32_bf16 a[108:111], v[140:143], v[172:175], a[108:111]
s_add_u32 s30, s30, 65536
v_mfma_f32_16x16x32_bf16 a[112:115], v[140:143], v[176:179], a[112:115]
s_add_u32 s31, s31, 16384
v_mfma_f32_16x16x32_bf16 a[116:119], v[140:143], v[180:183], a[116:119]
v_mfma_f32_16x16x32_bf16 a[120:123], v[140:143], v[184:187], a[120:123]
v_mfma_f32_16x16x32_bf16 a[124:127], v[140:143], v[188:191], a[124:127]
s_waitcnt lgkmcnt(0)
v_mfma_f32_16x16x32_bf16 a[0:3], v[64:67], v[96:99], a[0:3]
v_mfma_f32_16x16x32_bf16 a[4:7], v[64:67], v[100:103], a[4:7]
s_waitcnt vmcnt(18)
s_barrier
v_mfma_f32_16x16x32_bf16 a[8:11], v[64:67], v[104:107], a[8:11]
ds_read_b128 v[160:163], v10 offset:40960
v_mfma_f32_16x16x32_bf16 a[12:15], v[64:67], v[108:111], a[12:15]
ds_read_b128 v[164:167], v10 offset:41984
s_add_u32 m0, s32, 49152
v_mfma_f32_16x16x32_bf16 a[16:19], v[64:67], v[112:115], a[16:19]
ds_read_b128 v[168:171], v10 offset:43008
buffer_load_dwordx4 v11, s[8:11], s30 offen offset:0 lds
v_mfma_f32_16x16x32_bf16 a[20:23], v[64:67], v[116:119], a[20:23]
ds_read_b128 v[172:175], v10 offset:44032
v_mfma_f32_16x16x32_bf16 a[24:27], v[64:67], v[120:123], a[24:27]
ds_read_b128 v[176:179], v10 offset:45056
v_mfma_f32_16x16x32_bf16 a[28:31], v[64:67], v[124:127], a[28:31]
ds_read_b128 v[180:183], v10 offset:46080
v_mfma_f32_16x16x32_bf16 a[32:35], v[68:71], v[96:99], a[32:35]
ds_read_b128 v[184:187], v10 offset:47104
buffer_load_dwordx4 v12, s[8:11], s30 offen offset:1024 lds
v_mfma_f32_16x16x32_bf16 a[36:39], v[68:71], v[100:103], a[36:39]
ds_read_b128 v[188:191], v10 offset:48128
v_mfma_f32_16x16x32_bf16 a[40:43], v[68:71], v[104:107], a[40:43]
ds_read_b64_tr_b16 v[128:129], v192 offset:16384
v_mfma_f32_16x16x32_bf16 a[44:47], v[68:71], v[108:111], a[44:47]
ds_read_b64_tr_b16 v[130:131], v192 offset:24576
v_mfma_f32_16x16x32_bf16 a[48:51], v[68:71], v[112:115], a[48:51]
ds_read_b64_tr_b16 v[132:133], v193 offset:16384
buffer_load_dwordx4 v13, s[8:11], s30 offen offset:2048 lds
v_mfma_f32_16x16x32_bf16 a[52:55], v[68:71], v[116:119], a[52:55]
ds_read_b64_tr_b16 v[134:135], v193 offset:24576
v_mfma_f32_16x16x32_bf16 a[56:59], v[68:71], v[120:123], a[56:59]
ds_read_b64_tr_b16 v[136:137], v194 offset:16384
v_mfma_f32_16x16x32_bf16 a[60:63], v[68:71], v[124:127], a[60:63]
ds_read_b64_tr_b16 v[138:139], v194 offset:24576
v_mfma_f32_16x16x32_bf16 a[64:67], v[72:75], v[96:99], a[64:67]
ds_read_b64_tr_b16 v[140:141], v195 offset:16384
buffer_load_dwordx4 v14, s[8:11], s30 offen offset:3072 lds
v_mfma_f32_16x16x32_bf16 a[68:71], v[72:75], v[100:103], a[68:71]
ds_read_b64_tr_b16 v[142:143], v195 offset:24576
v_mfma_f32_16x16x32_bf16 a[72:75], v[72:75], v[104:107], a[72:75]
v_mfma_f32_16x16x32_bf16 a[76:79], v[72:75], v[108:111], a[76:79]
s_add_u32 m0, s33, 24576
v_mfma_f32_16x16x32_bf16 a[80:83], v[72:75], v[112:115], a[80:83]
buffer_load_dwordx4 v15, s[4:7], s31 offen offset:0 sc1 lds
v_mfma_f32_16x16x32_bf16 a[84:87], v[72:75], v[116:119], a[84:87]
v_mfma_f32_16x16x32_bf16 a[88:91], v[72:75], v[120:123], a[88:91]
v_mfma_f32_16x16x32_bf16 a[92:95], v[72:75], v[124:127], a[92:95]
v_mfma_f32_16x16x32_bf16 a[96:99], v[76:79], v[96:99], a[96:99]
buffer_load_dwordx4 v15, s[4:7], s31 offen offset:1024 sc1 lds
v_mfma_f32_16x16x32_bf16 a[100:103], v[76:79], v[100:103], a[100:103]
v_mfma_f32_16x16x32_bf16 a[104:107], v[76:79], v[104:107], a[104:107]
v_mfma_f32_16x16x32_bf16 a[108:111], v[76:79], v[108:111], a[108:111]
s_add_u32 s30, s30, 65536
v_mfma_f32_16x16x32_bf16 a[112:115], v[76:79], v[112:115], a[112:115]
s_add_u32 s31, s31, 16384
v_mfma_f32_16x16x32_bf16 a[116:119], v[76:79], v[116:119], a[116:119]
v_mfma_f32_16x16x32_bf16 a[120:123], v[76:79], v[120:123], a[120:123]
v_mfma_f32_16x16x32_bf16 a[124:127], v[76:79], v[124:127], a[124:127]
s_waitcnt lgkmcnt(0)
v_mfma_f32_16x16x32_bf16 a[0:3], v[128:131], v[160:163], a[0:3]
v_mfma_f32_16x16x32_bf16 a[4:7], v[128:131], v[164:167], a[4:7]
s_waitcnt vmcnt(18)
s_barrier
v_mfma_f32_16x16x32_bf16 a[8:11], v[128:131], v[168:171], a[8:11]
ds_read_b128 v[96:99], v10 offset:0
v_mfma_f32_16x16x32_bf16 a[12:15], v[128:131], v[172:175], a[12:15]
ds_read_b128 v[100:103], v10 offset:1024
v_mfma_f32_16x16x32_bf16 a[16:19], v[128:131], v[176:179], a[16:19]
ds_read_b128 v[104:107], v10 offset:2048
v_mfma_f32_16x16x32_bf16 a[20:23], v[128:131], v[180:183], a[20:23]
ds_read_b128 v[108:111], v10 offset:3072
v_mfma_f32_16x16x32_bf16 a[24:27], v[128:131], v[184:187], a[24:27]
ds_read_b128 v[112:115], v10 offset:4096
v_mfma_f32_16x16x32_bf16 a[28:31], v[128:131], v[188:191], a[28:31]
ds_read_b128 v[116:119], v10 offset:5120
v_mfma_f32_16x16x32_bf16 a[32:35], v[132:135], v[160:163], a[32:35]
ds_read_b128 v[120:123], v10 offset:6144
v_mfma_f32_16x16x32_bf16 a[36:39], v[132:135], v[164:167], a[36:39]
ds_read_b128 v[124:127], v10 offset:7168
v_mfma_f32_16x16x32_bf16 a[40:43], v[132:135], v[168:171], a[40:43]
ds_read_b64_tr_b16 v[64:65], v2 offset:0
v_mfma_f32_16x16x32_bf16 a[44:47], v[132:135], v[172:175], a[44:47]
ds_read_b64_tr_b16 v[66:67], v2 offset:8192
v_mfma_f32_16x16x32_bf16 a[48:51], v[132:135], v[176:179], a[48:51]
ds_read_b64_tr_b16 v[68:69], v3 offset:0
v_mfma_f32_16x16x32_bf16 a[52:55], v[132:135], v[180:183], a[52:55]
ds_read_b64_tr_b16 v[70:71], v3 offset:8192
v_mfma_f32_16x16x32_bf16 a[56:59], v[132:135], v[184:187], a[56:59]
ds_read_b64_tr_b16 v[72:73], v4 offset:0
v_mfma_f32_16x16x32_bf16 a[60:63], v[132:135], v[188:191], a[60:63]
ds_read_b64_tr_b16 v[74:75], v4 offset:8192
v_mfma_f32_16x16x32_bf16 a[64:67], v[136:139], v[160:163], a[64:67]
ds_read_b64_tr_b16 v[76:77], v5 offset:0
v_mfma_f32_16x16x32_bf16 a[68:71], v[136:139], v[164:167], a[68:71]
ds_read_b64_tr_b16 v[78:79], v5 offset:8192
v_mfma_f32_16x16x32_bf16 a[72:75], v[136:139], v[168:171], a[72:75]
v_mfma_f32_16x16x32_bf16 a[76:79], v[136:139], v[172:175], a[76:79]
v_mfma_f32_16x16x32_bf16 a[80:83], v[136:139], v[176:179], a[80:83]
v_mfma_f32_16x16x32_bf16 a[84:87], v[136:139], v[180:183], a[84:87]
v_mfma_f32_16x16x32_bf16 a[88:91], v[136:139], v[184:187], a[88:91]
v_mfma_f32_16x16x32_bf16 a[92:95], v[136:139], v[188:191], a[92:95]
v_mfma_f32_16x16x32_bf16 a[96:99], v[140:143], v[160:163], a[96:99]
v_mfma_f32_16x16x32_bf16 a[100:103], v[140:143], v[164:167], a[100:103]
v_mfma_f32_16x16x32_bf16 a[104:107], v[140:143], v[168:171], a[104:107]
v_mfma_f32_16x16x32_bf16 a[108:111], v[140:143], v[172:175], a[108:111]
v_mfma_f32_16x16x32_bf16 a[112:115], v[140:143], v[176:179], a[112:115]
v_mfma_f32_16x16x32_bf16 a[116:119], v[140:143], v[180:183], a[116:119]
v_mfma_f32_16x16x32_bf16 a[120:123], v[140:143], v[184:187], a[120:123]
v_mfma_f32_16x16x32_bf16 a[124:127], v[140:143], v[188:191], a[124:127]
s_waitcnt lgkmcnt(0)
v_mfma_f32_16x16x32_bf16 a[0:3], v[64:67], v[96:99], a[0:3]
v_mfma_f32_16x16x32_bf16 a[4:7], v[64:67], v[100:103], a[4:7]
s_waitcnt vmcnt(12)
s_barrier
v_mfma_f32_16x16x32_bf16 a[8:11], v[64:67], v[104:107], a[8:11]
ds_read_b128 v[160:163], v10 offset:8192
v_mfma_f32_16x16x32_bf16 a[12:15], v[64:67], v[108:111], a[12:15]
ds_read_b128 v[164:167], v10 offset:9216
v_mfma_f32_16x16x32_bf16 a[16:19], v[64:67], v[112:115], a[16:19]
ds_read_b128 v[168:171], v10 offset:10240
v_mfma_f32_16x16x32_bf16 a[20:23], v[64:67], v[116:119], a[20:23]
ds_read_b128 v[172:175], v10 offset:11264
v_mfma_f32_16x16x32_bf16 a[24:27], v[64:67], v[120:123], a[24:27]
ds_read_b128 v[176:179], v10 offset:12288
v_mfma_f32_16x16x32_bf16 a[28:31], v[64:67], v[124:127], a[28:31]
ds_read_b128 v[180:183], v10 offset:13312
v_mfma_f32_16x16x32_bf16 a[32:35], v[68:71], v[96:99], a[32:35]
ds_read_b128 v[184:187], v10 offset:14336
v_mfma_f32_16x16x32_bf16 a[36:39], v[68:71], v[100:103], a[36:39]
ds_read_b128 v[188:191], v10 offset:15360
v_mfma_f32_16x16x32_bf16 a[40:43], v[68:71], v[104:107], a[40:43]
ds_read_b64_tr_b16 v[128:129], v2 offset:16384
v_mfma_f32_16x16x32_bf16 a[44:47], v[68:71], v[108:111], a[44:47]
ds_read_b64_tr_b16 v[130:131], v2 offset:24576
v_mfma_f32_16x16x32_bf16 a[48:51], v[68:71], v[112:115], a[48:51]
ds_read_b64_tr_b16 v[132:133], v3 offset:16384
v_mfma_f32_16x16x32_bf16 a[52:55], v[68:71], v[116:119], a[52:55]
ds_read_b64_tr_b16 v[134:135], v3 offset:24576
v_mfma_f32_16x16x32_bf16 a[56:59], v[68:71], v[120:123], a[56:59]
ds_read_b64_tr_b16 v[136:137], v4 offset:16384
v_mfma_f32_16x16x32_bf16 a[60:63], v[68:71], v[124:127], a[60:63]
ds_read_b64_tr_b16 v[138:139], v4 offset:24576
v_mfma_f32_16x16x32_bf16 a[64:67], v[72:75], v[96:99], a[64:67]
ds_read_b64_tr_b16 v[140:141], v5 offset:16384
v_mfma_f32_16x16x32_bf16 a[68:71], v[72:75], v[100:103], a[68:71]
ds_read_b64_tr_b16 v[142:143], v5 offset:24576
v_mfma_f32_16x16x32_bf16 a[72:75], v[72:75], v[104:107], a[72:75]
v_mfma_f32_16x16x32_bf16 a[76:79], v[72:75], v[108:111], a[76:79]
v_mfma_f32_16x16x32_bf16 a[80:83], v[72:75], v[112:115], a[80:83]
v_mfma_f32_16x16x32_bf16 a[84:87], v[72:75], v[116:119], a[84:87]
v_mfma_f32_16x16x32_bf16 a[88:91], v[72:75], v[120:123], a[88:91]
v_mfma_f32_16x16x32_bf16 a[92:95], v[72:75], v[124:127], a[92:95]
v_mfma_f32_16x16x32_bf16 a[96:99], v[76:79], v[96:99], a[96:99]
v_mfma_f32_16x16x32_bf16 a[100:103], v[76:79], v[100:103], a[100:103]
v_mfma_f32_16x16x32_bf16 a[104:107], v[76:79], v[104:107], a[104:107]
v_mfma_f32_16x16x32_bf16 a[108:111], v[76:79], v[108:111], a[108:111]
v_mfma_f32_16x16x32_bf16 a[112:115], v[76:79], v[112:115], a[112:115]
v_mfma_f32_16x16x32_bf16 a[116:119], v[76:79], v[116:119], a[116:119]
v_mfma_f32_16x16x32_bf16 a[120:123], v[76:79], v[120:123], a[120:123]
v_mfma_f32_16x16x32_bf16 a[124:127], v[76:79], v[124:127], a[124:127]
s_waitcnt lgkmcnt(0)
v_mfma_f32_16x16x32_bf16 a[0:3], v[128:131], v[160:163], a[0:3]
v_mfma_f32_16x16x32_bf16 a[4:7], v[128:131], v[164:167], a[4:7]
s_waitcnt vmcnt(6)
s_barrier
v_mfma_f32_16x16x32_bf16 a[8:11], v[128:131], v[168:171], a[8:11]
ds_read_b128 v[96:99], v10 offset:16384
v_mfma_f32_16x16x32_bf16 a[12:15], v[128:131], v[172:175], a[12:15]
ds_read_b128 v[100:103], v10 offset:17408
v_mfma_f32_16x16x32_bf16 a[16:19], v[128:131], v[176:179], a[16:19]
ds_read_b128 v[104:107], v10 offset:18432
v_mfma_f32_16x16x32_bf16 a[20:23], v[128:131], v[180:183], a[20:23]
ds_read_b128 v[108:111], v10 offset:19456
v_mfma_f32_16x16x32_bf16 a[24:27], v[128:131], v[184:187], a[24:27]
ds_read_b128 v[112:115], v10 offset:20480
v_mfma_f32_16x16x32_bf16 a[28:31], v[128:131], v[188:191], a[28:31]
ds_read_b128 v[116:119], v10 offset:21504
v_mfma_f32_16x16x32_bf16 a[32:35], v[132:135], v[160:163], a[32:35]
ds_read_b128 v[120:123], v10 offset:22528
v_mfma_f32_16x16x32_bf16 a[36:39], v[132:135], v[164:167], a[36:39]
ds_read_b128 v[124:127], v10 offset:23552
v_mfma_f32_16x16x32_bf16 a[40:43], v[132:135], v[168:171], a[40:43]
ds_read_b64_tr_b16 v[64:65], v2 offset:32768
v_mfma_f32_16x16x32_bf16 a[44:47], v[132:135], v[172:175], a[44:47]
ds_read_b64_tr_b16 v[66:67], v2 offset:40960
v_mfma_f32_16x16x32_bf16 a[48:51], v[132:135], v[176:179], a[48:51]
ds_read_b64_tr_b16 v[68:69], v3 offset:32768
v_mfma_f32_16x16x32_bf16 a[52:55], v[132:135], v[180:183], a[52:55]
ds_read_b64_tr_b16 v[70:71], v3 offset:40960
v_mfma_f32_16x16x32_bf16 a[56:59], v[132:135], v[184:187], a[56:59]
ds_read_b64_tr_b16 v[72:73], v4 offset:32768
v_mfma_f32_16x16x32_bf16 a[60:63], v[132:135], v[188:191], a[60:63]
ds_read_b64_tr_b16 v[74:75], v4 offset:40960
v_mfma_f32_16x16x32_bf16 a[64:67], v[136:139], v[160:163], a[64:67]
ds_read_b64_tr_b16 v[76:77], v5 offset:32768
v_mfma_f32_16x16x32_bf16 a[68:71], v[136:139], v[164:167], a[68:71]
ds_read_b64_tr_b16 v[78:79], v5 offset:40960
v_mfma_f32_16x16x32_bf16 a[72:75], v[136:139], v[168:171], a[72:75]
v_mfma_f32_16x16x32_bf16 a[76:79], v[136:139], v[172:175], a[76:79]
v_mfma_f32_16x16x32_bf16 a[80:83], v[136:139], v[176:179], a[80:83]
v_mfma_f32_16x16x32_bf16 a[84:87], v[136:139], v[180:183], a[84:87]
v_mfma_f32_16x16x32_bf16 a[88:91], v[136:139], v[184:187], a[88:91]
v_mfma_f32_16x16x32_bf16 a[92:95], v[136:139], v[188:191], a[92:95]
v_mfma_f32_16x16x32_bf16 a[96:99], v[140:143], v[160:163], a[96:99]
v_mfma_f32_16x16x32_bf16 a[100:103], v[140:143], v[164:167], a[100:103]
v_mfma_f32_16x16x32_bf16 a[104:107], v[140:143], v[168:171], a[104:107]
v_mfma_f32_16x16x32_bf16 a[108:111], v[140:143], v[172:175], a[108:111]
v_mfma_f32_16x16x32_bf16 a[112:115], v[140:143], v[176:179], a[112:115]
v_mfma_f32_16x16x32_bf16 a[116:119], v[140:143], v[180:183], a[116:119]
v_mfma_f32_16x16x32_bf16 a[120:123], v[140:143], v[184:187], a[120:123]
v_mfma_f32_16x16x32_bf16 a[124:127], v[140:143], v[188:191], a[124:127]
s_waitcnt lgkmcnt(0)
v_mfma_f32_16x16x32_bf16 a[0:3], v[64:67], v[96:99], a[0:3]
v_mfma_f32_16x16x32_bf16 a[4:7], v[64:67], v[100:103], a[4:7]
s_waitcnt vmcnt(0)
s_barrier
v_mfma_f32_16x16x32_bf16 a[8:11], v[64:67], v[104:107], a[8:11]
ds_read_b128 v[160:163], v10 offset:24576
v_mfma_f32_16x16x32_bf16 a[12:15], v[64:67], v[108:111], a[12:15]
ds_read_b128 v[164:167], v10 offset:25600
v_mfma_f32_16x16x32_bf16 a[16:19], v[64:67], v[112:115], a[16:19]
ds_read_b128 v[168:171], v10 offset:26624
v_mfma_f32_16x16x32_bf16 a[20:23], v[64:67], v[116:119], a[20:23]
ds_read_b128 v[172:175], v10 offset:27648
v_mfma_f32_16x16x32_bf16 a[24:27], v[64:67], v[120:123], a[24:27]
ds_read_b128 v[176:179], v10 offset:28672
v_mfma_f32_16x16x32_bf16 a[28:31], v[64:67], v[124:127], a[28:31]
ds_read_b128 v[180:183], v10 offset:29696
v_mfma_f32_16x16x32_bf16 a[32:35], v[68:71], v[96:99], a[32:35]
ds_read_b128 v[184:187], v10 offset:30720
v_mfma_f32_16x16x32_bf16 a[36:39], v[68:71], v[100:103], a[36:39]
ds_read_b128 v[188:191], v10 offset:31744
v_mfma_f32_16x16x32_bf16 a[40:43], v[68:71], v[104:107], a[40:43]
ds_read_b64_tr_b16 v[128:129], v2 offset:49152
v_mfma_f32_16x16x32_bf16 a[44:47], v[68:71], v[108:111], a[44:47]
ds_read_b64_tr_b16 v[130:131], v2 offset:57344
v_mfma_f32_16x16x32_bf16 a[48:51], v[68:71], v[112:115], a[48:51]
ds_read_b64_tr_b16 v[132:133], v3 offset:49152
v_mfma_f32_16x16x32_bf16 a[52:55], v[68:71], v[116:119], a[52:55]
ds_read_b64_tr_b16 v[134:135], v3 offset:57344
v_mfma_f32_16x16x32_bf16 a[56:59], v[68:71], v[120:123], a[56:59]
ds_read_b64_tr_b16 v[136:137], v4 offset:49152
v_mfma_f32_16x16x32_bf16 a[60:63], v[68:71], v[124:127], a[60:63]
ds_read_b64_tr_b16 v[138:139], v4 offset:57344
v_mfma_f32_16x16x32_bf16 a[64:67], v[72:75], v[96:99], a[64:67]
ds_read_b64_tr_b16 v[140:141], v5 offset:49152
v_mfma_f32_16x16x32_bf16 a[68:71], v[72:75], v[100:103], a[68:71]
ds_read_b64_tr_b16 v[142:143], v5 offset:57344
v_mfma_f32_16x16x32_bf16 a[72:75], v[72:75], v[104:107], a[72:75]
v_mfma_f32_16x16x32_bf16 a[76:79], v[72:75], v[108:111], a[76:79]
v_mfma_f32_16x16x32_bf16 a[80:83], v[72:75], v[112:115], a[80:83]
v_mfma_f32_16x16x32_bf16 a[84:87], v[72:75], v[116:119], a[84:87]
v_mfma_f32_16x16x32_bf16 a[88:91], v[72:75], v[120:123], a[88:91]
v_mfma_f32_16x16x32_bf16 a[92:95], v[72:75], v[124:127], a[92:95]
v_mfma_f32_16x16x32_bf16 a[96:99], v[76:79], v[96:99], a[96:99]
v_mfma_f32_16x16x32_bf16 a[100:103], v[76:79], v[100:103], a[100:103]
v_mfma_f32_16x16x32_bf16 a[104:107], v[76:79], v[104:107], a[104:107]
v_mfma_f32_16x16x32_bf16 a[108:111], v[76:79], v[108:111], a[108:111]
v_mfma_f32_16x16x32_bf16 a[112:115], v[76:79], v[112:115], a[112:115]
v_mfma_f32_16x16x32_bf16 a[116:119], v[76:79], v[116:119], a[116:119]
v_mfma_f32_16x16x32_bf16 a[120:123], v[76:79], v[120:123], a[120:123]
v_mfma_f32_16x16x32_bf16 a[124:127], v[76:79], v[124:127], a[124:127]
s_waitcnt lgkmcnt(0)
v_mfma_f32_16x16x32_bf16 a[0:3], v[128:131], v[160:163], a[0:3]
v_mfma_f32_16x16x32_bf16 a[4:7], v[128:131], v[164:167], a[4:7]
v_mfma_f32_16x16x32_bf16 a[8:11], v[128:131], v[168:171], a[8:11]
v_mfma_f32_16x16x32_bf16 a[12:15], v[128:131], v[172:175], a[12:15]
v_mfma_f32_16x16x32_bf16 a[16:19], v[128:131], v[176:179], a[16:19]
v_mfma_f32_16x16x32_bf16 a[20:23], v[128:131], v[180:183], a[20:23]
v_mfma_f32_16x16x32_bf16 a[24:27], v[128:131], v[184:187], a[24:27]
v_mfma_f32_16x16x32_bf16 a[28:31], v[128:131], v[188:191], a[28:31]
v_mfma_f32_16x16x32_bf16 a[32:35], v[132:135], v[160:163], a[32:35]
v_mfma_f32_16x16x32_bf16 a[36:39], v[132:135], v[164:167], a[36:39]
v_mfma_f32_16x16x32_bf16 a[40:43], v[132:135], v[168:171], a[40:43]
v_mfma_f32_16x16x32_bf16 a[44:47], v[132:135], v[172:175], a[44:47]
v_mfma_f32_16x16x32_bf16 a[48:51], v[132:135], v[176:179], a[48:51]
v_mfma_f32_16x16x32_bf16 a[52:55], v[132:135], v[180:183], a[52:55]
v_mfma_f32_16x16x32_bf16 a[56:59], v[132:135], v[184:187], a[56:59]
v_mfma_f32_16x16x32_bf16 a[60:63], v[132:135], v[188:191], a[60:63]
v_mfma_f32_16x16x32_bf16 a[64:67], v[136:139], v[160:163], a[64:67]
v_mfma_f32_16x16x32_bf16 a[68:71], v[136:139], v[164:167], a[68:71]
v_mfma_f32_16x16x32_bf16 a[72:75], v[136:139], v[168:171], a[72:75]
v_mfma_f32_16x16x32_bf16 a[76:79], v[136:139], v[172:175], a[76:79]
v_mfma_f32_16x16x32_bf16 a[80:83], v[136:139], v[176:179], a[80:83]
v_mfma_f32_16x16x32_bf16 a[84:87], v[136:139], v[180:183], a[84:87]
v_mfma_f32_16x16x32_bf16 a[88:91], v[136:139], v[184:187], a[88:91]
v_mfma_f32_16x16x32_bf16 a[92:95], v[136:139], v[188:191], a[92:95]
v_mfma_f32_16x16x32_bf16 a[96:99], v[140:143], v[160:163], a[96:99]
v_mfma_f32_16x16x32_bf16 a[100:103], v[140:143], v[164:167], a[100:103]
v_mfma_f32_16x16x32_bf16 a[104:107], v[140:143], v[168:171], a[104:107]
v_mfma_f32_16x16x32_bf16 a[108:111], v[140:143], v[172:175], a[108:111]
v_mfma_f32_16x16x32_bf16 a[112:115], v[140:143], v[176:179], a[112:115]
v_mfma_f32_16x16x32_bf16 a[116:119], v[140:143], v[180:183], a[116:119]
v_mfma_f32_16x16x32_bf16 a[120:123], v[140:143], v[184:187], a[120:123]
v_mfma_f32_16x16x32_bf16 a[124:127], v[140:143], v[188:191], a[124:127]
s_nop 7
s_mov_b32 s42, 1.0
s_mov_b32 s40, 0xbfb8aa3b
s_lshl_b32 s36, s28, 18
s_lshl_b32 s37, s24, 11
s_add_u32 s36, s36, s37
s_lshl_b32 s37, s29, 13
s_add_u32 s36, s36, s37
s_lshl_b32 s37, s35, 12
s_add_u32 s36, s36, 18874368
s_add_u32 s38, s36, 0
v_accvgpr_read_b32 v64, a0
v_accvgpr_read_b32 v65, a1
v_accvgpr_read_b32 v66, a2
v_accvgpr_read_b32 v67, a3
v_accvgpr_read_b32 v68, a32
v_accvgpr_read_b32 v69, a33
v_accvgpr_read_b32 v70, a34
v_accvgpr_read_b32 v71, a35
v_pk_mul_f32 v[224:225], v[64:65], s[40:41] op_sel_hi:[1,0]
v_pk_mul_f32 v[226:227], v[66:67], s[40:41] op_sel_hi:[1,0]
v_pk_mul_f32 v[228:229], v[68:69], s[40:41] op_sel_hi:[1,0]
v_pk_mul_f32 v[230:231], v[70:71], s[40:41] op_sel_hi:[1,0]
v_exp_f32 v224, v224
v_exp_f32 v225, v225
v_exp_f32 v226, v226
v_exp_f32 v227, v227
v_exp_f32 v228, v228
v_exp_f32 v229, v229
v_exp_f32 v230, v230
v_exp_f32 v231, v231
v_pk_add_f32 v[224:225], v[224:225], s[42:43] op_sel_hi:[1,0]
v_pk_add_f32 v[226:227], v[226:227], s[42:43] op_sel_hi:[1,0]
v_pk_add_f32 v[228:229], v[228:229], s[42:43] op_sel_hi:[1,0]
v_pk_add_f32 v[230:231], v[230:231], s[42:43] op_sel_hi:[1,0]
v_rcp_f32 v224, v224
v_rcp_f32 v225, v225
v_rcp_f32 v226, v226
v_rcp_f32 v227, v227
v_rcp_f32 v228, v228
v_rcp_f32 v229, v229
v_rcp_f32 v230, v230
v_rcp_f32 v231, v231
v_pk_mul_f32 v[64:65], v[64:65], v[224:225]
v_pk_mul_f32 v[66:67], v[66:67], v[226:227]
v_pk_mul_f32 v[68:69], v[68:69], v[228:229]
v_pk_mul_f32 v[70:71], v[70:71], v[230:231]
v_cvt_pk_bf16_f32 v72, v64, v65
v_cvt_pk_bf16_f32 v73, v66, v67
v_cvt_pk_bf16_f32 v74, v68, v69
v_cvt_pk_bf16_f32 v75, v70, v71
buffer_store_dwordx4 v[72:75], v61, s[4:7], s38 offen offset:0 sc1
v_accvgpr_read_b32 v80, a64
v_accvgpr_read_b32 v81, a65
v_accvgpr_read_b32 v82, a66
v_accvgpr_read_b32 v83, a67
v_accvgpr_read_b32 v84, a96
v_accvgpr_read_b32 v85, a97
v_accvgpr_read_b32 v86, a98
v_accvgpr_read_b32 v87, a99
v_pk_mul_f32 v[224:225], v[80:81], s[40:41] op_sel_hi:[1,0]
v_pk_mul_f32 v[226:227], v[82:83], s[40:41] op_sel_hi:[1,0]
v_pk_mul_f32 v[228:229], v[84:85], s[40:41] op_sel_hi:[1,0]
v_pk_mul_f32 v[230:231], v[86:87], s[40:41] op_sel_hi:[1,0]
v_exp_f32 v224, v224
v_exp_f32 v225, v225
v_exp_f32 v226, v226
v_exp_f32 v227, v227
v_exp_f32 v228, v228
v_exp_f32 v229, v229
v_exp_f32 v230, v230
v_exp_f32 v231, v231
v_pk_add_f32 v[224:225], v[224:225], s[42:43] op_sel_hi:[1,0]
v_pk_add_f32 v[226:227], v[226:227], s[42:43] op_sel_hi:[1,0]
v_pk_add_f32 v[228:229], v[228:229], s[42:43] op_sel_hi:[1,0]
v_pk_add_f32 v[230:231], v[230:231], s[42:43] op_sel_hi:[1,0]
v_rcp_f32 v224, v224
v_rcp_f32 v225, v225
v_rcp_f32 v226, v226
v_rcp_f32 v227, v227
v_rcp_f32 v228, v228
v_rcp_f32 v229, v229
v_rcp_f32 v230, v230
v_rcp_f32 v231, v231
v_pk_mul_f32 v[80:81], v[80:81], v[224:225]
v_pk_mul_f32 v[82:83], v[82:83], v[226:227]
v_pk_mul_f32 v[84:85], v[84:85], v[228:229]
v_pk_mul_f32 v[86:87], v[86:87], v[230:231]
v_cvt_pk_bf16_f32 v88, v80, v81
v_cvt_pk_bf16_f32 v89, v82, v83
v_cvt_pk_bf16_f32 v90, v84, v85
v_cvt_pk_bf16_f32 v91, v86, v87
buffer_store_dwordx4 v[88:91], v61, s[4:7], s38 offen offset:1024 sc1
s_add_u32 s38, s36, 32768
v_accvgpr_read_b32 v96, a4
v_accvgpr_read_b32 v97, a5
v_accvgpr_read_b32 v98, a6
v_accvgpr_read_b32 v99, a7
v_accvgpr_read_b32 v100, a36
v_accvgpr_read_b32 v101, a37
v_accvgpr_read_b32 v102, a38
v_accvgpr_read_b32 v103, a39
v_pk_mul_f32 v[224:225], v[96:97], s[40:41] op_sel_hi:[1,0]
v_pk_mul_f32 v[226:227], v[98:99], s[40:41] op_sel_hi:[1,0]
v_pk_mul_f32 v[228:229], v[100:101], s[40:41] op_sel_hi:[1,0]
v_pk_mul_f32 v[230:231], v[102:103], s[40:41] op_sel_hi:[1,0]
v_exp_f32 v224, v224
v_exp_f32 v225, v225
v_exp_f32 v226, v226
v_exp_f32 v227, v227
v_exp_f32 v228, v228
v_exp_f32 v229, v229
v_exp_f32 v230, v230
v_exp_f32 v231, v231
v_pk_add_f32 v[224:225], v[224:225], s[42:43] op_sel_hi:[1,0]
v_pk_add_f32 v[226:227], v[226:227], s[42:43] op_sel_hi:[1,0]
v_pk_add_f32 v[228:229], v[228:229], s[42:43] op_sel_hi:[1,0]
v_pk_add_f32 v[230:231], v[230:231], s[42:43] op_sel_hi:[1,0]
v_rcp_f32 v224, v224
v_rcp_f32 v225, v225
v_rcp_f32 v226, v226
v_rcp_f32 v227, v227
v_rcp_f32 v228, v228
v_rcp_f32 v229, v229
v_rcp_f32 v230, v230
v_rcp_f32 v231, v231
v_pk_mul_f32 v[96:97], v[96:97], v[224:225]
v_pk_mul_f32 v[98:99], v[98:99], v[226:227]
v_pk_mul_f32 v[100:101], v[100:101], v[228:229]
v_pk_mul_f32 v[102:103], v[102:103], v[230:231]
v_cvt_pk_bf16_f32 v104, v96, v97
v_cvt_pk_bf16_f32 v105, v98, v99
v_cvt_pk_bf16_f32 v106, v100, v101
v_cvt_pk_bf16_f32 v107, v102, v103
buffer_store_dwordx4 v[104:107], v61, s[4:7], s38 offen offset:0 sc1
v_accvgpr_read_b32 v112, a68
v_accvgpr_read_b32 v113, a69
v_accvgpr_read_b32 v114, a70
v_accvgpr_read_b32 v115, a71
v_accvgpr_read_b32 v116, a100
v_accvgpr_read_b32 v117, a101
v_accvgpr_read_b32 v118, a102
v_accvgpr_read_b32 v119, a103
v_pk_mul_f32 v[224:225], v[112:113], s[40:41] op_sel_hi:[1,0]
v_pk_mul_f32 v[226:227], v[114:115], s[40:41] op_sel_hi:[1,0]
v_pk_mul_f32 v[228:229], v[116:117], s[40:41] op_sel_hi:[1,0]
v_pk_mul_f32 v[230:231], v[118:119], s[40:41] op_sel_hi:[1,0]
v_exp_f32 v224, v224
v_exp_f32 v225, v225
v_exp_f32 v226, v226
v_exp_f32 v227, v227
v_exp_f32 v228, v228
v_exp_f32 v229, v229
v_exp_f32 v230, v230
v_exp_f32 v231, v231
v_pk_add_f32 v[224:225], v[224:225], s[42:43] op_sel_hi:[1,0]
v_pk_add_f32 v[226:227], v[226:227], s[42:43] op_sel_hi:[1,0]
v_pk_add_f32 v[228:229], v[228:229], s[42:43] op_sel_hi:[1,0]
v_pk_add_f32 v[230:231], v[230:231], s[42:43] op_sel_hi:[1,0]
v_rcp_f32 v224, v224
v_rcp_f32 v225, v225
v_rcp_f32 v226, v226
v_rcp_f32 v227, v227
v_rcp_f32 v228, v228
v_rcp_f32 v229, v229
v_rcp_f32 v230, v230
v_rcp_f32 v231, v231
v_pk_mul_f32 v[112:113], v[112:113], v[224:225]
v_pk_mul_f32 v[114:115], v[114:115], v[226:227]
v_pk_mul_f32 v[116:117], v[116:117], v[228:229]
v_pk_mul_f32 v[118:119], v[118:119], v[230:231]
v_cvt_pk_bf16_f32 v120, v112, v113
v_cvt_pk_bf16_f32 v121, v114, v115
v_cvt_pk_bf16_f32 v122, v116, v117
v_cvt_pk_bf16_f32 v123, v118, v119
buffer_store_dwordx4 v[120:123], v61, s[4:7], s38 offen offset:1024 sc1
s_add_u32 s38, s36, 65536
v_accvgpr_read_b32 v64, a8
v_accvgpr_read_b32 v65, a9
v_accvgpr_read_b32 v66, a10
v_accvgpr_read_b32 v67, a11
v_accvgpr_read_b32 v68, a40
v_accvgpr_read_b32 v69, a41
v_accvgpr_read_b32 v70, a42
v_accvgpr_read_b32 v71, a43
v_pk_mul_f32 v[224:225], v[64:65], s[40:41] op_sel_hi:[1,0]
v_pk_mul_f32 v[226:227], v[66:67], s[40:41] op_sel_hi:[1,0]
v_pk_mul_f32 v[228:229], v[68:69], s[40:41] op_sel_hi:[1,0]
v_pk_mul_f32 v[230:231], v[70:71], s[40:41] op_sel_hi:[1,0]
v_exp_f32 v224, v224
v_exp_f32 v225, v225
v_exp_f32 v226, v226
v_exp_f32 v227, v227
v_exp_f32 v228, v228
v_exp_f32 v229, v229
v_exp_f32 v230, v230
v_exp_f32 v231, v231
v_pk_add_f32 v[224:225], v[224:225], s[42:43] op_sel_hi:[1,0]
v_pk_add_f32 v[226:227], v[226:227], s[42:43] op_sel_hi:[1,0]
v_pk_add_f32 v[228:229], v[228:229], s[42:43] op_sel_hi:[1,0]
v_pk_add_f32 v[230:231], v[230:231], s[42:43] op_sel_hi:[1,0]
v_rcp_f32 v224, v224
v_rcp_f32 v225, v225
v_rcp_f32 v226, v226
v_rcp_f32 v227, v227
v_rcp_f32 v228, v228
v_rcp_f32 v229, v229
v_rcp_f32 v230, v230
v_rcp_f32 v231, v231
v_pk_mul_f32 v[64:65], v[64:65], v[224:225]
v_pk_mul_f32 v[66:67], v[66:67], v[226:227]
v_pk_mul_f32 v[68:69], v[68:69], v[228:229]
v_pk_mul_f32 v[70:71], v[70:71], v[230:231]
v_cvt_pk_bf16_f32 v72, v64, v65
v_cvt_pk_bf16_f32 v73, v66, v67
v_cvt_pk_bf16_f32 v74, v68, v69
v_cvt_pk_bf16_f32 v75, v70, v71
buffer_store_dwordx4 v[72:75], v61, s[4:7], s38 offen offset:0 sc1
v_accvgpr_read_b32 v80, a72
v_accvgpr_read_b32 v81, a73
v_accvgpr_read_b32 v82, a74
v_accvgpr_read_b32 v83, a75
v_accvgpr_read_b32 v84, a104
v_accvgpr_read_b32 v85, a105
v_accvgpr_read_b32 v86, a106
v_accvgpr_read_b32 v87, a107
v_pk_mul_f32 v[224:225], v[80:81], s[40:41] op_sel_hi:[1,0]
v_pk_mul_f32 v[226:227], v[82:83], s[40:41] op_sel_hi:[1,0]
v_pk_mul_f32 v[228:229], v[84:85], s[40:41] op_sel_hi:[1,0]
v_pk_mul_f32 v[230:231], v[86:87], s[40:41] op_sel_hi:[1,0]
v_exp_f32 v224, v224
v_exp_f32 v225, v225
v_exp_f32 v226, v226
v_exp_f32 v227, v227
v_exp_f32 v228, v228
v_exp_f32 v229, v229
v_exp_f32 v230, v230
v_exp_f32 v231, v231
v_pk_add_f32 v[224:225], v[224:225], s[42:43] op_sel_hi:[1,0]
v_pk_add_f32 v[226:227], v[226:227], s[42:43] op_sel_hi:[1,0]
v_pk_add_f32 v[228:229], v[228:229], s[42:43] op_sel_hi:[1,0]
v_pk_add_f32 v[230:231], v[230:231], s[42:43] op_sel_hi:[1,0]
v_rcp_f32 v224, v224
v_rcp_f32 v225, v225
v_rcp_f32 v226, v226
v_rcp_f32 v227, v227
v_rcp_f32 v228, v228
v_rcp_f32 v229, v229
v_rcp_f32 v230, v230
v_rcp_f32 v231, v231
v_pk_mul_f32 v[80:81], v[80:81], v[224:225]
v_pk_mul_f32 v[82:83], v[82:83], v[226:227]
v_pk_mul_f32 v[84:85], v[84:85], v[228:229]
v_pk_mul_f32 v[86:87], v[86:87], v[230:231]
v_cvt_pk_bf16_f32 v88, v80, v81
v_cvt_pk_bf16_f32 v89, v82, v83
v_cvt_pk_bf16_f32 v90, v84, v85
v_cvt_pk_bf16_f32 v91, v86, v87
buffer_store_dwordx4 v[88:91], v61, s[4:7], s38 offen offset:1024 sc1
s_add_u32 s38, s36, 98304
v_accvgpr_read_b32 v96, a12
v_accvgpr_read_b32 v97, a13
v_accvgpr_read_b32 v98, a14
v_accvgpr_read_b32 v99, a15
v_accvgpr_read_b32 v100, a44
v_accvgpr_read_b32 v101, a45
v_accvgpr_read_b32 v102, a46
v_accvgpr_read_b32 v103, a47
v_pk_mul_f32 v[224:225], v[96:97], s[40:41] op_sel_hi:[1,0]
v_pk_mul_f32 v[226:227], v[98:99], s[40:41] op_sel_hi:[1,0]
v_pk_mul_f32 v[228:229], v[100:101], s[40:41] op_sel_hi:[1,0]
v_pk_mul_f32 v[230:231], v[102:103], s[40:41] op_sel_hi:[1,0]
v_exp_f32 v224, v224
v_exp_f32 v225, v225
v_exp_f32 v226, v226
v_exp_f32 v227, v227
v_exp_f32 v228, v228
v_exp_f32 v229, v229
v_exp_f32 v230, v230
v_exp_f32 v231, v231
v_pk_add_f32 v[224:225], v[224:225], s[42:43] op_sel_hi:[1,0]
v_pk_add_f32 v[226:227], v[226:227], s[42:43] op_sel_hi:[1,0]
v_pk_add_f32 v[228:229], v[228:229], s[42:43] op_sel_hi:[1,0]
v_pk_add_f32 v[230:231], v[230:231], s[42:43] op_sel_hi:[1,0]
v_rcp_f32 v224, v224
v_rcp_f32 v225, v225
v_rcp_f32 v226, v226
v_rcp_f32 v227, v227
v_rcp_f32 v228, v228
v_rcp_f32 v229, v229
v_rcp_f32 v230, v230
v_rcp_f32 v231, v231
v_pk_mul_f32 v[96:97], v[96:97], v[224:225]
v_pk_mul_f32 v[98:99], v[98:99], v[226:227]
v_pk_mul_f32 v[100:101], v[100:101], v[228:229]
v_pk_mul_f32 v[102:103], v[102:103], v[230:231]
v_cvt_pk_bf16_f32 v104, v96, v97
v_cvt_pk_bf16_f32 v105, v98, v99
v_cvt_pk_bf16_f32 v106, v100, v101
v_cvt_pk_bf16_f32 v107, v102, v103
buffer_store_dwordx4 v[104:107], v61, s[4:7], s38 offen offset:0 sc1
v_accvgpr_read_b32 v112, a76
v_accvgpr_read_b32 v113, a77
v_accvgpr_read_b32 v114, a78
v_accvgpr_read_b32 v115, a79
v_accvgpr_read_b32 v116, a108
v_accvgpr_read_b32 v117, a109
v_accvgpr_read_b32 v118, a110
v_accvgpr_read_b32 v119, a111
v_pk_mul_f32 v[224:225], v[112:113], s[40:41] op_sel_hi:[1,0]
v_pk_mul_f32 v[226:227], v[114:115], s[40:41] op_sel_hi:[1,0]
v_pk_mul_f32 v[228:229], v[116:117], s[40:41] op_sel_hi:[1,0]
v_pk_mul_f32 v[230:231], v[118:119], s[40:41] op_sel_hi:[1,0]
v_exp_f32 v224, v224
v_exp_f32 v225, v225
v_exp_f32 v226, v226
v_exp_f32 v227, v227
v_exp_f32 v228, v228
v_exp_f32 v229, v229
v_exp_f32 v230, v230
v_exp_f32 v231, v231
v_pk_add_f32 v[224:225], v[224:225], s[42:43] op_sel_hi:[1,0]
v_pk_add_f32 v[226:227], v[226:227], s[42:43] op_sel_hi:[1,0]
v_pk_add_f32 v[228:229], v[228:229], s[42:43] op_sel_hi:[1,0]
v_pk_add_f32 v[230:231], v[230:231], s[42:43] op_sel_hi:[1,0]
v_rcp_f32 v224, v224
v_rcp_f32 v225, v225
v_rcp_f32 v226, v226
v_rcp_f32 v227, v227
v_rcp_f32 v228, v228
v_rcp_f32 v229, v229
v_rcp_f32 v230, v230
v_rcp_f32 v231, v231
v_pk_mul_f32 v[112:113], v[112:113], v[224:225]
v_pk_mul_f32 v[114:115], v[114:115], v[226:227]
v_pk_mul_f32 v[116:117], v[116:117], v[228:229]
v_pk_mul_f32 v[118:119], v[118:119], v[230:231]
v_cvt_pk_bf16_f32 v120, v112, v113
v_cvt_pk_bf16_f32 v121, v114, v115
v_cvt_pk_bf16_f32 v122, v116, v117
v_cvt_pk_bf16_f32 v123, v118, v119
buffer_store_dwordx4 v[120:123], v61, s[4:7], s38 offen offset:1024 sc1
s_add_u32 s38, s36, 131072
v_accvgpr_read_b32 v64, a16
v_accvgpr_read_b32 v65, a17
v_accvgpr_read_b32 v66, a18
v_accvgpr_read_b32 v67, a19
v_accvgpr_read_b32 v68, a48
v_accvgpr_read_b32 v69, a49
v_accvgpr_read_b32 v70, a50
v_accvgpr_read_b32 v71, a51
v_pk_mul_f32 v[224:225], v[64:65], s[40:41] op_sel_hi:[1,0]
v_pk_mul_f32 v[226:227], v[66:67], s[40:41] op_sel_hi:[1,0]
v_pk_mul_f32 v[228:229], v[68:69], s[40:41] op_sel_hi:[1,0]
v_pk_mul_f32 v[230:231], v[70:71], s[40:41] op_sel_hi:[1,0]
v_exp_f32 v224, v224
v_exp_f32 v225, v225
v_exp_f32 v226, v226
v_exp_f32 v227, v227
v_exp_f32 v228, v228
v_exp_f32 v229, v229
v_exp_f32 v230, v230
v_exp_f32 v231, v231
v_pk_add_f32 v[224:225], v[224:225], s[42:43] op_sel_hi:[1,0]
v_pk_add_f32 v[226:227], v[226:227], s[42:43] op_sel_hi:[1,0]
v_pk_add_f32 v[228:229], v[228:229], s[42:43] op_sel_hi:[1,0]
v_pk_add_f32 v[230:231], v[230:231], s[42:43] op_sel_hi:[1,0]
v_rcp_f32 v224, v224
v_rcp_f32 v225, v225
v_rcp_f32 v226, v226
v_rcp_f32 v227, v227
v_rcp_f32 v228, v228
v_rcp_f32 v229, v229
v_rcp_f32 v230, v230
v_rcp_f32 v231, v231
v_pk_mul_f32 v[64:65], v[64:65], v[224:225]
v_pk_mul_f32 v[66:67], v[66:67], v[226:227]
v_pk_mul_f32 v[68:69], v[68:69], v[228:229]
v_pk_mul_f32 v[70:71], v[70:71], v[230:231]
v_cvt_pk_bf16_f32 v72, v64, v65
v_cvt_pk_bf16_f32 v73, v66, v67
v_cvt_pk_bf16_f32 v74, v68, v69
v_cvt_pk_bf16_f32 v75, v70, v71
buffer_store_dwordx4 v[72:75], v61, s[4:7], s38 offen offset:0 sc1
v_accvgpr_read_b32 v80, a80
v_accvgpr_read_b32 v81, a81
v_accvgpr_read_b32 v82, a82
v_accvgpr_read_b32 v83, a83
v_accvgpr_read_b32 v84, a112
v_accvgpr_read_b32 v85, a113
v_accvgpr_read_b32 v86, a114
v_accvgpr_read_b32 v87, a115
v_pk_mul_f32 v[224:225], v[80:81], s[40:41] op_sel_hi:[1,0]
v_pk_mul_f32 v[226:227], v[82:83], s[40:41] op_sel_hi:[1,0]
v_pk_mul_f32 v[228:229], v[84:85], s[40:41] op_sel_hi:[1,0]
v_pk_mul_f32 v[230:231], v[86:87], s[40:41] op_sel_hi:[1,0]
v_exp_f32 v224, v224
v_exp_f32 v225, v225
v_exp_f32 v226, v226
v_exp_f32 v227, v227
v_exp_f32 v228, v228
v_exp_f32 v229, v229
v_exp_f32 v230, v230
v_exp_f32 v231, v231
v_pk_add_f32 v[224:225], v[224:225], s[42:43] op_sel_hi:[1,0]
v_pk_add_f32 v[226:227], v[226:227], s[42:43] op_sel_hi:[1,0]
v_pk_add_f32 v[228:229], v[228:229], s[42:43] op_sel_hi:[1,0]
v_pk_add_f32 v[230:231], v[230:231], s[42:43] op_sel_hi:[1,0]
v_rcp_f32 v224, v224
v_rcp_f32 v225, v225
v_rcp_f32 v226, v226
v_rcp_f32 v227, v227
v_rcp_f32 v228, v228
v_rcp_f32 v229, v229
v_rcp_f32 v230, v230
v_rcp_f32 v231, v231
v_pk_mul_f32 v[80:81], v[80:81], v[224:225]
v_pk_mul_f32 v[82:83], v[82:83], v[226:227]
v_pk_mul_f32 v[84:85], v[84:85], v[228:229]
v_pk_mul_f32 v[86:87], v[86:87], v[230:231]
v_cvt_pk_bf16_f32 v88, v80, v81
v_cvt_pk_bf16_f32 v89, v82, v83
v_cvt_pk_bf16_f32 v90, v84, v85
v_cvt_pk_bf16_f32 v91, v86, v87
buffer_store_dwordx4 v[88:91], v61, s[4:7], s38 offen offset:1024 sc1
s_add_u32 s38, s36, 163840
v_accvgpr_read_b32 v96, a20
v_accvgpr_read_b32 v97, a21
v_accvgpr_read_b32 v98, a22
v_accvgpr_read_b32 v99, a23
v_accvgpr_read_b32 v100, a52
v_accvgpr_read_b32 v101, a53
v_accvgpr_read_b32 v102, a54
v_accvgpr_read_b32 v103, a55
v_pk_mul_f32 v[224:225], v[96:97], s[40:41] op_sel_hi:[1,0]
v_pk_mul_f32 v[226:227], v[98:99], s[40:41] op_sel_hi:[1,0]
v_pk_mul_f32 v[228:229], v[100:101], s[40:41] op_sel_hi:[1,0]
v_pk_mul_f32 v[230:231], v[102:103], s[40:41] op_sel_hi:[1,0]
v_exp_f32 v224, v224
v_exp_f32 v225, v225
v_exp_f32 v226, v226
v_exp_f32 v227, v227
v_exp_f32 v228, v228
v_exp_f32 v229, v229
v_exp_f32 v230, v230
v_exp_f32 v231, v231
v_pk_add_f32 v[224:225], v[224:225], s[42:43] op_sel_hi:[1,0]
v_pk_add_f32 v[226:227], v[226:227], s[42:43] op_sel_hi:[1,0]
v_pk_add_f32 v[228:229], v[228:229], s[42:43] op_sel_hi:[1,0]
v_pk_add_f32 v[230:231], v[230:231], s[42:43] op_sel_hi:[1,0]
v_rcp_f32 v224, v224
v_rcp_f32 v225, v225
v_rcp_f32 v226, v226
v_rcp_f32 v227, v227
v_rcp_f32 v228, v228
v_rcp_f32 v229, v229
v_rcp_f32 v230, v230
v_rcp_f32 v231, v231
v_pk_mul_f32 v[96:97], v[96:97], v[224:225]
v_pk_mul_f32 v[98:99], v[98:99], v[226:227]
v_pk_mul_f32 v[100:101], v[100:101], v[228:229]
v_pk_mul_f32 v[102:103], v[102:103], v[230:231]
v_cvt_pk_bf16_f32 v104, v96, v97
v_cvt_pk_bf16_f32 v105, v98, v99
v_cvt_pk_bf16_f32 v106, v100, v101
v_cvt_pk_bf16_f32 v107, v102, v103
buffer_store_dwordx4 v[104:107], v61, s[4:7], s38 offen offset:0 sc1
v_accvgpr_read_b32 v112, a84
v_accvgpr_read_b32 v113, a85
v_accvgpr_read_b32 v114, a86
v_accvgpr_read_b32 v115, a87
v_accvgpr_read_b32 v116, a116
v_accvgpr_read_b32 v117, a117
v_accvgpr_read_b32 v118, a118
v_accvgpr_read_b32 v119, a119
v_pk_mul_f32 v[224:225], v[112:113], s[40:41] op_sel_hi:[1,0]
v_pk_mul_f32 v[226:227], v[114:115], s[40:41] op_sel_hi:[1,0]
v_pk_mul_f32 v[228:229], v[116:117], s[40:41] op_sel_hi:[1,0]
v_pk_mul_f32 v[230:231], v[118:119], s[40:41] op_sel_hi:[1,0]
v_exp_f32 v224, v224
v_exp_f32 v225, v225
v_exp_f32 v226, v226
v_exp_f32 v227, v227
v_exp_f32 v228, v228
v_exp_f32 v229, v229
v_exp_f32 v230, v230
v_exp_f32 v231, v231
v_pk_add_f32 v[224:225], v[224:225], s[42:43] op_sel_hi:[1,0]
v_pk_add_f32 v[226:227], v[226:227], s[42:43] op_sel_hi:[1,0]
v_pk_add_f32 v[228:229], v[228:229], s[42:43] op_sel_hi:[1,0]
v_pk_add_f32 v[230:231], v[230:231], s[42:43] op_sel_hi:[1,0]
v_rcp_f32 v224, v224
v_rcp_f32 v225, v225
v_rcp_f32 v226, v226
v_rcp_f32 v227, v227
v_rcp_f32 v228, v228
v_rcp_f32 v229, v229
v_rcp_f32 v230, v230
v_rcp_f32 v231, v231
v_pk_mul_f32 v[112:113], v[112:113], v[224:225]
v_pk_mul_f32 v[114:115], v[114:115], v[226:227]
v_pk_mul_f32 v[116:117], v[116:117], v[228:229]
v_pk_mul_f32 v[118:119], v[118:119], v[230:231]
v_cvt_pk_bf16_f32 v120, v112, v113
v_cvt_pk_bf16_f32 v121, v114, v115
v_cvt_pk_bf16_f32 v122, v116, v117
v_cvt_pk_bf16_f32 v123, v118, v119
buffer_store_dwordx4 v[120:123], v61, s[4:7], s38 offen offset:1024 sc1
s_add_u32 s38, s36, 196608
v_accvgpr_read_b32 v64, a24
v_accvgpr_read_b32 v65, a25
v_accvgpr_read_b32 v66, a26
v_accvgpr_read_b32 v67, a27
v_accvgpr_read_b32 v68, a56
v_accvgpr_read_b32 v69, a57
v_accvgpr_read_b32 v70, a58
v_accvgpr_read_b32 v71, a59
v_pk_mul_f32 v[224:225], v[64:65], s[40:41] op_sel_hi:[1,0]
v_pk_mul_f32 v[226:227], v[66:67], s[40:41] op_sel_hi:[1,0]
v_pk_mul_f32 v[228:229], v[68:69], s[40:41] op_sel_hi:[1,0]
v_pk_mul_f32 v[230:231], v[70:71], s[40:41] op_sel_hi:[1,0]
v_exp_f32 v224, v224
v_exp_f32 v225, v225
v_exp_f32 v226, v226
v_exp_f32 v227, v227
v_exp_f32 v228, v228
v_exp_f32 v229, v229
v_exp_f32 v230, v230
v_exp_f32 v231, v231
v_pk_add_f32 v[224:225], v[224:225], s[42:43] op_sel_hi:[1,0]
v_pk_add_f32 v[226:227], v[226:227], s[42:43] op_sel_hi:[1,0]
v_pk_add_f32 v[228:229], v[228:229], s[42:43] op_sel_hi:[1,0]
v_pk_add_f32 v[230:231], v[230:231], s[42:43] op_sel_hi:[1,0]
v_rcp_f32 v224, v224
v_rcp_f32 v225, v225
v_rcp_f32 v226, v226
v_rcp_f32 v227, v227
v_rcp_f32 v228, v228
v_rcp_f32 v229, v229
v_rcp_f32 v230, v230
v_rcp_f32 v231, v231
v_pk_mul_f32 v[64:65], v[64:65], v[224:225]
v_pk_mul_f32 v[66:67], v[66:67], v[226:227]
v_pk_mul_f32 v[68:69], v[68:69], v[228:229]
v_pk_mul_f32 v[70:71], v[70:71], v[230:231]
v_cvt_pk_bf16_f32 v72, v64, v65
v_cvt_pk_bf16_f32 v73, v66, v67
v_cvt_pk_bf16_f32 v74, v68, v69
v_cvt_pk_bf16_f32 v75, v70, v71
buffer_store_dwordx4 v[72:75], v61, s[4:7], s38 offen offset:0 sc1
v_accvgpr_read_b32 v80, a88
v_accvgpr_read_b32 v81, a89
v_accvgpr_read_b32 v82, a90
v_accvgpr_read_b32 v83, a91
v_accvgpr_read_b32 v84, a120
v_accvgpr_read_b32 v85, a121
v_accvgpr_read_b32 v86, a122
v_accvgpr_read_b32 v87, a123
v_pk_mul_f32 v[224:225], v[80:81], s[40:41] op_sel_hi:[1,0]
v_pk_mul_f32 v[226:227], v[82:83], s[40:41] op_sel_hi:[1,0]
v_pk_mul_f32 v[228:229], v[84:85], s[40:41] op_sel_hi:[1,0]
v_pk_mul_f32 v[230:231], v[86:87], s[40:41] op_sel_hi:[1,0]
v_exp_f32 v224, v224
v_exp_f32 v225, v225
v_exp_f32 v226, v226
v_exp_f32 v227, v227
v_exp_f32 v228, v228
v_exp_f32 v229, v229
v_exp_f32 v230, v230
v_exp_f32 v231, v231
v_pk_add_f32 v[224:225], v[224:225], s[42:43] op_sel_hi:[1,0]
v_pk_add_f32 v[226:227], v[226:227], s[42:43] op_sel_hi:[1,0]
v_pk_add_f32 v[228:229], v[228:229], s[42:43] op_sel_hi:[1,0]
v_pk_add_f32 v[230:231], v[230:231], s[42:43] op_sel_hi:[1,0]
v_rcp_f32 v224, v224
v_rcp_f32 v225, v225
v_rcp_f32 v226, v226
v_rcp_f32 v227, v227
v_rcp_f32 v228, v228
v_rcp_f32 v229, v229
v_rcp_f32 v230, v230
v_rcp_f32 v231, v231
v_pk_mul_f32 v[80:81], v[80:81], v[224:225]
v_pk_mul_f32 v[82:83], v[82:83], v[226:227]
v_pk_mul_f32 v[84:85], v[84:85], v[228:229]
v_pk_mul_f32 v[86:87], v[86:87], v[230:231]
v_cvt_pk_bf16_f32 v88, v80, v81
v_cvt_pk_bf16_f32 v89, v82, v83
v_cvt_pk_bf16_f32 v90, v84, v85
v_cvt_pk_bf16_f32 v91, v86, v87
buffer_store_dwordx4 v[88:91], v61, s[4:7], s38 offen offset:1024 sc1
s_add_u32 s38, s36, 229376
v_accvgpr_read_b32 v96, a28
v_accvgpr_read_b32 v97, a29
v_accvgpr_read_b32 v98, a30
v_accvgpr_read_b32 v99, a31
v_accvgpr_read_b32 v100, a60
v_accvgpr_read_b32 v101, a61
v_accvgpr_read_b32 v102, a62
v_accvgpr_read_b32 v103, a63
v_pk_mul_f32 v[224:225], v[96:97], s[40:41] op_sel_hi:[1,0]
v_pk_mul_f32 v[226:227], v[98:99], s[40:41] op_sel_hi:[1,0]
v_pk_mul_f32 v[228:229], v[100:101], s[40:41] op_sel_hi:[1,0]
v_pk_mul_f32 v[230:231], v[102:103], s[40:41] op_sel_hi:[1,0]
v_exp_f32 v224, v224
v_exp_f32 v225, v225
v_exp_f32 v226, v226
v_exp_f32 v227, v227
v_exp_f32 v228, v228
v_exp_f32 v229, v229
v_exp_f32 v230, v230
v_exp_f32 v231, v231
v_pk_add_f32 v[224:225], v[224:225], s[42:43] op_sel_hi:[1,0]
v_pk_add_f32 v[226:227], v[226:227], s[42:43] op_sel_hi:[1,0]
v_pk_add_f32 v[228:229], v[228:229], s[42:43] op_sel_hi:[1,0]
v_pk_add_f32 v[230:231], v[230:231], s[42:43] op_sel_hi:[1,0]
v_rcp_f32 v224, v224
v_rcp_f32 v225, v225
v_rcp_f32 v226, v226
v_rcp_f32 v227, v227
v_rcp_f32 v228, v228
v_rcp_f32 v229, v229
v_rcp_f32 v230, v230
v_rcp_f32 v231, v231
v_pk_mul_f32 v[96:97], v[96:97], v[224:225]
v_pk_mul_f32 v[98:99], v[98:99], v[226:227]
v_pk_mul_f32 v[100:101], v[100:101], v[228:229]
v_pk_mul_f32 v[102:103], v[102:103], v[230:231]
v_cvt_pk_bf16_f32 v104, v96, v97
v_cvt_pk_bf16_f32 v105, v98, v99
v_cvt_pk_bf16_f32 v106, v100, v101
v_cvt_pk_bf16_f32 v107, v102, v103
buffer_store_dwordx4 v[104:107], v61, s[4:7], s38 offen offset:0 sc1
v_accvgpr_read_b32 v112, a92
v_accvgpr_read_b32 v113, a93
v_accvgpr_read_b32 v114, a94
v_accvgpr_read_b32 v115, a95
v_accvgpr_read_b32 v116, a124
v_accvgpr_read_b32 v117, a125
v_accvgpr_read_b32 v118, a126
v_accvgpr_read_b32 v119, a127
v_pk_mul_f32 v[224:225], v[112:113], s[40:41] op_sel_hi:[1,0]
v_pk_mul_f32 v[226:227], v[114:115], s[40:41] op_sel_hi:[1,0]
v_pk_mul_f32 v[228:229], v[116:117], s[40:41] op_sel_hi:[1,0]
v_pk_mul_f32 v[230:231], v[118:119], s[40:41] op_sel_hi:[1,0]
v_exp_f32 v224, v224
v_exp_f32 v225, v225
v_exp_f32 v226, v226
v_exp_f32 v227, v227
v_exp_f32 v228, v228
v_exp_f32 v229, v229
v_exp_f32 v230, v230
v_exp_f32 v231, v231
v_pk_add_f32 v[224:225], v[224:225], s[42:43] op_sel_hi:[1,0]
v_pk_add_f32 v[226:227], v[226:227], s[42:43] op_sel_hi:[1,0]
v_pk_add_f32 v[228:229], v[228:229], s[42:43] op_sel_hi:[1,0]
v_pk_add_f32 v[230:231], v[230:231], s[42:43] op_sel_hi:[1,0]
v_rcp_f32 v224, v224
v_rcp_f32 v225, v225
v_rcp_f32 v226, v226
v_rcp_f32 v227, v227
v_rcp_f32 v228, v228
v_rcp_f32 v229, v229
v_rcp_f32 v230, v230
v_rcp_f32 v231, v231
v_pk_mul_f32 v[112:113], v[112:113], v[224:225]
v_pk_mul_f32 v[114:115], v[114:115], v[226:227]
v_pk_mul_f32 v[116:117], v[116:117], v[228:229]
v_pk_mul_f32 v[118:119], v[118:119], v[230:231]
v_cvt_pk_bf16_f32 v120, v112, v113
v_cvt_pk_bf16_f32 v121, v114, v115
v_cvt_pk_bf16_f32 v122, v116, v117
v_cvt_pk_bf16_f32 v123, v118, v119
buffer_store_dwordx4 v[120:123], v61, s[4:7], s38 offen offset:1024 sc1
s_lshl_b32 s36, s28, 7
s_lshl_b32 s37, s29, 2
s_add_u32 s36, s36, s37
s_add_u32 s36, s36, 119541760
v_lshlrev_b32 v7, 7, v1
s_mov_b32 s46, 119545856
s_mov_b32 s47, 119554048
s_cmp_lg_u32 s24, 0
s_cbranch_scc1 TI_70
s_lshl_b32 s26, s20, 8
s_add_u32 s26, s26, 119537664
v_mov_b32 v2, 1
v_mov_b32 v3, 0
buffer_load_dword v5, v7, s[4:7], s46 offen sc1
buffer_load_dword v6, v7, s[4:7], s47 offen sc1
s_mov_b64 exec, 1
buffer_atomic_add v2, v3, s[4:7], s26 offen sc0 sc1
s_mov_b64 exec, -1
TI_70:
v_mov_b32 v4, 163808
s_waitcnt vmcnt(0)
s_cmp_lg_u32 s24, 0
s_cbranch_scc1 TP_71
s_mov_b32 s44, 0
TPL_72:
v_and_b32 v5, v5, v6
v_cmp_eq_u32 vcc, 0, v5
s_cbranch_vccz TPK_73
buffer_load_dword v5, v7, s[4:7], s46 offen sc1
buffer_load_dword v6, v7, s[4:7], s47 offen sc1
s_add_u32 s44, s44, 1
s_waitcnt vmcnt(0)
s_cmp_lt_u32 s44, 40000
s_cbranch_scc1 TPL_72
TPK_73:
s_mov_b64 exec, 1
ds_write_b32 v4, v2
s_mov_b64 exec, -1
s_waitcnt lgkmcnt(0)
TP_71:
s_barrier
ds_read_b32 v2, v4
s_cmp_lg_u32 s24, 0
s_cbranch_scc1 W_TICKET
v_mov_b32 v16, 1
v_mov_b32 v17, 0
s_mov_b64 exec, 1
buffer_store_dword v16, v17, s[4:7], s36 offen sc1
s_mov_b64 exec, -1
s_branch W_TICKET
T_K64:
s_load_dwordx2 s[8:9], s[0:1], 24
s_mov_b32 s10, 8388608
s_mov_b32 s11, 0x20000
s_and_b32 s36, s28, 1
s_lshl_b32 s36, s36, 8
s_lshl_b32 s30, s29, 9
s_add_u32 s30, s30, s36
s_lshr_b32 s31, s28, 1
s_lshl_b32 s31, s31, 13
s_add_u32 s31, s31, 0
s_lshl_b32 s32, s24, 11
s_mov_b32 s38, s32
s_add_u32 s33, s38, 65536
s_lshr_b32 s34, s24, 1
s_and_b32 s35, s24, 1
v_lshrrev_b32 v16, 5, v1
v_and_b32 v17, 15, v1
v_lshlrev_b32 v18, 1, v16
v_xor_b32 v17, v17, v18
s_lshl_b32 s36, s35, 3
v_xor_b32 v17, s36, v17
v_and_b32 v18, 16, v1
v_add_u32 v16, v16, v18
s_lshl_b32 s36, s24, 2
v_add_u32 v16, s36, v16
v_lshlrev_b32 v16, 13, v16
v_xor_b32 v18, 0, v17
v_lshl_add_u32 v18, v18, 4, v16
v_add_u32 v11, 0, v18
v_xor_b32 v18, 4, v17
v_lshl_add_u32 v18, v18, 4, v16
v_add_u32 v12, 15360, v18
v_lshlrev_b32 v61, 4, v1
v_add_u32 v15, s38, v61
s_waitcnt lgkmcnt(0)
s_add_u32 m0, s32, 0
s_nop 0
buffer_load_dwordx4 v11, s[8:11], s30 offen offset:0 lds
buffer_load_dwordx4 v12, s[8:11], s30 offen offset:1024 lds
s_add_u32 m0, s33, 0
s_nop 0
buffer_load_dwordx4 v15, s[4:7], s31 offen offset:0 sc1 lds
buffer_load_dwordx4 v15, s[4:7], s31 offen offset:1024 sc1 lds
s_add_u32 s30, s30, 262144
s_add_u32 s31, s31, 16384
s_add_u32 m0, s32, 8192
s_nop 0
buffer_load_dwordx4 v11, s[8:11], s30 offen offset:0 lds
buffer_load_dwordx4 v12, s[8:11], s30 offen offset:1024 lds
s_add_u32 m0, s33, 8192
s_nop 0
buffer_load_dwordx4 v15, s[4:7], s31 offen offset:0 sc1 lds
buffer_load_dwordx4 v15, s[4:7], s31 offen offset:1024 sc1 lds
s_add_u32 s30, s30, 262144
s_add_u32 s31, s31, 16384
s_add_u32 m0, s32, 16384
s_nop 0
buffer_load_dwordx4 v11, s[8:11], s30 offen offset:0 lds
buffer_load_dwordx4 v12, s[8:11], s30 offen offset:1024 lds
s_add_u32 m0, s33, 16384
s_nop 0
buffer_load_dwordx4 v15, s[4:7], s31 offen offset:0 sc1 lds
buffer_load_dwordx4 v15, s[4:7], s31 offen offset:1024 sc1 lds
s_add_u32 s30, s30, 262144
s_add_u32 s31, s31, 16384
s_add_u32 m0, s32, 24576
s_nop 0
buffer_load_dwordx4 v11, s[8:11], s30 offen offset:0 lds
buffer_load_dwordx4 v12, s[8:11], s30 offen offset:1024 lds
s_add_u32 m0, s33, 24576
s_nop 0
buffer_load_dwordx4 v15, s[4:7], s31 offen offset:0 sc1 lds
buffer_load_dwordx4 v15, s[4:7], s31 offen offset:1024 sc1 lds
s_add_u32 s30, s30, 262144
s_add_u32 s31, s31, 16384
s_add_u32 m0, s32, 32768
s_nop 0
buffer_load_dwordx4 v11, s[8:11], s30 offen offset:0 lds
buffer_load_dwordx4 v12, s[8:11], s30 offen offset:1024 lds
s_add_u32 m0, s33, 32768
s_nop 0
buffer_load_dwordx4 v15, s[4:7], s31 offen offset:0 sc1 lds
buffer_load_dwordx4 v15, s[4:7], s31 offen offset:1024 sc1 lds
s_add_u32 s30, s30, 262144
s_add_u32 s31, s31, 16384
s_add_u32 m0, s32, 40960
s_nop 0
buffer_load_dwordx4 v11, s[8:11], s30 offen offset:0 lds
buffer_load_dwordx4 v12, s[8:11], s30 offen offset:1024 lds
s_add_u32 m0, s33, 40960
s_nop 0
buffer_load_dwordx4 v15, s[4:7], s31 offen offset:0 sc1 lds
buffer_load_dwordx4 v15, s[4:7], s31 offen offset:1024 sc1 lds
s_add_u32 s30, s30, 262144
s_add_u32 s31, s31, 16384
s_add_u32 m0, s32, 49152
s_nop 0
buffer_load_dwordx4 v11, s[8:11], s30 offen offset:0 lds
buffer_load_dwordx4 v12, s[8:11], s30 offen offset:1024 lds
s_add_u32 m0, s33, 49152
s_nop 0
buffer_load_dwordx4 v15, s[4:7], s31 offen offset:0 sc1 lds
buffer_load_dwordx4 v15, s[4:7], s31 offen offset:1024 sc1 lds
s_add_u32 s30, s30, 262144
s_add_u32 s31, s31, 16384
s_lshl_b32 s36, s34, 12
s_add_u32 s36, s36, 65536
v_add_u32 v10, s36, v61
v_lshrrev_b32 v16, 2, v1
v_and_b32 v17, 7, v16
v_lshlrev_b32 v17, 1, v17
v_lshlrev_b32 v16, 9, v16
v_and_b32 v18, 3, v1
v_lshl_add_u32 v16, v18, 3, v16
s_lshl_b32 s36, s34, 8
s_mov_b32 s36, 0
v_add_u32 v16, s36, v16
s_lshl_b32 s36, s35, 3
v_xor_b32 v17, s36, v17
v_xor_b32 v18, 0, v17
v_lshl_add_u32 v2, v18, 4, v16
v_add_u32 v40, 0x10000, v2
v_xor_b32 v18, 2, v17
v_lshl_add_u32 v3, v18, 4, v16
v_add_u32 v41, 0x10000, v3
v_xor_b32 v18, 4, v17
v_lshl_add_u32 v4, v18, 4, v16
v_add_u32 v42, 0x10000, v4
v_xor_b32 v18, 6, v17
v_lshl_add_u32 v5, v18, 4, v16
v_add_u32 v43, 0x10000, v5
v_accvgpr_write_b32 a0, 0
v_accvgpr_write_b32 a1, 0
v_accvgpr_write_b32 a2, 0
v_accvgpr_write_b32 a3, 0
v_accvgpr_write_b32 a4, 0
v_accvgpr_write_b32 a5, 0
v_accvgpr_write_b32 a6, 0
v_accvgpr_write_b32 a7, 0
v_accvgpr_write_b32 a8, 0
v_accvgpr_write_b32 a9, 0
v_accvgpr_write_b32 a10, 0
v_accvgpr_write_b32 a11, 0
v_accvgpr_write_b32 a12, 0
v_accvgpr_write_b32 a13, 0
v_accvgpr_write_b32 a14, 0
v_accvgpr_write_b32 a15, 0
v_accvgpr_write_b32 a16, 0
v_accvgpr_write_b32 a17, 0
v_accvgpr_write_b32 a18, 0
v_accvgpr_write_b32 a19, 0
v_accvgpr_write_b32 a20, 0
v_accvgpr_write_b32 a21, 0
v_accvgpr_write_b32 a22, 0
v_accvgpr_write_b32 a23, 0
v_accvgpr_write_b32 a24, 0
v_accvgpr_write_b32 a25, 0
v_accvgpr_write_b32 a26, 0
v_accvgpr_write_b32 a27, 0
v_accvgpr_write_b32 a28, 0
v_accvgpr_write_b32 a29, 0
v_accvgpr_write_b32 a30, 0
v_accvgpr_write_b32 a31, 0
v_accvgpr_write_b32 a32, 0
v_accvgpr_write_b32 a33, 0
v_accvgpr_write_b32 a34, 0
v_accvgpr_write_b32 a35, 0
v_accvgpr_write_b32 a36, 0
v_accvgpr_write_b32 a37, 0
v_accvgpr_write_b32 a38, 0
v_accvgpr_write_b32 a39, 0
v_accvgpr_write_b32 a40, 0
v_accvgpr_write_b32 a41, 0
v_accvgpr_write_b32 a42, 0
v_accvgpr_write_b32 a43, 0
v_accvgpr_write_b32 a44, 0
v_accvgpr_write_b32 a45, 0
v_accvgpr_write_b32 a46, 0
v_accvgpr_write_b32 a47, 0
v_accvgpr_write_b32 a48, 0
v_accvgpr_write_b32 a49, 0
v_accvgpr_write_b32 a50, 0
v_accvgpr_write_b32 a51, 0
v_accvgpr_write_b32 a52, 0
v_accvgpr_write_b32 a53, 0
v_accvgpr_write_b32 a54, 0
v_accvgpr_write_b32 a55, 0
v_accvgpr_write_b32 a56, 0
v_accvgpr_write_b32 a57, 0
v_accvgpr_write_b32 a58, 0
v_accvgpr_write_b32 a59, 0
v_accvgpr_write_b32 a60, 0
v_accvgpr_write_b32 a61, 0
v_accvgpr_write_b32 a62, 0
v_accvgpr_write_b32 a63, 0
s_waitcnt vmcnt(24)
s_barrier
ds_read_b128 v[96:99], v10 offset:0
ds_read_b128 v[100:103], v10 offset:1024
ds_read_b128 v[104:107], v10 offset:2048
ds_read_b128 v[108:111], v10 offset:3072
ds_read_b64_tr_b16 v[64:65], v2 offset:0
ds_read_b64_tr_b16 v[66:67], v2 offset:256
ds_read_b64_tr_b16 v[68:69], v3 offset:0
ds_read_b64_tr_b16 v[70:71], v3 offset:256
ds_read_b64_tr_b16 v[72:73], v4 offset:0
ds_read_b64_tr_b16 v[74:75], v4 offset:256
ds_read_b64_tr_b16 v[76:77], v5 offset:0
ds_read_b64_tr_b16 v[78:79], v5 offset:256
s_mov_b32 s37, 3
GL_74:
s_waitcnt lgkmcnt(0)
v_mfma_f32_16x16x32_bf16 a[0:3], v[64:67], v[96:99], a[0:3]
s_waitcnt vmcnt(20)
s_barrier
s_add_u32 m0, s32, 57344
v_mfma_f32_16x16x32_bf16 a[4:7], v[64:67], v[100:103], a[4:7]
ds_read_b128 v[160:163], v10 offset:8192
buffer_load_dwordx4 v11, s[8:11], s30 offen offset:0 lds
v_mfma_f32_16x16x32_bf16 a[8:11], v[64:67], v[104:107], a[8:11]
ds_read_b128 v[164:167], v10 offset:9216
v_mfma_f32_16x16x32_bf16 a[12:15], v[64:67], v[108:111], a[12:15]
ds_read_b128 v[168:171], v10 offset:10240
buffer_load_dwordx4 v12, s[8:11], s30 offen offset:1024 lds
v_mfma_f32_16x16x32_bf16 a[16:19], v[68:71], v[96:99], a[16:19]
ds_read_b128 v[172:175], v10 offset:11264
v_mfma_f32_16x16x32_bf16 a[20:23], v[68:71], v[100:103], a[20:23]
ds_read_b64_tr_b16 v[128:129], v2 offset:8192
s_add_u32 m0, s33, 57344
v_mfma_f32_16x16x32_bf16 a[24:27], v[68:71], v[104:107], a[24:27]
ds_read_b64_tr_b16 v[130:131], v2 offset:8448
v_mfma_f32_16x16x32_bf16 a[28:31], v[68:71], v[108:111], a[28:31]
ds_read_b64_tr_b16 v[132:133], v3 offset:8192
buffer_load_dwordx4 v15, s[4:7], s31 offen offset:0 sc1 lds
v_mfma_f32_16x16x32_bf16 a[32:35], v[72:75], v[96:99], a[32:35]
ds_read_b64_tr_b16 v[134:135], v3 offset:8448
v_mfma_f32_16x16x32_bf16 a[36:39], v[72:75], v[100:103], a[36:39]
ds_read_b64_tr_b16 v[136:137], v4 offset:8192
buffer_load_dwordx4 v15, s[4:7], s31 offen offset:1024 sc1 lds
v_mfma_f32_16x16x32_bf16 a[40:43], v[72:75], v[104:107], a[40:43]
ds_read_b64_tr_b16 v[138:139], v4 offset:8448
v_mfma_f32_16x16x32_bf16 a[44:47], v[72:75], v[108:111], a[44:47]
ds_read_b64_tr_b16 v[140:141], v5 offset:8192
s_add_u32 s30, s30, 262144
v_mfma_f32_16x16x32_bf16 a[48:51], v[76:79], v[96:99], a[48:51]
ds_read_b64_tr_b16 v[142:143], v5 offset:8448
s_add_u32 s31, s31, 16384
v_mfma_f32_16x16x32_bf16 a[52:55], v[76:79], v[100:103], a[52:55]
v_mfma_f32_16x16x32_bf16 a[56:59], v[76:79], v[104:107], a[56:59]
v_mfma_f32_16x16x32_bf16 a[60:63], v[76:79], v[108:111], a[60:63]
s_waitcnt lgkmcnt(0)
v_mfma_f32_16x16x32_bf16 a[0:3], v[128:131], v[160:163], a[0:3]
s_waitcnt vmcnt(20)
s_barrier
s_add_u32 m0, s32, 0
v_mfma_f32_16x16x32_bf16 a[4:7], v[128:131], v[164:167], a[4:7]
ds_read_b128 v[96:99], v10 offset:16384
buffer_load_dwordx4 v11, s[8:11], s30 offen offset:0 lds
v_mfma_f32_16x16x32_bf16 a[8:11], v[128:131], v[168:171], a[8:11]
ds_read_b128 v[100:103], v10 offset:17408
v_mfma_f32_16x16x32_bf16 a[12:15], v[128:131], v[172:175], a[12:15]
ds_read_b128 v[104:107], v10 offset:18432
buffer_load_dwordx4 v12, s[8:11], s30 offen offset:1024 lds
v_mfma_f32_16x16x32_bf16 a[16:19], v[132:135], v[160:163], a[16:19]
ds_read_b128 v[108:111], v10 offset:19456
v_mfma_f32_16x16x32_bf16 a[20:23], v[132:135], v[164:167], a[20:23]
ds_read_b64_tr_b16 v[64:65], v2 offset:16384
s_add_u32 m0, s33, 0
v_mfma_f32_16x16x32_bf16 a[24:27], v[132:135], v[168:171], a[24:27]
ds_read_b64_tr_b16 v[66:67], v2 offset:16640
v_mfma_f32_16x16x32_bf16 a[28:31], v[132:135], v[172:175], a[28:31]
ds_read_b64_tr_b16 v[68:69], v3 offset:16384
buffer_load_dwordx4 v15, s[4:7], s31 offen offset:0 sc1 lds
v_mfma_f32_16x16x32_bf16 a[32:35], v[136:139], v[160:163], a[32:35]
ds_read_b64_tr_b16 v[70:71], v3 offset:16640
v_mfma_f32_16x16x32_bf16 a[36:39], v[136:139], v[164:167], a[36:39]
ds_read_b64_tr_b16 v[72:73], v4 offset:16384
buffer_load_dwordx4 v15, s[4:7], s31 offen offset:1024 sc1 lds
v_mfma_f32_16x16x32_bf16 a[40:43], v[136:139], v[168:171], a[40:43]
ds_read_b64_tr_b16 v[74:75], v4 offset:16640
v_mfma_f32_16x16x32_bf16 a[44:47], v[136:139], v[172:175], a[44:47]
ds_read_b64_tr_b16 v[76:77], v5 offset:16384
s_add_u32 s30, s30, 262144
v_mfma_f32_16x16x32_bf16 a[48:51], v[140:143], v[160:163], a[48:51]
ds_read_b64_tr_b16 v[78:79], v5 offset:16640
s_add_u32 s31, s31, 16384
v_mfma_f32_16x16x32_bf16 a[52:55], v[140:143], v[164:167], a[52:55]
v_mfma_f32_16x16x32_bf16 a[56:59], v[140:143], v[168:171], a[56:59]
v_mfma_f32_16x16x32_bf16 a[60:63], v[140:143], v[172:175], a[60:63]
s_waitcnt lgkmcnt(0)
v_mfma_f32_16x16x32_bf16 a[0:3], v[64:67], v[96:99], a[0:3]
s_waitcnt vmcnt(20)
s_barrier
s_add_u32 m0, s32, 8192
v_mfma_f32_16x16x32_bf16 a[4:7], v[64:67], v[100:103], a[4:7]
ds_read_b128 v[160:163], v10 offset:24576
buffer_load_dwordx4 v11, s[8:11], s30 offen offset:0 lds
v_mfma_f32_16x16x32_bf16 a[8:11], v[64:67], v[104:107], a[8:11]
ds_read_b128 v[164:167], v10 offset:25600
v_mfma_f32_16x16x32_bf16 a[12:15], v[64:67], v[108:111], a[12:15]
ds_read_b128 v[168:171], v10 offset:26624
buffer_load_dwordx4 v12, s[8:11], s30 offen offset:1024 lds
v_mfma_f32_16x16x32_bf16 a[16:19], v[68:71], v[96:99], a[16:19]
ds_read_b128 v[172:175], v10 offset:27648
v_mfma_f32_16x16x32_bf16 a[20:23], v[68:71], v[100:103], a[20:23]
ds_read_b64_tr_b16 v[128:129], v2 offset:24576
s_add_u32 m0, s33, 8192
v_mfma_f32_16x16x32_bf16 a[24:27], v[68:71], v[104:107], a[24:27]
ds_read_b64_tr_b16 v[130:131], v2 offset:24832
v_mfma_f32_16x16x32_bf16 a[28:31], v[68:71], v[108:111], a[28:31]
ds_read_b64_tr_b16 v[132:133], v3 offset:24576
buffer_load_dwordx4 v15, s[4:7], s31 offen offset:0 sc1 lds
v_mfma_f32_16x16x32_bf16 a[32:35], v[72:75], v[96:99], a[32:35]
ds_read_b64_tr_b16 v[134:135], v3 offset:24832
v_mfma_f32_16x16x32_bf16 a[36:39], v[72:75], v[100:103], a[36:39]
ds_read_b64_tr_b16 v[136:137], v4 offset:24576
buffer_load_dwordx4 v15, s[4:7], s31 offen offset:1024 sc1 lds
v_mfma_f32_16x16x32_bf16 a[40:43], v[72:75], v[104:107], a[40:43]
ds_read_b64_tr_b16 v[138:139], v4 offset:24832
v_mfma_f32_16x16x32_bf16 a[44:47], v[72:75], v[108:111], a[44:47]
ds_read_b64_tr_b16 v[140:141], v5 offset:24576
s_add_u32 s30, s30, 262144
v_mfma_f32_16x16x32_bf16 a[48:51], v[76:79], v[96:99], a[48:51]
ds_read_b64_tr_b16 v[142:143], v5 offset:24832
s_add_u32 s31, s31, 16384
v_mfma_f32_16x16x32_bf16 a[52:55], v[76:79], v[100:103], a[52:55]
v_mfma_f32_16x16x32_bf16 a[56:59], v[76:79], v[104:107], a[56:59]
v_mfma_f32_16x16x32_bf16 a[60:63], v[76:79], v[108:111], a[60:63]
s_waitcnt lgkmcnt(0)
v_mfma_f32_16x16x32_bf16 a[0:3], v[128:131], v[160:163], a[0:3]
s_waitcnt vmcnt(20)
s_barrier
s_add_u32 m0, s32, 16384
v_mfma_f32_16x16x32_bf16 a[4:7], v[128:131], v[164:167], a[4:7]
ds_read_b128 v[96:99], v10 offset:32768
buffer_load_dwordx4 v11, s[8:11], s30 offen offset:0 lds
v_mfma_f32_16x16x32_bf16 a[8:11], v[128:131], v[168:171], a[8:11]
ds_read_b128 v[100:103], v10 offset:33792
v_mfma_f32_16x16x32_bf16 a[12:15], v[128:131], v[172:175], a[12:15]
ds_read_b128 v[104:107], v10 offset:34816
buffer_load_dwordx4 v12, s[8:11], s30 offen offset:1024 lds
v_mfma_f32_16x16x32_bf16 a[16:19], v[132:135], v[160:163], a[16:19]
ds_read_b128 v[108:111], v10 offset:35840
v_mfma_f32_16x16x32_bf16 a[20:23], v[132:135], v[164:167], a[20:23]
ds_read_b64_tr_b16 v[64:65], v2 offset:32768
s_add_u32 m0, s33, 16384
v_mfma_f32_16x16x32_bf16 a[24:27], v[132:135], v[168:171], a[24:27]
ds_read_b64_tr_b16 v[66:67], v2 offset:33024
v_mfma_f32_16x16x32_bf16 a[28:31], v[132:135], v[172:175], a[28:31]
ds_read_b64_tr_b16 v[68:69], v3 offset:32768
buffer_load_dwordx4 v15, s[4:7], s31 offen offset:0 sc1 lds
v_mfma_f32_16x16x32_bf16 a[32:35], v[136:139], v[160:163], a[32:35]
ds_read_b64_tr_b16 v[70:71], v3 offset:33024
v_mfma_f32_16x16x32_bf16 a[36:39], v[136:139], v[164:167], a[36:39]
ds_read_b64_tr_b16 v[72:73], v4 offset:32768
buffer_load_dwordx4 v15, s[4:7], s31 offen offset:1024 sc1 lds
v_mfma_f32_16x16x32_bf16 a[40:43], v[136:139], v[168:171], a[40:43]
ds_read_b64_tr_b16 v[74:75], v4 offset:33024
v_mfma_f32_16x16x32_bf16 a[44:47], v[136:139], v[172:175], a[44:47]
ds_read_b64_tr_b16 v[76:77], v5 offset:32768
s_add_u32 s30, s30, 262144
v_mfma_f32_16x16x32_bf16 a[48:51], v[140:143], v[160:163], a[48:51]
ds_read_b64_tr_b16 v[78:79], v5 offset:33024
s_add_u32 s31, s31, 16384
v_mfma_f32_16x16x32_bf16 a[52:55], v[140:143], v[164:167], a[52:55]
v_mfma_f32_16x16x32_bf16 a[56:59], v[140:143], v[168:171], a[56:59]
v_mfma_f32_16x16x32_bf16 a[60:63], v[140:143], v[172:175], a[60:63]
s_waitcnt lgkmcnt(0)
v_mfma_f32_16x16x32_bf16 a[0:3], v[64:67], v[96:99], a[0:3]
s_waitcnt vmcnt(20)
s_barrier
s_add_u32 m0, s32, 24576
v_mfma_f32_16x16x32_bf16 a[4:7], v[64:67], v[100:103], a[4:7]
ds_read_b128 v[160:163], v10 offset:40960
buffer_load_dwordx4 v11, s[8:11], s30 offen offset:0 lds
v_mfma_f32_16x16x32_bf16 a[8:11], v[64:67], v[104:107], a[8:11]
ds_read_b128 v[164:167], v10 offset:41984
v_mfma_f32_16x16x32_bf16 a[12:15], v[64:67], v[108:111], a[12:15]
ds_read_b128 v[168:171], v10 offset:43008
buffer_load_dwordx4 v12, s[8:11], s30 offen offset:1024 lds
v_mfma_f32_16x16x32_bf16 a[16:19], v[68:71], v[96:99], a[16:19]
ds_read_b128 v[172:175], v10 offset:44032
v_mfma_f32_16x16x32_bf16 a[20:23], v[68:71], v[100:103], a[20:23]
ds_read_b64_tr_b16 v[128:129], v2 offset:40960
s_add_u32 m0, s33, 24576
v_mfma_f32_16x16x32_bf16 a[24:27], v[68:71], v[104:107], a[24:27]
ds_read_b64_tr_b16 v[130:131], v2 offset:41216
v_mfma_f32_16x16x32_bf16 a[28:31], v[68:71], v[108:111], a[28:31]
ds_read_b64_tr_b16 v[132:133], v3 offset:40960
buffer_load_dwordx4 v15, s[4:7], s31 offen offset:0 sc1 lds
v_mfma_f32_16x16x32_bf16 a[32:35], v[72:75], v[96:99], a[32:35]
ds_read_b64_tr_b16 v[134:135], v3 offset:41216
v_mfma_f32_16x16x32_bf16 a[36:39], v[72:75], v[100:103], a[36:39]
ds_read_b64_tr_b16 v[136:137], v4 offset:40960
buffer_load_dwordx4 v15, s[4:7], s31 offen offset:1024 sc1 lds
v_mfma_f32_16x16x32_bf16 a[40:43], v[72:75], v[104:107], a[40:43]
ds_read_b64_tr_b16 v[138:139], v4 offset:41216
v_mfma_f32_16x16x32_bf16 a[44:47], v[72:75], v[108:111], a[44:47]
ds_read_b64_tr_b16 v[140:141], v5 offset:40960
s_add_u32 s30, s30, 262144
v_mfma_f32_16x16x32_bf16 a[48:51], v[76:79], v[96:99], a[48:51]
ds_read_b64_tr_b16 v[142:143], v5 offset:41216
s_add_u32 s31, s31, 16384
v_mfma_f32_16x16x32_bf16 a[52:55], v[76:79], v[100:103], a[52:55]
v_mfma_f32_16x16x32_bf16 a[56:59], v[76:79], v[104:107], a[56:59]
v_mfma_f32_16x16x32_bf16 a[60:63], v[76:79], v[108:111], a[60:63]
s_waitcnt lgkmcnt(0)
v_mfma_f32_16x16x32_bf16 a[0:3], v[128:131], v[160:163], a[0:3]
s_waitcnt vmcnt(20)
s_barrier
s_add_u32 m0, s32, 32768
v_mfma_f32_16x16x32_bf16 a[4:7], v[128:131], v[164:167], a[4:7]
ds_read_b128 v[96:99], v10 offset:49152
buffer_load_dwordx4 v11, s[8:11], s30 offen offset:0 lds
v_mfma_f32_16x16x32_bf16 a[8:11], v[128:131], v[168:171], a[8:11]
ds_read_b128 v[100:103], v10 offset:50176
v_mfma_f32_16x16x32_bf16 a[12:15], v[128:131], v[172:175], a[12:15]
ds_read_b128 v[104:107], v10 offset:51200
buffer_load_dwordx4 v12, s[8:11], s30 offen offset:1024 lds
v_mfma_f32_16x16x32_bf16 a[16:19], v[132:135], v[160:163], a[16:19]
ds_read_b128 v[108:111], v10 offset:52224
v_mfma_f32_16x16x32_bf16 a[20:23], v[132:135], v[164:167], a[20:23]
ds_read_b64_tr_b16 v[64:65], v2 offset:49152
s_add_u32 m0, s33, 32768
v_mfma_f32_16x16x32_bf16 a[24:27], v[132:135], v[168:171], a[24:27]
ds_read_b64_tr_b16 v[66:67], v2 offset:49408
v_mfma_f32_16x16x32_bf16 a[28:31], v[132:135], v[172:175], a[28:31]
ds_read_b64_tr_b16 v[68:69], v3 offset:49152
buffer_load_dwordx4 v15, s[4:7], s31 offen offset:0 sc1 lds
v_mfma_f32_16x16x32_bf16 a[32:35], v[136:139], v[160:163], a[32:35]
ds_read_b64_tr_b16 v[70:71], v3 offset:49408
v_mfma_f32_16x16x32_bf16 a[36:39], v[136:139], v[164:167], a[36:39]
ds_read_b64_tr_b16 v[72:73], v4 offset:49152
buffer_load_dwordx4 v15, s[4:7], s31 offen offset:1024 sc1 lds
v_mfma_f32_16x16x32_bf16 a[40:43], v[136:139], v[168:171], a[40:43]
ds_read_b64_tr_b16 v[74:75], v4 offset:49408
v_mfma_f32_16x16x32_bf16 a[44:47], v[136:139], v[172:175], a[44:47]
ds_read_b64_tr_b16 v[76:77], v5 offset:49152
s_add_u32 s30, s30, 262144
v_mfma_f32_16x16x32_bf16 a[48:51], v[140:143], v[160:163], a[48:51]
ds_read_b64_tr_b16 v[78:79], v5 offset:49408
s_add_u32 s31, s31, 16384
v_mfma_f32_16x16x32_bf16 a[52:55], v[140:143], v[164:167], a[52:55]
v_mfma_f32_16x16x32_bf16 a[56:59], v[140:143], v[168:171], a[56:59]
v_mfma_f32_16x16x32_bf16 a[60:63], v[140:143], v[172:175], a[60:63]
s_waitcnt lgkmcnt(0)
v_mfma_f32_16x16x32_bf16 a[0:3], v[64:67], v[96:99], a[0:3]
s_waitcnt vmcnt(20)
s_barrier
s_add_u32 m0, s32, 40960
v_mfma_f32_16x16x32_bf16 a[4:7], v[64:67], v[100:103], a[4:7]
ds_read_b128 v[160:163], v10 offset:57344
buffer_load_dwordx4 v11, s[8:11], s30 offen offset:0 lds
v_mfma_f32_16x16x32_bf16 a[8:11], v[64:67], v[104:107], a[8:11]
ds_read_b128 v[164:167], v10 offset:58368
v_mfma_f32_16x16x32_bf16 a[12:15], v[64:67], v[108:111], a[12:15]
ds_read_b128 v[168:171], v10 offset:59392
buffer_load_dwordx4 v12, s[8:11], s30 offen offset:1024 lds
v_mfma_f32_16x16x32_bf16 a[16:19], v[68:71], v[96:99], a[16:19]
ds_read_b128 v[172:175], v10 offset:60416
v_mfma_f32_16x16x32_bf16 a[20:23], v[68:71], v[100:103], a[20:23]
ds_read_b64_tr_b16 v[128:129], v2 offset:57344
s_add_u32 m0, s33, 40960
v_mfma_f32_16x16x32_bf16 a[24:27], v[68:71], v[104:107], a[24:27]
ds_read_b64_tr_b16 v[130:131], v2 offset:57600
v_mfma_f32_16x16x32_bf16 a[28:31], v[68:71], v[108:111], a[28:31]
ds_read_b64_tr_b16 v[132:133], v3 offset:57344
buffer_load_dwordx4 v15, s[4:7], s31 offen offset:0 sc1 lds
v_mfma_f32_16x16x32_bf16 a[32:35], v[72:75], v[96:99], a[32:35]
ds_read_b64_tr_b16 v[134:135], v3 offset:57600
v_mfma_f32_16x16x32_bf16 a[36:39], v[72:75], v[100:103], a[36:39]
ds_read_b64_tr_b16 v[136:137], v4 offset:57344
buffer_load_dwordx4 v15, s[4:7], s31 offen offset:1024 sc1 lds
v_mfma_f32_16x16x32_bf16 a[40:43], v[72:75], v[104:107], a[40:43]
ds_read_b64_tr_b16 v[138:139], v4 offset:57600
v_mfma_f32_16x16x32_bf16 a[44:47], v[72:75], v[108:111], a[44:47]
ds_read_b64_tr_b16 v[140:141], v5 offset:57344
s_add_u32 s30, s30, 262144
v_mfma_f32_16x16x32_bf16 a[48:51], v[76:79], v[96:99], a[48:51]
ds_read_b64_tr_b16 v[142:143], v5 offset:57600
s_add_u32 s31, s31, 16384
v_mfma_f32_16x16x32_bf16 a[52:55], v[76:79], v[100:103], a[52:55]
v_mfma_f32_16x16x32_bf16 a[56:59], v[76:79], v[104:107], a[56:59]
v_mfma_f32_16x16x32_bf16 a[60:63], v[76:79], v[108:111], a[60:63]
s_waitcnt lgkmcnt(0)
v_mfma_f32_16x16x32_bf16 a[0:3], v[128:131], v[160:163], a[0:3]
s_waitcnt vmcnt(20)
s_barrier
s_add_u32 m0, s32, 49152
v_mfma_f32_16x16x32_bf16 a[4:7], v[128:131], v[164:167], a[4:7]
ds_read_b128 v[96:99], v10 offset:0
buffer_load_dwordx4 v11, s[8:11], s30 offen offset:0 lds
v_mfma_f32_16x16x32_bf16 a[8:11], v[128:131], v[168:171], a[8:11]
ds_read_b128 v[100:103], v10 offset:1024
v_mfma_f32_16x16x32_bf16 a[12:15], v[128:131], v[172:175], a[12:15]
ds_read_b128 v[104:107], v10 offset:2048
buffer_load_dwordx4 v12, s[8:11], s30 offen offset:1024 lds
v_mfma_f32_16x16x32_bf16 a[16:19], v[132:135], v[160:163], a[16:19]
ds_read_b128 v[108:111], v10 offset:3072
v_mfma_f32_16x16x32_bf16 a[20:23], v[132:135], v[164:167], a[20:23]
ds_read_b64_tr_b16 v[64:65], v2 offset:0
s_add_u32 m0, s33, 49152
v_mfma_f32_16x16x32_bf16 a[24:27], v[132:135], v[168:171], a[24:27]
ds_read_b64_tr_b16 v[66:67], v2 offset:256
v_mfma_f32_16x16x32_bf16 a[28:31], v[132:135], v[172:175], a[28:31]
ds_read_b64_tr_b16 v[68:69], v3 offset:0
buffer_load_dwordx4 v15, s[4:7], s31 offen offset:0 sc1 lds
v_mfma_f32_16x16x32_bf16 a[32:35], v[136:139], v[160:163], a[32:35]
ds_read_b64_tr_b16 v[70:71], v3 offset:256
v_mfma_f32_16x16x32_bf16 a[36:39], v[136:139], v[164:167], a[36:39]
ds_read_b64_tr_b16 v[72:73], v4 offset:0
buffer_load_dwordx4 v15, s[4:7], s31 offen offset:1024 sc1 lds
v_mfma_f32_16x16x32_bf16 a[40:43], v[136:139], v[168:171], a[40:43]
ds_read_b64_tr_b16 v[74:75], v4 offset:256
v_mfma_f32_16x16x32_bf16 a[44:47], v[136:139], v[172:175], a[44:47]
ds_read_b64_tr_b16 v[76:77], v5 offset:0
s_add_u32 s30, s30, 262144
v_mfma_f32_16x16x32_bf16 a[48:51], v[140:143], v[160:163], a[48:51]
ds_read_b64_tr_b16 v[78:79], v5 offset:256
s_add_u32 s31, s31, 16384
v_mfma_f32_16x16x32_bf16 a[52:55], v[140:143], v[164:167], a[52:55]
v_mfma_f32_16x16x32_bf16 a[56:59], v[140:143], v[168:171], a[56:59]
v_mfma_f32_16x16x32_bf16 a[60:63], v[140:143], v[172:175], a[60:63]
s_sub_u32 s37, s37, 1
s_cmp_lg_u32 s37, 0
s_cbranch_scc1 GL_74
s_waitcnt lgkmcnt(0)
v_mfma_f32_16x16x32_bf16 a[0:3], v[64:67], v[96:99], a[0:3]
s_waitcnt vmcnt(20)
s_barrier
s_add_u32 m0, s32, 57344
v_mfma_f32_16x16x32_bf16 a[4:7], v[64:67], v[100:103], a[4:7]
ds_read_b128 v[160:163], v10 offset:8192
buffer_load_dwordx4 v11, s[8:11], s30 offen offset:0 lds
v_mfma_f32_16x16x32_bf16 a[8:11], v[64:67], v[104:107], a[8:11]
ds_read_b128 v[164:167], v10 offset:9216
v_mfma_f32_16x16x32_bf16 a[12:15], v[64:67], v[108:111], a[12:15]
ds_read_b128 v[168:171], v10 offset:10240
buffer_load_dwordx4 v12, s[8:11], s30 offen offset:1024 lds
v_mfma_f32_16x16x32_bf16 a[16:19], v[68:71], v[96:99], a[16:19]
ds_read_b128 v[172:175], v10 offset:11264
v_mfma_f32_16x16x32_bf16 a[20:23], v[68:71], v[100:103], a[20:23]
ds_read_b64_tr_b16 v[128:129], v2 offset:8192
s_add_u32 m0, s33, 57344
v_mfma_f32_16x16x32_bf16 a[24:27], v[68:71], v[104:107], a[24:27]
ds_read_b64_tr_b16 v[130:131], v2 offset:8448
v_mfma_f32_16x16x32_bf16 a[28:31], v[68:71], v[108:111], a[28:31]
ds_read_b64_tr_b16 v[132:133], v3 offset:8192
buffer_load_dwordx4 v15, s[4:7], s31 offen offset:0 sc1 lds
v_mfma_f32_16x16x32_bf16 a[32:35], v[72:75], v[96:99], a[32:35]
ds_read_b64_tr_b16 v[134:135], v3 offset:8448
v_mfma_f32_16x16x32_bf16 a[36:39], v[72:75], v[100:103], a[36:39]
ds_read_b64_tr_b16 v[136:137], v4 offset:8192
buffer_load_dwordx4 v15, s[4:7], s31 offen offset:1024 sc1 lds
v_mfma_f32_16x16x32_bf16 a[40:43], v[72:75], v[104:107], a[40:43]
ds_read_b64_tr_b16 v[138:139], v4 offset:8448
v_mfma_f32_16x16x32_bf16 a[44:47], v[72:75], v[108:111], a[44:47]
ds_read_b64_tr_b16 v[140:141], v5 offset:8192
s_add_u32 s30, s30, 262144
v_mfma_f32_16x16x32_bf16 a[48:51], v[76:79], v[96:99], a[48:51]
ds_read_b64_tr_b16 v[142:143], v5 offset:8448
s_add_u32 s31, s31, 16384
v_mfma_f32_16x16x32_bf16 a[52:55], v[76:79], v[100:103], a[52:55]
v_mfma_f32_16x16x32_bf16 a[56:59], v[76:79], v[104:107], a[56:59]
v_mfma_f32_16x16x32_bf16 a[60:63], v[76:79], v[108:111], a[60:63]
s_waitcnt lgkmcnt(0)
v_mfma_f32_16x16x32_bf16 a[0:3], v[128:131], v[160:163], a[0:3]
s_waitcnt vmcnt(20)
s_barrier
v_mfma_f32_16x16x32_bf16 a[4:7], v[128:131], v[164:167], a[4:7]
ds_read_b128 v[96:99], v10 offset:16384
v_mfma_f32_16x16x32_bf16 a[8:11], v[128:131], v[168:171], a[8:11]
ds_read_b128 v[100:103], v10 offset:17408
v_mfma_f32_16x16x32_bf16 a[12:15], v[128:131], v[172:175], a[12:15]
ds_read_b128 v[104:107], v10 offset:18432
v_mfma_f32_16x16x32_bf16 a[16:19], v[132:135], v[160:163], a[16:19]
ds_read_b128 v[108:111], v10 offset:19456
v_mfma_f32_16x16x32_bf16 a[20:23], v[132:135], v[164:167], a[20:23]
ds_read_b64_tr_b16 v[64:65], v2 offset:16384
v_mfma_f32_16x16x32_bf16 a[24:27], v[132:135], v[168:171], a[24:27]
ds_read_b64_tr_b16 v[66:67], v2 offset:16640
v_mfma_f32_16x16x32_bf16 a[28:31], v[132:135], v[172:175], a[28:31]
ds_read_b64_tr_b16 v[68:69], v3 offset:16384
v_mfma_f32_16x16x32_bf16 a[32:35], v[136:139], v[160:163], a[32:35]
ds_read_b64_tr_b16 v[70:71], v3 offset:16640
v_mfma_f32_16x16x32_bf16 a[36:39], v[136:139], v[164:167], a[36:39]
ds_read_b64_tr_b16 v[72:73], v4 offset:16384
v_mfma_f32_16x16x32_bf16 a[40:43], v[136:139], v[168:171], a[40:43]
ds_read_b64_tr_b16 v[74:75], v4 offset:16640
v_mfma_f32_16x16x32_bf16 a[44:47], v[136:139], v[172:175], a[44:47]
ds_read_b64_tr_b16 v[76:77], v5 offset:16384
v_mfma_f32_16x16x32_bf16 a[48:51], v[140:143], v[160:163], a[48:51]
ds_read_b64_tr_b16 v[78:79], v5 offset:16640
v_mfma_f32_16x16x32_bf16 a[52:55], v[140:143], v[164:167], a[52:55]
v_mfma_f32_16x16x32_bf16 a[56:59], v[140:143], v[168:171], a[56:59]
v_mfma_f32_16x16x32_bf16 a[60:63], v[140:143], v[172:175], a[60:63]
s_waitcnt lgkmcnt(0)
v_mfma_f32_16x16x32_bf16 a[0:3], v[64:67], v[96:99], a[0:3]
s_waitcnt vmcnt(16)
s_barrier
v_mfma_f32_16x16x32_bf16 a[4:7], v[64:67], v[100:103], a[4:7]
ds_read_b128 v[160:163], v10 offset:24576
v_mfma_f32_16x16x32_bf16 a[8:11], v[64:67], v[104:107], a[8:11]
ds_read_b128 v[164:167], v10 offset:25600
v_mfma_f32_16x16x32_bf16 a[12:15], v[64:67], v[108:111], a[12:15]
ds_read_b128 v[168:171], v10 offset:26624
v_mfma_f32_16x16x32_bf16 a[16:19], v[68:71], v[96:99], a[16:19]
ds_read_b128 v[172:175], v10 offset:27648
v_mfma_f32_16x16x32_bf16 a[20:23], v[68:71], v[100:103], a[20:23]
ds_read_b64_tr_b16 v[128:129], v2 offset:24576
v_mfma_f32_16x16x32_bf16 a[24:27], v[68:71], v[104:107], a[24:27]
ds_read_b64_tr_b16 v[130:131], v2 offset:24832
v_mfma_f32_16x16x32_bf16 a[28:31], v[68:71], v[108:111], a[28:31]
ds_read_b64_tr_b16 v[132:133], v3 offset:24576
v_mfma_f32_16x16x32_bf16 a[32:35], v[72:75], v[96:99], a[32:35]
ds_read_b64_tr_b16 v[134:135], v3 offset:24832
v_mfma_f32_16x16x32_bf16 a[36:39], v[72:75], v[100:103], a[36:39]
ds_read_b64_tr_b16 v[136:137], v4 offset:24576
v_mfma_f32_16x16x32_bf16 a[40:43], v[72:75], v[104:107], a[40:43]
ds_read_b64_tr_b16 v[138:139], v4 offset:24832
v_mfma_f32_16x16x32_bf16 a[44:47], v[72:75], v[108:111], a[44:47]
ds_read_b64_tr_b16 v[140:141], v5 offset:24576
v_mfma_f32_16x16x32_bf16 a[48:51], v[76:79], v[96:99], a[48:51]
ds_read_b64_tr_b16 v[142:143], v5 offset:24832
v_mfma_f32_16x16x32_bf16 a[52:55], v[76:79], v[100:103], a[52:55]
v_mfma_f32_16x16x32_bf16 a[56:59], v[76:79], v[104:107], a[56:59]
v_mfma_f32_16x16x32_bf16 a[60:63], v[76:79], v[108:111], a[60:63]
s_waitcnt lgkmcnt(0)
v_mfma_f32_16x16x32_bf16 a[0:3], v[128:131], v[160:163], a[0:3]
s_waitcnt vmcnt(12)
s_barrier
v_mfma_f32_16x16x32_bf16 a[4:7], v[128:131], v[164:167], a[4:7]
ds_read_b128 v[96:99], v10 offset:32768
v_mfma_f32_16x16x32_bf16 a[8:11], v[128:131], v[168:171], a[8:11]
ds_read_b128 v[100:103], v10 offset:33792
v_mfma_f32_16x16x32_bf16 a[12:15], v[128:131], v[172:175], a[12:15]
ds_read_b128 v[104:107], v10 offset:34816
v_mfma_f32_16x16x32_bf16 a[16:19], v[132:135], v[160:163], a[16:19]
ds_read_b128 v[108:111], v10 offset:35840
v_mfma_f32_16x16x32_bf16 a[20:23], v[132:135], v[164:167], a[20:23]
ds_read_b64_tr_b16 v[64:65], v2 offset:32768
v_mfma_f32_16x16x32_bf16 a[24:27], v[132:135], v[168:171], a[24:27]
ds_read_b64_tr_b16 v[66:67], v2 offset:33024
v_mfma_f32_16x16x32_bf16 a[28:31], v[132:135], v[172:175], a[28:31]
ds_read_b64_tr_b16 v[68:69], v3 offset:32768
v_mfma_f32_16x16x32_bf16 a[32:35], v[136:139], v[160:163], a[32:35]
ds_read_b64_tr_b16 v[70:71], v3 offset:33024
v_mfma_f32_16x16x32_bf16 a[36:39], v[136:139], v[164:167], a[36:39]
ds_read_b64_tr_b16 v[72:73], v4 offset:32768
v_mfma_f32_16x16x32_bf16 a[40:43], v[136:139], v[168:171], a[40:43]
ds_read_b64_tr_b16 v[74:75], v4 offset:33024
v_mfma_f32_16x16x32_bf16 a[44:47], v[136:139], v[172:175], a[44:47]
ds_read_b64_tr_b16 v[76:77], v5 offset:32768
v_mfma_f32_16x16x32_bf16 a[48:51], v[140:143], v[160:163], a[48:51]
ds_read_b64_tr_b16 v[78:79], v5 offset:33024
v_mfma_f32_16x16x32_bf16 a[52:55], v[140:143], v[164:167], a[52:55]
v_mfma_f32_16x16x32_bf16 a[56:59], v[140:143], v[168:171], a[56:59]
v_mfma_f32_16x16x32_bf16 a[60:63], v[140:143], v[172:175], a[60:63]
s_waitcnt lgkmcnt(0)
v_mfma_f32_16x16x32_bf16 a[0:3], v[64:67], v[96:99], a[0:3]
s_waitcnt vmcnt(8)
s_barrier
v_mfma_f32_16x16x32_bf16 a[4:7], v[64:67], v[100:103], a[4:7]
ds_read_b128 v[160:163], v10 offset:40960
v_mfma_f32_16x16x32_bf16 a[8:11], v[64:67], v[104:107], a[8:11]
ds_read_b128 v[164:167], v10 offset:41984
v_mfma_f32_16x16x32_bf16 a[12:15], v[64:67], v[108:111], a[12:15]
ds_read_b128 v[168:171], v10 offset:43008
v_mfma_f32_16x16x32_bf16 a[16:19], v[68:71], v[96:99], a[16:19]
ds_read_b128 v[172:175], v10 offset:44032
v_mfma_f32_16x16x32_bf16 a[20:23], v[68:71], v[100:103], a[20:23]
ds_read_b64_tr_b16 v[128:129], v2 offset:40960
v_mfma_f32_16x16x32_bf16 a[24:27], v[68:71], v[104:107], a[24:27]
ds_read_b64_tr_b16 v[130:131], v2 offset:41216
v_mfma_f32_16x16x32_bf16 a[28:31], v[68:71], v[108:111], a[28:31]
ds_read_b64_tr_b16 v[132:133], v3 offset:40960
v_mfma_f32_16x16x32_bf16 a[32:35], v[72:75], v[96:99], a[32:35]
ds_read_b64_tr_b16 v[134:135], v3 offset:41216
v_mfma_f32_16x16x32_bf16 a[36:39], v[72:75], v[100:103], a[36:39]
ds_read_b64_tr_b16 v[136:137], v4 offset:40960
v_mfma_f32_16x16x32_bf16 a[40:43], v[72:75], v[104:107], a[40:43]
ds_read_b64_tr_b16 v[138:139], v4 offset:41216
v_mfma_f32_16x16x32_bf16 a[44:47], v[72:75], v[108:111], a[44:47]
ds_read_b64_tr_b16 v[140:141], v5 offset:40960
v_mfma_f32_16x16x32_bf16 a[48:51], v[76:79], v[96:99], a[48:51]
ds_read_b64_tr_b16 v[142:143], v5 offset:41216
v_mfma_f32_16x16x32_bf16 a[52:55], v[76:79], v[100:103], a[52:55]
v_mfma_f32_16x16x32_bf16 a[56:59], v[76:79], v[104:107], a[56:59]
v_mfma_f32_16x16x32_bf16 a[60:63], v[76:79], v[108:111], a[60:63]
s_waitcnt lgkmcnt(0)
v_mfma_f32_16x16x32_bf16 a[0:3], v[128:131], v[160:163], a[0:3]
s_waitcnt vmcnt(4)
s_barrier
v_mfma_f32_16x16x32_bf16 a[4:7], v[128:131], v[164:167], a[4:7]
ds_read_b128 v[96:99], v10 offset:49152
v_mfma_f32_16x16x32_bf16 a[8:11], v[128:131], v[168:171], a[8:11]
ds_read_b128 v[100:103], v10 offset:50176
v_mfma_f32_16x16x32_bf16 a[12:15], v[128:131], v[172:175], a[12:15]
ds_read_b128 v[104:107], v10 offset:51200
v_mfma_f32_16x16x32_bf16 a[16:19], v[132:135], v[160:163], a[16:19]
ds_read_b128 v[108:111], v10 offset:52224
v_mfma_f32_16x16x32_bf16 a[20:23], v[132:135], v[164:167], a[20:23]
ds_read_b64_tr_b16 v[64:65], v2 offset:49152
v_mfma_f32_16x16x32_bf16 a[24:27], v[132:135], v[168:171], a[24:27]
ds_read_b64_tr_b16 v[66:67], v2 offset:49408
v_mfma_f32_16x16x32_bf16 a[28:31], v[132:135], v[172:175], a[28:31]
ds_read_b64_tr_b16 v[68:69], v3 offset:49152
v_mfma_f32_16x16x32_bf16 a[32:35], v[136:139], v[160:163], a[32:35]
ds_read_b64_tr_b16 v[70:71], v3 offset:49408
v_mfma_f32_16x16x32_bf16 a[36:39], v[136:139], v[164:167], a[36:39]
ds_read_b64_tr_b16 v[72:73], v4 offset:49152
v_mfma_f32_16x16x32_bf16 a[40:43], v[136:139], v[168:171], a[40:43]
ds_read_b64_tr_b16 v[74:75], v4 offset:49408
v_mfma_f32_16x16x32_bf16 a[44:47], v[136:139], v[172:175], a[44:47]
ds_read_b64_tr_b16 v[76:77], v5 offset:49152
v_mfma_f32_16x16x32_bf16 a[48:51], v[140:143], v[160:163], a[48:51]
ds_read_b64_tr_b16 v[78:79], v5 offset:49408
v_mfma_f32_16x16x32_bf16 a[52:55], v[140:143], v[164:167], a[52:55]
v_mfma_f32_16x16x32_bf16 a[56:59], v[140:143], v[168:171], a[56:59]
v_mfma_f32_16x16x32_bf16 a[60:63], v[140:143], v[172:175], a[60:63]
s_waitcnt lgkmcnt(0)
v_mfma_f32_16x16x32_bf16 a[0:3], v[64:67], v[96:99], a[0:3]
s_waitcnt vmcnt(0)
s_barrier
v_mfma_f32_16x16x32_bf16 a[4:7], v[64:67], v[100:103], a[4:7]
ds_read_b128 v[160:163], v10 offset:57344
v_mfma_f32_16x16x32_bf16 a[8:11], v[64:67], v[104:107], a[8:11]
ds_read_b128 v[164:167], v10 offset:58368
v_mfma_f32_16x16x32_bf16 a[12:15], v[64:67], v[108:111], a[12:15]
ds_read_b128 v[168:171], v10 offset:59392
v_mfma_f32_16x16x32_bf16 a[16:19], v[68:71], v[96:99], a[16:19]
ds_read_b128 v[172:175], v10 offset:60416
v_mfma_f32_16x16x32_bf16 a[20:23], v[68:71], v[100:103], a[20:23]
ds_read_b64_tr_b16 v[128:129], v2 offset:57344
v_mfma_f32_16x16x32_bf16 a[24:27], v[68:71], v[104:107], a[24:27]
ds_read_b64_tr_b16 v[130:131], v2 offset:57600
v_mfma_f32_16x16x32_bf16 a[28:31], v[68:71], v[108:111], a[28:31]
ds_read_b64_tr_b16 v[132:133], v3 offset:57344
v_mfma_f32_16x16x32_bf16 a[32:35], v[72:75], v[96:99], a[32:35]
ds_read_b64_tr_b16 v[134:135], v3 offset:57600
v_mfma_f32_16x16x32_bf16 a[36:39], v[72:75], v[100:103], a[36:39]
ds_read_b64_tr_b16 v[136:137], v4 offset:57344
v_mfma_f32_16x16x32_bf16 a[40:43], v[72:75], v[104:107], a[40:43]
ds_read_b64_tr_b16 v[138:139], v4 offset:57600
v_mfma_f32_16x16x32_bf16 a[44:47], v[72:75], v[108:111], a[44:47]
ds_read_b64_tr_b16 v[140:141], v5 offset:57344
v_mfma_f32_16x16x32_bf16 a[48:51], v[76:79], v[96:99], a[48:51]
ds_read_b64_tr_b16 v[142:143], v5 offset:57600
v_mfma_f32_16x16x32_bf16 a[52:55], v[76:79], v[100:103], a[52:55]
v_mfma_f32_16x16x32_bf16 a[56:59], v[76:79], v[104:107], a[56:59]
v_mfma_f32_16x16x32_bf16 a[60:63], v[76:79], v[108:111], a[60:63]
s_waitcnt lgkmcnt(0)
v_mfma_f32_16x16x32_bf16 a[0:3], v[128:131], v[160:163], a[0:3]
v_mfma_f32_16x16x32_bf16 a[4:7], v[128:131], v[164:167], a[4:7]
v_mfma_f32_16x16x32_bf16 a[8:11], v[128:131], v[168:171], a[8:11]
v_mfma_f32_16x16x32_bf16 a[12:15], v[128:131], v[172:175], a[12:15]
v_mfma_f32_16x16x32_bf16 a[16:19], v[132:135], v[160:163], a[16:19]
v_mfma_f32_16x16x32_bf16 a[20:23], v[132:135], v[164:167], a[20:23]
v_mfma_f32_16x16x32_bf16 a[24:27], v[132:135], v[168:171], a[24:27]
v_mfma_f32_16x16x32_bf16 a[28:31], v[132:135], v[172:175], a[28:31]
v_mfma_f32_16x16x32_bf16 a[32:35], v[136:139], v[160:163], a[32:35]
v_mfma_f32_16x16x32_bf16 a[36:39], v[136:139], v[164:167], a[36:39]
v_mfma_f32_16x16x32_bf16 a[40:43], v[136:139], v[168:171], a[40:43]
v_mfma_f32_16x16x32_bf16 a[44:47], v[136:139], v[172:175], a[44:47]
v_mfma_f32_16x16x32_bf16 a[48:51], v[140:143], v[160:163], a[48:51]
v_mfma_f32_16x16x32_bf16 a[52:55], v[140:143], v[164:167], a[52:55]
v_mfma_f32_16x16x32_bf16 a[56:59], v[140:143], v[168:171], a[56:59]
v_mfma_f32_16x16x32_bf16 a[60:63], v[140:143], v[172:175], a[60:63]
s_nop 7
s_barrier
s_mov_b32 s42, 1.0
s_lshr_b32 s36, s28, 1
s_lshl_b32 s36, s36, 20
s_lshl_b32 s37, s34, 19
s_add_u32 s36, s36, s37
s_lshl_b32 s37, s29, 14
s_add_u32 s36, s36, s37
s_and_b32 s37, s28, 1
s_lshl_b32 s37, s37, 13
s_add_u32 s36, s36, s37
s_lshl_b32 s37, s35, 11
s_add_u32 s36, s36, s37
s_add_u32 s36, s36, 41943040
s_add_u32 s38, s36, 4096
v_accvgpr_read_b32 v64, a0
v_accvgpr_read_b32 v65, a1
v_accvgpr_read_b32 v66, a2
v_accvgpr_read_b32 v67, a3
v_accvgpr_read_b32 v68, a16
v_accvgpr_read_b32 v69, a17
v_accvgpr_read_b32 v70, a18
v_accvgpr_read_b32 v71, a19
v_cvt_pk_bf16_f32 v72, v64, v65
v_cvt_pk_bf16_f32 v73, v66, v67
v_cvt_pk_bf16_f32 v74, v68, v69
v_cvt_pk_bf16_f32 v75, v70, v71
buffer_store_dwordx4 v[72:75], v61, s[4:7], s36 offen offset:0 sc1
v_accvgpr_read_b32 v80, a32
v_accvgpr_read_b32 v81, a33
v_accvgpr_read_b32 v82, a34
v_accvgpr_read_b32 v83, a35
v_accvgpr_read_b32 v84, a48
v_accvgpr_read_b32 v85, a49
v_accvgpr_read_b32 v86, a50
v_accvgpr_read_b32 v87, a51
v_cvt_pk_bf16_f32 v88, v80, v81
v_cvt_pk_bf16_f32 v89, v82, v83
v_cvt_pk_bf16_f32 v90, v84, v85
v_cvt_pk_bf16_f32 v91, v86, v87
buffer_store_dwordx4 v[88:91], v61, s[4:7], s36 offen offset:1024 sc1
v_accvgpr_read_b32 v96, a4
v_accvgpr_read_b32 v97, a5
v_accvgpr_read_b32 v98, a6
v_accvgpr_read_b32 v99, a7
v_accvgpr_read_b32 v100, a20
v_accvgpr_read_b32 v101, a21
v_accvgpr_read_b32 v102, a22
v_accvgpr_read_b32 v103, a23
v_cvt_pk_bf16_f32 v104, v96, v97
v_cvt_pk_bf16_f32 v105, v98, v99
v_cvt_pk_bf16_f32 v106, v100, v101
v_cvt_pk_bf16_f32 v107, v102, v103
buffer_store_dwordx4 v[104:107], v61, s[4:7], s38 offen offset:0 sc1
v_accvgpr_read_b32 v112, a36
v_accvgpr_read_b32 v113, a37
v_accvgpr_read_b32 v114, a38
v_accvgpr_read_b32 v115, a39
v_accvgpr_read_b32 v116, a52
v_accvgpr_read_b32 v117, a53
v_accvgpr_read_b32 v118, a54
v_accvgpr_read_b32 v119, a55
v_cvt_pk_bf16_f32 v120, v112, v113
v_cvt_pk_bf16_f32 v121, v114, v115
v_cvt_pk_bf16_f32 v122, v116, v117
v_cvt_pk_bf16_f32 v123, v118, v119
buffer_store_dwordx4 v[120:123], v61, s[4:7], s38 offen offset:1024 sc1
s_add_u32 s36, s36, 262144
s_add_u32 s38, s38, 262144
v_accvgpr_read_b32 v64, a8
v_accvgpr_read_b32 v65, a9
v_accvgpr_read_b32 v66, a10
v_accvgpr_read_b32 v67, a11
v_accvgpr_read_b32 v68, a24
v_accvgpr_read_b32 v69, a25
v_accvgpr_read_b32 v70, a26
v_accvgpr_read_b32 v71, a27
v_cvt_pk_bf16_f32 v72, v64, v65
v_cvt_pk_bf16_f32 v73, v66, v67
v_cvt_pk_bf16_f32 v74, v68, v69
v_cvt_pk_bf16_f32 v75, v70, v71
buffer_store_dwordx4 v[72:75], v61, s[4:7], s36 offen offset:0 sc1
v_accvgpr_read_b32 v80, a40
v_accvgpr_read_b32 v81, a41
v_accvgpr_read_b32 v82, a42
v_accvgpr_read_b32 v83, a43
v_accvgpr_read_b32 v84, a56
v_accvgpr_read_b32 v85, a57
v_accvgpr_read_b32 v86, a58
v_accvgpr_read_b32 v87, a59
v_cvt_pk_bf16_f32 v88, v80, v81
v_cvt_pk_bf16_f32 v89, v82, v83
v_cvt_pk_bf16_f32 v90, v84, v85
v_cvt_pk_bf16_f32 v91, v86, v87
buffer_store_dwordx4 v[88:91], v61, s[4:7], s36 offen offset:1024 sc1
v_accvgpr_read_b32 v96, a12
v_accvgpr_read_b32 v97, a13
v_accvgpr_read_b32 v98, a14
v_accvgpr_read_b32 v99, a15
v_accvgpr_read_b32 v100, a28
v_accvgpr_read_b32 v101, a29
v_accvgpr_read_b32 v102, a30
v_accvgpr_read_b32 v103, a31
v_cvt_pk_bf16_f32 v104, v96, v97
v_cvt_pk_bf16_f32 v105, v98, v99
v_cvt_pk_bf16_f32 v106, v100, v101
v_cvt_pk_bf16_f32 v107, v102, v103
buffer_store_dwordx4 v[104:107], v61, s[4:7], s38 offen offset:0 sc1
v_accvgpr_read_b32 v112, a44
v_accvgpr_read_b32 v113, a45
v_accvgpr_read_b32 v114, a46
v_accvgpr_read_b32 v115, a47
v_accvgpr_read_b32 v116, a60
v_accvgpr_read_b32 v117, a61
v_accvgpr_read_b32 v118, a62
v_accvgpr_read_b32 v119, a63
v_cvt_pk_bf16_f32 v120, v112, v113
v_cvt_pk_bf16_f32 v121, v114, v115
v_cvt_pk_bf16_f32 v122, v116, v117
v_cvt_pk_bf16_f32 v123, v118, v119
buffer_store_dwordx4 v[120:123], v61, s[4:7], s38 offen offset:1024 sc1
s_and_b32 s36, s28, 2
s_lshl_b32 s36, s36, 11
s_and_b32 s37, s28, 1
s_lshl_b32 s37, s37, 4
s_add_u32 s36, s36, s37
s_lshl_b32 s37, s29, 7
s_add_u32 s36, s36, s37
s_add_u32 s36, s36, 119595008
v_lshlrev_b32 v7, 7, v1
s_mov_b32 s46, 119545856
s_mov_b32 s47, 119554048
s_cmp_lg_u32 s24, 0
s_cbranch_scc1 TI_75
s_lshl_b32 s26, s20, 8
s_add_u32 s26, s26, 119537664
v_mov_b32 v2, 1
v_mov_b32 v3, 0
buffer_load_dword v5, v7, s[4:7], s46 offen sc1
buffer_load_dword v6, v7, s[4:7], s47 offen sc1
s_mov_b64 exec, 1
buffer_atomic_add v2, v3, s[4:7], s26 offen sc0 sc1
s_mov_b64 exec, -1
TI_75:
v_mov_b32 v4, 163808
s_waitcnt vmcnt(0)
s_cmp_lg_u32 s24, 0
s_cbranch_scc1 TP_76
s_mov_b32 s44, 0
TPL_77:
v_and_b32 v5, v5, v6
v_cmp_eq_u32 vcc, 0, v5
s_cbranch_vccz TPK_78
buffer_load_dword v5, v7, s[4:7], s46 offen sc1
buffer_load_dword v6, v7, s[4:7], s47 offen sc1
s_add_u32 s44, s44, 1
s_waitcnt vmcnt(0)
s_cmp_lt_u32 s44, 40000
s_cbranch_scc1 TPL_77
TPK_78:
s_mov_b64 exec, 1
ds_write_b32 v4, v2
s_mov_b64 exec, -1
s_waitcnt lgkmcnt(0)
TP_76:
s_barrier
ds_read_b32 v2, v4
s_lshl_b32 s38, s29, 2
s_add_u32 s38, s38, s28
s_add_u32 s38, s38, 0
s_mul_i32 s38, s38, 3
s_add_u32 s38, s38, s24
s_sub_u32 s38, s38, 1
s_cmp_lg_u32 s24, 0
s_cbranch_scc1 R2_79
v_mov_b32 v16, 1
v_mov_b32 v17, 0
s_mov_b64 exec, 1
buffer_store_dword v16, v17, s[4:7], s36 offen sc1
buffer_store_dword v16, v17, s[4:7], s36 offen offset:2048 sc1
s_mov_b64 exec, -1
s_branch W_TICKET
R2_79:
s_load_dwordx2 s[72:73], s[0:1], 80
s_mov_b32 s74, 7340032
s_mov_b32 s75, 0x20000
s_mul_i32 s38, s38, 24576
v_lshlrev_b32 v240, 7, v1
v_add_u32 v240, s38, v240
v_add_u32 v241, 8192, v240
v_add_u32 v242, 16384, v240
s_waitcnt lgkmcnt(0)
buffer_load_dword v255, v240, s[72:75], 0 offen
buffer_load_dword v255, v241, s[72:75], 0 offen
buffer_load_dword v255, v242, s[72:75], 0 offen
s_branch W_TICKET
T_V64:
s_load_dwordx2 s[8:9], s[0:1], 32
s_mov_b32 s10, 8388608
s_mov_b32 s11, 0x20000
s_and_b32 s36, s28, 1
s_lshl_b32 s36, s36, 8
s_lshl_b32 s30, s29, 9
s_add_u32 s30, s30, s36
s_lshr_b32 s31, s28, 1
s_lshl_b32 s31, s31, 13
s_add_u32 s31, s31, 0
s_lshl_b32 s32, s24, 11
s_mov_b32 s38, s32
s_add_u32 s33, s38, 65536
s_lshr_b32 s34, s24, 1
s_and_b32 s35, s24, 1
v_lshrrev_b32 v16, 5, v1
v_and_b32 v17, 15, v1
v_lshlrev_b32 v18, 1, v16
v_xor_b32 v17, v17, v18
s_lshl_b32 s36, s35, 3
v_xor_b32 v17, s36, v17
v_and_b32 v18, 16, v1
v_add_u32 v16, v16, v18
s_lshl_b32 s36, s24, 2
v_add_u32 v16, s36, v16
v_lshlrev_b32 v16, 13, v16
v_xor_b32 v18, 0, v17
v_lshl_add_u32 v18, v18, 4, v16
v_add_u32 v11, 0, v18
v_xor_b32 v18, 4, v17
v_lshl_add_u32 v18, v18, 4, v16
v_add_u32 v12, 15360, v18
v_lshlrev_b32 v61, 4, v1
v_add_u32 v15, s38, v61
s_waitcnt lgkmcnt(0)
s_add_u32 m0, s32, 0
s_nop 0
buffer_load_dwordx4 v11, s[8:11], s30 offen offset:0 lds
buffer_load_dwordx4 v12, s[8:11], s30 offen offset:1024 lds
s_add_u32 m0, s33, 0
s_nop 0
buffer_load_dwordx4 v15, s[4:7], s31 offen offset:0 sc1 lds
buffer_load_dwordx4 v15, s[4:7], s31 offen offset:1024 sc1 lds
s_add_u32 s30, s30, 262144
s_add_u32 s31, s31, 16384
s_add_u32 m0, s32, 8192
s_nop 0
buffer_load_dwordx4 v11, s[8:11], s30 offen offset:0 lds
buffer_load_dwordx4 v12, s[8:11], s30 offen offset:1024 lds
s_add_u32 m0, s33, 8192
s_nop 0
buffer_load_dwordx4 v15, s[4:7], s31 offen offset:0 sc1 lds
buffer_load_dwordx4 v15, s[4:7], s31 offen offset:1024 sc1 lds
s_add_u32 s30, s30, 262144
s_add_u32 s31, s31, 16384
s_add_u32 m0, s32, 16384
s_nop 0
buffer_load_dwordx4 v11, s[8:11], s30 offen offset:0 lds
buffer_load_dwordx4 v12, s[8:11], s30 offen offset:1024 lds
s_add_u32 m0, s33, 16384
s_nop 0
buffer_load_dwordx4 v15, s[4:7], s31 offen offset:0 sc1 lds
buffer_load_dwordx4 v15, s[4:7], s31 offen offset:1024 sc1 lds
s_add_u32 s30, s30, 262144
s_add_u32 s31, s31, 16384
s_add_u32 m0, s32, 24576
s_nop 0
buffer_load_dwordx4 v11, s[8:11], s30 offen offset:0 lds
buffer_load_dwordx4 v12, s[8:11], s30 offen offset:1024 lds
s_add_u32 m0, s33, 24576
s_nop 0
buffer_load_dwordx4 v15, s[4:7], s31 offen offset:0 sc1 lds
buffer_load_dwordx4 v15, s[4:7], s31 offen offset:1024 sc1 lds
s_add_u32 s30, s30, 262144
s_add_u32 s31, s31, 16384
s_add_u32 m0, s32, 32768
s_nop 0
buffer_load_dwordx4 v11, s[8:11], s30 offen offset:0 lds
buffer_load_dwordx4 v12, s[8:11], s30 offen offset:1024 lds
s_add_u32 m0, s33, 32768
s_nop 0
buffer_load_dwordx4 v15, s[4:7], s31 offen offset:0 sc1 lds
buffer_load_dwordx4 v15, s[4:7], s31 offen offset:1024 sc1 lds
s_add_u32 s30, s30, 262144
s_add_u32 s31, s31, 16384
s_add_u32 m0, s32, 40960
s_nop 0
buffer_load_dwordx4 v11, s[8:11], s30 offen offset:0 lds
buffer_load_dwordx4 v12, s[8:11], s30 offen offset:1024 lds
s_add_u32 m0, s33, 40960
s_nop 0
buffer_load_dwordx4 v15, s[4:7], s31 offen offset:0 sc1 lds
buffer_load_dwordx4 v15, s[4:7], s31 offen offset:1024 sc1 lds
s_add_u32 s30, s30, 262144
s_add_u32 s31, s31, 16384
s_add_u32 m0, s32, 49152
s_nop 0
buffer_load_dwordx4 v11, s[8:11], s30 offen offset:0 lds
buffer_load_dwordx4 v12, s[8:11], s30 offen offset:1024 lds
s_add_u32 m0, s33, 49152
s_nop 0
buffer_load_dwordx4 v15, s[4:7], s31 offen offset:0 sc1 lds
buffer_load_dwordx4 v15, s[4:7], s31 offen offset:1024 sc1 lds
s_add_u32 s30, s30, 262144
s_add_u32 s31, s31, 16384
s_lshl_b32 s36, s34, 12
s_add_u32 s36, s36, 65536
v_add_u32 v10, s36, v61
v_lshrrev_b32 v16, 2, v1
v_and_b32 v17, 7, v16
v_lshlrev_b32 v17, 1, v17
v_lshlrev_b32 v16, 9, v16
v_and_b32 v18, 3, v1
v_lshl_add_u32 v16, v18, 3, v16
s_lshl_b32 s36, s34, 8
s_mov_b32 s36, 0
v_add_u32 v16, s36, v16
s_lshl_b32 s36, s35, 3
v_xor_b32 v17, s36, v17
v_xor_b32 v18, 0, v17
v_lshl_add_u32 v2, v18, 4, v16
v_add_u32 v40, 0x10000, v2
v_xor_b32 v18, 2, v17
v_lshl_add_u32 v3, v18, 4, v16
v_add_u32 v41, 0x10000, v3
v_xor_b32 v18, 4, v17
v_lshl_add_u32 v4, v18, 4, v16
v_add_u32 v42, 0x10000, v4
v_xor_b32 v18, 6, v17
v_lshl_add_u32 v5, v18, 4, v16
v_add_u32 v43, 0x10000, v5
v_accvgpr_write_b32 a0, 0
v_accvgpr_write_b32 a1, 0
v_accvgpr_write_b32 a2, 0
v_accvgpr_write_b32 a3, 0
v_accvgpr_write_b32 a4, 0
v_accvgpr_write_b32 a5, 0
v_accvgpr_write_b32 a6, 0
v_accvgpr_write_b32 a7, 0
v_accvgpr_write_b32 a8, 0
v_accvgpr_write_b32 a9, 0
v_accvgpr_write_b32 a10, 0
v_accvgpr_write_b32 a11, 0
v_accvgpr_write_b32 a12, 0
v_accvgpr_write_b32 a13, 0
v_accvgpr_write_b32 a14, 0
v_accvgpr_write_b32 a15, 0
v_accvgpr_write_b32 a16, 0
v_accvgpr_write_b32 a17, 0
v_accvgpr_write_b32 a18, 0
v_accvgpr_write_b32 a19, 0
v_accvgpr_write_b32 a20, 0
v_accvgpr_write_b32 a21, 0
v_accvgpr_write_b32 a22, 0
v_accvgpr_write_b32 a23, 0
v_accvgpr_write_b32 a24, 0
v_accvgpr_write_b32 a25, 0
v_accvgpr_write_b32 a26, 0
v_accvgpr_write_b32 a27, 0
v_accvgpr_write_b32 a28, 0
v_accvgpr_write_b32 a29, 0
v_accvgpr_write_b32 a30, 0
v_accvgpr_write_b32 a31, 0
v_accvgpr_write_b32 a32, 0
v_accvgpr_write_b32 a33, 0
v_accvgpr_write_b32 a34, 0
v_accvgpr_write_b32 a35, 0
v_accvgpr_write_b32 a36, 0
v_accvgpr_write_b32 a37, 0
v_accvgpr_write_b32 a38, 0
v_accvgpr_write_b32 a39, 0
v_accvgpr_write_b32 a40, 0
v_accvgpr_write_b32 a41, 0
v_accvgpr_write_b32 a42, 0
v_accvgpr_write_b32 a43, 0
v_accvgpr_write_b32 a44, 0
v_accvgpr_write_b32 a45, 0
v_accvgpr_write_b32 a46, 0
v_accvgpr_write_b32 a47, 0
v_accvgpr_write_b32 a48, 0
v_accvgpr_write_b32 a49, 0
v_accvgpr_write_b32 a50, 0
v_accvgpr_write_b32 a51, 0
v_accvgpr_write_b32 a52, 0
v_accvgpr_write_b32 a53, 0
v_accvgpr_write_b32 a54, 0
v_accvgpr_write_b32 a55, 0
v_accvgpr_write_b32 a56, 0
v_accvgpr_write_b32 a57, 0
v_accvgpr_write_b32 a58, 0
v_accvgpr_write_b32 a59, 0
v_accvgpr_write_b32 a60, 0
v_accvgpr_write_b32 a61, 0
v_accvgpr_write_b32 a62, 0
v_accvgpr_write_b32 a63, 0
s_waitcnt vmcnt(24)
s_barrier
ds_read_b128 v[96:99], v10 offset:0
ds_read_b128 v[100:103], v10 offset:1024
ds_read_b128 v[104:107], v10 offset:2048
ds_read_b128 v[108:111], v10 offset:3072
ds_read_b64_tr_b16 v[64:65], v2 offset:0
ds_read_b64_tr_b16 v[66:67], v2 offset:256
ds_read_b64_tr_b16 v[68:69], v3 offset:0
ds_read_b64_tr_b16 v[70:71], v3 offset:256
ds_read_b64_tr_b16 v[72:73], v4 offset:0
ds_read_b64_tr_b16 v[74:75], v4 offset:256
ds_read_b64_tr_b16 v[76:77], v5 offset:0
ds_read_b64_tr_b16 v[78:79], v5 offset:256
s_mov_b32 s37, 3
GL_80:
s_waitcnt lgkmcnt(0)
v_mfma_f32_16x16x32_bf16 a[0:3], v[96:99], v[64:67], a[0:3]
s_waitcnt vmcnt(20)
s_barrier
s_add_u32 m0, s32, 57344
v_mfma_f32_16x16x32_bf16 a[4:7], v[100:103], v[64:67], a[4:7]
ds_read_b128 v[160:163], v10 offset:8192
buffer_load_dwordx4 v11, s[8:11], s30 offen offset:0 lds
v_mfma_f32_16x16x32_bf16 a[8:11], v[104:107], v[64:67], a[8:11]
ds_read_b128 v[164:167], v10 offset:9216
v_mfma_f32_16x16x32_bf16 a[12:15], v[108:111], v[64:67], a[12:15]
ds_read_b128 v[168:171], v10 offset:10240
buffer_load_dwordx4 v12, s[8:11], s30 offen offset:1024 lds
v_mfma_f32_16x16x32_bf16 a[16:19], v[96:99], v[68:71], a[16:19]
ds_read_b128 v[172:175], v10 offset:11264
v_mfma_f32_16x16x32_bf16 a[20:23], v[100:103], v[68:71], a[20:23]
ds_read_b64_tr_b16 v[128:129], v2 offset:8192
s_add_u32 m0, s33, 57344
v_mfma_f32_16x16x32_bf16 a[24:27], v[104:107], v[68:71], a[24:27]
ds_read_b64_tr_b16 v[130:131], v2 offset:8448
v_mfma_f32_16x16x32_bf16 a[28:31], v[108:111], v[68:71], a[28:31]
ds_read_b64_tr_b16 v[132:133], v3 offset:8192
buffer_load_dwordx4 v15, s[4:7], s31 offen offset:0 sc1 lds
v_mfma_f32_16x16x32_bf16 a[32:35], v[96:99], v[72:75], a[32:35]
ds_read_b64_tr_b16 v[134:135], v3 offset:8448
v_mfma_f32_16x16x32_bf16 a[36:39], v[100:103], v[72:75], a[36:39]
ds_read_b64_tr_b16 v[136:137], v4 offset:8192
buffer_load_dwordx4 v15, s[4:7], s31 offen offset:1024 sc1 lds
v_mfma_f32_16x16x32_bf16 a[40:43], v[104:107], v[72:75], a[40:43]
ds_read_b64_tr_b16 v[138:139], v4 offset:8448
v_mfma_f32_16x16x32_bf16 a[44:47], v[108:111], v[72:75], a[44:47]
ds_read_b64_tr_b16 v[140:141], v5 offset:8192
s_add_u32 s30, s30, 262144
v_mfma_f32_16x16x32_bf16 a[48:51], v[96:99], v[76:79], a[48:51]
ds_read_b64_tr_b16 v[142:143], v5 offset:8448
s_add_u32 s31, s31, 16384
v_mfma_f32_16x16x32_bf16 a[52:55], v[100:103], v[76:79], a[52:55]
v_mfma_f32_16x16x32_bf16 a[56:59], v[104:107], v[76:79], a[56:59]
v_mfma_f32_16x16x32_bf16 a[60:63], v[108:111], v[76:79], a[60:63]
s_waitcnt lgkmcnt(0)
v_mfma_f32_16x16x32_bf16 a[0:3], v[160:163], v[128:131], a[0:3]
s_waitcnt vmcnt(20)
s_barrier
s_add_u32 m0, s32, 0
v_mfma_f32_16x16x32_bf16 a[4:7], v[164:167], v[128:131], a[4:7]
ds_read_b128 v[96:99], v10 offset:16384
buffer_load_dwordx4 v11, s[8:11], s30 offen offset:0 lds
v_mfma_f32_16x16x32_bf16 a[8:11], v[168:171], v[128:131], a[8:11]
ds_read_b128 v[100:103], v10 offset:17408
v_mfma_f32_16x16x32_bf16 a[12:15], v[172:175], v[128:131], a[12:15]
ds_read_b128 v[104:107], v10 offset:18432
buffer_load_dwordx4 v12, s[8:11], s30 offen offset:1024 lds
v_mfma_f32_16x16x32_bf16 a[16:19], v[160:163], v[132:135], a[16:19]
ds_read_b128 v[108:111], v10 offset:19456
v_mfma_f32_16x16x32_bf16 a[20:23], v[164:167], v[132:135], a[20:23]
ds_read_b64_tr_b16 v[64:65], v2 offset:16384
s_add_u32 m0, s33, 0
v_mfma_f32_16x16x32_bf16 a[24:27], v[168:171], v[132:135], a[24:27]
ds_read_b64_tr_b16 v[66:67], v2 offset:16640
v_mfma_f32_16x16x32_bf16 a[28:31], v[172:175], v[132:135], a[28:31]
ds_read_b64_tr_b16 v[68:69], v3 offset:16384
buffer_load_dwordx4 v15, s[4:7], s31 offen offset:0 sc1 lds
v_mfma_f32_16x16x32_bf16 a[32:35], v[160:163], v[136:139], a[32:35]
ds_read_b64_tr_b16 v[70:71], v3 offset:16640
v_mfma_f32_16x16x32_bf16 a[36:39], v[164:167], v[136:139], a[36:39]
ds_read_b64_tr_b16 v[72:73], v4 offset:16384
buffer_load_dwordx4 v15, s[4:7], s31 offen offset:1024 sc1 lds
v_mfma_f32_16x16x32_bf16 a[40:43], v[168:171], v[136:139], a[40:43]
ds_read_b64_tr_b16 v[74:75], v4 offset:16640
v_mfma_f32_16x16x32_bf16 a[44:47], v[172:175], v[136:139], a[44:47]
ds_read_b64_tr_b16 v[76:77], v5 offset:16384
s_add_u32 s30, s30, 262144
v_mfma_f32_16x16x32_bf16 a[48:51], v[160:163], v[140:143], a[48:51]
ds_read_b64_tr_b16 v[78:79], v5 offset:16640
s_add_u32 s31, s31, 16384
v_mfma_f32_16x16x32_bf16 a[52:55], v[164:167], v[140:143], a[52:55]
v_mfma_f32_16x16x32_bf16 a[56:59], v[168:171], v[140:143], a[56:59]
v_mfma_f32_16x16x32_bf16 a[60:63], v[172:175], v[140:143], a[60:63]
s_waitcnt lgkmcnt(0)
v_mfma_f32_16x16x32_bf16 a[0:3], v[96:99], v[64:67], a[0:3]
s_waitcnt vmcnt(20)
s_barrier
s_add_u32 m0, s32, 8192
v_mfma_f32_16x16x32_bf16 a[4:7], v[100:103], v[64:67], a[4:7]
ds_read_b128 v[160:163], v10 offset:24576
buffer_load_dwordx4 v11, s[8:11], s30 offen offset:0 lds
v_mfma_f32_16x16x32_bf16 a[8:11], v[104:107], v[64:67], a[8:11]
ds_read_b128 v[164:167], v10 offset:25600
v_mfma_f32_16x16x32_bf16 a[12:15], v[108:111], v[64:67], a[12:15]
ds_read_b128 v[168:171], v10 offset:26624
buffer_load_dwordx4 v12, s[8:11], s30 offen offset:1024 lds
v_mfma_f32_16x16x32_bf16 a[16:19], v[96:99], v[68:71], a[16:19]
ds_read_b128 v[172:175], v10 offset:27648
v_mfma_f32_16x16x32_bf16 a[20:23], v[100:103], v[68:71], a[20:23]
ds_read_b64_tr_b16 v[128:129], v2 offset:24576
s_add_u32 m0, s33, 8192
v_mfma_f32_16x16x32_bf16 a[24:27], v[104:107], v[68:71], a[24:27]
ds_read_b64_tr_b16 v[130:131], v2 offset:24832
v_mfma_f32_16x16x32_bf16 a[28:31], v[108:111], v[68:71], a[28:31]
ds_read_b64_tr_b16 v[132:133], v3 offset:24576
buffer_load_dwordx4 v15, s[4:7], s31 offen offset:0 sc1 lds
v_mfma_f32_16x16x32_bf16 a[32:35], v[96:99], v[72:75], a[32:35]
ds_read_b64_tr_b16 v[134:135], v3 offset:24832
v_mfma_f32_16x16x32_bf16 a[36:39], v[100:103], v[72:75], a[36:39]
ds_read_b64_tr_b16 v[136:137], v4 offset:24576
buffer_load_dwordx4 v15, s[4:7], s31 offen offset:1024 sc1 lds
v_mfma_f32_16x16x32_bf16 a[40:43], v[104:107], v[72:75], a[40:43]
ds_read_b64_tr_b16 v[138:139], v4 offset:24832
v_mfma_f32_16x16x32_bf16 a[44:47], v[108:111], v[72:75], a[44:47]
ds_read_b64_tr_b16 v[140:141], v5 offset:24576
s_add_u32 s30, s30, 262144
v_mfma_f32_16x16x32_bf16 a[48:51], v[96:99], v[76:79], a[48:51]
ds_read_b64_tr_b16 v[142:143], v5 offset:24832
s_add_u32 s31, s31, 16384
v_mfma_f32_16x16x32_bf16 a[52:55], v[100:103], v[76:79], a[52:55]
v_mfma_f32_16x16x32_bf16 a[56:59], v[104:107], v[76:79], a[56:59]
v_mfma_f32_16x16x32_bf16 a[60:63], v[108:111], v[76:79], a[60:63]
s_waitcnt lgkmcnt(0)
v_mfma_f32_16x16x32_bf16 a[0:3], v[160:163], v[128:131], a[0:3]
s_waitcnt vmcnt(20)
s_barrier
s_add_u32 m0, s32, 16384
v_mfma_f32_16x16x32_bf16 a[4:7], v[164:167], v[128:131], a[4:7]
ds_read_b128 v[96:99], v10 offset:32768
buffer_load_dwordx4 v11, s[8:11], s30 offen offset:0 lds
v_mfma_f32_16x16x32_bf16 a[8:11], v[168:171], v[128:131], a[8:11]
ds_read_b128 v[100:103], v10 offset:33792
v_mfma_f32_16x16x32_bf16 a[12:15], v[172:175], v[128:131], a[12:15]
ds_read_b128 v[104:107], v10 offset:34816
buffer_load_dwordx4 v12, s[8:11], s30 offen offset:1024 lds
v_mfma_f32_16x16x32_bf16 a[16:19], v[160:163], v[132:135], a[16:19]
ds_read_b128 v[108:111], v10 offset:35840
v_mfma_f32_16x16x32_bf16 a[20:23], v[164:167], v[132:135], a[20:23]
ds_read_b64_tr_b16 v[64:65], v2 offset:32768
s_add_u32 m0, s33, 16384
v_mfma_f32_16x16x32_bf16 a[24:27], v[168:171], v[132:135], a[24:27]
ds_read_b64_tr_b16 v[66:67], v2 offset:33024
v_mfma_f32_16x16x32_bf16 a[28:31], v[172:175], v[132:135], a[28:31]
ds_read_b64_tr_b16 v[68:69], v3 offset:32768
buffer_load_dwordx4 v15, s[4:7], s31 offen offset:0 sc1 lds
v_mfma_f32_16x16x32_bf16 a[32:35], v[160:163], v[136:139], a[32:35]
ds_read_b64_tr_b16 v[70:71], v3 offset:33024
v_mfma_f32_16x16x32_bf16 a[36:39], v[164:167], v[136:139], a[36:39]
ds_read_b64_tr_b16 v[72:73], v4 offset:32768
buffer_load_dwordx4 v15, s[4:7], s31 offen offset:1024 sc1 lds
v_mfma_f32_16x16x32_bf16 a[40:43], v[168:171], v[136:139], a[40:43]
ds_read_b64_tr_b16 v[74:75], v4 offset:33024
v_mfma_f32_16x16x32_bf16 a[44:47], v[172:175], v[136:139], a[44:47]
ds_read_b64_tr_b16 v[76:77], v5 offset:32768
s_add_u32 s30, s30, 262144
v_mfma_f32_16x16x32_bf16 a[48:51], v[160:163], v[140:143], a[48:51]
ds_read_b64_tr_b16 v[78:79], v5 offset:33024
s_add_u32 s31, s31, 16384
v_mfma_f32_16x16x32_bf16 a[52:55], v[164:167], v[140:143], a[52:55]
v_mfma_f32_16x16x32_bf16 a[56:59], v[168:171], v[140:143], a[56:59]
v_mfma_f32_16x16x32_bf16 a[60:63], v[172:175], v[140:143], a[60:63]
s_waitcnt lgkmcnt(0)
v_mfma_f32_16x16x32_bf16 a[0:3], v[96:99], v[64:67], a[0:3]
s_waitcnt vmcnt(20)
s_barrier
s_add_u32 m0, s32, 24576
v_mfma_f32_16x16x32_bf16 a[4:7], v[100:103], v[64:67], a[4:7]
ds_read_b128 v[160:163], v10 offset:40960
buffer_load_dwordx4 v11, s[8:11], s30 offen offset:0 lds
v_mfma_f32_16x16x32_bf16 a[8:11], v[104:107], v[64:67], a[8:11]
ds_read_b128 v[164:167], v10 offset:41984
v_mfma_f32_16x16x32_bf16 a[12:15], v[108:111], v[64:67], a[12:15]
ds_read_b128 v[168:171], v10 offset:43008
buffer_load_dwordx4 v12, s[8:11], s30 offen offset:1024 lds
v_mfma_f32_16x16x32_bf16 a[16:19], v[96:99], v[68:71], a[16:19]
ds_read_b128 v[172:175], v10 offset:44032
v_mfma_f32_16x16x32_bf16 a[20:23], v[100:103], v[68:71], a[20:23]
ds_read_b64_tr_b16 v[128:129], v2 offset:40960
s_add_u32 m0, s33, 24576
v_mfma_f32_16x16x32_bf16 a[24:27], v[104:107], v[68:71], a[24:27]
ds_read_b64_tr_b16 v[130:131], v2 offset:41216
v_mfma_f32_16x16x32_bf16 a[28:31], v[108:111], v[68:71], a[28:31]
ds_read_b64_tr_b16 v[132:133], v3 offset:40960
buffer_load_dwordx4 v15, s[4:7], s31 offen offset:0 sc1 lds
v_mfma_f32_16x16x32_bf16 a[32:35], v[96:99], v[72:75], a[32:35]
ds_read_b64_tr_b16 v[134:135], v3 offset:41216
v_mfma_f32_16x16x32_bf16 a[36:39], v[100:103], v[72:75], a[36:39]
ds_read_b64_tr_b16 v[136:137], v4 offset:40960
buffer_load_dwordx4 v15, s[4:7], s31 offen offset:1024 sc1 lds
v_mfma_f32_16x16x32_bf16 a[40:43], v[104:107], v[72:75], a[40:43]
ds_read_b64_tr_b16 v[138:139], v4 offset:41216
v_mfma_f32_16x16x32_bf16 a[44:47], v[108:111], v[72:75], a[44:47]
ds_read_b64_tr_b16 v[140:141], v5 offset:40960
s_add_u32 s30, s30, 262144
v_mfma_f32_16x16x32_bf16 a[48:51], v[96:99], v[76:79], a[48:51]
ds_read_b64_tr_b16 v[142:143], v5 offset:41216
s_add_u32 s31, s31, 16384
v_mfma_f32_16x16x32_bf16 a[52:55], v[100:103], v[76:79], a[52:55]
v_mfma_f32_16x16x32_bf16 a[56:59], v[104:107], v[76:79], a[56:59]
v_mfma_f32_16x16x32_bf16 a[60:63], v[108:111], v[76:79], a[60:63]
s_waitcnt lgkmcnt(0)
v_mfma_f32_16x16x32_bf16 a[0:3], v[160:163], v[128:131], a[0:3]
s_waitcnt vmcnt(20)
s_barrier
s_add_u32 m0, s32, 32768
v_mfma_f32_16x16x32_bf16 a[4:7], v[164:167], v[128:131], a[4:7]
ds_read_b128 v[96:99], v10 offset:49152
buffer_load_dwordx4 v11, s[8:11], s30 offen offset:0 lds
v_mfma_f32_16x16x32_bf16 a[8:11], v[168:171], v[128:131], a[8:11]
ds_read_b128 v[100:103], v10 offset:50176
v_mfma_f32_16x16x32_bf16 a[12:15], v[172:175], v[128:131], a[12:15]
ds_read_b128 v[104:107], v10 offset:51200
buffer_load_dwordx4 v12, s[8:11], s30 offen offset:1024 lds
v_mfma_f32_16x16x32_bf16 a[16:19], v[160:163], v[132:135], a[16:19]
ds_read_b128 v[108:111], v10 offset:52224
v_mfma_f32_16x16x32_bf16 a[20:23], v[164:167], v[132:135], a[20:23]
ds_read_b64_tr_b16 v[64:65], v2 offset:49152
s_add_u32 m0, s33, 32768
v_mfma_f32_16x16x32_bf16 a[24:27], v[168:171], v[132:135], a[24:27]
ds_read_b64_tr_b16 v[66:67], v2 offset:49408
v_mfma_f32_16x16x32_bf16 a[28:31], v[172:175], v[132:135], a[28:31]
ds_read_b64_tr_b16 v[68:69], v3 offset:49152
buffer_load_dwordx4 v15, s[4:7], s31 offen offset:0 sc1 lds
v_mfma_f32_16x16x32_bf16 a[32:35], v[160:163], v[136:139], a[32:35]
ds_read_b64_tr_b16 v[70:71], v3 offset:49408
v_mfma_f32_16x16x32_bf16 a[36:39], v[164:167], v[136:139], a[36:39]
ds_read_b64_tr_b16 v[72:73], v4 offset:49152
buffer_load_dwordx4 v15, s[4:7], s31 offen offset:1024 sc1 lds
v_mfma_f32_16x16x32_bf16 a[40:43], v[168:171], v[136:139], a[40:43]
ds_read_b64_tr_b16 v[74:75], v4 offset:49408
v_mfma_f32_16x16x32_bf16 a[44:47], v[172:175], v[136:139], a[44:47]
ds_read_b64_tr_b16 v[76:77], v5 offset:49152
s_add_u32 s30, s30, 262144
v_mfma_f32_16x16x32_bf16 a[48:51], v[160:163], v[140:143], a[48:51]
ds_read_b64_tr_b16 v[78:79], v5 offset:49408
s_add_u32 s31, s31, 16384
v_mfma_f32_16x16x32_bf16 a[52:55], v[164:167], v[140:143], a[52:55]
v_mfma_f32_16x16x32_bf16 a[56:59], v[168:171], v[140:143], a[56:59]
v_mfma_f32_16x16x32_bf16 a[60:63], v[172:175], v[140:143], a[60:63]
s_waitcnt lgkmcnt(0)
v_mfma_f32_16x16x32_bf16 a[0:3], v[96:99], v[64:67], a[0:3]
s_waitcnt vmcnt(20)
s_barrier
s_add_u32 m0, s32, 40960
v_mfma_f32_16x16x32_bf16 a[4:7], v[100:103], v[64:67], a[4:7]
ds_read_b128 v[160:163], v10 offset:57344
buffer_load_dwordx4 v11, s[8:11], s30 offen offset:0 lds
v_mfma_f32_16x16x32_bf16 a[8:11], v[104:107], v[64:67], a[8:11]
ds_read_b128 v[164:167], v10 offset:58368
v_mfma_f32_16x16x32_bf16 a[12:15], v[108:111], v[64:67], a[12:15]
ds_read_b128 v[168:171], v10 offset:59392
buffer_load_dwordx4 v12, s[8:11], s30 offen offset:1024 lds
v_mfma_f32_16x16x32_bf16 a[16:19], v[96:99], v[68:71], a[16:19]
ds_read_b128 v[172:175], v10 offset:60416
v_mfma_f32_16x16x32_bf16 a[20:23], v[100:103], v[68:71], a[20:23]
ds_read_b64_tr_b16 v[128:129], v2 offset:57344
s_add_u32 m0, s33, 40960
v_mfma_f32_16x16x32_bf16 a[24:27], v[104:107], v[68:71], a[24:27]
ds_read_b64_tr_b16 v[130:131], v2 offset:57600
v_mfma_f32_16x16x32_bf16 a[28:31], v[108:111], v[68:71], a[28:31]
ds_read_b64_tr_b16 v[132:133], v3 offset:57344
buffer_load_dwordx4 v15, s[4:7], s31 offen offset:0 sc1 lds
v_mfma_f32_16x16x32_bf16 a[32:35], v[96:99], v[72:75], a[32:35]
ds_read_b64_tr_b16 v[134:135], v3 offset:57600
v_mfma_f32_16x16x32_bf16 a[36:39], v[100:103], v[72:75], a[36:39]
ds_read_b64_tr_b16 v[136:137], v4 offset:57344
buffer_load_dwordx4 v15, s[4:7], s31 offen offset:1024 sc1 lds
v_mfma_f32_16x16x32_bf16 a[40:43], v[104:107], v[72:75], a[40:43]
ds_read_b64_tr_b16 v[138:139], v4 offset:57600
v_mfma_f32_16x16x32_bf16 a[44:47], v[108:111], v[72:75], a[44:47]
ds_read_b64_tr_b16 v[140:141], v5 offset:57344
s_add_u32 s30, s30, 262144
v_mfma_f32_16x16x32_bf16 a[48:51], v[96:99], v[76:79], a[48:51]
ds_read_b64_tr_b16 v[142:143], v5 offset:57600
s_add_u32 s31, s31, 16384
v_mfma_f32_16x16x32_bf16 a[52:55], v[100:103], v[76:79], a[52:55]
v_mfma_f32_16x16x32_bf16 a[56:59], v[104:107], v[76:79], a[56:59]
v_mfma_f32_16x16x32_bf16 a[60:63], v[108:111], v[76:79], a[60:63]
s_waitcnt lgkmcnt(0)
v_mfma_f32_16x16x32_bf16 a[0:3], v[160:163], v[128:131], a[0:3]
s_waitcnt vmcnt(20)
s_barrier
s_add_u32 m0, s32, 49152
v_mfma_f32_16x16x32_bf16 a[4:7], v[164:167], v[128:131], a[4:7]
ds_read_b128 v[96:99], v10 offset:0
buffer_load_dwordx4 v11, s[8:11], s30 offen offset:0 lds
v_mfma_f32_16x16x32_bf16 a[8:11], v[168:171], v[128:131], a[8:11]
ds_read_b128 v[100:103], v10 offset:1024
v_mfma_f32_16x16x32_bf16 a[12:15], v[172:175], v[128:131], a[12:15]
ds_read_b128 v[104:107], v10 offset:2048
buffer_load_dwordx4 v12, s[8:11], s30 offen offset:1024 lds
v_mfma_f32_16x16x32_bf16 a[16:19], v[160:163], v[132:135], a[16:19]
ds_read_b128 v[108:111], v10 offset:3072
v_mfma_f32_16x16x32_bf16 a[20:23], v[164:167], v[132:135], a[20:23]
ds_read_b64_tr_b16 v[64:65], v2 offset:0
s_add_u32 m0, s33, 49152
v_mfma_f32_16x16x32_bf16 a[24:27], v[168:171], v[132:135], a[24:27]
ds_read_b64_tr_b16 v[66:67], v2 offset:256
v_mfma_f32_16x16x32_bf16 a[28:31], v[172:175], v[132:135], a[28:31]
ds_read_b64_tr_b16 v[68:69], v3 offset:0
buffer_load_dwordx4 v15, s[4:7], s31 offen offset:0 sc1 lds
v_mfma_f32_16x16x32_bf16 a[32:35], v[160:163], v[136:139], a[32:35]
ds_read_b64_tr_b16 v[70:71], v3 offset:256
v_mfma_f32_16x16x32_bf16 a[36:39], v[164:167], v[136:139], a[36:39]
ds_read_b64_tr_b16 v[72:73], v4 offset:0
buffer_load_dwordx4 v15, s[4:7], s31 offen offset:1024 sc1 lds
v_mfma_f32_16x16x32_bf16 a[40:43], v[168:171], v[136:139], a[40:43]
ds_read_b64_tr_b16 v[74:75], v4 offset:256
v_mfma_f32_16x16x32_bf16 a[44:47], v[172:175], v[136:139], a[44:47]
ds_read_b64_tr_b16 v[76:77], v5 offset:0
s_add_u32 s30, s30, 262144
v_mfma_f32_16x16x32_bf16 a[48:51], v[160:163], v[140:143], a[48:51]
ds_read_b64_tr_b16 v[78:79], v5 offset:256
s_add_u32 s31, s31, 16384
v_mfma_f32_16x16x32_bf16 a[52:55], v[164:167], v[140:143], a[52:55]
v_mfma_f32_16x16x32_bf16 a[56:59], v[168:171], v[140:143], a[56:59]
v_mfma_f32_16x16x32_bf16 a[60:63], v[172:175], v[140:143], a[60:63]
s_sub_u32 s37, s37, 1
s_cmp_lg_u32 s37, 0
s_cbranch_scc1 GL_80
s_waitcnt lgkmcnt(0)
v_mfma_f32_16x16x32_bf16 a[0:3], v[96:99], v[64:67], a[0:3]
s_waitcnt vmcnt(20)
s_barrier
s_add_u32 m0, s32, 57344
v_mfma_f32_16x16x32_bf16 a[4:7], v[100:103], v[64:67], a[4:7]
ds_read_b128 v[160:163], v10 offset:8192
buffer_load_dwordx4 v11, s[8:11], s30 offen offset:0 lds
v_mfma_f32_16x16x32_bf16 a[8:11], v[104:107], v[64:67], a[8:11]
ds_read_b128 v[164:167], v10 offset:9216
v_mfma_f32_16x16x32_bf16 a[12:15], v[108:111], v[64:67], a[12:15]
ds_read_b128 v[168:171], v10 offset:10240
buffer_load_dwordx4 v12, s[8:11], s30 offen offset:1024 lds
v_mfma_f32_16x16x32_bf16 a[16:19], v[96:99], v[68:71], a[16:19]
ds_read_b128 v[172:175], v10 offset:11264
v_mfma_f32_16x16x32_bf16 a[20:23], v[100:103], v[68:71], a[20:23]
ds_read_b64_tr_b16 v[128:129], v2 offset:8192
s_add_u32 m0, s33, 57344
v_mfma_f32_16x16x32_bf16 a[24:27], v[104:107], v[68:71], a[24:27]
ds_read_b64_tr_b16 v[130:131], v2 offset:8448
v_mfma_f32_16x16x32_bf16 a[28:31], v[108:111], v[68:71], a[28:31]
ds_read_b64_tr_b16 v[132:133], v3 offset:8192
buffer_load_dwordx4 v15, s[4:7], s31 offen offset:0 sc1 lds
v_mfma_f32_16x16x32_bf16 a[32:35], v[96:99], v[72:75], a[32:35]
ds_read_b64_tr_b16 v[134:135], v3 offset:8448
v_mfma_f32_16x16x32_bf16 a[36:39], v[100:103], v[72:75], a[36:39]
ds_read_b64_tr_b16 v[136:137], v4 offset:8192
buffer_load_dwordx4 v15, s[4:7], s31 offen offset:1024 sc1 lds
v_mfma_f32_16x16x32_bf16 a[40:43], v[104:107], v[72:75], a[40:43]
ds_read_b64_tr_b16 v[138:139], v4 offset:8448
v_mfma_f32_16x16x32_bf16 a[44:47], v[108:111], v[72:75], a[44:47]
ds_read_b64_tr_b16 v[140:141], v5 offset:8192
s_add_u32 s30, s30, 262144
v_mfma_f32_16x16x32_bf16 a[48:51], v[96:99], v[76:79], a[48:51]
ds_read_b64_tr_b16 v[142:143], v5 offset:8448
s_add_u32 s31, s31, 16384
v_mfma_f32_16x16x32_bf16 a[52:55], v[100:103], v[76:79], a[52:55]
v_mfma_f32_16x16x32_bf16 a[56:59], v[104:107], v[76:79], a[56:59]
v_mfma_f32_16x16x32_bf16 a[60:63], v[108:111], v[76:79], a[60:63]
s_waitcnt lgkmcnt(0)
v_mfma_f32_16x16x32_bf16 a[0:3], v[160:163], v[128:131], a[0:3]
s_waitcnt vmcnt(20)
s_barrier
v_mfma_f32_16x16x32_bf16 a[4:7], v[164:167], v[128:131], a[4:7]
ds_read_b128 v[96:99], v10 offset:16384
v_mfma_f32_16x16x32_bf16 a[8:11], v[168:171], v[128:131], a[8:11]
ds_read_b128 v[100:103], v10 offset:17408
v_mfma_f32_16x16x32_bf16 a[12:15], v[172:175], v[128:131], a[12:15]
ds_read_b128 v[104:107], v10 offset:18432
v_mfma_f32_16x16x32_bf16 a[16:19], v[160:163], v[132:135], a[16:19]
ds_read_b128 v[108:111], v10 offset:19456
v_mfma_f32_16x16x32_bf16 a[20:23], v[164:167], v[132:135], a[20:23]
ds_read_b64_tr_b16 v[64:65], v2 offset:16384
v_mfma_f32_16x16x32_bf16 a[24:27], v[168:171], v[132:135], a[24:27]
ds_read_b64_tr_b16 v[66:67], v2 offset:16640
v_mfma_f32_16x16x32_bf16 a[28:31], v[172:175], v[132:135], a[28:31]
ds_read_b64_tr_b16 v[68:69], v3 offset:16384
v_mfma_f32_16x16x32_bf16 a[32:35], v[160:163], v[136:139], a[32:35]
ds_read_b64_tr_b16 v[70:71], v3 offset:16640
v_mfma_f32_16x16x32_bf16 a[36:39], v[164:167], v[136:139], a[36:39]
ds_read_b64_tr_b16 v[72:73], v4 offset:16384
v_mfma_f32_16x16x32_bf16 a[40:43], v[168:171], v[136:139], a[40:43]
ds_read_b64_tr_b16 v[74:75], v4 offset:16640
v_mfma_f32_16x16x32_bf16 a[44:47], v[172:175], v[136:139], a[44:47]
ds_read_b64_tr_b16 v[76:77], v5 offset:16384
v_mfma_f32_16x16x32_bf16 a[48:51], v[160:163], v[140:143], a[48:51]
ds_read_b64_tr_b16 v[78:79], v5 offset:16640
v_mfma_f32_16x16x32_bf16 a[52:55], v[164:167], v[140:143], a[52:55]
v_mfma_f32_16x16x32_bf16 a[56:59], v[168:171], v[140:143], a[56:59]
v_mfma_f32_16x16x32_bf16 a[60:63], v[172:175], v[140:143], a[60:63]
s_waitcnt lgkmcnt(0)
v_mfma_f32_16x16x32_bf16 a[0:3], v[96:99], v[64:67], a[0:3]
s_waitcnt vmcnt(16)
s_barrier
v_mfma_f32_16x16x32_bf16 a[4:7], v[100:103], v[64:67], a[4:7]
ds_read_b128 v[160:163], v10 offset:24576
v_mfma_f32_16x16x32_bf16 a[8:11], v[104:107], v[64:67], a[8:11]
ds_read_b128 v[164:167], v10 offset:25600
v_mfma_f32_16x16x32_bf16 a[12:15], v[108:111], v[64:67], a[12:15]
ds_read_b128 v[168:171], v10 offset:26624
v_mfma_f32_16x16x32_bf16 a[16:19], v[96:99], v[68:71], a[16:19]
ds_read_b128 v[172:175], v10 offset:27648
v_mfma_f32_16x16x32_bf16 a[20:23], v[100:103], v[68:71], a[20:23]
ds_read_b64_tr_b16 v[128:129], v2 offset:24576
v_mfma_f32_16x16x32_bf16 a[24:27], v[104:107], v[68:71], a[24:27]
ds_read_b64_tr_b16 v[130:131], v2 offset:24832
v_mfma_f32_16x16x32_bf16 a[28:31], v[108:111], v[68:71], a[28:31]
ds_read_b64_tr_b16 v[132:133], v3 offset:24576
v_mfma_f32_16x16x32_bf16 a[32:35], v[96:99], v[72:75], a[32:35]
ds_read_b64_tr_b16 v[134:135], v3 offset:24832
v_mfma_f32_16x16x32_bf16 a[36:39], v[100:103], v[72:75], a[36:39]
ds_read_b64_tr_b16 v[136:137], v4 offset:24576
v_mfma_f32_16x16x32_bf16 a[40:43], v[104:107], v[72:75], a[40:43]
ds_read_b64_tr_b16 v[138:139], v4 offset:24832
v_mfma_f32_16x16x32_bf16 a[44:47], v[108:111], v[72:75], a[44:47]
ds_read_b64_tr_b16 v[140:141], v5 offset:24576
v_mfma_f32_16x16x32_bf16 a[48:51], v[96:99], v[76:79], a[48:51]
ds_read_b64_tr_b16 v[142:143], v5 offset:24832
v_mfma_f32_16x16x32_bf16 a[52:55], v[100:103], v[76:79], a[52:55]
v_mfma_f32_16x16x32_bf16 a[56:59], v[104:107], v[76:79], a[56:59]
v_mfma_f32_16x16x32_bf16 a[60:63], v[108:111], v[76:79], a[60:63]
s_waitcnt lgkmcnt(0)
v_mfma_f32_16x16x32_bf16 a[0:3], v[160:163], v[128:131], a[0:3]
s_waitcnt vmcnt(12)
s_barrier
v_mfma_f32_16x16x32_bf16 a[4:7], v[164:167], v[128:131], a[4:7]
ds_read_b128 v[96:99], v10 offset:32768
v_mfma_f32_16x16x32_bf16 a[8:11], v[168:171], v[128:131], a[8:11]
ds_read_b128 v[100:103], v10 offset:33792
v_mfma_f32_16x16x32_bf16 a[12:15], v[172:175], v[128:131], a[12:15]
ds_read_b128 v[104:107], v10 offset:34816
v_mfma_f32_16x16x32_bf16 a[16:19], v[160:163], v[132:135], a[16:19]
ds_read_b128 v[108:111], v10 offset:35840
v_mfma_f32_16x16x32_bf16 a[20:23], v[164:167], v[132:135], a[20:23]
ds_read_b64_tr_b16 v[64:65], v2 offset:32768
v_mfma_f32_16x16x32_bf16 a[24:27], v[168:171], v[132:135], a[24:27]
ds_read_b64_tr_b16 v[66:67], v2 offset:33024
v_mfma_f32_16x16x32_bf16 a[28:31], v[172:175], v[132:135], a[28:31]
ds_read_b64_tr_b16 v[68:69], v3 offset:32768
v_mfma_f32_16x16x32_bf16 a[32:35], v[160:163], v[136:139], a[32:35]
ds_read_b64_tr_b16 v[70:71], v3 offset:33024
v_mfma_f32_16x16x32_bf16 a[36:39], v[164:167], v[136:139], a[36:39]
ds_read_b64_tr_b16 v[72:73], v4 offset:32768
v_mfma_f32_16x16x32_bf16 a[40:43], v[168:171], v[136:139], a[40:43]
ds_read_b64_tr_b16 v[74:75], v4 offset:33024
v_mfma_f32_16x16x32_bf16 a[44:47], v[172:175], v[136:139], a[44:47]
ds_read_b64_tr_b16 v[76:77], v5 offset:32768
v_mfma_f32_16x16x32_bf16 a[48:51], v[160:163], v[140:143], a[48:51]
ds_read_b64_tr_b16 v[78:79], v5 offset:33024
v_mfma_f32_16x16x32_bf16 a[52:55], v[164:167], v[140:143], a[52:55]
v_mfma_f32_16x16x32_bf16 a[56:59], v[168:171], v[140:143], a[56:59]
v_mfma_f32_16x16x32_bf16 a[60:63], v[172:175], v[140:143], a[60:63]
s_waitcnt lgkmcnt(0)
v_mfma_f32_16x16x32_bf16 a[0:3], v[96:99], v[64:67], a[0:3]
s_waitcnt vmcnt(8)
s_barrier
v_mfma_f32_16x16x32_bf16 a[4:7], v[100:103], v[64:67], a[4:7]
ds_read_b128 v[160:163], v10 offset:40960
v_mfma_f32_16x16x32_bf16 a[8:11], v[104:107], v[64:67], a[8:11]
ds_read_b128 v[164:167], v10 offset:41984
v_mfma_f32_16x16x32_bf16 a[12:15], v[108:111], v[64:67], a[12:15]
ds_read_b128 v[168:171], v10 offset:43008
v_mfma_f32_16x16x32_bf16 a[16:19], v[96:99], v[68:71], a[16:19]
ds_read_b128 v[172:175], v10 offset:44032
v_mfma_f32_16x16x32_bf16 a[20:23], v[100:103], v[68:71], a[20:23]
ds_read_b64_tr_b16 v[128:129], v2 offset:40960
v_mfma_f32_16x16x32_bf16 a[24:27], v[104:107], v[68:71], a[24:27]
ds_read_b64_tr_b16 v[130:131], v2 offset:41216
v_mfma_f32_16x16x32_bf16 a[28:31], v[108:111], v[68:71], a[28:31]
ds_read_b64_tr_b16 v[132:133], v3 offset:40960
v_mfma_f32_16x16x32_bf16 a[32:35], v[96:99], v[72:75], a[32:35]
ds_read_b64_tr_b16 v[134:135], v3 offset:41216
v_mfma_f32_16x16x32_bf16 a[36:39], v[100:103], v[72:75], a[36:39]
ds_read_b64_tr_b16 v[136:137], v4 offset:40960
v_mfma_f32_16x16x32_bf16 a[40:43], v[104:107], v[72:75], a[40:43]
ds_read_b64_tr_b16 v[138:139], v4 offset:41216
v_mfma_f32_16x16x32_bf16 a[44:47], v[108:111], v[72:75], a[44:47]
ds_read_b64_tr_b16 v[140:141], v5 offset:40960
v_mfma_f32_16x16x32_bf16 a[48:51], v[96:99], v[76:79], a[48:51]
ds_read_b64_tr_b16 v[142:143], v5 offset:41216
v_mfma_f32_16x16x32_bf16 a[52:55], v[100:103], v[76:79], a[52:55]
v_mfma_f32_16x16x32_bf16 a[56:59], v[104:107], v[76:79], a[56:59]
v_mfma_f32_16x16x32_bf16 a[60:63], v[108:111], v[76:79], a[60:63]
s_waitcnt lgkmcnt(0)
v_mfma_f32_16x16x32_bf16 a[0:3], v[160:163], v[128:131], a[0:3]
s_waitcnt vmcnt(4)
s_barrier
v_mfma_f32_16x16x32_bf16 a[4:7], v[164:167], v[128:131], a[4:7]
ds_read_b128 v[96:99], v10 offset:49152
v_mfma_f32_16x16x32_bf16 a[8:11], v[168:171], v[128:131], a[8:11]
ds_read_b128 v[100:103], v10 offset:50176
v_mfma_f32_16x16x32_bf16 a[12:15], v[172:175], v[128:131], a[12:15]
ds_read_b128 v[104:107], v10 offset:51200
v_mfma_f32_16x16x32_bf16 a[16:19], v[160:163], v[132:135], a[16:19]
ds_read_b128 v[108:111], v10 offset:52224
v_mfma_f32_16x16x32_bf16 a[20:23], v[164:167], v[132:135], a[20:23]
ds_read_b64_tr_b16 v[64:65], v2 offset:49152
v_mfma_f32_16x16x32_bf16 a[24:27], v[168:171], v[132:135], a[24:27]
ds_read_b64_tr_b16 v[66:67], v2 offset:49408
v_mfma_f32_16x16x32_bf16 a[28:31], v[172:175], v[132:135], a[28:31]
ds_read_b64_tr_b16 v[68:69], v3 offset:49152
v_mfma_f32_16x16x32_bf16 a[32:35], v[160:163], v[136:139], a[32:35]
ds_read_b64_tr_b16 v[70:71], v3 offset:49408
v_mfma_f32_16x16x32_bf16 a[36:39], v[164:167], v[136:139], a[36:39]
ds_read_b64_tr_b16 v[72:73], v4 offset:49152
v_mfma_f32_16x16x32_bf16 a[40:43], v[168:171], v[136:139], a[40:43]
ds_read_b64_tr_b16 v[74:75], v4 offset:49408
v_mfma_f32_16x16x32_bf16 a[44:47], v[172:175], v[136:139], a[44:47]
ds_read_b64_tr_b16 v[76:77], v5 offset:49152
v_mfma_f32_16x16x32_bf16 a[48:51], v[160:163], v[140:143], a[48:51]
ds_read_b64_tr_b16 v[78:79], v5 offset:49408
v_mfma_f32_16x16x32_bf16 a[52:55], v[164:167], v[140:143], a[52:55]
v_mfma_f32_16x16x32_bf16 a[56:59], v[168:171], v[140:143], a[56:59]
v_mfma_f32_16x16x32_bf16 a[60:63], v[172:175], v[140:143], a[60:63]
s_waitcnt lgkmcnt(0)
v_mfma_f32_16x16x32_bf16 a[0:3], v[96:99], v[64:67], a[0:3]
s_waitcnt vmcnt(0)
s_barrier
v_mfma_f32_16x16x32_bf16 a[4:7], v[100:103], v[64:67], a[4:7]
ds_read_b128 v[160:163], v10 offset:57344
v_mfma_f32_16x16x32_bf16 a[8:11], v[104:107], v[64:67], a[8:11]
ds_read_b128 v[164:167], v10 offset:58368
v_mfma_f32_16x16x32_bf16 a[12:15], v[108:111], v[64:67], a[12:15]
ds_read_b128 v[168:171], v10 offset:59392
v_mfma_f32_16x16x32_bf16 a[16:19], v[96:99], v[68:71], a[16:19]
ds_read_b128 v[172:175], v10 offset:60416
v_mfma_f32_16x16x32_bf16 a[20:23], v[100:103], v[68:71], a[20:23]
ds_read_b64_tr_b16 v[128:129], v2 offset:57344
v_mfma_f32_16x16x32_bf16 a[24:27], v[104:107], v[68:71], a[24:27]
ds_read_b64_tr_b16 v[130:131], v2 offset:57600
v_mfma_f32_16x16x32_bf16 a[28:31], v[108:111], v[68:71], a[28:31]
ds_read_b64_tr_b16 v[132:133], v3 offset:57344
v_mfma_f32_16x16x32_bf16 a[32:35], v[96:99], v[72:75], a[32:35]
ds_read_b64_tr_b16 v[134:135], v3 offset:57600
v_mfma_f32_16x16x32_bf16 a[36:39], v[100:103], v[72:75], a[36:39]
ds_read_b64_tr_b16 v[136:137], v4 offset:57344
v_mfma_f32_16x16x32_bf16 a[40:43], v[104:107], v[72:75], a[40:43]
ds_read_b64_tr_b16 v[138:139], v4 offset:57600
v_mfma_f32_16x16x32_bf16 a[44:47], v[108:111], v[72:75], a[44:47]
ds_read_b64_tr_b16 v[140:141], v5 offset:57344
v_mfma_f32_16x16x32_bf16 a[48:51], v[96:99], v[76:79], a[48:51]
ds_read_b64_tr_b16 v[142:143], v5 offset:57600
v_mfma_f32_16x16x32_bf16 a[52:55], v[100:103], v[76:79], a[52:55]
v_mfma_f32_16x16x32_bf16 a[56:59], v[104:107], v[76:79], a[56:59]
v_mfma_f32_16x16x32_bf16 a[60:63], v[108:111], v[76:79], a[60:63]
s_waitcnt lgkmcnt(0)
v_mfma_f32_16x16x32_bf16 a[0:3], v[160:163], v[128:131], a[0:3]
v_mfma_f32_16x16x32_bf16 a[4:7], v[164:167], v[128:131], a[4:7]
v_mfma_f32_16x16x32_bf16 a[8:11], v[168:171], v[128:131], a[8:11]
v_mfma_f32_16x16x32_bf16 a[12:15], v[172:175], v[128:131], a[12:15]
v_mfma_f32_16x16x32_bf16 a[16:19], v[160:163], v[132:135], a[16:19]
v_mfma_f32_16x16x32_bf16 a[20:23], v[164:167], v[132:135], a[20:23]
v_mfma_f32_16x16x32_bf16 a[24:27], v[168:171], v[132:135], a[24:27]
v_mfma_f32_16x16x32_bf16 a[28:31], v[172:175], v[132:135], a[28:31]
v_mfma_f32_16x16x32_bf16 a[32:35], v[160:163], v[136:139], a[32:35]
v_mfma_f32_16x16x32_bf16 a[36:39], v[164:167], v[136:139], a[36:39]
v_mfma_f32_16x16x32_bf16 a[40:43], v[168:171], v[136:139], a[40:43]
v_mfma_f32_16x16x32_bf16 a[44:47], v[172:175], v[136:139], a[44:47]
v_mfma_f32_16x16x32_bf16 a[48:51], v[160:163], v[140:143], a[48:51]
v_mfma_f32_16x16x32_bf16 a[52:55], v[164:167], v[140:143], a[52:55]
v_mfma_f32_16x16x32_bf16 a[56:59], v[168:171], v[140:143], a[56:59]
v_mfma_f32_16x16x32_bf16 a[60:63], v[172:175], v[140:143], a[60:63]
s_nop 7
s_barrier
s_mov_b32 s42, 1.0
s_lshr_b32 s36, s28, 1
s_lshl_b32 s36, s36, 20
s_lshl_b32 s37, s34, 19
s_add_u32 s36, s36, s37
s_lshl_b32 s37, s29, 14
s_add_u32 s36, s36, s37
s_and_b32 s37, s28, 1
s_lshl_b32 s37, s37, 13
s_add_u32 s36, s36, s37
s_lshl_b32 s37, s35, 12
s_add_u32 s36, s36, s37
s_add_u32 s36, s36, 58720256
s_add_u32 s38, s36, 262144
v_accvgpr_read_b32 v64, a0
v_accvgpr_read_b32 v65, a1
v_accvgpr_read_b32 v66, a2
v_accvgpr_read_b32 v67, a3
v_accvgpr_read_b32 v68, a4
v_accvgpr_read_b32 v69, a5
v_accvgpr_read_b32 v70, a6
v_accvgpr_read_b32 v71, a7
v_cvt_pk_bf16_f32 v72, v64, v65
v_cvt_pk_bf16_f32 v73, v66, v67
v_cvt_pk_bf16_f32 v74, v68, v69
v_cvt_pk_bf16_f32 v75, v70, v71
buffer_store_dwordx4 v[72:75], v61, s[4:7], s36 offen offset:0 sc1
v_accvgpr_read_b32 v80, a16
v_accvgpr_read_b32 v81, a17
v_accvgpr_read_b32 v82, a18
v_accvgpr_read_b32 v83, a19
v_accvgpr_read_b32 v84, a20
v_accvgpr_read_b32 v85, a21
v_accvgpr_read_b32 v86, a22
v_accvgpr_read_b32 v87, a23
v_cvt_pk_bf16_f32 v88, v80, v81
v_cvt_pk_bf16_f32 v89, v82, v83
v_cvt_pk_bf16_f32 v90, v84, v85
v_cvt_pk_bf16_f32 v91, v86, v87
buffer_store_dwordx4 v[88:91], v61, s[4:7], s36 offen offset:1024 sc1
v_accvgpr_read_b32 v96, a32
v_accvgpr_read_b32 v97, a33
v_accvgpr_read_b32 v98, a34
v_accvgpr_read_b32 v99, a35
v_accvgpr_read_b32 v100, a36
v_accvgpr_read_b32 v101, a37
v_accvgpr_read_b32 v102, a38
v_accvgpr_read_b32 v103, a39
v_cvt_pk_bf16_f32 v104, v96, v97
v_cvt_pk_bf16_f32 v105, v98, v99
v_cvt_pk_bf16_f32 v106, v100, v101
v_cvt_pk_bf16_f32 v107, v102, v103
buffer_store_dwordx4 v[104:107], v61, s[4:7], s36 offen offset:2048 sc1
v_accvgpr_read_b32 v112, a48
v_accvgpr_read_b32 v113, a49
v_accvgpr_read_b32 v114, a50
v_accvgpr_read_b32 v115, a51
v_accvgpr_read_b32 v116, a52
v_accvgpr_read_b32 v117, a53
v_accvgpr_read_b32 v118, a54
v_accvgpr_read_b32 v119, a55
v_cvt_pk_bf16_f32 v120, v112, v113
v_cvt_pk_bf16_f32 v121, v114, v115
v_cvt_pk_bf16_f32 v122, v116, v117
v_cvt_pk_bf16_f32 v123, v118, v119
buffer_store_dwordx4 v[120:123], v61, s[4:7], s36 offen offset:3072 sc1
v_accvgpr_read_b32 v64, a8
v_accvgpr_read_b32 v65, a9
v_accvgpr_read_b32 v66, a10
v_accvgpr_read_b32 v67, a11
v_accvgpr_read_b32 v68, a12
v_accvgpr_read_b32 v69, a13
v_accvgpr_read_b32 v70, a14
v_accvgpr_read_b32 v71, a15
v_cvt_pk_bf16_f32 v72, v64, v65
v_cvt_pk_bf16_f32 v73, v66, v67
v_cvt_pk_bf16_f32 v74, v68, v69
v_cvt_pk_bf16_f32 v75, v70, v71
buffer_store_dwordx4 v[72:75], v61, s[4:7], s38 offen offset:0 sc1
v_accvgpr_read_b32 v80, a24
v_accvgpr_read_b32 v81, a25
v_accvgpr_read_b32 v82, a26
v_accvgpr_read_b32 v83, a27
v_accvgpr_read_b32 v84, a28
v_accvgpr_read_b32 v85, a29
v_accvgpr_read_b32 v86, a30
v_accvgpr_read_b32 v87, a31
v_cvt_pk_bf16_f32 v88, v80, v81
v_cvt_pk_bf16_f32 v89, v82, v83
v_cvt_pk_bf16_f32 v90, v84, v85
v_cvt_pk_bf16_f32 v91, v86, v87
buffer_store_dwordx4 v[88:91], v61, s[4:7], s38 offen offset:1024 sc1
v_accvgpr_read_b32 v96, a40
v_accvgpr_read_b32 v97, a41
v_accvgpr_read_b32 v98, a42
v_accvgpr_read_b32 v99, a43
v_accvgpr_read_b32 v100, a44
v_accvgpr_read_b32 v101, a45
v_accvgpr_read_b32 v102, a46
v_accvgpr_read_b32 v103, a47
v_cvt_pk_bf16_f32 v104, v96, v97
v_cvt_pk_bf16_f32 v105, v98, v99
v_cvt_pk_bf16_f32 v106, v100, v101
v_cvt_pk_bf16_f32 v107, v102, v103
buffer_store_dwordx4 v[104:107], v61, s[4:7], s38 offen offset:2048 sc1
v_accvgpr_read_b32 v112, a56
v_accvgpr_read_b32 v113, a57
v_accvgpr_read_b32 v114, a58
v_accvgpr_read_b32 v115, a59
v_accvgpr_read_b32 v116, a60
v_accvgpr_read_b32 v117, a61
v_accvgpr_read_b32 v118, a62
v_accvgpr_read_b32 v119, a63
v_cvt_pk_bf16_f32 v120, v112, v113
v_cvt_pk_bf16_f32 v121, v114, v115
v_cvt_pk_bf16_f32 v122, v116, v117
v_cvt_pk_bf16_f32 v123, v118, v119
buffer_store_dwordx4 v[120:123], v61, s[4:7], s38 offen offset:3072 sc1
s_and_b32 s36, s28, 2
s_lshl_b32 s36, s36, 11
s_and_b32 s37, s28, 1
s_lshl_b32 s37, s37, 4
s_add_u32 s36, s36, s37
s_lshl_b32 s37, s29, 7
s_add_u32 s36, s36, s37
s_add_u32 s36, s36, 119595012
v_lshlrev_b32 v7, 7, v1
s_mov_b32 s46, 119545856
s_mov_b32 s47, 119554048
s_cmp_lg_u32 s24, 0
s_cbranch_scc1 TI_81
s_lshl_b32 s26, s20, 8
s_add_u32 s26, s26, 119537664
v_mov_b32 v2, 1
v_mov_b32 v3, 0
buffer_load_dword v5, v7, s[4:7], s46 offen sc1
buffer_load_dword v6, v7, s[4:7], s47 offen sc1
s_mov_b64 exec, 1
buffer_atomic_add v2, v3, s[4:7], s26 offen sc0 sc1
s_mov_b64 exec, -1
TI_81:
v_mov_b32 v4, 163808
s_waitcnt vmcnt(0)
s_cmp_lg_u32 s24, 0
s_cbranch_scc1 TP_82
s_mov_b32 s44, 0
TPL_83:
v_and_b32 v5, v5, v6
v_cmp_eq_u32 vcc, 0, v5
s_cbranch_vccz TPK_84
buffer_load_dword v5, v7, s[4:7], s46 offen sc1
buffer_load_dword v6, v7, s[4:7], s47 offen sc1
s_add_u32 s44, s44, 1
s_waitcnt vmcnt(0)
s_cmp_lt_u32 s44, 40000
s_cbranch_scc1 TPL_83
TPK_84:
s_mov_b64 exec, 1
ds_write_b32 v4, v2
s_mov_b64 exec, -1
s_waitcnt lgkmcnt(0)
TP_82:
s_barrier
ds_read_b32 v2, v4
s_lshl_b32 s38, s29, 2
s_add_u32 s38, s38, s28
s_add_u32 s38, s38, 64
s_mul_i32 s38, s38, 3
s_add_u32 s38, s38, s24
s_sub_u32 s38, s38, 1
s_cmp_lg_u32 s24, 0
s_cbranch_scc1 R2_85
v_mov_b32 v16, 1
v_mov_b32 v17, 0
s_mov_b64 exec, 1
buffer_store_dword v16, v17, s[4:7], s36 offen sc1
buffer_store_dword v16, v17, s[4:7], s36 offen offset:2048 sc1
s_mov_b64 exec, -1
s_branch W_TICKET
R2_85:
s_load_dwordx2 s[72:73], s[0:1], 80
s_mov_b32 s74, 7340032
s_mov_b32 s75, 0x20000
s_mul_i32 s38, s38, 24576
v_lshlrev_b32 v240, 7, v1
v_add_u32 v240, s38, v240
v_add_u32 v241, 8192, v240
v_add_u32 v242, 16384, v240
s_waitcnt lgkmcnt(0)
buffer_load_dword v255, v240, s[72:75], 0 offen
buffer_load_dword v255, v241, s[72:75], 0 offen
buffer_load_dword v255, v242, s[72:75], 0 offen
s_branch W_TICKET
R_S:
s_setprio 3
s_load_dwordx2 s[8:9], s[0:1], 16
s_mov_b32 s10, 8388608
s_mov_b32 s11, 0x20000
s_load_dwordx2 s[12:13], s[0:1], 24
s_mov_b32 s14, 8388608
s_mov_b32 s15, 0x20000
s_lshl_b32 s40, s24, 15
s_add_u32 s40, s40, 32768
s_lshl_b32 s42, s27, 8
s_and_b32 s43, s24, 1
s_lshl_b32 s43, s43, 7
s_add_u32 s42, s42, s43
s_add_u32 s43, s24, 0
s_and_b32 s43, s43, 3
s_lshl_b32 s47, s43, 21
s_add_u32 s52, s47, s42
s_add_u32 s43, s24, 1
s_and_b32 s43, s43, 3
s_lshl_b32 s47, s43, 21
s_add_u32 s53, s47, s42
s_lshl_b32 s43, s43, 12
s_add_u32 s43, s43, 8192
v_lshlrev_b32 v116, 4, v1
v_add_u32 v116, s43, v116
s_add_u32 s43, s24, 2
s_and_b32 s43, s43, 3
s_lshl_b32 s47, s43, 21
s_add_u32 s54, s47, s42
s_lshl_b32 s43, s43, 12
s_add_u32 s43, s43, 8192
v_lshlrev_b32 v117, 4, v1
v_add_u32 v117, s43, v117
s_add_u32 s43, s24, 3
s_and_b32 s43, s43, 3
s_lshl_b32 s47, s43, 21
s_add_u32 s55, s47, s42
s_lshl_b32 s43, s43, 12
s_add_u32 s43, s43, 8192
v_lshlrev_b32 v118, 4, v1
v_add_u32 v118, s43, v118
v_lshrrev_b32 v8, 3, v1
v_lshlrev_b32 v8, 13, v8
v_lshrrev_b32 v9, 5, v1
v_lshlrev_b32 v9, 1, v9
v_and_b32 v10, 7, v1
v_xor_b32 v9, v9, v10
v_lshl_add_u32 v2, v9, 4, v8
v_xor_b32 v9, 4, v9
v_lshl_add_u32 v3, v9, 4, v8
v_bfe_u32 v8, v1, 2, 1
v_bfe_u32 v9, v1, 4, 1
v_bfe_u32 v10, v1, 3, 1
v_lshl_add_u32 v9, v10, 1, v9
v_lshl_add_u32 v8, v9, 2, v8
v_bfe_u32 v10, v1, 5, 1
v_lshl_add_u32 v8, v10, 4, v8
v_lshlrev_b32 v8, 7, v8
v_and_b32 v10, 3, v1
v_lshl_add_u32 v8, v10, 3, v8
v_add_u32 v8, s40, v8
v_xor_b32 v10, 0, v9
v_lshl_add_u32 v4, v10, 5, v8
v_xor_b32 v10, 1, v9
v_lshl_add_u32 v5, v10, 5, v8
v_xor_b32 v10, 2, v9
v_lshl_add_u32 v6, v10, 5, v8
v_xor_b32 v10, 3, v9
v_lshl_add_u32 v7, v10, 5, v8
v_lshlrev_b32 v12, 4, v1
v_add_u32 v12, s40, v12
s_waitcnt lgkmcnt(0)
s_cmp_lt_u32 s24, 2
s_cselect_b32 s8, s8, s12
s_cselect_b32 s9, s9, s13
v_and_b32 v11, 15, v1
v_lshrrev_b32 v16, 4, v1
v_and_b32 v17, 1, v16
v_and_b32 v18, 7, v1
v_lshlrev_b32 v10, 4, v18
v_lshl_add_u32 v10, v16, 7, v10
s_lshl_b32 s43, s27, 11
v_add_u32 v10, s43, v10
v_bfe_u32 v18, v1, 2, 1
v_lshlrev_b32 v9, 16, v18
v_and_b32 v18, 3, v1
v_lshl_add_u32 v9, v18, 5, v9
v_lshl_add_u32 v9, v17, 4, v9
v_lshrrev_b32 v18, 5, v1
v_lshl_add_u32 v9, v18, 7, v9
s_and_b32 s43, s27, 7
s_lshl_b32 s43, s43, 10
s_lshr_b32 s47, s27, 3
s_lshl_b32 s47, s47, 14
s_add_u32 s43, s43, s47
s_lshl_b32 s47, s24, 8
s_add_u32 s43, s43, s47
s_add_u32 s43, s43, 0
v_add_u32 v9, s43, v9
v_mov_b32 v18, 2147483648
v_cmp_gt_u32 vcc, 8, v11
s_nop 1
v_cndmask_b32 v9, v18, v9, vcc
v_cndmask_b32 v10, v10, v18, vcc
v_lshrrev_b32 v17, 2, v1
v_and_b32 v0, 3, v1
v_lshlrev_b32 v0, 2, v0
v_lshl_add_u32 v0, v17, 10, v0
v_add_u32 v0, 0, v0
s_mov_b32 s43, 294912
v_cmp_gt_u32 vcc, 64, v1
v_and_b32 v17, 0xe000, v0
v_add3_u32 v0, v0, v17, s43
v_cndmask_b32 v0, v18, v0, vcc
s_lshr_b32 s48, s27, 2
s_lshl_b32 s48, s48, 10
s_and_b32 s47, s27, 3
s_lshl_b32 s47, s47, 2
s_add_u32 s48, s48, s47
s_add_u32 s48, s48, 16384
v_and_b32 v119, 7, v1
v_lshlrev_b32 v119, 7, v119
v_add_u32 v119, s48, v119
v_and_b32 v17, 0xe000, v119
v_add3_u32 v119, v119, v17, s43
s_cmp_eq_u32 s24, 1
s_cselect_b32 s47, 8, 0
v_cmp_gt_u32 vcc, s47, v1
s_nop 1
v_cndmask_b32 v119, v18, v119, vcc
s_cmp_eq_u32 s24, 0
s_cbranch_scc1 CR_86
s_and_b32 s47, s48, 0xfc00
v_lshlrev_b32 v0, 4, v1
v_add_u32 v0, s47, v0
v_and_b32 v17, 0xe000, v0
v_add3_u32 v0, v0, v17, s43
s_and_b32 s47, s27, 3
s_lshl_b32 s47, s47, 2
s_or_b32 s47, s47, s24
s_cmp_eq_u32 s47, 2
s_cselect_b64 vcc, -1, 0
s_nop 1
v_cndmask_b32 v0, v18, v0, vcc
CR_86:
v_mov_b32 v20, -1
v_mov_b32 v21, -1
v_mov_b32 v22, -1
v_mov_b32 v23, -1
s_mov_b32 s43, 92274688
s_mov_b32 s47, 0
AF_87:
buffer_store_dwordx4 v[20:23], v9, s[4:7], s43 offen sc1
s_cmp_lg_u32 s24, 2
s_cbranch_scc1 AM_88
buffer_store_dwordx4 v[20:23], v0, s[4:7], s43 offen sc1
AM_88:
s_add_u32 s47, s47, 1
s_bitcmp1_b32 s47, 0
s_cselect_b32 s48, 0, 327680
s_add_u32 s43, s43, s48
s_add_u32 s43, s43, 8192
s_cmp_lt_u32 s47, 12
s_cbranch_scc1 AF_87
s_lshl_b32 s43, s24, 9
s_add_u32 s43, s43, 115343360
buffer_store_dwordx4 v[20:23], v10, s[4:7], s43 offen sc1
s_add_u32 s43, s43, 65536
buffer_store_dwordx4 v[20:23], v10, s[4:7], s43 offen sc1
s_add_u32 s43, s43, 65536
buffer_store_dwordx4 v[20:23], v10, s[4:7], s43 offen sc1
s_add_u32 s43, s43, 65536
buffer_store_dwordx4 v[20:23], v10, s[4:7], s43 offen sc1
s_add_u32 s43, s43, 65536
buffer_store_dwordx4 v[20:23], v10, s[4:7], s43 offen sc1
s_add_u32 s43, s43, 65536
buffer_store_dwordx4 v[20:23], v10, s[4:7], s43 offen sc1
s_add_u32 s43, s43, 65536
s_add_u32 m0, s40, 0
s_add_u32 s41, s53, 0
buffer_load_dwordx4 v2, s[8:11], s41 offen offset:0 lds
s_add_u32 s41, s53, 64512
buffer_load_dwordx4 v3, s[8:11], s41 offen offset:1024 lds
s_add_u32 s41, s53, 129024
buffer_load_dwordx4 v2, s[8:11], s41 offen offset:2048 lds
s_add_u32 s41, s53, 193536
buffer_load_dwordx4 v3, s[8:11], s41 offen offset:3072 lds
s_add_u32 m0, s40, 4096
s_add_u32 s41, s53, 262144
buffer_load_dwordx4 v2, s[8:11], s41 offen offset:0 lds
s_add_u32 s41, s53, 326656
buffer_load_dwordx4 v3, s[8:11], s41 offen offset:1024 lds
s_add_u32 s41, s53, 391168
buffer_load_dwordx4 v2, s[8:11], s41 offen offset:2048 lds
s_add_u32 s41, s53, 455680
buffer_load_dwordx4 v3, s[8:11], s41 offen offset:3072 lds
s_add_u32 m0, s40, 8192
s_add_u32 s41, s55, 0
buffer_load_dwordx4 v2, s[8:11], s41 offen offset:0 lds
s_add_u32 s41, s55, 64512
buffer_load_dwordx4 v3, s[8:11], s41 offen offset:1024 lds
s_add_u32 s41, s55, 129024
buffer_load_dwordx4 v2, s[8:11], s41 offen offset:2048 lds
s_add_u32 s41, s55, 193536
buffer_load_dwordx4 v3, s[8:11], s41 offen offset:3072 lds
s_add_u32 m0, s40, 12288
s_add_u32 s41, s55, 262144
buffer_load_dwordx4 v2, s[8:11], s41 offen offset:0 lds
s_add_u32 s41, s55, 326656
buffer_load_dwordx4 v3, s[8:11], s41 offen offset:1024 lds
s_add_u32 s41, s55, 391168
buffer_load_dwordx4 v2, s[8:11], s41 offen offset:2048 lds
s_add_u32 s41, s55, 455680
buffer_load_dwordx4 v3, s[8:11], s41 offen offset:3072 lds
s_add_u32 m0, s40, 16384
s_add_u32 s41, s54, 524288
buffer_load_dwordx4 v2, s[8:11], s41 offen offset:0 lds
s_add_u32 s41, s54, 588800
buffer_load_dwordx4 v3, s[8:11], s41 offen offset:1024 lds
s_add_u32 s41, s54, 653312
buffer_load_dwordx4 v2, s[8:11], s41 offen offset:2048 lds
s_add_u32 s41, s54, 717824
buffer_load_dwordx4 v3, s[8:11], s41 offen offset:3072 lds
s_add_u32 m0, s40, 20480
s_add_u32 s41, s54, 786432
buffer_load_dwordx4 v2, s[8:11], s41 offen offset:0 lds
s_add_u32 s41, s54, 850944
buffer_load_dwordx4 v3, s[8:11], s41 offen offset:1024 lds
s_add_u32 s41, s54, 915456
buffer_load_dwordx4 v2, s[8:11], s41 offen offset:2048 lds
s_add_u32 s41, s54, 979968
buffer_load_dwordx4 v3, s[8:11], s41 offen offset:3072 lds
s_add_u32 m0, s40, 24576
s_add_u32 s41, s53, 1048576
buffer_load_dwordx4 v2, s[8:11], s41 offen offset:0 lds
s_add_u32 s41, s53, 1113088
buffer_load_dwordx4 v3, s[8:11], s41 offen offset:1024 lds
s_add_u32 s41, s53, 1177600
buffer_load_dwordx4 v2, s[8:11], s41 offen offset:2048 lds
s_add_u32 s41, s53, 1242112
buffer_load_dwordx4 v3, s[8:11], s41 offen offset:3072 lds
s_add_u32 m0, s40, 28672
s_add_u32 s41, s53, 1310720
buffer_load_dwordx4 v2, s[8:11], s41 offen offset:0 lds
s_add_u32 s41, s53, 1375232
buffer_load_dwordx4 v3, s[8:11], s41 offen offset:1024 lds
s_add_u32 s41, s53, 1439744
buffer_load_dwordx4 v2, s[8:11], s41 offen offset:2048 lds
s_add_u32 s41, s53, 1504256
buffer_load_dwordx4 v3, s[8:11], s41 offen offset:3072 lds
s_waitcnt vmcnt(24)
ds_read_b64_tr_b16 a[16:17], v4 offset:0
ds_read_b64_tr_b16 a[18:19], v4 offset:256
ds_read_b64_tr_b16 a[20:21], v4 offset:4096
ds_read_b64_tr_b16 a[22:23], v4 offset:4352
ds_read_b64_tr_b16 a[24:25], v5 offset:0
ds_read_b64_tr_b16 a[26:27], v5 offset:256
ds_read_b64_tr_b16 a[28:29], v5 offset:4096
ds_read_b64_tr_b16 a[30:31], v5 offset:4352
ds_read_b64_tr_b16 a[32:33], v6 offset:0
ds_read_b64_tr_b16 a[34:35], v6 offset:256
ds_read_b64_tr_b16 a[36:37], v6 offset:4096
ds_read_b64_tr_b16 a[38:39], v6 offset:4352
ds_read_b64_tr_b16 a[40:41], v7 offset:0
ds_read_b64_tr_b16 a[42:43], v7 offset:256
ds_read_b64_tr_b16 a[44:45], v7 offset:4096
ds_read_b64_tr_b16 a[46:47], v7 offset:4352
s_waitcnt lgkmcnt(0)
s_add_u32 m0, s40, 0
s_add_u32 s41, s53, 1572864
buffer_load_dwordx4 v2, s[8:11], s41 offen offset:0 lds
s_add_u32 s41, s53, 1637376
buffer_load_dwordx4 v3, s[8:11], s41 offen offset:1024 lds
s_add_u32 s41, s53, 1701888
buffer_load_dwordx4 v2, s[8:11], s41 offen offset:2048 lds
s_add_u32 s41, s53, 1766400
buffer_load_dwordx4 v3, s[8:11], s41 offen offset:3072 lds
s_add_u32 m0, s40, 4096
s_add_u32 s41, s53, 1835008
buffer_load_dwordx4 v2, s[8:11], s41 offen offset:0 lds
s_add_u32 s41, s53, 1899520
buffer_load_dwordx4 v3, s[8:11], s41 offen offset:1024 lds
s_add_u32 s41, s53, 1964032
buffer_load_dwordx4 v2, s[8:11], s41 offen offset:2048 lds
s_add_u32 s41, s53, 2028544
buffer_load_dwordx4 v3, s[8:11], s41 offen offset:3072 lds
s_waitcnt vmcnt(24)
ds_read_b64_tr_b16 a[64:65], v4 offset:8192
ds_read_b64_tr_b16 a[66:67], v4 offset:8448
ds_read_b64_tr_b16 a[68:69], v4 offset:12288
ds_read_b64_tr_b16 a[70:71], v4 offset:12544
ds_read_b64_tr_b16 a[72:73], v5 offset:8192
ds_read_b64_tr_b16 a[74:75], v5 offset:8448
ds_read_b64_tr_b16 a[76:77], v5 offset:12288
ds_read_b64_tr_b16 a[78:79], v5 offset:12544
ds_read_b64_tr_b16 a[80:81], v6 offset:8192
ds_read_b64_tr_b16 a[82:83], v6 offset:8448
ds_read_b64_tr_b16 a[84:85], v6 offset:12288
ds_read_b64_tr_b16 a[86:87], v6 offset:12544
ds_read_b64_tr_b16 a[88:89], v7 offset:8192
ds_read_b64_tr_b16 a[90:91], v7 offset:8448
ds_read_b64_tr_b16 a[92:93], v7 offset:12288
ds_read_b64_tr_b16 a[94:95], v7 offset:12544
s_waitcnt lgkmcnt(0)
s_add_u32 m0, s40, 8192
s_add_u32 s41, s54, 1048576
buffer_load_dwordx4 v2, s[8:11], s41 offen offset:0 lds
s_add_u32 s41, s54, 1113088
buffer_load_dwordx4 v3, s[8:11], s41 offen offset:1024 lds
s_add_u32 s41, s54, 1177600
buffer_load_dwordx4 v2, s[8:11], s41 offen offset:2048 lds
s_add_u32 s41, s54, 1242112
buffer_load_dwordx4 v3, s[8:11], s41 offen offset:3072 lds
s_add_u32 m0, s40, 12288
s_add_u32 s41, s54, 1310720
buffer_load_dwordx4 v2, s[8:11], s41 offen offset:0 lds
s_add_u32 s41, s54, 1375232
buffer_load_dwordx4 v3, s[8:11], s41 offen offset:1024 lds
s_add_u32 s41, s54, 1439744
buffer_load_dwordx4 v2, s[8:11], s41 offen offset:2048 lds
s_add_u32 s41, s54, 1504256
buffer_load_dwordx4 v3, s[8:11], s41 offen offset:3072 lds
s_waitcnt vmcnt(24)
ds_read_b64_tr_b16 a[112:113], v4 offset:16384
ds_read_b64_tr_b16 a[114:115], v4 offset:16640
ds_read_b64_tr_b16 a[116:117], v4 offset:20480
ds_read_b64_tr_b16 a[118:119], v4 offset:20736
ds_read_b64_tr_b16 a[120:121], v5 offset:16384
ds_read_b64_tr_b16 a[122:123], v5 offset:16640
ds_read_b64_tr_b16 a[124:125], v5 offset:20480
ds_read_b64_tr_b16 a[126:127], v5 offset:20736
ds_read_b64_tr_b16 a[128:129], v6 offset:16384
ds_read_b64_tr_b16 a[130:131], v6 offset:16640
ds_read_b64_tr_b16 a[132:133], v6 offset:20480
ds_read_b64_tr_b16 a[134:135], v6 offset:20736
ds_read_b64_tr_b16 a[136:137], v7 offset:16384
ds_read_b64_tr_b16 a[138:139], v7 offset:16640
ds_read_b64_tr_b16 a[140:141], v7 offset:20480
ds_read_b64_tr_b16 a[142:143], v7 offset:20736
s_waitcnt lgkmcnt(0)
s_add_u32 m0, s40, 16384
s_add_u32 s41, s54, 1572864
buffer_load_dwordx4 v2, s[8:11], s41 offen offset:0 lds
s_add_u32 s41, s54, 1637376
buffer_load_dwordx4 v3, s[8:11], s41 offen offset:1024 lds
s_add_u32 s41, s54, 1701888
buffer_load_dwordx4 v2, s[8:11], s41 offen offset:2048 lds
s_add_u32 s41, s54, 1766400
buffer_load_dwordx4 v3, s[8:11], s41 offen offset:3072 lds
s_add_u32 m0, s40, 20480
s_add_u32 s41, s54, 1835008
buffer_load_dwordx4 v2, s[8:11], s41 offen offset:0 lds
s_add_u32 s41, s54, 1899520
buffer_load_dwordx4 v3, s[8:11], s41 offen offset:1024 lds
s_add_u32 s41, s54, 1964032
buffer_load_dwordx4 v2, s[8:11], s41 offen offset:2048 lds
s_add_u32 s41, s54, 2028544
buffer_load_dwordx4 v3, s[8:11], s41 offen offset:3072 lds
s_waitcnt vmcnt(24)
ds_read_b64_tr_b16 a[192:193], v4 offset:24576
ds_read_b64_tr_b16 a[194:195], v4 offset:24832
ds_read_b64_tr_b16 a[196:197], v4 offset:28672
ds_read_b64_tr_b16 a[198:199], v4 offset:28928
ds_read_b64_tr_b16 a[200:201], v5 offset:24576
ds_read_b64_tr_b16 a[202:203], v5 offset:24832
ds_read_b64_tr_b16 a[204:205], v5 offset:28672
ds_read_b64_tr_b16 a[206:207], v5 offset:28928
ds_read_b64_tr_b16 a[208:209], v6 offset:24576
ds_read_b64_tr_b16 a[210:211], v6 offset:24832
ds_read_b64_tr_b16 a[212:213], v6 offset:28672
ds_read_b64_tr_b16 a[214:215], v6 offset:28928
ds_read_b64_tr_b16 a[216:217], v7 offset:24576
ds_read_b64_tr_b16 a[218:219], v7 offset:24832
ds_read_b64_tr_b16 a[220:221], v7 offset:28672
ds_read_b64_tr_b16 a[222:223], v7 offset:28928
s_waitcnt lgkmcnt(0)
s_add_u32 m0, s40, 24576
s_add_u32 s41, s55, 1048576
buffer_load_dwordx4 v2, s[8:11], s41 offen offset:0 lds
s_add_u32 s41, s55, 1113088
buffer_load_dwordx4 v3, s[8:11], s41 offen offset:1024 lds
s_add_u32 s41, s55, 1177600
buffer_load_dwordx4 v2, s[8:11], s41 offen offset:2048 lds
s_add_u32 s41, s55, 1242112
buffer_load_dwordx4 v3, s[8:11], s41 offen offset:3072 lds
s_add_u32 m0, s40, 28672
s_add_u32 s41, s55, 1310720
buffer_load_dwordx4 v2, s[8:11], s41 offen offset:0 lds
s_add_u32 s41, s55, 1375232
buffer_load_dwordx4 v3, s[8:11], s41 offen offset:1024 lds
s_add_u32 s41, s55, 1439744
buffer_load_dwordx4 v2, s[8:11], s41 offen offset:2048 lds
s_add_u32 s41, s55, 1504256
buffer_load_dwordx4 v3, s[8:11], s41 offen offset:3072 lds
s_waitcnt vmcnt(24)
ds_read_b64_tr_b16 a[224:225], v4 offset:0
ds_read_b64_tr_b16 a[226:227], v4 offset:256
ds_read_b64_tr_b16 a[228:229], v4 offset:4096
ds_read_b64_tr_b16 a[230:231], v4 offset:4352
ds_read_b64_tr_b16 a[232:233], v5 offset:0
ds_read_b64_tr_b16 a[234:235], v5 offset:256
ds_read_b64_tr_b16 a[236:237], v5 offset:4096
ds_read_b64_tr_b16 a[238:239], v5 offset:4352
ds_read_b64_tr_b16 a[240:241], v6 offset:0
ds_read_b64_tr_b16 a[242:243], v6 offset:256
ds_read_b64_tr_b16 a[244:245], v6 offset:4096
ds_read_b64_tr_b16 a[246:247], v6 offset:4352
ds_read_b64_tr_b16 a[248:249], v7 offset:0
ds_read_b64_tr_b16 a[250:251], v7 offset:256
ds_read_b64_tr_b16 a[252:253], v7 offset:4096
ds_read_b64_tr_b16 a[254:255], v7 offset:4352
s_waitcnt lgkmcnt(0)
s_add_u32 m0, s40, 0
s_add_u32 s41, s55, 1572864
buffer_load_dwordx4 v2, s[8:11], s41 offen offset:0 lds
s_add_u32 s41, s55, 1637376
buffer_load_dwordx4 v3, s[8:11], s41 offen offset:1024 lds
s_add_u32 s41, s55, 1701888
buffer_load_dwordx4 v2, s[8:11], s41 offen offset:2048 lds
s_add_u32 s41, s55, 1766400
buffer_load_dwordx4 v3, s[8:11], s41 offen offset:3072 lds
s_add_u32 m0, s40, 4096
s_add_u32 s41, s55, 1835008
buffer_load_dwordx4 v2, s[8:11], s41 offen offset:0 lds
s_add_u32 s41, s55, 1899520
buffer_load_dwordx4 v3, s[8:11], s41 offen offset:1024 lds
s_add_u32 s41, s55, 1964032
buffer_load_dwordx4 v2, s[8:11], s41 offen offset:2048 lds
s_add_u32 s41, s55, 2028544
buffer_load_dwordx4 v3, s[8:11], s41 offen offset:3072 lds
s_waitcnt vmcnt(24)
ds_read_b64_tr_b16 v[128:129], v4 offset:8192
ds_read_b64_tr_b16 v[130:131], v4 offset:8448
ds_read_b64_tr_b16 v[132:133], v4 offset:12288
ds_read_b64_tr_b16 v[134:135], v4 offset:12544
ds_read_b64_tr_b16 v[136:137], v5 offset:8192
ds_read_b64_tr_b16 v[138:139], v5 offset:8448
ds_read_b64_tr_b16 v[140:141], v5 offset:12288
ds_read_b64_tr_b16 v[142:143], v5 offset:12544
ds_read_b64_tr_b16 v[144:145], v6 offset:8192
ds_read_b64_tr_b16 v[146:147], v6 offset:8448
ds_read_b64_tr_b16 v[148:149], v6 offset:12288
ds_read_b64_tr_b16 v[150:151], v6 offset:12544
ds_read_b64_tr_b16 v[152:153], v7 offset:8192
ds_read_b64_tr_b16 v[154:155], v7 offset:8448
ds_read_b64_tr_b16 v[156:157], v7 offset:12288
ds_read_b64_tr_b16 v[158:159], v7 offset:12544
s_waitcnt lgkmcnt(0)
s_add_u32 m0, s40, 8192
s_add_u32 s41, s52, 524288
buffer_load_dwordx4 v2, s[8:11], s41 offen offset:0 lds
s_add_u32 s41, s52, 588800
buffer_load_dwordx4 v3, s[8:11], s41 offen offset:1024 lds
s_add_u32 s41, s52, 653312
buffer_load_dwordx4 v2, s[8:11], s41 offen offset:2048 lds
s_add_u32 s41, s52, 717824
buffer_load_dwordx4 v3, s[8:11], s41 offen offset:3072 lds
s_add_u32 m0, s40, 12288
s_add_u32 s41, s52, 786432
buffer_load_dwordx4 v2, s[8:11], s41 offen offset:0 lds
s_add_u32 s41, s52, 850944
buffer_load_dwordx4 v3, s[8:11], s41 offen offset:1024 lds
s_add_u32 s41, s52, 915456
buffer_load_dwordx4 v2, s[8:11], s41 offen offset:2048 lds
s_add_u32 s41, s52, 979968
buffer_load_dwordx4 v3, s[8:11], s41 offen offset:3072 lds
s_waitcnt vmcnt(24)
ds_read_b64_tr_b16 v[160:161], v4 offset:16384
ds_read_b64_tr_b16 v[162:163], v4 offset:16640
ds_read_b64_tr_b16 v[164:165], v4 offset:20480
ds_read_b64_tr_b16 v[166:167], v4 offset:20736
ds_read_b64_tr_b16 v[168:169], v5 offset:16384
ds_read_b64_tr_b16 v[170:171], v5 offset:16640
ds_read_b64_tr_b16 v[172:173], v5 offset:20480
ds_read_b64_tr_b16 v[174:175], v5 offset:20736
ds_read_b64_tr_b16 v[176:177], v6 offset:16384
ds_read_b64_tr_b16 v[178:179], v6 offset:16640
ds_read_b64_tr_b16 v[180:181], v6 offset:20480
ds_read_b64_tr_b16 v[182:183], v6 offset:20736
ds_read_b64_tr_b16 v[184:185], v7 offset:16384
ds_read_b64_tr_b16 v[186:187], v7 offset:16640
ds_read_b64_tr_b16 v[188:189], v7 offset:20480
ds_read_b64_tr_b16 v[190:191], v7 offset:20736
s_waitcnt lgkmcnt(0)
s_add_u32 m0, s40, 16384
s_add_u32 s41, s54, 0
buffer_load_dwordx4 v2, s[8:11], s41 offen offset:0 lds
s_add_u32 s41, s54, 64512
buffer_load_dwordx4 v3, s[8:11], s41 offen offset:1024 lds
s_add_u32 s41, s54, 129024
buffer_load_dwordx4 v2, s[8:11], s41 offen offset:2048 lds
s_add_u32 s41, s54, 193536
buffer_load_dwordx4 v3, s[8:11], s41 offen offset:3072 lds
s_add_u32 m0, s40, 20480
s_add_u32 s41, s54, 262144
buffer_load_dwordx4 v2, s[8:11], s41 offen offset:0 lds
s_add_u32 s41, s54, 326656
buffer_load_dwordx4 v3, s[8:11], s41 offen offset:1024 lds
s_add_u32 s41, s54, 391168
buffer_load_dwordx4 v2, s[8:11], s41 offen offset:2048 lds
s_add_u32 s41, s54, 455680
buffer_load_dwordx4 v3, s[8:11], s41 offen offset:3072 lds
s_barrier
s_lshl_b32 s43, s24, 12
s_add_u32 s43, s43, 200
v_mov_b32 v18, 1
v_mov_b32 v19, s43
s_mov_b64 exec, 1
buffer_atomic_add v18, v19, s[16:19], 0 offen sc1
s_mov_b64 exec, -1
s_waitcnt vmcnt(25)
ds_read_b64_tr_b16 v[192:193], v4 offset:24576
ds_read_b64_tr_b16 v[194:195], v4 offset:24832
ds_read_b64_tr_b16 v[196:197], v4 offset:28672
ds_read_b64_tr_b16 v[198:199], v4 offset:28928
ds_read_b64_tr_b16 v[200:201], v5 offset:24576
ds_read_b64_tr_b16 v[202:203], v5 offset:24832
ds_read_b64_tr_b16 v[204:205], v5 offset:28672
ds_read_b64_tr_b16 v[206:207], v5 offset:28928
ds_read_b64_tr_b16 v[208:209], v6 offset:24576
ds_read_b64_tr_b16 v[210:211], v6 offset:24832
ds_read_b64_tr_b16 v[212:213], v6 offset:28672
ds_read_b64_tr_b16 v[214:215], v6 offset:28928
ds_read_b64_tr_b16 v[216:217], v7 offset:24576
ds_read_b64_tr_b16 v[218:219], v7 offset:24832
ds_read_b64_tr_b16 v[220:221], v7 offset:28672
ds_read_b64_tr_b16 v[222:223], v7 offset:28928
s_waitcnt lgkmcnt(0)
s_add_u32 m0, s40, 24576
s_add_u32 s41, s53, 524288
buffer_load_dwordx4 v2, s[8:11], s41 offen offset:0 lds
s_add_u32 s41, s53, 588800
buffer_load_dwordx4 v3, s[8:11], s41 offen offset:1024 lds
s_add_u32 s41, s53, 653312
buffer_load_dwordx4 v2, s[8:11], s41 offen offset:2048 lds
s_add_u32 s41, s53, 717824
buffer_load_dwordx4 v3, s[8:11], s41 offen offset:3072 lds
s_add_u32 m0, s40, 28672
s_add_u32 s41, s53, 786432
buffer_load_dwordx4 v2, s[8:11], s41 offen offset:0 lds
s_add_u32 s41, s53, 850944
buffer_load_dwordx4 v3, s[8:11], s41 offen offset:1024 lds
s_add_u32 s41, s53, 915456
buffer_load_dwordx4 v2, s[8:11], s41 offen offset:2048 lds
s_add_u32 s41, s53, 979968
buffer_load_dwordx4 v3, s[8:11], s41 offen offset:3072 lds
s_waitcnt vmcnt(25)
ds_read_b64_tr_b16 v[224:225], v4 offset:0
ds_read_b64_tr_b16 v[226:227], v4 offset:256
ds_read_b64_tr_b16 v[228:229], v4 offset:4096
ds_read_b64_tr_b16 v[230:231], v4 offset:4352
ds_read_b64_tr_b16 v[232:233], v5 offset:0
ds_read_b64_tr_b16 v[234:235], v5 offset:256
ds_read_b64_tr_b16 v[236:237], v5 offset:4096
ds_read_b64_tr_b16 v[238:239], v5 offset:4352
ds_read_b64_tr_b16 v[240:241], v6 offset:0
ds_read_b64_tr_b16 v[242:243], v6 offset:256
ds_read_b64_tr_b16 v[244:245], v6 offset:4096
ds_read_b64_tr_b16 v[246:247], v6 offset:4352
ds_read_b64_tr_b16 v[248:249], v7 offset:0
ds_read_b64_tr_b16 v[250:251], v7 offset:256
ds_read_b64_tr_b16 v[252:253], v7 offset:4096
ds_read_b64_tr_b16 v[254:255], v7 offset:4352
s_waitcnt lgkmcnt(0)
s_add_u32 m0, s40, 0
s_add_u32 s41, s55, 524288
buffer_load_dwordx4 v2, s[8:11], s41 offen offset:0 lds
s_add_u32 s41, s55, 588800
buffer_load_dwordx4 v3, s[8:11], s41 offen offset:1024 lds
s_add_u32 s41, s55, 653312
buffer_load_dwordx4 v2, s[8:11], s41 offen offset:2048 lds
s_add_u32 s41, s55, 717824
buffer_load_dwordx4 v3, s[8:11], s41 offen offset:3072 lds
s_add_u32 m0, s40, 4096
s_add_u32 s41, s55, 786432
buffer_load_dwordx4 v2, s[8:11], s41 offen offset:0 lds
s_add_u32 s41, s55, 850944
buffer_load_dwordx4 v3, s[8:11], s41 offen offset:1024 lds
s_add_u32 s41, s55, 915456
buffer_load_dwordx4 v2, s[8:11], s41 offen offset:2048 lds
s_add_u32 s41, s55, 979968
buffer_load_dwordx4 v3, s[8:11], s41 offen offset:3072 lds
s_waitcnt vmcnt(25)
ds_read_b64_tr_b16 v[64:65], v4 offset:8192
ds_read_b64_tr_b16 v[66:67], v4 offset:8448
ds_read_b64_tr_b16 v[68:69], v4 offset:12288
ds_read_b64_tr_b16 v[70:71], v4 offset:12544
ds_read_b64_tr_b16 v[72:73], v5 offset:8192
ds_read_b64_tr_b16 v[74:75], v5 offset:8448
ds_read_b64_tr_b16 v[76:77], v5 offset:12288
ds_read_b64_tr_b16 v[78:79], v5 offset:12544
ds_read_b64_tr_b16 a[0:1], v6 offset:8192
ds_read_b64_tr_b16 a[2:3], v6 offset:8448
ds_read_b64_tr_b16 a[4:5], v6 offset:12288
ds_read_b64_tr_b16 a[6:7], v6 offset:12544
ds_read_b64_tr_b16 a[8:9], v7 offset:8192
ds_read_b64_tr_b16 a[10:11], v7 offset:8448
ds_read_b64_tr_b16 a[12:13], v7 offset:12288
ds_read_b64_tr_b16 a[14:15], v7 offset:12544
s_waitcnt lgkmcnt(0)
s_add_u32 m0, s40, 8192
s_add_u32 s41, s52, 1048576
buffer_load_dwordx4 v2, s[8:11], s41 offen offset:0 lds
s_add_u32 s41, s52, 1113088
buffer_load_dwordx4 v3, s[8:11], s41 offen offset:1024 lds
s_add_u32 s41, s52, 1177600
buffer_load_dwordx4 v2, s[8:11], s41 offen offset:2048 lds
s_add_u32 s41, s52, 1242112
buffer_load_dwordx4 v3, s[8:11], s41 offen offset:3072 lds
s_add_u32 m0, s40, 12288
s_add_u32 s41, s52, 1310720
buffer_load_dwordx4 v2, s[8:11], s41 offen offset:0 lds
s_add_u32 s41, s52, 1375232
buffer_load_dwordx4 v3, s[8:11], s41 offen offset:1024 lds
s_add_u32 s41, s52, 1439744
buffer_load_dwordx4 v2, s[8:11], s41 offen offset:2048 lds
s_add_u32 s41, s52, 1504256
buffer_load_dwordx4 v3, s[8:11], s41 offen offset:3072 lds
s_waitcnt vmcnt(25)
ds_read_b64_tr_b16 a[48:49], v4 offset:16384
ds_read_b64_tr_b16 a[50:51], v4 offset:16640
ds_read_b64_tr_b16 a[52:53], v4 offset:20480
ds_read_b64_tr_b16 a[54:55], v4 offset:20736
ds_read_b64_tr_b16 a[56:57], v5 offset:16384
ds_read_b64_tr_b16 a[58:59], v5 offset:16640
ds_read_b64_tr_b16 a[60:61], v5 offset:20480
ds_read_b64_tr_b16 a[62:63], v5 offset:20736
ds_read_b64_tr_b16 v[80:81], v6 offset:16384
ds_read_b64_tr_b16 v[82:83], v6 offset:16640
ds_read_b64_tr_b16 v[84:85], v6 offset:20480
ds_read_b64_tr_b16 v[86:87], v6 offset:20736
ds_read_b64_tr_b16 v[88:89], v7 offset:16384
ds_read_b64_tr_b16 v[90:91], v7 offset:16640
ds_read_b64_tr_b16 v[92:93], v7 offset:20480
ds_read_b64_tr_b16 v[94:95], v7 offset:20736
s_waitcnt lgkmcnt(0)
s_add_u32 m0, s40, 16384
s_add_u32 s41, s52, 1572864
buffer_load_dwordx4 v2, s[8:11], s41 offen offset:0 lds
s_add_u32 s41, s52, 1637376
buffer_load_dwordx4 v3, s[8:11], s41 offen offset:1024 lds
s_add_u32 s41, s52, 1701888
buffer_load_dwordx4 v2, s[8:11], s41 offen offset:2048 lds
s_add_u32 s41, s52, 1766400
buffer_load_dwordx4 v3, s[8:11], s41 offen offset:3072 lds
s_add_u32 m0, s40, 20480
s_add_u32 s41, s52, 1835008
buffer_load_dwordx4 v2, s[8:11], s41 offen offset:0 lds
s_add_u32 s41, s52, 1899520
buffer_load_dwordx4 v3, s[8:11], s41 offen offset:1024 lds
s_add_u32 s41, s52, 1964032
buffer_load_dwordx4 v2, s[8:11], s41 offen offset:2048 lds
s_add_u32 s41, s52, 2028544
buffer_load_dwordx4 v3, s[8:11], s41 offen offset:3072 lds
s_waitcnt vmcnt(24)
ds_read_b64_tr_b16 a[96:97], v4 offset:24576
ds_read_b64_tr_b16 a[98:99], v4 offset:24832
ds_read_b64_tr_b16 a[100:101], v4 offset:28672
ds_read_b64_tr_b16 a[102:103], v4 offset:28928
ds_read_b64_tr_b16 a[104:105], v5 offset:24576
ds_read_b64_tr_b16 a[106:107], v5 offset:24832
ds_read_b64_tr_b16 a[108:109], v5 offset:28672
ds_read_b64_tr_b16 a[110:111], v5 offset:28928
ds_read_b64_tr_b16 v[96:97], v6 offset:24576
ds_read_b64_tr_b16 v[98:99], v6 offset:24832
ds_read_b64_tr_b16 v[100:101], v6 offset:28672
ds_read_b64_tr_b16 v[102:103], v6 offset:28928
ds_read_b64_tr_b16 v[104:105], v7 offset:24576
ds_read_b64_tr_b16 v[106:107], v7 offset:24832
ds_read_b64_tr_b16 v[108:109], v7 offset:28672
ds_read_b64_tr_b16 v[110:111], v7 offset:28928
s_waitcnt lgkmcnt(0)
s_add_u32 m0, s40, 24576
s_add_u32 s41, s52, 0
buffer_load_dwordx4 v2, s[8:11], s41 offen offset:0 lds
s_add_u32 s41, s52, 64512
buffer_load_dwordx4 v3, s[8:11], s41 offen offset:1024 lds
s_add_u32 s41, s52, 129024
buffer_load_dwordx4 v2, s[8:11], s41 offen offset:2048 lds
s_add_u32 s41, s52, 193536
buffer_load_dwordx4 v3, s[8:11], s41 offen offset:3072 lds
s_add_u32 m0, s40, 28672
s_add_u32 s41, s52, 262144
buffer_load_dwordx4 v2, s[8:11], s41 offen offset:0 lds
s_add_u32 s41, s52, 326656
buffer_load_dwordx4 v3, s[8:11], s41 offen offset:1024 lds
s_add_u32 s41, s52, 391168
buffer_load_dwordx4 v2, s[8:11], s41 offen offset:2048 lds
s_add_u32 s41, s52, 455680
buffer_load_dwordx4 v3, s[8:11], s41 offen offset:3072 lds
s_waitcnt vmcnt(24)
ds_read_b64_tr_b16 v[32:33], v4 offset:0
ds_read_b64_tr_b16 v[34:35], v4 offset:256
ds_read_b64_tr_b16 v[36:37], v4 offset:4096
ds_read_b64_tr_b16 v[38:39], v4 offset:4352
ds_read_b64_tr_b16 v[40:41], v5 offset:0
ds_read_b64_tr_b16 v[42:43], v5 offset:256
ds_read_b64_tr_b16 v[44:45], v5 offset:4096
ds_read_b64_tr_b16 v[46:47], v5 offset:4352
ds_read_b64_tr_b16 a[144:145], v6 offset:0
ds_read_b64_tr_b16 a[146:147], v6 offset:256
ds_read_b64_tr_b16 a[148:149], v6 offset:4096
ds_read_b64_tr_b16 a[150:151], v6 offset:4352
ds_read_b64_tr_b16 a[152:153], v7 offset:0
ds_read_b64_tr_b16 a[154:155], v7 offset:256
ds_read_b64_tr_b16 a[156:157], v7 offset:4096
ds_read_b64_tr_b16 a[158:159], v7 offset:4352
s_waitcnt lgkmcnt(0)
ds_write_b128 v12, v[32:35] offset:0
ds_write_b128 v12, v[36:39] offset:1024
ds_write_b128 v12, v[40:43] offset:2048
ds_write_b128 v12, v[44:47] offset:3072
ds_write_b128 v12, v[64:67] offset:4096
ds_write_b128 v12, v[68:71] offset:5120
ds_write_b128 v12, v[72:75] offset:6144
ds_write_b128 v12, v[76:79] offset:7168
s_waitcnt lgkmcnt(0)
s_waitcnt vmcnt(16)
ds_read_b64_tr_b16 a[160:161], v4 offset:8192
ds_read_b64_tr_b16 a[162:163], v4 offset:8448
ds_read_b64_tr_b16 a[164:165], v4 offset:12288
ds_read_b64_tr_b16 a[166:167], v4 offset:12544
ds_read_b64_tr_b16 a[168:169], v5 offset:8192
ds_read_b64_tr_b16 a[170:171], v5 offset:8448
ds_read_b64_tr_b16 a[172:173], v5 offset:12288
ds_read_b64_tr_b16 a[174:175], v5 offset:12544
ds_read_b64_tr_b16 v[32:33], v6 offset:8192
ds_read_b64_tr_b16 v[34:35], v6 offset:8448
ds_read_b64_tr_b16 v[36:37], v6 offset:12288
ds_read_b64_tr_b16 v[38:39], v6 offset:12544
ds_read_b64_tr_b16 v[40:41], v7 offset:8192
ds_read_b64_tr_b16 v[42:43], v7 offset:8448
ds_read_b64_tr_b16 v[44:45], v7 offset:12288
ds_read_b64_tr_b16 v[46:47], v7 offset:12544
s_waitcnt lgkmcnt(0)
ds_write_b128 v12, v[32:35] offset:8192
ds_write_b128 v12, v[36:39] offset:9216
ds_write_b128 v12, v[40:43] offset:10240
ds_write_b128 v12, v[44:47] offset:11264
ds_write_b128 v12, v[80:83] offset:12288
ds_write_b128 v12, v[84:87] offset:13312
ds_write_b128 v12, v[88:91] offset:14336
ds_write_b128 v12, v[92:95] offset:15360
s_waitcnt lgkmcnt(0)
s_waitcnt vmcnt(8)
ds_read_b64_tr_b16 a[176:177], v4 offset:16384
ds_read_b64_tr_b16 a[178:179], v4 offset:16640
ds_read_b64_tr_b16 a[180:181], v4 offset:20480
ds_read_b64_tr_b16 a[182:183], v4 offset:20736
ds_read_b64_tr_b16 a[184:185], v5 offset:16384
ds_read_b64_tr_b16 a[186:187], v5 offset:16640
ds_read_b64_tr_b16 a[188:189], v5 offset:20480
ds_read_b64_tr_b16 a[190:191], v5 offset:20736
ds_read_b64_tr_b16 v[32:33], v6 offset:16384
ds_read_b64_tr_b16 v[34:35], v6 offset:16640
ds_read_b64_tr_b16 v[36:37], v6 offset:20480
ds_read_b64_tr_b16 v[38:39], v6 offset:20736
ds_read_b64_tr_b16 v[40:41], v7 offset:16384
ds_read_b64_tr_b16 v[42:43], v7 offset:16640
ds_read_b64_tr_b16 v[44:45], v7 offset:20480
ds_read_b64_tr_b16 v[46:47], v7 offset:20736
s_waitcnt lgkmcnt(0)
ds_write_b128 v12, v[32:35] offset:16384
ds_write_b128 v12, v[36:39] offset:17408
ds_write_b128 v12, v[40:43] offset:18432
ds_write_b128 v12, v[44:47] offset:19456
ds_write_b128 v12, v[96:99] offset:20480
ds_write_b128 v12, v[100:103] offset:21504
ds_write_b128 v12, v[104:107] offset:22528
ds_write_b128 v12, v[108:111] offset:23552
s_waitcnt lgkmcnt(0)
s_waitcnt vmcnt(0)
ds_read_b64_tr_b16 v[32:33], v4 offset:24576
ds_read_b64_tr_b16 v[34:35], v4 offset:24832
ds_read_b64_tr_b16 v[36:37], v4 offset:28672
ds_read_b64_tr_b16 v[38:39], v4 offset:28928
ds_read_b64_tr_b16 v[40:41], v5 offset:24576
ds_read_b64_tr_b16 v[42:43], v5 offset:24832
ds_read_b64_tr_b16 v[44:45], v5 offset:28672
ds_read_b64_tr_b16 v[46:47], v5 offset:28928
ds_read_b64_tr_b16 v[48:49], v6 offset:24576
ds_read_b64_tr_b16 v[50:51], v6 offset:24832
ds_read_b64_tr_b16 v[52:53], v6 offset:28672
ds_read_b64_tr_b16 v[54:55], v6 offset:28928
ds_read_b64_tr_b16 v[56:57], v7 offset:24576
ds_read_b64_tr_b16 v[58:59], v7 offset:24832
ds_read_b64_tr_b16 v[60:61], v7 offset:28672
ds_read_b64_tr_b16 v[62:63], v7 offset:28928
s_waitcnt lgkmcnt(0)
ds_write_b128 v12, v[32:35] offset:24576
ds_write_b128 v12, v[36:39] offset:25600
ds_write_b128 v12, v[40:43] offset:26624
ds_write_b128 v12, v[44:47] offset:27648
ds_write_b128 v12, v[48:51] offset:28672
ds_write_b128 v12, v[52:55] offset:29696
ds_write_b128 v12, v[56:59] offset:30720
ds_write_b128 v12, v[60:63] offset:31744
s_waitcnt lgkmcnt(0)
v_and_b32 v11, 1, v1
v_mov_b32 v2, 0x4444
v_cmp_eq_u32 vcc, 1, v11
v_mov_b32 v11, 0xeeee
s_nop 0
v_cndmask_b32 v2, v2, v11, vcc
v_mov_b32 v4, v12
v_lshlrev_b32 v7, 4, v1
s_lshl_b32 s43, s24, 12
v_add_u32 v13, s43, v7
v_add_u32 v13, 8192, v13
s_and_b32 s43, s24, 1
s_lshl_b32 s43, s43, 12
s_lshr_b32 s47, s24, 1
s_lshl_b32 s47, s47, 14
s_or_b32 s43, s43, s47
s_add_u32 s43, s43, 262144
v_add_u32 v3, s43, v7
v_and_b32 v11, 15, v1
v_lshrrev_b32 v16, 4, v1
s_and_b32 s43, s24, 1
s_lshl_b32 s43, s43, 11
s_lshr_b32 s47, s24, 1
s_lshl_b32 s47, s47, 4
s_add_u32 s43, s43, s47
s_add_u32 s43, s43, 24576
v_lshlrev_b32 v5, 5, v11
v_lshl_add_u32 v5, v16, 2, v5
v_add_u32 v5, s43, v5
v_lshlrev_b32 v6, 3, v1
v_add_u32 v6, 24576, v6
s_lshl_b32 s43, s24, 11
v_add_u32 v12, s43, v7
s_and_b32 s43, s27, 3
s_lshl_b32 s43, s43, 11
s_lshr_b32 s47, s27, 2
s_lshl_b32 s47, s47, 14
s_add_u32 s43, s43, s47
s_lshl_b32 s47, s24, 9
s_add_u32 s43, s43, s47
v_lshlrev_b32 v8, 4, v11
v_and_b32 v17, 1, v16
v_lshl_add_u32 v8, v17, 3, v8
v_add_u32 v8, s43, v8
v_add_u32 v8, 131072, v8
v_mov_b32 v108, 0
v_mov_b32 v18, 0xf149f2ca
v_cmp_gt_u32 vcc, 32, v1
s_lshr_b32 s46, s27, 1
s_lshl_b32 s46, s46, 7
v_cndmask_b32 v108, v108, v18, vcc
s_add_u32 s46, s46, 119578624
s_lshl_b32 s49, s27, 13
s_add_u32 s50, s49, 41943040
s_add_u32 s51, s49, 58720256
s_lshl_b32 s52, s24, 10
s_sub_u32 s52, s52, 1024
s_mov_b32 s60, 0
s_mov_b32 s66, 0x3e0293ee
s_mov_b32 s62, s66
s_mov_b32 s63, s66
s_mov_b32 s67, -2
s_mov_b32 s68, 0
s_mov_b32 s36, 0
s_mov_b32 s37, 0
s_mov_b32 s38, 0
s_mov_b32 s39, 0
s_mov_b32 s45, 8
s_mov_b32 s69, 30
s_mov_b32 s53, 8
s_mov_b32 s61, 92274688
s_mov_b32 s56, 0
s_mov_b32 s59, 115343360
v_mov_b32 v109, v108
v_mov_b32 v110, v108
v_mov_b32 v111, v108
v_mov_b32 v112, 0x3f803f80
v_mov_b32 v113, 0x3f803f80
v_mov_b32 v114, 0x3f803f80
v_mov_b32 v115, 0x3f803f80
v_mov_b32 v16, 0
s_mov_b32 s44, 0
CW_89:
buffer_load_dwordx4 v[20:23], v16, s[16:19], 0 offen offset:192 sc1
s_waitcnt vmcnt(0)
v_readfirstlane_b32 s43, v20
v_readfirstlane_b32 s47, v21
v_readfirstlane_b32 s48, v22
s_lshl_b32 s43, s43, 20
s_lshl_b32 s48, s48, 11
s_or_b32 s43, s43, s48
s_and_b32 s48, s47, 0x7ff
s_or_b32 s43, s43, s48
s_cmp_eq_u32 s43, 4392959
s_cbranch_scc1 CWOK_90
s_sleep 8
s_add_u32 s44, s44, 1
s_cmp_lt_u32 s44, 40000
s_cbranch_scc1 CW_89
s_branch S_END
CWOK_90:
v_mul_u32_u24 v16, 43, v1
v_lshrrev_b32 v16, 8, v16
v_add_u32 v16, 16, v16
v_lshrrev_b32 v16, v16, v21
v_and_b32 v16, 1, v16
v_cmp_ne_u32 s[86:87], 0, v16
s_nop 3
s_lshl_b32 s47, s45, 11
s_add_u32 s47, s47, s46
s_cmp_ge_u32 s45, 8
s_cselect_b32 s48, 16, 0
s_bitcmp1_b32 s27, 0
s_cselect_b32 s48, s48, 0
s_add_u32 s47, s47, s48
s_mov_b32 s44, 0
v_mov_b32 v11, 0
KF_91:
buffer_load_dwordx2 v[16:17], v11, s[4:7], s47 offen sc1
s_waitcnt vmcnt(0)
v_and_b32 v16, v16, v17
s_nop 0
v_readfirstlane_b32 s48, v16
s_cmp_lg_u32 s48, 0
s_cbranch_scc1 KFOK_92
s_sleep 8
s_add_u32 s44, s44, 1
s_cmp_lt_u32 s44, 30000
s_cbranch_scc1 KF_91
s_branch S_END
KFOK_92:
s_bitcmp1_b64 s[86:87], s60
s_cselect_b32 s65, 8192, 0
s_add_u32 s65, s65, s61
s_cmp_eq_u32 s24, 0
s_cbranch_scc1 PF_93
s_mov_b32 m0, s52
s_add_u32 s47, s50, s52
buffer_load_dwordx4 v7, s[4:7], s47 offen sc1 lds
buffer_load_dwordx4 v7, s[4:7], s47 offen offset:3072 sc1 lds
s_cmp_eq_u32 s24, 3
s_cbranch_scc1 PF3_94
s_add_u32 m0, s52, 6144
s_add_u32 s47, s47, 6144
buffer_load_dwordx4 v7, s[4:7], s47 offen sc1 lds
s_branch PF_93
PF3_94:
v_lshlrev_b32 v11, 7, v1
buffer_load_dword v11, v11, s[4:7], s51 offen sc1
PF_93:
s_add_u32 s50, s50, 262144
S_LOOP:
ds_read_b128 v[80:83], v4 offset:24576
ds_read_b128 v[84:87], v4 offset:25600
ds_read_b128 v[88:91], v4 offset:26624
ds_read_b128 v[92:95], v4 offset:27648
ds_read_b128 v[32:35], v4 offset:28672
ds_read_b128 v[36:39], v4 offset:29696
ds_read_b128 v[40:43], v4 offset:30720
ds_read_b128 v[44:47], v4 offset:31744
ds_read_b128 v[48:51], v4 offset:4096
ds_read_b128 v[52:55], v4 offset:5120
ds_read_b128 v[56:59], v4 offset:6144
ds_read_b128 v[60:63], v4 offset:7168
ds_read_b128 v[120:123], v4 offset:12288
ds_read_b128 v[124:127], v4 offset:13312
v_mov_b32 v16, 0
v_mov_b32 v17, 0
v_mov_b32 v18, 0
v_mov_b32 v19, 0
v_mov_b32 v20, 0
v_mov_b32 v21, 0
v_mov_b32 v22, 0
v_mov_b32 v23, 0
v_mov_b32 v24, 0
v_mov_b32 v25, 0
v_mov_b32 v26, 0
v_mov_b32 v27, 0
v_mov_b32 v28, 0
v_mov_b32 v29, 0
v_mov_b32 v30, 0
v_mov_b32 v31, 0
s_mov_b32 s44, 0
s_cmp_lg_u32 s24, 0
s_cbranch_scc1 GO_95
s_cmp_eq_u32 s60, 0
s_cbranch_scc1 GO_95
v_mov_b32 v64, -1
v_mov_b32 v65, -1
v_mov_b32 v66, -1
v_mov_b32 v67, -1
v_mov_b32 v68, -1
v_mov_b32 v69, -1
v_mov_b32 v70, -1
s_mov_b32 s71, s69
.p2alignl 4, 0xBF800000
BK_98:
s_sub_u32 s71, s71, 1
s_cbranch_scc0 BK_98
s_memrealtime s[88:89]
s_mov_b32 s53, 0
PT_96:
s_waitcnt lgkmcnt(0)
s_lshl_b32 s54, s88, 5
s_memrealtime s[88:89]
s_and_b32 s54, s54, 0x380
s_add_u32 s54, s54, s65
buffer_load_dword v64, v0, s[4:7], s54 offen sc1
s_add_u32 s53, s53, 1
s_waitcnt vmcnt(6)
v_cmp_eq_u32 vcc, -1, v65
s_cbranch_vccz GOT_97
s_waitcnt lgkmcnt(0)
s_lshl_b32 s54, s88, 5
s_memrealtime s[88:89]
s_and_b32 s54, s54, 0x380
s_add_u32 s54, s54, s65
buffer_load_dword v65, v0, s[4:7], s54 offen sc1
s_add_u32 s53, s53, 1
s_waitcnt vmcnt(6)
v_cmp_eq_u32 vcc, -1, v66
s_cbranch_vccz GOT_97
s_waitcnt lgkmcnt(0)
s_lshl_b32 s54, s88, 5
s_memrealtime s[88:89]
s_and_b32 s54, s54, 0x380
s_add_u32 s54, s54, s65
buffer_load_dword v66, v0, s[4:7], s54 offen sc1
s_add_u32 s53, s53, 1
s_waitcnt vmcnt(6)
v_cmp_eq_u32 vcc, -1, v67
s_cbranch_vccz GOT_97
s_waitcnt lgkmcnt(0)
s_lshl_b32 s54, s88, 5
s_memrealtime s[88:89]
s_and_b32 s54, s54, 0x380
s_add_u32 s54, s54, s65
buffer_load_dword v67, v0, s[4:7], s54 offen sc1
s_add_u32 s53, s53, 1
s_waitcnt vmcnt(6)
v_cmp_eq_u32 vcc, -1, v68
s_cbranch_vccz GOT_97
s_waitcnt lgkmcnt(0)
s_lshl_b32 s54, s88, 5
s_memrealtime s[88:89]
s_and_b32 s54, s54, 0x380
s_add_u32 s54, s54, s65
buffer_load_dword v68, v0, s[4:7], s54 offen sc1
s_add_u32 s53, s53, 1
s_waitcnt vmcnt(6)
v_cmp_eq_u32 vcc, -1, v69
s_cbranch_vccz GOT_97
s_waitcnt lgkmcnt(0)
s_lshl_b32 s54, s88, 5
s_memrealtime s[88:89]
s_and_b32 s54, s54, 0x380
s_add_u32 s54, s54, s65
buffer_load_dword v69, v0, s[4:7], s54 offen sc1
s_add_u32 s53, s53, 1
s_waitcnt vmcnt(6)
v_cmp_eq_u32 vcc, -1, v70
s_cbranch_vccz GOT_97
s_waitcnt lgkmcnt(0)
s_lshl_b32 s54, s88, 5
s_memrealtime s[88:89]
s_and_b32 s54, s54, 0x380
s_add_u32 s54, s54, s65
buffer_load_dword v70, v0, s[4:7], s54 offen sc1
s_add_u32 s53, s53, 1
s_waitcnt vmcnt(6)
v_cmp_eq_u32 vcc, -1, v64
s_cbranch_vccz GOT_97
s_cmp_lt_u32 s53, 1000
s_cbranch_scc1 PT_96
GOT_97:
GO_95:
s_barrier
buffer_load_dwordx4 v[64:67], v3, s[4:7], s65 offen offset:0 sc1
s_nop 3
buffer_load_dwordx4 v[68:71], v3, s[4:7], s65 offen offset:1024 sc1
s_nop 3
buffer_load_dwordx4 v[72:75], v3, s[4:7], s65 offen offset:2048 sc1
s_nop 3
buffer_load_dwordx4 v[76:79], v3, s[4:7], s65 offen offset:3072 sc1
s_sub_u32 s53, s53, 8
s_min_i32 s53, s53, 1
s_add_u32 s69, s69, s53
s_max_i32 s69, s69, 0
s_waitcnt lgkmcnt(0)
s_waitcnt vmcnt(3)
v_cmp_eq_u32 vcc, -1, v64
s_cbranch_vccnz SR_99
SC_103:
v_smfmac_f32_16x16x64_bf16 v[16:19], v[64:67], v[80:87], v2
ds_write_b128 v13, v[64:67] offset:0
v_smfmac_f32_16x16x64_bf16 v[20:23], v[64:67], v[88:95], v2
v_smfmac_f32_16x16x64_bf16 v[24:27], v[64:67], v[32:39], v2
v_smfmac_f32_16x16x64_bf16 v[28:31], v[64:67], v[40:47], v2
s_waitcnt lgkmcnt(0)
s_barrier
ds_read_b128 v[80:83], v116 offset:0
ds_read_b128 v[84:87], v117 offset:0
s_waitcnt vmcnt(2)
v_cmp_eq_u32 vcc, -1, v68
s_cbranch_vccnz SR_100
SC_104:
v_smfmac_f32_16x16x64_bf16 v[16:19], v[68:71], v[48:55], v2
ds_read_b128 v[32:35], v4 offset:14336
v_smfmac_f32_16x16x64_bf16 v[20:23], v[68:71], v[56:63], v2
ds_read_b128 v[36:39], v4 offset:15360
v_smfmac_f32_16x16x64_bf16 v[24:27], v[68:71], a[0:7], v2
ds_write_b128 v13, v[68:71] offset:1024
v_smfmac_f32_16x16x64_bf16 v[28:31], v[68:71], a[8:15], v2
s_waitcnt lgkmcnt(4)
v_smfmac_f32_16x16x64_bf16 v[16:19], v[80:83], a[16:23], v2
buffer_load_dwordx4 v[96:99], v12, s[4:7], s51 offen sc1
ds_read_b128 v[88:91], v118 offset:0
v_smfmac_f32_16x16x64_bf16 v[20:23], v[80:83], a[24:31], v2
buffer_load_dwordx4 v[100:103], v12, s[4:7], s51 offen offset:1024 sc1
s_add_u32 s51, s51, 262144
ds_read_b128 v[40:43], v4 offset:20480
v_smfmac_f32_16x16x64_bf16 v[24:27], v[80:83], a[32:39], v2
ds_read_b128 v[44:47], v4 offset:21504
v_smfmac_f32_16x16x64_bf16 v[28:31], v[80:83], a[40:47], v2
s_waitcnt lgkmcnt(3)
s_barrier
v_smfmac_f32_16x16x64_bf16 v[16:19], v[84:87], a[48:55], v2
ds_read_b128 v[92:95], v116 offset:1024
v_smfmac_f32_16x16x64_bf16 v[20:23], v[84:87], a[56:63], v2
ds_read_b128 v[48:51], v4 offset:22528
v_smfmac_f32_16x16x64_bf16 v[24:27], v[84:87], v[120:127], v2
ds_read_b128 v[52:55], v4 offset:23552
v_smfmac_f32_16x16x64_bf16 v[28:31], v[84:87], v[32:39], v2
ds_read_b128 v[64:67], v117 offset:1024
s_waitcnt lgkmcnt(6)
v_smfmac_f32_16x16x64_bf16 v[16:19], v[88:91], a[64:71], v2
ds_read_b128 v[56:59], v4 offset:0
v_smfmac_f32_16x16x64_bf16 v[20:23], v[88:91], a[72:79], v2
ds_read_b128 v[60:63], v4 offset:1024
v_smfmac_f32_16x16x64_bf16 v[24:27], v[88:91], a[80:87], v2
ds_read_b128 v[32:35], v4 offset:2048
v_smfmac_f32_16x16x64_bf16 v[28:31], v[88:91], a[88:95], v2
ds_read_b128 v[36:39], v4 offset:3072
s_waitcnt lgkmcnt(7)
v_smfmac_f32_16x16x64_bf16 v[16:19], v[92:95], a[96:103], v2
ds_read_b128 v[68:71], v118 offset:1024
v_smfmac_f32_16x16x64_bf16 v[20:23], v[92:95], a[104:111], v2
s_waitcnt vmcnt(2)
v_max_u32 v11, v72, v76
v_smfmac_f32_16x16x64_bf16 v[24:27], v[92:95], v[40:47], v2
v_cmp_eq_u32 vcc, -1, v11
s_waitcnt lgkmcnt(6)
v_smfmac_f32_16x16x64_bf16 v[28:31], v[92:95], v[48:55], v2
s_cbranch_vccnz SR_101
SC_105:
ds_read_b128 v[40:43], v4 offset:8192
s_waitcnt lgkmcnt(6)
v_smfmac_f32_16x16x64_bf16 v[16:19], v[64:67], a[112:119], v2
ds_read_b128 v[44:47], v4 offset:9216
v_smfmac_f32_16x16x64_bf16 v[20:23], v[64:67], a[120:127], v2
ds_write_b128 v13, v[72:75] offset:2048
v_smfmac_f32_16x16x64_bf16 v[24:27], v[64:67], a[128:135], v2
v_smfmac_f32_16x16x64_bf16 v[28:31], v[64:67], a[136:143], v2
ds_write_b128 v13, v[76:79] offset:3072
s_waitcnt lgkmcnt(4)
v_smfmac_f32_16x16x64_bf16 v[16:19], v[68:71], v[56:63], v2
v_smfmac_f32_16x16x64_bf16 v[20:23], v[68:71], v[32:39], v2
ds_read_b128 v[48:51], v4 offset:10240
v_smfmac_f32_16x16x64_bf16 v[24:27], v[68:71], a[144:151], v2
ds_read_b128 v[52:55], v4 offset:11264
v_smfmac_f32_16x16x64_bf16 v[28:31], v[68:71], a[152:159], v2
s_waitcnt lgkmcnt(2)
s_barrier
ds_read_b128 v[56:59], v4 offset:16384
v_smfmac_f32_16x16x64_bf16 v[16:19], v[72:75], a[160:167], v2
ds_read_b128 v[60:63], v4 offset:17408
v_smfmac_f32_16x16x64_bf16 v[20:23], v[72:75], a[168:175], v2
ds_read_b128 v[32:35], v4 offset:18432
v_smfmac_f32_16x16x64_bf16 v[24:27], v[72:75], v[40:47], v2
ds_read_b128 v[36:39], v4 offset:19456
s_waitcnt lgkmcnt(4)
v_smfmac_f32_16x16x64_bf16 v[28:31], v[72:75], v[48:55], v2
ds_read_b128 v[80:83], v116 offset:2048
v_smfmac_f32_16x16x64_bf16 v[16:19], v[76:79], a[176:183], v2
ds_read_b128 v[84:87], v116 offset:3072
v_smfmac_f32_16x16x64_bf16 v[20:23], v[76:79], a[184:191], v2
ds_read_b128 v[88:91], v117 offset:2048
s_waitcnt lgkmcnt(5)
v_smfmac_f32_16x16x64_bf16 v[24:27], v[76:79], v[56:63], v2
ds_read_b128 v[92:95], v117 offset:3072
s_waitcnt lgkmcnt(4)
v_smfmac_f32_16x16x64_bf16 v[28:31], v[76:79], v[32:39], v2
ds_read_b128 v[64:67], v118 offset:2048
s_waitcnt lgkmcnt(4)
v_smfmac_f32_16x16x64_bf16 v[16:19], v[80:83], a[192:199], v2
ds_read_b128 v[68:71], v118 offset:3072
v_smfmac_f32_16x16x64_bf16 v[20:23], v[80:83], a[200:207], v2
ds_read_b128 v[40:43], v7 offset:2048
s_waitcnt lgkmcnt(5)
v_smfmac_f32_16x16x64_bf16 v[16:19], v[84:87], a[224:231], v2
ds_read_b128 v[44:47], v7 offset:3072
v_smfmac_f32_16x16x64_bf16 v[20:23], v[84:87], a[232:239], v2
ds_read_b128 v[48:51], v7 offset:4096
s_waitcnt lgkmcnt(6)
v_smfmac_f32_16x16x64_bf16 v[16:19], v[88:91], v[128:135], v2
ds_read_b128 v[52:55], v7 offset:5120
v_smfmac_f32_16x16x64_bf16 v[20:23], v[88:91], v[136:143], v2
ds_read_b128 v[56:59], v7 offset:6144
s_waitcnt lgkmcnt(7)
v_smfmac_f32_16x16x64_bf16 v[16:19], v[92:95], v[160:167], v2
ds_read_b128 v[60:63], v7 offset:7168
v_smfmac_f32_16x16x64_bf16 v[20:23], v[92:95], v[168:175], v2
ds_read_b128 v[32:35], v7 offset:0
s_waitcnt lgkmcnt(8)
v_smfmac_f32_16x16x64_bf16 v[16:19], v[64:67], v[192:199], v2
ds_read_b128 v[36:39], v7 offset:1024
v_smfmac_f32_16x16x64_bf16 v[20:23], v[64:67], v[200:207], v2
s_waitcnt lgkmcnt(8)
v_smfmac_f32_16x16x64_bf16 v[16:19], v[68:71], v[224:231], v2
v_smfmac_f32_16x16x64_bf16 v[20:23], v[68:71], v[232:239], v2
v_smfmac_f32_16x16x64_bf16 v[24:27], v[80:83], a[208:215], v2
v_smfmac_f32_16x16x64_bf16 v[24:27], v[84:87], a[240:247], v2
v_smfmac_f32_16x16x64_bf16 v[24:27], v[88:91], v[144:151], v2
v_add_f32 v16, v16, v17
v_add_f32 v18, v18, v19
v_smfmac_f32_16x16x64_bf16 v[24:27], v[92:95], v[176:183], v2
v_cvt_pk_bf16_f32 v16, v16, v18
v_add_f32 v20, v20, v21
v_smfmac_f32_16x16x64_bf16 v[24:27], v[64:67], v[208:215], v2
v_add_f32 v22, v22, v23
v_cvt_pk_bf16_f32 v20, v20, v22
v_smfmac_f32_16x16x64_bf16 v[24:27], v[68:71], v[240:247], v2
ds_write2_b32 v5, v16, v20 offset0:0 offset1:128
v_smfmac_f32_16x16x64_bf16 v[28:31], v[80:83], a[216:223], v2
v_smfmac_f32_16x16x64_bf16 v[28:31], v[84:87], a[248:255], v2
v_smfmac_f32_16x16x64_bf16 v[28:31], v[88:91], v[152:159], v2
s_waitcnt lgkmcnt(0)
s_barrier
v_smfmac_f32_16x16x64_bf16 v[28:31], v[92:95], v[184:191], v2
ds_read_b64_tr_b16 v[72:73], v6 offset:0
ds_read_b64_tr_b16 v[74:75], v6 offset:512
v_add_f32 v24, v24, v25
v_smfmac_f32_16x16x64_bf16 v[28:31], v[64:67], v[216:223], v2
ds_read_b64_tr_b16 v[76:77], v6 offset:2048
ds_read_b64_tr_b16 v[78:79], v6 offset:2560
v_add_f32 v26, v26, v27
v_smfmac_f32_16x16x64_bf16 v[28:31], v[68:71], v[248:255], v2
v_cvt_pk_bf16_f32 v24, v24, v26
ds_write_b32 v5, v24 offset:1024
s_nop 5
v_add_f32 v28, v28, v29
v_add_f32 v30, v30, v31
v_cvt_pk_bf16_f32 v28, v28, v30
ds_write_b32 v5, v28 offset:1536
s_waitcnt lgkmcnt(4)
v_mfma_f32_16x16x32_bf16 v[120:123], v[72:75], v[72:75], v[108:111]
v_mfma_f32_16x16x32_bf16 v[16:19], v[32:35], v[72:75], 0
v_mfma_f32_16x16x32_bf16 v[20:23], v[48:51], v[72:75], 0
s_waitcnt vmcnt(0)
buffer_load_dwordx2 v[104:105], v8, s[4:7], s65 offen offset:0 sc1
buffer_load_dwordx2 v[106:107], v8, s[4:7], s65 offen offset:256 sc1
s_waitcnt lgkmcnt(0)
s_barrier
ds_read_b64_tr_b16 v[80:81], v6 offset:1024
ds_read_b64_tr_b16 v[82:83], v6 offset:1536
ds_read_b64_tr_b16 v[84:85], v6 offset:3072
ds_read_b64_tr_b16 v[86:87], v6 offset:3584
v_mfma_f32_16x16x32_bf16 v[120:123], v[76:79], v[76:79], v[120:123]
v_mfma_f32_16x16x32_bf16 v[16:19], v[40:43], v[76:79], v[16:19]
v_mfma_f32_16x16x32_bf16 v[20:23], v[56:59], v[76:79], v[20:23]
buffer_store_dword v1, v119, s[4:7], s65 offen sc1
s_cmp_eq_u32 s60, 63
s_cbranch_scc1 S_LAST
s_waitcnt lgkmcnt(2)
v_mfma_f32_16x16x32_bf16 v[120:123], v[80:83], v[80:83], v[120:123]
v_mfma_f32_16x16x32_bf16 v[16:19], v[36:39], v[80:83], v[16:19]
v_mfma_f32_16x16x32_bf16 v[20:23], v[52:55], v[80:83], v[20:23]
s_waitcnt lgkmcnt(0)
v_mfma_f32_16x16x32_bf16 v[120:123], v[84:87], v[84:87], v[120:123]
v_mfma_f32_16x16x32_bf16 v[16:19], v[44:47], v[84:87], v[16:19]
v_mfma_f32_16x16x32_bf16 v[20:23], v[60:63], v[84:87], v[20:23]
s_nop 3
v_max3_f32 v26, v120, v121, v122
s_nop 2
v_max3_f32 v26, v26, v123, v16
v_max3_f32 v27, v17, v18, v19
v_max3_f32 v26, v26, v20, v21
v_max3_f32 v27, v27, v22, v23
v_max_f32 v26, v26, v27
v_max_f32 v27, v26, v27
s_nop 1
v_permlane32_swap_b32 v26, v27
v_max_f32 v24, v26, v27
v_max_f32 v25, v26, v27
s_nop 1
v_permlane16_swap_b32 v24, v25
v_max_f32 v26, v24, v25
v_mul_f32 v26, s66, v26
v_pk_fma_f32 v[16:17], v[16:17], s[62:63], v[26:27] op_sel_hi:[1,1,0] neg_lo:[0,0,1] neg_hi:[0,0,1]
v_pk_fma_f32 v[18:19], v[18:19], s[62:63], v[26:27] op_sel_hi:[1,1,0] neg_lo:[0,0,1] neg_hi:[0,0,1]
v_pk_fma_f32 v[20:21], v[20:21], s[62:63], v[26:27] op_sel_hi:[1,1,0] neg_lo:[0,0,1] neg_hi:[0,0,1]
v_pk_fma_f32 v[22:23], v[22:23], s[62:63], v[26:27] op_sel_hi:[1,1,0] neg_lo:[0,0,1] neg_hi:[0,0,1]
v_exp_f32 v16, v16
v_exp_f32 v17, v17
v_exp_f32 v18, v18
v_exp_f32 v19, v19
v_exp_f32 v20, v20
v_exp_f32 v21, v21
v_exp_f32 v22, v22
v_exp_f32 v23, v23
v_fma_f32 v120, v120, s66, -v26
v_cvt_pk_bf16_f32 v68, v16, v17
v_cvt_pk_bf16_f32 v69, v18, v19
v_cvt_pk_bf16_f32 v70, v20, v21
v_cvt_pk_bf16_f32 v71, v22, v23
v_fma_f32 v121, v121, s66, -v26
v_fma_f32 v122, v122, s66, -v26
v_mfma_f32_16x16x32_bf16 v[40:43], v[112:115], v[68:71], 0
v_fma_f32 v123, v123, s66, -v26
v_exp_f32 v120, v120
v_mfma_f32_16x16x32_bf16 v[32:35], v[96:99], v[68:71], 0
v_exp_f32 v121, v121
v_mfma_f32_16x16x32_bf16 v[36:39], v[100:103], v[68:71], 0
v_exp_f32 v122, v122
v_exp_f32 v123, v123
v_cvt_pk_bf16_f32 v24, v120, v121
v_cvt_pk_bf16_f32 v25, v122, v123
s_waitcnt vmcnt(1)
v_max_u32 v11, v104, v106
v_mfma_f32_16x16x16_bf16 v[40:43], v[112:113], v[24:25], v[40:43]
v_cmp_eq_u32 vcc, -1, v11
s_cbranch_vccnz SRV_107
SCV_108:
v_mfma_f32_16x16x16_bf16 v[32:35], v[104:105], v[24:25], v[32:35]
v_mfma_f32_16x16x16_bf16 v[36:39], v[106:107], v[24:25], v[36:39]
s_nop 3
v_rcp_f32 v40, v40
s_nop 1
v_pk_mul_f32 v[32:33], v[32:33], v[40:41] op_sel_hi:[1,0]
v_pk_mul_f32 v[34:35], v[34:35], v[40:41] op_sel_hi:[1,0]
v_cvt_pk_bf16_f32 v28, v32, v33
v_cvt_pk_bf16_f32 v29, v34, v35
v_pk_mul_f32 v[36:37], v[36:37], v[40:41] op_sel_hi:[1,0]
v_pk_mul_f32 v[38:39], v[38:39], v[40:41] op_sel_hi:[1,0]
v_min_u32 v28, s67, v28
v_cvt_pk_bf16_f32 v30, v36, v37
v_cvt_pk_bf16_f32 v31, v38, v39
buffer_store_dwordx4 v[28:31], v9, s[4:7], s65 offen sc1
S_KM:
s_waitcnt lgkmcnt(0)
s_cmp_eq_u32 s24, 0
s_cbranch_scc1 KMD_109
s_cmp_lg_u32 s24, 3
s_cbranch_scc1 KM_111
v_min_u32 v104, s67, v84
v_min_u32 v105, s67, v85
v_min_u32 v106, s67, v86
v_min_u32 v107, s67, v87
buffer_store_dwordx4 v[104:107], v10, s[4:7], s59 offen offset:1536 sc1
s_branch ARM_110
KM_111:
s_cmp_lg_u32 s24, 2
s_cbranch_scc1 KM_112
v_min_u32 v104, s67, v76
v_min_u32 v105, s67, v77
v_min_u32 v106, s67, v78
v_min_u32 v107, s67, v79
buffer_store_dwordx4 v[104:107], v10, s[4:7], s59 offen offset:1024 sc1
s_branch ARM_110
KM_112:
v_min_u32 v104, s67, v80
v_min_u32 v105, s67, v81
v_min_u32 v106, s67, v82
v_min_u32 v107, s67, v83
buffer_store_dwordx4 v[104:107], v10, s[4:7], s59 offen offset:512 sc1
v_min_u32 v96, s67, v72
v_min_u32 v97, s67, v73
v_min_u32 v98, s67, v74
v_min_u32 v99, s67, v75
buffer_store_dwordx4 v[96:99], v10, s[4:7], s59 offen offset:0 sc1
ARM_110:
s_cmp_ge_u32 s60, 58
s_cbranch_scc1 KMD_109
s_add_u32 s47, s60, 6
s_bitcmp1_b64 s[86:87], s47
s_cselect_b32 s47, 8192, 0
s_add_u32 s47, s47, s61
s_add_u32 s47, s47, 2097152
s_lshl_b32 s48, s24, 9
s_add_u32 s48, s48, s59
s_add_u32 s48, s48, 392704
v_mov_b32 v16, -1
v_mov_b32 v17, -1
v_mov_b32 v18, -1
v_mov_b32 v19, -1
buffer_store_dwordx4 v[16:19], v9, s[4:7], s47 offen sc1
buffer_store_dwordx4 v[16:19], v0, s[4:7], s47 offen sc1
buffer_store_dwordx4 v[16:19], v10, s[4:7], s48 offen offset:512 sc1
s_cmp_lg_u32 s24, 1
s_cbranch_scc1 KMD_109
s_sub_u32 s47, s47, 256
buffer_store_dwordx4 v[16:19], v10, s[4:7], s48 offen sc1
buffer_store_dwordx4 v[16:19], v9, s[4:7], s47 offen sc1
KMD_109:
s_cmp_eq_u32 s60, 63
s_cbranch_scc1 S_END
s_add_u32 s60, s60, 1
s_add_u32 s59, s59, 65536
s_add_u32 s56, s56, 1
s_cmp_eq_u32 s56, 6
s_cselect_b32 s47, 32768, 0
s_cselect_b32 s56, 0, s56
s_add_u32 s61, s61, s47
s_add_u32 s61, s61, 344064
s_bitcmp1_b64 s[86:87], s60
s_cselect_b32 s65, 8192, 0
s_add_u32 s65, s65, s61
s_cmp_eq_u32 s60, 63
s_cbranch_scc1 S_LOOP
s_lshr_b32 s45, s60, 3
s_lshr_b32 s48, s60, 1
s_add_u32 s48, s48, 8
s_cmp_lt_u32 s60, 8
s_cselect_b32 s45, s48, s45
s_cselect_b32 s47, 1, 7
s_and_b32 s47, s60, s47
s_cmp_eq_u32 s60, 16
s_cselect_b32 s45, 0, s45
s_cmp_eq_u32 s60, 18
s_cselect_b32 s47, 0, s47
s_cmp_lg_u32 s47, 0
s_cbranch_scc1 NF_115
s_cmp_eq_u32 s24, 0
s_cbranch_scc1 NF_115
s_and_b32 s47, s36, s37
s_mov_b32 s36, 0
s_cmp_lg_u32 s47, 0
s_cbranch_scc1 NF_115
s_lshl_b32 s47, s45, 11
s_add_u32 s47, s47, s46
s_cmp_ge_u32 s45, 8
s_cselect_b32 s48, 16, 0
s_bitcmp1_b32 s27, 0
s_cselect_b32 s48, s48, 0
s_add_u32 s47, s47, s48
s_mov_b32 s44, 0
v_mov_b32 v11, 0
KF_116:
buffer_load_dwordx2 v[16:17], v11, s[4:7], s47 offen sc1
s_waitcnt vmcnt(0)
v_and_b32 v16, v16, v17
s_nop 0
v_readfirstlane_b32 s48, v16
s_cmp_lg_u32 s48, 0
s_cbranch_scc1 KFOK_117
s_sleep 8
s_add_u32 s44, s44, 1
s_cmp_lt_u32 s44, 30000
s_cbranch_scc1 KF_116
s_branch S_END
KFOK_117:
NF_115:
s_cmp_eq_u32 s24, 0
s_cbranch_scc1 PF_118
s_mov_b32 m0, s52
s_add_u32 s47, s50, s52
buffer_load_dwordx4 v7, s[4:7], s47 offen sc1 lds
buffer_load_dwordx4 v7, s[4:7], s47 offen offset:3072 sc1 lds
s_cmp_eq_u32 s24, 3
s_cbranch_scc1 PF3_119
s_add_u32 m0, s52, 6144
s_add_u32 s47, s47, 6144
buffer_load_dwordx4 v7, s[4:7], s47 offen sc1 lds
s_branch PF_118
PF3_119:
v_lshlrev_b32 v11, 7, v1
buffer_load_dword v11, v11, s[4:7], s51 offen sc1
PF_118:
s_add_u32 s50, s50, 262144
s_add_u32 s40, s60, 1
s_lshr_b32 s41, s40, 3
s_lshr_b32 s42, s40, 1
s_add_u32 s42, s42, 8
s_cmp_lt_u32 s40, 8
s_cselect_b32 s41, s42, s41
s_cselect_b32 s47, 1, 7
s_and_b32 s47, s40, s47
s_cmp_eq_u32 s40, 16
s_cselect_b32 s41, 0, s41
s_cmp_eq_u32 s40, 18
s_cselect_b32 s47, 0, s47
s_cmp_lg_u32 s47, 0
s_cbranch_scc1 NE_120
s_cmp_eq_u32 s24, 0
s_cbranch_scc1 NE_120
s_lshl_b32 s47, s41, 11
s_add_u32 s47, s47, s46
s_cmp_ge_u32 s41, 8
s_cselect_b32 s42, 16, 0
s_bitcmp1_b32 s27, 0
s_cselect_b32 s42, s42, 0
s_add_u32 s47, s47, s42
s_load_dwordx2 s[36:37], s[4:5], s47 glc
NE_120:
s_branch S_LOOP
S_LAST:
s_waitcnt vmcnt(0)
s_branch S_KM
SR_99:
s_add_u32 s68, s68, 1
s_add_u32 s44, s44, 1
s_cmp_gt_u32 s44, 30000
s_cbranch_scc1 S_END
buffer_load_dwordx4 v[64:67], v3, s[4:7], s65 offen offset:0 sc1
buffer_load_dwordx4 v[68:71], v3, s[4:7], s65 offen offset:1024 sc1
buffer_load_dwordx4 v[72:75], v3, s[4:7], s65 offen offset:2048 sc1
buffer_load_dwordx4 v[76:79], v3, s[4:7], s65 offen offset:3072 sc1
s_waitcnt vmcnt(0)
v_cmp_eq_u32 vcc, -1, v64
s_cbranch_vccz SC_103
s_branch SR_99
SR_100:
s_add_u32 s68, s68, 1
s_add_u32 s44, s44, 1
s_cmp_gt_u32 s44, 30000
s_cbranch_scc1 S_END
buffer_load_dwordx4 v[68:71], v3, s[4:7], s65 offen offset:1024 sc1
buffer_load_dwordx4 v[72:75], v3, s[4:7], s65 offen offset:2048 sc1
buffer_load_dwordx4 v[76:79], v3, s[4:7], s65 offen offset:3072 sc1
s_waitcnt vmcnt(0)
v_cmp_eq_u32 vcc, -1, v68
s_cbranch_vccz SC_104
s_branch SR_100
SR_101:
s_add_u32 s68, s68, 1
s_add_u32 s44, s44, 1
s_cmp_gt_u32 s44, 30000
s_cbranch_scc1 S_END
buffer_load_dwordx4 v[72:75], v3, s[4:7], s65 offen offset:2048 sc1
buffer_load_dwordx4 v[76:79], v3, s[4:7], s65 offen offset:3072 sc1
s_waitcnt vmcnt(0)
v_max_u32 v11, v72, v76
v_cmp_eq_u32 vcc, -1, v11
s_cbranch_vccz SC_105
s_branch SR_101
SRV_107:
s_add_u32 s68, s68, 0x10000
s_add_u32 s44, s44, 1
s_cmp_gt_u32 s44, 30000
s_cbranch_scc1 S_END
buffer_load_dwordx2 v[104:105], v8, s[4:7], s65 offen offset:0 sc1
buffer_load_dwordx2 v[106:107], v8, s[4:7], s65 offen offset:256 sc1
s_waitcnt vmcnt(0)
v_max_u32 v11, v104, v106
v_cmp_eq_u32 vcc, -1, v11
s_cbranch_vccz SCV_108
s_branch SRV_107
S_END:
s_endpgm
R_VO:
s_setprio 3
s_load_dwordx2 s[8:9], s[0:1], 40
s_mov_b32 s10, 8388608
s_mov_b32 s11, 0x20000
s_load_dwordx2 s[12:13], s[0:1], 32
s_mov_b32 s14, 8388608
s_mov_b32 s15, 0x20000
s_sub_u32 s26, s25, 1
s_lshl_b32 s40, s24, 15
s_lshl_b32 s42, s24, 21
s_lshl_b32 s43, s27, 6
s_add_u32 s42, s42, s43
s_lshl_b32 s49, s27, 8
s_lshl_b32 s43, s26, 7
s_add_u32 s49, s49, s43
s_lshl_b32 s43, s24, 21
s_add_u32 s49, s49, s43
v_lshrrev_b32 v8, 3, v1
v_lshlrev_b32 v8, 13, v8
v_lshrrev_b32 v9, 5, v1
v_lshlrev_b32 v9, 1, v9
v_and_b32 v10, 7, v1
v_xor_b32 v9, v9, v10
v_lshl_add_u32 v2, v9, 4, v8
v_xor_b32 v9, 4, v9
v_lshl_add_u32 v3, v9, 4, v8
v_bfe_u32 v8, v1, 2, 1
v_bfe_u32 v9, v1, 4, 1
v_bfe_u32 v10, v1, 3, 1
v_lshl_add_u32 v9, v10, 1, v9
v_lshl_add_u32 v8, v9, 2, v8
v_bfe_u32 v10, v1, 5, 1
v_lshl_add_u32 v8, v10, 4, v8
v_lshlrev_b32 v8, 7, v8
v_and_b32 v10, 3, v1
v_lshl_add_u32 v8, v10, 3, v8
v_add_u32 v8, s40, v8
v_xor_b32 v10, 0, v9
v_lshl_add_u32 v4, v10, 5, v8
v_xor_b32 v10, 1, v9
v_lshl_add_u32 v5, v10, 5, v8
v_xor_b32 v10, 2, v9
v_lshl_add_u32 v6, v10, 5, v8
v_xor_b32 v10, 3, v9
v_lshl_add_u32 v7, v10, 5, v8
v_bfe_u32 v8, v1, 4, 1
v_lshlrev_b32 v8, 3, v8
v_xor_b32 v8, v8, v1
v_lshrrev_b32 v9, 2, v8
v_lshlrev_b32 v9, 11, v9
v_and_b32 v8, 3, v8
v_lshl_add_u32 v12, v8, 4, v9
v_xor_b32 v8, 2, v8
v_lshl_add_u32 v13, v8, 4, v9
v_lshrrev_b32 v8, 4, v1
v_lshlrev_b32 v8, 10, v8
v_bfe_u32 v9, v1, 3, 1
v_lshl_add_u32 v8, v9, 8, v8
v_bfe_u32 v10, v1, 2, 1
v_lshl_add_u32 v8, v10, 6, v8
v_and_b32 v10, 3, v1
v_lshl_add_u32 v8, v10, 3, v8
v_add_u32 v8, s40, v8
v_bfe_u32 v10, v1, 4, 1
v_lshlrev_b32 v10, 5, v10
v_lshl_add_u32 v9, v9, 7, v10
v_xor_b32 v10, 0, v9
v_add_u32 v14, v8, v10
v_xor_b32 v10, 32, v9
v_add_u32 v15, v8, v10
v_xor_b32 v10, 128, v9
v_add_u32 v16, v8, v10
v_xor_b32 v10, 160, v9
v_add_u32 v17, v8, v10
s_load_dwordx2 s[72:73], s[0:1], 8
s_mov_b32 s74, 16384
s_mov_b32 s75, 0x20000
s_and_b32 s43, s27, 3
s_lshl_b32 s43, s43, 11
s_lshr_b32 s47, s27, 2
s_lshl_b32 s47, s47, 14
s_add_u32 s43, s43, s47
s_lshl_b32 s47, s26, 10
s_add_u32 s43, s43, s47
s_lshl_b32 s47, s24, 8
s_add_u32 s43, s43, s47
s_add_u32 s43, s43, 131072
v_lshrrev_b32 v21, 2, v1
v_lshlrev_b32 v8, 4, v21
v_add_u32 v8, s43, v8
v_lshrrev_b32 v21, 4, v1
v_bfe_u32 v22, v1, 2, 1
v_bfe_u32 v23, v1, 3, 1
v_lshlrev_b32 v20, 5, v21
v_lshl_add_u32 v20, v22, 4, v20
v_lshl_add_u32 v20, v23, 8, v20
v_lshlrev_b32 v21, 11, v21
v_lshl_add_u32 v21, v22, 4, v21
v_lshl_add_u32 v21, v23, 5, v21
s_and_b32 s43, s27, 15
s_lshl_b32 s43, s43, 9
s_lshr_b32 s47, s27, 4
s_lshl_b32 s47, s47, 14
s_add_u32 s43, s43, s47
s_lshl_b32 s47, s26, 7
s_add_u32 s43, s43, s47
s_add_u32 s43, s43, 262144
v_add_u32 v20, s43, v20
v_and_b32 v22, 3, v1
v_mov_b32 v23, 2147483648
v_cmp_eq_u32 vcc, 0, v22
s_lshl_b32 s43, s26, 13
s_lshl_b32 s47, s27, 6
s_add_u32 s43, s43, s47
v_cndmask_b32 v8, v23, v8, vcc
v_cndmask_b32 v20, v23, v20, vcc
s_lshl_b32 s53, s26, 5
s_add_u32 s53, s53, s27
s_waitcnt lgkmcnt(0)
buffer_load_dwordx4 v[24:27], v21, s[72:75], s43 offen
v_lshrrev_b32 v22, 2, v1
v_and_b32 v0, 3, v1
v_lshlrev_b32 v0, 2, v0
v_lshl_add_u32 v0, v22, 10, v0
v_add_u32 v0, 16384, v0
s_mov_b32 s43, 294912
v_cmp_gt_u32 vcc, 32, v1
v_and_b32 v22, 0xe000, v0
v_add3_u32 v0, v0, v22, s43
v_cndmask_b32 v0, v23, v0, vcc
s_lshr_b32 s48, s53, 2
s_lshl_b32 s48, s48, 10
s_and_b32 s47, s53, 3
s_lshl_b32 s47, s47, 2
s_add_u32 s48, s48, s47
s_add_u32 s48, s48, 0
v_and_b32 v119, 7, v1
v_lshlrev_b32 v119, 7, v119
v_add_u32 v119, s48, v119
v_and_b32 v22, 0xe000, v119
v_add3_u32 v119, v119, v22, s43
s_cmp_eq_u32 s24, 1
s_cselect_b32 s47, 8, 0
v_cmp_gt_u32 vcc, s47, v1
s_nop 1
v_cndmask_b32 v119, v23, v119, vcc
s_cmp_eq_u32 s24, 0
s_cbranch_scc1 CR_121
s_and_b32 s47, s48, 0xfc00
v_lshlrev_b32 v0, 4, v1
v_add_u32 v0, s47, v0
v_and_b32 v22, 0xe000, v0
v_add3_u32 v0, v0, v22, s43
s_and_b32 s47, s53, 3
s_lshl_b32 s47, s47, 2
s_or_b32 s47, s47, s24
s_cmp_eq_u32 s47, 2
s_cselect_b64 vcc, -1, 0
s_nop 1
v_cndmask_b32 v0, v23, v0, vcc
CR_121:
v_mov_b32 v120, -1
v_mov_b32 v121, -1
v_mov_b32 v122, -1
v_mov_b32 v123, -1
s_mov_b32 s43, 92274688
s_mov_b32 s47, 0
AF_122:
buffer_store_dwordx4 v[120:123], v8, s[4:7], s43 offen sc1
s_cmp_lg_u32 s24, 2
s_cbranch_scc1 AM_123
buffer_store_dwordx4 v[120:123], v0, s[4:7], s43 offen sc1
s_cmp_lt_u32 s47, 2
s_cbranch_scc1 AM_123
buffer_store_dwordx4 v[120:123], v20, s[4:7], s43 offen sc1
AM_123:
s_add_u32 s47, s47, 1
s_bitcmp1_b32 s47, 0
s_cselect_b32 s48, 0, 327680
s_add_u32 s43, s43, s48
s_add_u32 s43, s43, 8192
s_cmp_lt_u32 s47, 12
s_cbranch_scc1 AF_122
s_cmp_lg_u32 s24, 0
s_cbranch_scc1 AM_124
s_waitcnt vmcnt(12)
v_min_u32 v24, -2, v24
s_mov_b32 s43, 92274688
s_mov_b32 s47, 92282880
buffer_store_dwordx4 v[24:27], v20, s[4:7], s43 offen sc1
buffer_store_dwordx4 v[24:27], v20, s[4:7], s47 offen sc1
AM_124:
s_and_b32 s76, s27, 7
s_lshl_b32 s77, s76, 18
s_bfe_u32 s78, s27, 65540
s_lshl_b32 s78, s78, 17
s_add_u32 s77, s77, s78
s_lshl_b32 s78, s24, 21
s_add_u32 s77, s77, s78
s_bfe_u32 s78, s27, 65539
s_lshl_b32 s78, s78, 10
s_add_u32 s77, s77, s78
s_add_u32 s77, s77, 384
v_lshlrev_b32 v126, 11, v1
s_cmp_le_u32 s76, 0
s_cbranch_scc0 HP_125
buffer_load_dword v127, v126, s[8:11], s77 offen
HP_125:
s_add_u32 m0, s40, 0
s_add_u32 s41, s49, 0
buffer_load_dwordx4 v2, s[12:15], s41 offen offset:0 lds
s_add_u32 s41, s49, 64512
buffer_load_dwordx4 v3, s[12:15], s41 offen offset:1024 lds
s_add_u32 s41, s49, 129024
buffer_load_dwordx4 v2, s[12:15], s41 offen offset:2048 lds
s_add_u32 s41, s49, 193536
buffer_load_dwordx4 v3, s[12:15], s41 offen offset:3072 lds
s_add_u32 m0, s40, 4096
s_add_u32 s41, s49, 262144
buffer_load_dwordx4 v2, s[12:15], s41 offen offset:0 lds
s_add_u32 s41, s49, 326656
buffer_load_dwordx4 v3, s[12:15], s41 offen offset:1024 lds
s_add_u32 s41, s49, 391168
buffer_load_dwordx4 v2, s[12:15], s41 offen offset:2048 lds
s_add_u32 s41, s49, 455680
buffer_load_dwordx4 v3, s[12:15], s41 offen offset:3072 lds
s_add_u32 m0, s40, 8192
s_add_u32 s41, s49, 524288
buffer_load_dwordx4 v2, s[12:15], s41 offen offset:0 lds
s_add_u32 s41, s49, 588800
buffer_load_dwordx4 v3, s[12:15], s41 offen offset:1024 lds
s_add_u32 s41, s49, 653312
buffer_load_dwordx4 v2, s[12:15], s41 offen offset:2048 lds
s_add_u32 s41, s49, 717824
buffer_load_dwordx4 v3, s[12:15], s41 offen offset:3072 lds
s_add_u32 m0, s40, 12288
s_add_u32 s41, s49, 786432
buffer_load_dwordx4 v2, s[12:15], s41 offen offset:0 lds
s_add_u32 s41, s49, 850944
buffer_load_dwordx4 v3, s[12:15], s41 offen offset:1024 lds
s_add_u32 s41, s49, 915456
buffer_load_dwordx4 v2, s[12:15], s41 offen offset:2048 lds
s_add_u32 s41, s49, 979968
buffer_load_dwordx4 v3, s[12:15], s41 offen offset:3072 lds
s_add_u32 m0, s40, 16384
s_add_u32 s41, s49, 1048576
buffer_load_dwordx4 v2, s[12:15], s41 offen offset:0 lds
s_add_u32 s41, s49, 1113088
buffer_load_dwordx4 v3, s[12:15], s41 offen offset:1024 lds
s_add_u32 s41, s49, 1177600
buffer_load_dwordx4 v2, s[12:15], s41 offen offset:2048 lds
s_add_u32 s41, s49, 1242112
buffer_load_dwordx4 v3, s[12:15], s41 offen offset:3072 lds
s_add_u32 m0, s40, 20480
s_add_u32 s41, s49, 1310720
buffer_load_dwordx4 v2, s[12:15], s41 offen offset:0 lds
s_add_u32 s41, s49, 1375232
buffer_load_dwordx4 v3, s[12:15], s41 offen offset:1024 lds
s_add_u32 s41, s49, 1439744
buffer_load_dwordx4 v2, s[12:15], s41 offen offset:2048 lds
s_add_u32 s41, s49, 1504256
buffer_load_dwordx4 v3, s[12:15], s41 offen offset:3072 lds
s_cmp_eq_u32 s76, 1
s_cbranch_scc0 HP_128
buffer_load_dword v127, v126, s[8:11], s77 offen
HP_128:
s_add_u32 m0, s40, 24576
s_add_u32 s41, s49, 1572864
buffer_load_dwordx4 v2, s[12:15], s41 offen offset:0 lds
s_add_u32 s41, s49, 1637376
buffer_load_dwordx4 v3, s[12:15], s41 offen offset:1024 lds
s_add_u32 s41, s49, 1701888
buffer_load_dwordx4 v2, s[12:15], s41 offen offset:2048 lds
s_add_u32 s41, s49, 1766400
buffer_load_dwordx4 v3, s[12:15], s41 offen offset:3072 lds
s_add_u32 m0, s40, 28672
s_add_u32 s41, s49, 1835008
buffer_load_dwordx4 v2, s[12:15], s41 offen offset:0 lds
s_add_u32 s41, s49, 1899520
buffer_load_dwordx4 v3, s[12:15], s41 offen offset:1024 lds
s_add_u32 s41, s49, 1964032
buffer_load_dwordx4 v2, s[12:15], s41 offen offset:2048 lds
s_add_u32 s41, s49, 2028544
buffer_load_dwordx4 v3, s[12:15], s41 offen offset:3072 lds
s_waitcnt vmcnt(24)
ds_read_b64_tr_b16 v[128:129], v4 offset:0
ds_read_b64_tr_b16 v[130:131], v4 offset:256
ds_read_b64_tr_b16 v[132:133], v4 offset:4096
ds_read_b64_tr_b16 v[134:135], v4 offset:4352
ds_read_b64_tr_b16 v[136:137], v5 offset:0
ds_read_b64_tr_b16 v[138:139], v5 offset:256
ds_read_b64_tr_b16 v[140:141], v5 offset:4096
ds_read_b64_tr_b16 v[142:143], v5 offset:4352
ds_read_b64_tr_b16 v[144:145], v6 offset:0
ds_read_b64_tr_b16 v[146:147], v6 offset:256
ds_read_b64_tr_b16 v[148:149], v6 offset:4096
ds_read_b64_tr_b16 v[150:151], v6 offset:4352
ds_read_b64_tr_b16 v[152:153], v7 offset:0
ds_read_b64_tr_b16 v[154:155], v7 offset:256
ds_read_b64_tr_b16 v[156:157], v7 offset:4096
ds_read_b64_tr_b16 v[158:159], v7 offset:4352
s_waitcnt lgkmcnt(0)
s_cmp_eq_u32 s76, 2
s_cbranch_scc0 HP_129
buffer_load_dword v127, v126, s[8:11], s77 offen
HP_129:
s_add_u32 m0, s40, 0
s_add_u32 s41, s42, 0
buffer_load_dwordx4 v12, s[8:11], s41 offen offset:0 lds
s_add_u32 s41, s42, 31744
buffer_load_dwordx4 v13, s[8:11], s41 offen offset:1024 lds
s_add_u32 s41, s42, 63488
buffer_load_dwordx4 v12, s[8:11], s41 offen offset:2048 lds
s_add_u32 s41, s42, 95232
buffer_load_dwordx4 v13, s[8:11], s41 offen offset:3072 lds
s_add_u32 m0, s40, 4096
s_add_u32 s41, s42, 131072
buffer_load_dwordx4 v12, s[8:11], s41 offen offset:0 lds
s_add_u32 s41, s42, 162816
buffer_load_dwordx4 v13, s[8:11], s41 offen offset:1024 lds
s_add_u32 s41, s42, 194560
buffer_load_dwordx4 v12, s[8:11], s41 offen offset:2048 lds
s_add_u32 s41, s42, 226304
buffer_load_dwordx4 v13, s[8:11], s41 offen offset:3072 lds
s_waitcnt vmcnt(24)
ds_read_b64_tr_b16 v[160:161], v4 offset:8192
ds_read_b64_tr_b16 v[162:163], v4 offset:8448
ds_read_b64_tr_b16 v[164:165], v4 offset:12288
ds_read_b64_tr_b16 v[166:167], v4 offset:12544
ds_read_b64_tr_b16 v[168:169], v5 offset:8192
ds_read_b64_tr_b16 v[170:171], v5 offset:8448
ds_read_b64_tr_b16 v[172:173], v5 offset:12288
ds_read_b64_tr_b16 v[174:175], v5 offset:12544
ds_read_b64_tr_b16 v[176:177], v6 offset:8192
ds_read_b64_tr_b16 v[178:179], v6 offset:8448
ds_read_b64_tr_b16 v[180:181], v6 offset:12288
ds_read_b64_tr_b16 v[182:183], v6 offset:12544
ds_read_b64_tr_b16 v[184:185], v7 offset:8192
ds_read_b64_tr_b16 v[186:187], v7 offset:8448
ds_read_b64_tr_b16 v[188:189], v7 offset:12288
ds_read_b64_tr_b16 v[190:191], v7 offset:12544
s_waitcnt lgkmcnt(0)
s_cmp_eq_u32 s76, 3
s_cbranch_scc0 HP_130
buffer_load_dword v127, v126, s[8:11], s77 offen
HP_130:
s_add_u32 m0, s40, 8192
s_add_u32 s41, s42, 262144
buffer_load_dwordx4 v12, s[8:11], s41 offen offset:0 lds
s_add_u32 s41, s42, 293888
buffer_load_dwordx4 v13, s[8:11], s41 offen offset:1024 lds
s_add_u32 s41, s42, 325632
buffer_load_dwordx4 v12, s[8:11], s41 offen offset:2048 lds
s_add_u32 s41, s42, 357376
buffer_load_dwordx4 v13, s[8:11], s41 offen offset:3072 lds
s_add_u32 m0, s40, 12288
s_add_u32 s41, s42, 393216
buffer_load_dwordx4 v12, s[8:11], s41 offen offset:0 lds
s_add_u32 s41, s42, 424960
buffer_load_dwordx4 v13, s[8:11], s41 offen offset:1024 lds
s_add_u32 s41, s42, 456704
buffer_load_dwordx4 v12, s[8:11], s41 offen offset:2048 lds
s_add_u32 s41, s42, 488448
buffer_load_dwordx4 v13, s[8:11], s41 offen offset:3072 lds
s_waitcnt vmcnt(24)
ds_read_b64_tr_b16 v[192:193], v4 offset:16384
ds_read_b64_tr_b16 v[194:195], v4 offset:16640
ds_read_b64_tr_b16 v[196:197], v4 offset:20480
ds_read_b64_tr_b16 v[198:199], v4 offset:20736
ds_read_b64_tr_b16 v[200:201], v5 offset:16384
ds_read_b64_tr_b16 v[202:203], v5 offset:16640
ds_read_b64_tr_b16 v[204:205], v5 offset:20480
ds_read_b64_tr_b16 v[206:207], v5 offset:20736
ds_read_b64_tr_b16 v[208:209], v6 offset:16384
ds_read_b64_tr_b16 v[210:211], v6 offset:16640
ds_read_b64_tr_b16 v[212:213], v6 offset:20480
ds_read_b64_tr_b16 v[214:215], v6 offset:20736
ds_read_b64_tr_b16 v[216:217], v7 offset:16384
ds_read_b64_tr_b16 v[218:219], v7 offset:16640
ds_read_b64_tr_b16 v[220:221], v7 offset:20480
ds_read_b64_tr_b16 v[222:223], v7 offset:20736
s_waitcnt lgkmcnt(0)
s_cmp_eq_u32 s76, 4
s_cbranch_scc0 HP_131
buffer_load_dword v127, v126, s[8:11], s77 offen
HP_131:
s_add_u32 m0, s40, 16384
s_add_u32 s41, s42, 524288
buffer_load_dwordx4 v12, s[8:11], s41 offen offset:0 lds
s_add_u32 s41, s42, 556032
buffer_load_dwordx4 v13, s[8:11], s41 offen offset:1024 lds
s_add_u32 s41, s42, 587776
buffer_load_dwordx4 v12, s[8:11], s41 offen offset:2048 lds
s_add_u32 s41, s42, 619520
buffer_load_dwordx4 v13, s[8:11], s41 offen offset:3072 lds
s_add_u32 m0, s40, 20480
s_add_u32 s41, s42, 655360
buffer_load_dwordx4 v12, s[8:11], s41 offen offset:0 lds
s_add_u32 s41, s42, 687104
buffer_load_dwordx4 v13, s[8:11], s41 offen offset:1024 lds
s_add_u32 s41, s42, 718848
buffer_load_dwordx4 v12, s[8:11], s41 offen offset:2048 lds
s_add_u32 s41, s42, 750592
buffer_load_dwordx4 v13, s[8:11], s41 offen offset:3072 lds
s_waitcnt vmcnt(24)
ds_read_b64_tr_b16 v[224:225], v4 offset:24576
ds_read_b64_tr_b16 v[226:227], v4 offset:24832
ds_read_b64_tr_b16 v[228:229], v4 offset:28672
ds_read_b64_tr_b16 v[230:231], v4 offset:28928
ds_read_b64_tr_b16 v[232:233], v5 offset:24576
ds_read_b64_tr_b16 v[234:235], v5 offset:24832
ds_read_b64_tr_b16 v[236:237], v5 offset:28672
ds_read_b64_tr_b16 v[238:239], v5 offset:28928
ds_read_b64_tr_b16 v[240:241], v6 offset:24576
ds_read_b64_tr_b16 v[242:243], v6 offset:24832
ds_read_b64_tr_b16 v[244:245], v6 offset:28672
ds_read_b64_tr_b16 v[246:247], v6 offset:28928
ds_read_b64_tr_b16 v[248:249], v7 offset:24576
ds_read_b64_tr_b16 v[250:251], v7 offset:24832
ds_read_b64_tr_b16 v[252:253], v7 offset:28672
ds_read_b64_tr_b16 v[254:255], v7 offset:28928
s_waitcnt lgkmcnt(0)
s_cmp_eq_u32 s76, 5
s_cbranch_scc0 HP_132
buffer_load_dword v127, v126, s[8:11], s77 offen
HP_132:
s_add_u32 m0, s40, 24576
s_add_u32 s41, s42, 786432
buffer_load_dwordx4 v12, s[8:11], s41 offen offset:0 lds
s_add_u32 s41, s42, 818176
buffer_load_dwordx4 v13, s[8:11], s41 offen offset:1024 lds
s_add_u32 s41, s42, 849920
buffer_load_dwordx4 v12, s[8:11], s41 offen offset:2048 lds
s_add_u32 s41, s42, 881664
buffer_load_dwordx4 v13, s[8:11], s41 offen offset:3072 lds
s_add_u32 m0, s40, 28672
s_add_u32 s41, s42, 917504
buffer_load_dwordx4 v12, s[8:11], s41 offen offset:0 lds
s_add_u32 s41, s42, 949248
buffer_load_dwordx4 v13, s[8:11], s41 offen offset:1024 lds
s_add_u32 s41, s42, 980992
buffer_load_dwordx4 v12, s[8:11], s41 offen offset:2048 lds
s_add_u32 s41, s42, 1012736
buffer_load_dwordx4 v13, s[8:11], s41 offen offset:3072 lds
s_waitcnt vmcnt(24)
ds_read_b64_tr_b16 a[0:1], v14 offset:0
ds_read_b64_tr_b16 a[2:3], v16 offset:0
ds_read_b64_tr_b16 a[4:5], v14 offset:4096
ds_read_b64_tr_b16 a[6:7], v16 offset:4096
ds_read_b64_tr_b16 a[8:9], v15 offset:0
ds_read_b64_tr_b16 a[10:11], v17 offset:0
ds_read_b64_tr_b16 a[12:13], v15 offset:4096
ds_read_b64_tr_b16 a[14:15], v17 offset:4096
ds_read_b64_tr_b16 a[16:17], v14 offset:512
ds_read_b64_tr_b16 a[18:19], v16 offset:512
ds_read_b64_tr_b16 a[20:21], v14 offset:4608
ds_read_b64_tr_b16 a[22:23], v16 offset:4608
ds_read_b64_tr_b16 a[24:25], v15 offset:512
ds_read_b64_tr_b16 a[26:27], v17 offset:512
ds_read_b64_tr_b16 a[28:29], v15 offset:4608
ds_read_b64_tr_b16 a[30:31], v17 offset:4608
s_waitcnt lgkmcnt(0)
s_cmp_eq_u32 s76, 6
s_cbranch_scc0 HP_133
buffer_load_dword v127, v126, s[8:11], s77 offen
HP_133:
s_add_u32 m0, s40, 0
s_add_u32 s41, s42, 1048576
buffer_load_dwordx4 v12, s[8:11], s41 offen offset:0 lds
s_add_u32 s41, s42, 1080320
buffer_load_dwordx4 v13, s[8:11], s41 offen offset:1024 lds
s_add_u32 s41, s42, 1112064
buffer_load_dwordx4 v12, s[8:11], s41 offen offset:2048 lds
s_add_u32 s41, s42, 1143808
buffer_load_dwordx4 v13, s[8:11], s41 offen offset:3072 lds
s_add_u32 m0, s40, 4096
s_add_u32 s41, s42, 1179648
buffer_load_dwordx4 v12, s[8:11], s41 offen offset:0 lds
s_add_u32 s41, s42, 1211392
buffer_load_dwordx4 v13, s[8:11], s41 offen offset:1024 lds
s_add_u32 s41, s42, 1243136
buffer_load_dwordx4 v12, s[8:11], s41 offen offset:2048 lds
s_add_u32 s41, s42, 1274880
buffer_load_dwordx4 v13, s[8:11], s41 offen offset:3072 lds
s_waitcnt vmcnt(24)
ds_read_b64_tr_b16 a[32:33], v14 offset:8192
ds_read_b64_tr_b16 a[34:35], v16 offset:8192
ds_read_b64_tr_b16 a[36:37], v14 offset:12288
ds_read_b64_tr_b16 a[38:39], v16 offset:12288
ds_read_b64_tr_b16 a[40:41], v15 offset:8192
ds_read_b64_tr_b16 a[42:43], v17 offset:8192
ds_read_b64_tr_b16 a[44:45], v15 offset:12288
ds_read_b64_tr_b16 a[46:47], v17 offset:12288
ds_read_b64_tr_b16 a[48:49], v14 offset:8704
ds_read_b64_tr_b16 a[50:51], v16 offset:8704
ds_read_b64_tr_b16 a[52:53], v14 offset:12800
ds_read_b64_tr_b16 a[54:55], v16 offset:12800
ds_read_b64_tr_b16 a[56:57], v15 offset:8704
ds_read_b64_tr_b16 a[58:59], v17 offset:8704
ds_read_b64_tr_b16 a[60:61], v15 offset:12800
ds_read_b64_tr_b16 a[62:63], v17 offset:12800
s_waitcnt lgkmcnt(0)
s_cmp_eq_u32 s76, 7
s_cbranch_scc0 HP_134
buffer_load_dword v127, v126, s[8:11], s77 offen
HP_134:
s_add_u32 m0, s40, 8192
s_add_u32 s41, s42, 1310720
buffer_load_dwordx4 v12, s[8:11], s41 offen offset:0 lds
s_add_u32 s41, s42, 1342464
buffer_load_dwordx4 v13, s[8:11], s41 offen offset:1024 lds
s_add_u32 s41, s42, 1374208
buffer_load_dwordx4 v12, s[8:11], s41 offen offset:2048 lds
s_add_u32 s41, s42, 1405952
buffer_load_dwordx4 v13, s[8:11], s41 offen offset:3072 lds
s_add_u32 m0, s40, 12288
s_add_u32 s41, s42, 1441792
buffer_load_dwordx4 v12, s[8:11], s41 offen offset:0 lds
s_add_u32 s41, s42, 1473536
buffer_load_dwordx4 v13, s[8:11], s41 offen offset:1024 lds
s_add_u32 s41, s42, 1505280
buffer_load_dwordx4 v12, s[8:11], s41 offen offset:2048 lds
s_add_u32 s41, s42, 1537024
buffer_load_dwordx4 v13, s[8:11], s41 offen offset:3072 lds
s_waitcnt vmcnt(24)
ds_read_b64_tr_b16 a[64:65], v14 offset:16384
ds_read_b64_tr_b16 a[66:67], v16 offset:16384
ds_read_b64_tr_b16 a[68:69], v14 offset:20480
ds_read_b64_tr_b16 a[70:71], v16 offset:20480
ds_read_b64_tr_b16 a[72:73], v15 offset:16384
ds_read_b64_tr_b16 a[74:75], v17 offset:16384
ds_read_b64_tr_b16 a[76:77], v15 offset:20480
ds_read_b64_tr_b16 a[78:79], v17 offset:20480
ds_read_b64_tr_b16 a[80:81], v14 offset:16896
ds_read_b64_tr_b16 a[82:83], v16 offset:16896
ds_read_b64_tr_b16 a[84:85], v14 offset:20992
ds_read_b64_tr_b16 a[86:87], v16 offset:20992
ds_read_b64_tr_b16 a[88:89], v15 offset:16896
ds_read_b64_tr_b16 a[90:91], v17 offset:16896
ds_read_b64_tr_b16 a[92:93], v15 offset:20992
ds_read_b64_tr_b16 a[94:95], v17 offset:20992
s_waitcnt lgkmcnt(0)
s_add_u32 m0, s40, 16384
s_add_u32 s41, s42, 1572864
buffer_load_dwordx4 v12, s[8:11], s41 offen offset:0 lds
s_add_u32 s41, s42, 1604608
buffer_load_dwordx4 v13, s[8:11], s41 offen offset:1024 lds
s_add_u32 s41, s42, 1636352
buffer_load_dwordx4 v12, s[8:11], s41 offen offset:2048 lds
s_add_u32 s41, s42, 1668096
buffer_load_dwordx4 v13, s[8:11], s41 offen offset:3072 lds
s_add_u32 m0, s40, 20480
s_add_u32 s41, s42, 1703936
buffer_load_dwordx4 v12, s[8:11], s41 offen offset:0 lds
s_add_u32 s41, s42, 1735680
buffer_load_dwordx4 v13, s[8:11], s41 offen offset:1024 lds
s_add_u32 s41, s42, 1767424
buffer_load_dwordx4 v12, s[8:11], s41 offen offset:2048 lds
s_add_u32 s41, s42, 1799168
buffer_load_dwordx4 v13, s[8:11], s41 offen offset:3072 lds
s_barrier
s_lshl_b32 s43, s24, 12
s_add_u32 s43, s43, 200
v_mov_b32 v18, 1
v_mov_b32 v19, s43
s_mov_b64 exec, 1
buffer_atomic_add v18, v19, s[16:19], 0 offen sc1
s_mov_b64 exec, -1
s_waitcnt vmcnt(25)
ds_read_b64_tr_b16 a[96:97], v14 offset:24576
ds_read_b64_tr_b16 a[98:99], v16 offset:24576
ds_read_b64_tr_b16 a[100:101], v14 offset:28672
ds_read_b64_tr_b16 a[102:103], v16 offset:28672
ds_read_b64_tr_b16 a[104:105], v15 offset:24576
ds_read_b64_tr_b16 a[106:107], v17 offset:24576
ds_read_b64_tr_b16 a[108:109], v15 offset:28672
ds_read_b64_tr_b16 a[110:111], v17 offset:28672
ds_read_b64_tr_b16 a[112:113], v14 offset:25088
ds_read_b64_tr_b16 a[114:115], v16 offset:25088
ds_read_b64_tr_b16 a[116:117], v14 offset:29184
ds_read_b64_tr_b16 a[118:119], v16 offset:29184
ds_read_b64_tr_b16 a[120:121], v15 offset:25088
ds_read_b64_tr_b16 a[122:123], v17 offset:25088
ds_read_b64_tr_b16 a[124:125], v15 offset:29184
ds_read_b64_tr_b16 a[126:127], v17 offset:29184
s_waitcnt lgkmcnt(0)
s_add_u32 m0, s40, 24576
s_add_u32 s41, s42, 1835008
buffer_load_dwordx4 v12, s[8:11], s41 offen offset:0 lds
s_add_u32 s41, s42, 1866752
buffer_load_dwordx4 v13, s[8:11], s41 offen offset:1024 lds
s_add_u32 s41, s42, 1898496
buffer_load_dwordx4 v12, s[8:11], s41 offen offset:2048 lds
s_add_u32 s41, s42, 1930240
buffer_load_dwordx4 v13, s[8:11], s41 offen offset:3072 lds
s_add_u32 m0, s40, 28672
s_add_u32 s41, s42, 1966080
buffer_load_dwordx4 v12, s[8:11], s41 offen offset:0 lds
s_add_u32 s41, s42, 1997824
buffer_load_dwordx4 v13, s[8:11], s41 offen offset:1024 lds
s_add_u32 s41, s42, 2029568
buffer_load_dwordx4 v12, s[8:11], s41 offen offset:2048 lds
s_add_u32 s41, s42, 2061312
buffer_load_dwordx4 v13, s[8:11], s41 offen offset:3072 lds
s_waitcnt vmcnt(25)
ds_read_b64_tr_b16 a[128:129], v14 offset:0
ds_read_b64_tr_b16 a[130:131], v16 offset:0
ds_read_b64_tr_b16 a[132:133], v14 offset:4096
ds_read_b64_tr_b16 a[134:135], v16 offset:4096
ds_read_b64_tr_b16 a[136:137], v15 offset:0
ds_read_b64_tr_b16 a[138:139], v17 offset:0
ds_read_b64_tr_b16 a[140:141], v15 offset:4096
ds_read_b64_tr_b16 a[142:143], v17 offset:4096
ds_read_b64_tr_b16 a[144:145], v14 offset:512
ds_read_b64_tr_b16 a[146:147], v16 offset:512
ds_read_b64_tr_b16 a[148:149], v14 offset:4608
ds_read_b64_tr_b16 a[150:151], v16 offset:4608
ds_read_b64_tr_b16 a[152:153], v15 offset:512
ds_read_b64_tr_b16 a[154:155], v17 offset:512
ds_read_b64_tr_b16 a[156:157], v15 offset:4608
ds_read_b64_tr_b16 a[158:159], v17 offset:4608
s_waitcnt lgkmcnt(0)
s_waitcnt vmcnt(17)
ds_read_b64_tr_b16 a[160:161], v14 offset:8192
ds_read_b64_tr_b16 a[162:163], v16 offset:8192
ds_read_b64_tr_b16 a[164:165], v14 offset:12288
ds_read_b64_tr_b16 a[166:167], v16 offset:12288
ds_read_b64_tr_b16 a[168:169], v15 offset:8192
ds_read_b64_tr_b16 a[170:171], v17 offset:8192
ds_read_b64_tr_b16 a[172:173], v15 offset:12288
ds_read_b64_tr_b16 a[174:175], v17 offset:12288
ds_read_b64_tr_b16 a[176:177], v14 offset:8704
ds_read_b64_tr_b16 a[178:179], v16 offset:8704
ds_read_b64_tr_b16 a[180:181], v14 offset:12800
ds_read_b64_tr_b16 a[182:183], v16 offset:12800
ds_read_b64_tr_b16 a[184:185], v15 offset:8704
ds_read_b64_tr_b16 a[186:187], v17 offset:8704
ds_read_b64_tr_b16 a[188:189], v15 offset:12800
ds_read_b64_tr_b16 a[190:191], v17 offset:12800
s_waitcnt lgkmcnt(0)
s_waitcnt vmcnt(9)
ds_read_b64_tr_b16 a[192:193], v14 offset:16384
ds_read_b64_tr_b16 a[194:195], v16 offset:16384
ds_read_b64_tr_b16 a[196:197], v14 offset:20480
ds_read_b64_tr_b16 a[198:199], v16 offset:20480
ds_read_b64_tr_b16 a[200:201], v15 offset:16384
ds_read_b64_tr_b16 a[202:203], v17 offset:16384
ds_read_b64_tr_b16 a[204:205], v15 offset:20480
ds_read_b64_tr_b16 a[206:207], v17 offset:20480
ds_read_b64_tr_b16 a[208:209], v14 offset:16896
ds_read_b64_tr_b16 a[210:211], v16 offset:16896
ds_read_b64_tr_b16 a[212:213], v14 offset:20992
ds_read_b64_tr_b16 a[214:215], v16 offset:20992
ds_read_b64_tr_b16 a[216:217], v15 offset:16896
ds_read_b64_tr_b16 a[218:219], v17 offset:16896
ds_read_b64_tr_b16 a[220:221], v15 offset:20992
ds_read_b64_tr_b16 a[222:223], v17 offset:20992
s_waitcnt lgkmcnt(0)
s_waitcnt vmcnt(0)
ds_read_b64_tr_b16 a[224:225], v14 offset:24576
ds_read_b64_tr_b16 a[226:227], v16 offset:24576
ds_read_b64_tr_b16 a[228:229], v14 offset:28672
ds_read_b64_tr_b16 a[230:231], v16 offset:28672
ds_read_b64_tr_b16 a[232:233], v15 offset:24576
ds_read_b64_tr_b16 a[234:235], v17 offset:24576
ds_read_b64_tr_b16 a[236:237], v15 offset:28672
ds_read_b64_tr_b16 a[238:239], v17 offset:28672
ds_read_b64_tr_b16 a[240:241], v14 offset:25088
ds_read_b64_tr_b16 a[242:243], v16 offset:25088
ds_read_b64_tr_b16 a[244:245], v14 offset:29184
ds_read_b64_tr_b16 a[246:247], v16 offset:29184
ds_read_b64_tr_b16 a[248:249], v15 offset:25088
ds_read_b64_tr_b16 a[250:251], v17 offset:25088
ds_read_b64_tr_b16 a[252:253], v15 offset:29184
ds_read_b64_tr_b16 a[254:255], v17 offset:29184
s_waitcnt lgkmcnt(0)
s_barrier
v_mov_b32 v13, v20
v_and_b32 v11, 1, v1
v_mov_b32 v2, 0x4444
v_cmp_eq_u32 vcc, 1, v11
v_mov_b32 v11, 0xeeee
s_nop 0
v_cndmask_b32 v2, v2, v11, vcc
v_lshlrev_b32 v3, 4, v1
s_and_b32 s43, s24, 1
s_lshl_b32 s43, s43, 12
s_lshr_b32 s47, s24, 1
s_lshl_b32 s47, s47, 14
s_or_b32 s43, s43, s47
v_add_u32 v4, s43, v3
v_add_u32 v4, 262144, v4
s_lshl_b32 s43, s24, 14
s_lshl_b32 s47, s26, 16
s_add_u32 s43, s43, s47
s_add_u32 s43, s43, 0
v_add_u32 v5, s43, v3
v_add_u32 v12, 4096, v5
v_lshrrev_b32 v16, 5, v1
v_lshlrev_b32 v6, 3, v1
v_lshl_add_u32 v6, v16, 6, v6
s_mul_i32 s43, s24, 2560
v_add_u32 v6, s43, v6
v_lshrrev_b32 v17, 2, v1
v_and_b32 v18, 3, v1
v_lshlrev_b32 v7, 3, v17
v_lshl_add_u32 v7, v18, 7, v7
v_lshrrev_b32 v19, 1, v18
v_lshl_add_u32 v7, v19, 6, v7
s_mul_i32 s43, s24, 640
v_add_u32 v7, s43, v7
v_and_b32 v19, 15, v1
v_lshlrev_b32 v9, 2, v19
v_bfe_u32 v20, v1, 4, 1
v_lshl_add_u32 v9, v20, 8, v9
v_lshl_add_u32 v9, v16, 7, v9
s_lshl_b32 s43, s24, 9
s_add_u32 s43, s43, 16384
v_add_u32 v9, s43, v9
v_lshlrev_b32 v10, 3, v1
v_add_u32 v10, 16384, v10
s_mov_b32 s60, 0
s_mov_b32 s67, -2
s_mov_b32 s68, 0
s_mov_b32 s69, 0
s_mov_b32 s61, 92274688
s_mov_b32 s56, 0
s_lshl_b32 s43, s25, 5
s_add_u32 s43, s43, s27
v_mov_b32 v16, 0
s_mov_b32 s44, 0
CW_137:
buffer_load_dwordx4 v[20:23], v16, s[16:19], 0 offen offset:192 sc1
s_waitcnt vmcnt(0)
v_readfirstlane_b32 s43, v20
v_readfirstlane_b32 s47, v21
v_readfirstlane_b32 s48, v22
s_lshl_b32 s43, s43, 20
s_lshl_b32 s48, s48, 11
s_or_b32 s43, s43, s48
s_and_b32 s48, s47, 0x7ff
s_or_b32 s43, s43, s48
s_cmp_eq_u32 s43, 4392959
s_cbranch_scc1 CWOK_138
s_sleep 8
s_add_u32 s44, s44, 1
s_cmp_lt_u32 s44, 40000
s_cbranch_scc1 CW_137
s_branch V_END
CWOK_138:
v_mul_u32_u24 v16, 43, v1
v_lshrrev_b32 v16, 8, v16
v_add_u32 v16, 16, v16
v_lshrrev_b32 v16, v16, v21
v_and_b32 v16, 1, v16
v_cmp_ne_u32 s[86:87], 0, v16
s_nop 3
s_bitcmp1_b64 s[86:87], 0
s_cselect_b32 s50, 8192, 0
s_add_u32 s50, s50, s61
s_mov_b32 s62, 92274688
s_mov_b32 s60, -1
s_mov_b32 s69, 16
s_mov_b32 s53, 8
v_mov_b32 v64, 0
v_mov_b32 v65, 0
v_mov_b32 v66, 0
v_mov_b32 v67, 0
v_mov_b32 v68, 0
v_mov_b32 v69, 0
v_mov_b32 v70, 0
v_mov_b32 v71, 0
v_mov_b32 v72, 0
v_mov_b32 v73, 0
v_mov_b32 v74, 0
v_mov_b32 v75, 0
v_mov_b32 v76, 0
v_mov_b32 v77, 0
v_mov_b32 v78, 0
v_mov_b32 v79, 0
V_LOOP:
buffer_load_dwordx4 v[16:19], v4, s[4:7], s50 offen offset:0 sc1
s_nop 3
buffer_load_dwordx4 v[20:23], v4, s[4:7], s50 offen offset:1024 sc1
s_nop 3
buffer_load_dwordx4 v[24:27], v4, s[4:7], s50 offen offset:2048 sc1
s_nop 3
buffer_load_dwordx4 v[28:31], v4, s[4:7], s50 offen offset:3072 sc1
s_add_u32 s60, s60, 1
s_mov_b32 s65, s50
s_mov_b32 s44, 0
s_add_u32 s61, s62, 0x200000
s_add_u32 s56, s56, 1
s_cmp_eq_u32 s56, 6
s_cselect_b32 s47, 32768, 0
s_cselect_b32 s56, 0, s56
s_add_u32 s62, s62, s47
s_add_u32 s62, s62, 344064
s_add_u32 s47, s60, 1
s_bitcmp1_b64 s[86:87], s47
s_cselect_b32 s50, 8192, 0
s_add_u32 s50, s50, s62
v_mov_b32 v80, 0
v_mov_b32 v81, 0
v_mov_b32 v82, 0
v_mov_b32 v83, 0
v_mov_b32 v84, 0
v_mov_b32 v85, 0
v_mov_b32 v86, 0
v_mov_b32 v87, 0
v_mov_b32 v88, 0
v_mov_b32 v89, 0
v_mov_b32 v90, 0
v_mov_b32 v91, 0
v_mov_b32 v92, 0
v_mov_b32 v93, 0
v_mov_b32 v94, 0
v_mov_b32 v95, 0
s_waitcnt vmcnt(3)
v_cmp_eq_u32 vcc, -1, v16
s_cbranch_vccnz VR_139
VC_143:
v_smfmac_f32_16x16x64_bf16 v[64:67], v[16:19], v[128:135], v2
v_smfmac_f32_16x16x64_bf16 v[68:71], v[16:19], v[136:143], v2
v_smfmac_f32_16x16x64_bf16 v[72:75], v[16:19], v[144:151], v2
s_waitcnt vmcnt(2)
v_cmp_eq_u32 vcc, -1, v20
v_smfmac_f32_16x16x64_bf16 v[76:79], v[16:19], v[152:159], v2
s_cbranch_vccnz VR_140
VC_144:
v_smfmac_f32_16x16x64_bf16 v[64:67], v[20:23], v[160:167], v2
v_smfmac_f32_16x16x64_bf16 v[68:71], v[20:23], v[168:175], v2
v_smfmac_f32_16x16x64_bf16 v[72:75], v[20:23], v[176:183], v2
s_waitcnt vmcnt(1)
v_cmp_eq_u32 vcc, -1, v24
v_smfmac_f32_16x16x64_bf16 v[76:79], v[20:23], v[184:191], v2
s_cbranch_vccnz VR_141
VC_145:
v_smfmac_f32_16x16x64_bf16 v[64:67], v[24:27], v[192:199], v2
v_smfmac_f32_16x16x64_bf16 v[68:71], v[24:27], v[200:207], v2
v_smfmac_f32_16x16x64_bf16 v[72:75], v[24:27], v[208:215], v2
s_waitcnt vmcnt(0)
v_cmp_eq_u32 vcc, -1, v28
v_smfmac_f32_16x16x64_bf16 v[76:79], v[24:27], v[216:223], v2
s_cbranch_vccnz VR_142
VC_146:
v_smfmac_f32_16x16x64_bf16 v[64:67], v[28:31], v[224:231], v2
v_smfmac_f32_16x16x64_bf16 v[68:71], v[28:31], v[232:239], v2
v_smfmac_f32_16x16x64_bf16 v[72:75], v[28:31], v[240:247], v2
v_smfmac_f32_16x16x64_bf16 v[76:79], v[28:31], v[248:255], v2
v_add_f32 v96, v64, v65
v_add_f32 v97, v66, v67
ds_write_b64 v6, v[96:97] offset:0
s_nop 0
v_add_f32 v98, v68, v69
v_add_f32 v99, v70, v71
ds_write_b64 v6, v[98:99] offset:640
s_nop 0
v_add_f32 v100, v72, v73
v_add_f32 v101, v74, v75
ds_write_b64 v6, v[100:101] offset:1280
v_add_f32 v102, v76, v77
v_add_f32 v103, v78, v79
ds_write_b64 v6, v[102:103] offset:1920
s_waitcnt lgkmcnt(0)
s_barrier
ds_read_b64 v[96:97], v7 offset:0
ds_read_b64 v[98:99], v7 offset:2560
ds_read_b64 v[100:101], v7 offset:5120
ds_read_b64 v[102:103], v7 offset:7680
v_mov_b32 v64, 0
v_mov_b32 v65, 0
v_mov_b32 v66, 0
v_mov_b32 v67, 0
v_mov_b32 v68, 0
v_mov_b32 v69, 0
v_mov_b32 v70, 0
v_mov_b32 v71, 0
v_mov_b32 v72, 0
v_mov_b32 v73, 0
v_mov_b32 v74, 0
v_mov_b32 v75, 0
v_mov_b32 v76, 0
v_mov_b32 v77, 0
v_mov_b32 v78, 0
v_mov_b32 v79, 0
s_waitcnt lgkmcnt(2)
v_pk_add_f32 v[96:97], v[96:97], v[98:99]
s_waitcnt lgkmcnt(0)
v_pk_add_f32 v[100:101], v[100:101], v[102:103]
v_pk_add_f32 v[96:97], v[96:97], v[100:101]
v_cvt_pk_bf16_f32 v104, v96, v97
v_min_u32 v104, s67, v104
s_nop 1
v_mov_b32_dpp v105, v104 quad_perm:[1,1,1,1] row_mask:0xf bank_mask:0xf
v_mov_b32_dpp v106, v104 quad_perm:[2,2,2,2] row_mask:0xf bank_mask:0xf
v_mov_b32_dpp v107, v104 quad_perm:[3,3,3,3] row_mask:0xf bank_mask:0xf
buffer_store_dwordx4 v[104:107], v8, s[4:7], s65 offen sc1
s_cmp_eq_u32 s60, 63
s_cbranch_scc1 V_END
s_cmp_eq_u32 s24, 0
s_cbranch_scc1 ARD_147
s_cmp_ge_u32 s60, 58
s_cbranch_scc1 ARD_147
s_add_u32 s47, s60, 6
s_bitcmp1_b64 s[86:87], s47
s_cselect_b32 s47, 8192, 0
s_add_u32 s47, s47, s61
buffer_store_dwordx4 v[120:123], v8, s[4:7], s47 offen sc1
buffer_store_dwordx4 v[120:123], v0, s[4:7], s47 offen sc1
s_cmp_lg_u32 s24, 2
s_cbranch_scc1 ARN_148
buffer_store_dwordx4 v[120:123], v13, s[4:7], s47 offen sc1
ARN_148:
s_cmp_lg_u32 s24, 3
s_cbranch_scc1 ARD_147
s_sub_u32 s47, s47, 768
buffer_store_dwordx4 v[120:123], v8, s[4:7], s47 offen sc1
ARD_147:
s_mov_b32 s44, 0
s_cmp_lg_u32 s24, 0
s_cbranch_scc1 GO_149
v_mov_b32 v32, -1
v_mov_b32 v33, -1
v_mov_b32 v34, -1
v_mov_b32 v35, -1
v_mov_b32 v36, -1
v_mov_b32 v37, -1
v_mov_b32 v38, -1
s_mov_b32 s71, s69
.p2alignl 4, 0xBF800000
BK_152:
s_sub_u32 s71, s71, 1
s_cbranch_scc0 BK_152
s_memrealtime s[88:89]
s_mov_b32 s53, 0
PT_150:
s_waitcnt lgkmcnt(0)
s_lshl_b32 s54, s88, 5
s_memrealtime s[88:89]
s_and_b32 s54, s54, 0x380
s_add_u32 s54, s54, s65
buffer_load_dword v32, v0, s[4:7], s54 offen sc1
s_add_u32 s53, s53, 1
s_waitcnt vmcnt(6)
v_cmp_eq_u32 vcc, -1, v33
s_cbranch_vccz GOT_151
s_waitcnt lgkmcnt(0)
s_lshl_b32 s54, s88, 5
s_memrealtime s[88:89]
s_and_b32 s54, s54, 0x380
s_add_u32 s54, s54, s65
buffer_load_dword v33, v0, s[4:7], s54 offen sc1
s_add_u32 s53, s53, 1
s_waitcnt vmcnt(6)
v_cmp_eq_u32 vcc, -1, v34
s_cbranch_vccz GOT_151
s_waitcnt lgkmcnt(0)
s_lshl_b32 s54, s88, 5
s_memrealtime s[88:89]
s_and_b32 s54, s54, 0x380
s_add_u32 s54, s54, s65
buffer_load_dword v34, v0, s[4:7], s54 offen sc1
s_add_u32 s53, s53, 1
s_waitcnt vmcnt(6)
v_cmp_eq_u32 vcc, -1, v35
s_cbranch_vccz GOT_151
s_waitcnt lgkmcnt(0)
s_lshl_b32 s54, s88, 5
s_memrealtime s[88:89]
s_and_b32 s54, s54, 0x380
s_add_u32 s54, s54, s65
buffer_load_dword v35, v0, s[4:7], s54 offen sc1
s_add_u32 s53, s53, 1
s_waitcnt vmcnt(6)
v_cmp_eq_u32 vcc, -1, v36
s_cbranch_vccz GOT_151
s_waitcnt lgkmcnt(0)
s_lshl_b32 s54, s88, 5
s_memrealtime s[88:89]
s_and_b32 s54, s54, 0x380
s_add_u32 s54, s54, s65
buffer_load_dword v36, v0, s[4:7], s54 offen sc1
s_add_u32 s53, s53, 1
s_waitcnt vmcnt(6)
v_cmp_eq_u32 vcc, -1, v37
s_cbranch_vccz GOT_151
s_waitcnt lgkmcnt(0)
s_lshl_b32 s54, s88, 5
s_memrealtime s[88:89]
s_and_b32 s54, s54, 0x380
s_add_u32 s54, s54, s65
buffer_load_dword v37, v0, s[4:7], s54 offen sc1
s_add_u32 s53, s53, 1
s_waitcnt vmcnt(6)
v_cmp_eq_u32 vcc, -1, v38
s_cbranch_vccz GOT_151
s_waitcnt lgkmcnt(0)
s_lshl_b32 s54, s88, 5
s_memrealtime s[88:89]
s_and_b32 s54, s54, 0x380
s_add_u32 s54, s54, s65
buffer_load_dword v38, v0, s[4:7], s54 offen sc1
s_add_u32 s53, s53, 1
s_waitcnt vmcnt(6)
v_cmp_eq_u32 vcc, -1, v32
s_cbranch_vccz GOT_151
s_cmp_lt_u32 s53, 1000
s_cbranch_scc1 PT_150
GOT_151:
GO_149:
s_barrier
buffer_load_dwordx4 v[32:35], v5, s[4:7], s65 offen offset:0 sc1
s_nop 7
buffer_load_dwordx4 v[36:39], v5, s[4:7], s65 offen offset:1024 sc1
s_nop 7
buffer_load_dwordx4 v[40:43], v5, s[4:7], s65 offen offset:2048 sc1
s_nop 7
buffer_load_dwordx4 v[44:47], v5, s[4:7], s65 offen offset:3072 sc1
s_nop 7
buffer_load_dwordx4 v[48:51], v12, s[4:7], s65 offen offset:0 sc1
s_nop 7
buffer_load_dwordx4 v[52:55], v12, s[4:7], s65 offen offset:1024 sc1
s_nop 7
buffer_load_dwordx4 v[56:59], v12, s[4:7], s65 offen offset:2048 sc1
s_nop 7
buffer_load_dwordx4 v[60:63], v12, s[4:7], s65 offen offset:3072 sc1
s_sub_u32 s53, s53, 8
s_min_i32 s53, s53, 1
s_add_u32 s69, s69, s53
s_max_i32 s69, s69, 0
s_waitcnt vmcnt(7)
v_cmp_eq_u32 vcc, -1, v32
s_cbranch_vccnz OR_153
OC_161:
v_smfmac_f32_16x16x64_bf16 v[80:83], v[32:35], a[0:7], v2
v_smfmac_f32_16x16x64_bf16 v[84:87], v[32:35], a[8:15], v2
v_smfmac_f32_16x16x64_bf16 v[88:91], v[32:35], a[16:23], v2
s_waitcnt vmcnt(6)
v_cmp_eq_u32 vcc, -1, v36
v_smfmac_f32_16x16x64_bf16 v[92:95], v[32:35], a[24:31], v2
s_cbranch_vccnz OR_154
OC_162:
v_smfmac_f32_16x16x64_bf16 v[80:83], v[36:39], a[32:39], v2
v_smfmac_f32_16x16x64_bf16 v[84:87], v[36:39], a[40:47], v2
v_smfmac_f32_16x16x64_bf16 v[88:91], v[36:39], a[48:55], v2
s_waitcnt vmcnt(5)
v_cmp_eq_u32 vcc, -1, v40
v_smfmac_f32_16x16x64_bf16 v[92:95], v[36:39], a[56:63], v2
s_cbranch_vccnz OR_155
OC_163:
v_smfmac_f32_16x16x64_bf16 v[80:83], v[40:43], a[64:71], v2
v_smfmac_f32_16x16x64_bf16 v[84:87], v[40:43], a[72:79], v2
v_smfmac_f32_16x16x64_bf16 v[88:91], v[40:43], a[80:87], v2
s_waitcnt vmcnt(4)
v_cmp_eq_u32 vcc, -1, v44
v_smfmac_f32_16x16x64_bf16 v[92:95], v[40:43], a[88:95], v2
s_cbranch_vccnz OR_156
OC_164:
v_smfmac_f32_16x16x64_bf16 v[80:83], v[44:47], a[96:103], v2
buffer_store_dword v1, v119, s[4:7], s50 offen sc1
v_smfmac_f32_16x16x64_bf16 v[84:87], v[44:47], a[104:111], v2
v_smfmac_f32_16x16x64_bf16 v[88:91], v[44:47], a[112:119], v2
s_waitcnt vmcnt(4)
v_cmp_eq_u32 vcc, -1, v48
v_smfmac_f32_16x16x64_bf16 v[92:95], v[44:47], a[120:127], v2
s_cbranch_vccnz OR_157
OC_165:
v_smfmac_f32_16x16x64_bf16 v[80:83], v[48:51], a[128:135], v2
v_smfmac_f32_16x16x64_bf16 v[84:87], v[48:51], a[136:143], v2
v_smfmac_f32_16x16x64_bf16 v[88:91], v[48:51], a[144:151], v2
s_waitcnt vmcnt(3)
v_cmp_eq_u32 vcc, -1, v52
v_smfmac_f32_16x16x64_bf16 v[92:95], v[48:51], a[152:159], v2
s_cbranch_vccnz OR_158
OC_166:
v_smfmac_f32_16x16x64_bf16 v[80:83], v[52:55], a[160:167], v2
v_smfmac_f32_16x16x64_bf16 v[84:87], v[52:55], a[168:175], v2
v_smfmac_f32_16x16x64_bf16 v[88:91], v[52:55], a[176:183], v2
s_waitcnt vmcnt(2)
v_cmp_eq_u32 vcc, -1, v56
v_smfmac_f32_16x16x64_bf16 v[92:95], v[52:55], a[184:191], v2
s_cbranch_vccnz OR_159
OC_167:
v_smfmac_f32_16x16x64_bf16 v[80:83], v[56:59], a[192:199], v2
v_smfmac_f32_16x16x64_bf16 v[84:87], v[56:59], a[200:207], v2
v_smfmac_f32_16x16x64_bf16 v[88:91], v[56:59], a[208:215], v2
s_waitcnt vmcnt(1)
v_cmp_eq_u32 vcc, -1, v60
v_smfmac_f32_16x16x64_bf16 v[92:95], v[56:59], a[216:223], v2
s_cbranch_vccnz OR_160
OC_168:
v_smfmac_f32_16x16x64_bf16 v[80:83], v[60:63], a[224:231], v2
v_smfmac_f32_16x16x64_bf16 v[84:87], v[60:63], a[232:239], v2
v_smfmac_f32_16x16x64_bf16 v[88:91], v[60:63], a[240:247], v2
v_smfmac_f32_16x16x64_bf16 v[92:95], v[60:63], a[248:255], v2
s_mov_b32 exec_hi, 0
v_add_f32 v96, v80, v81
v_add_f32 v98, v82, v83
s_nop 0
v_add_f32 v97, v84, v85
v_add_f32 v99, v86, v87
s_not_b64 exec, exec
s_nop 0
v_add_f32 v96, v88, v89
v_add_f32 v98, v90, v91
v_add_f32 v97, v92, v93
v_add_f32 v99, v94, v95
s_mov_b64 exec, -1
s_nop 0
v_permlane32_swap_b32 v96, v98
v_permlane32_swap_b32 v97, v99
s_nop 0
v_add_f32 v96, v96, v98
v_add_f32 v97, v97, v99
ds_write2_b32 v9, v96, v97 offset0:0 offset1:16
s_waitcnt lgkmcnt(0)
s_barrier
s_cmp_lg_u32 s24, 0
s_cbranch_scc1 V_NEXT
ds_read_b64 v[96:97], v10 offset:0
ds_read_b64 v[98:99], v10 offset:512
ds_read_b64 v[100:101], v10 offset:1024
ds_read_b64 v[102:103], v10 offset:1536
s_waitcnt lgkmcnt(2)
v_pk_add_f32 v[96:97], v[96:97], v[98:99]
s_waitcnt lgkmcnt(0)
v_pk_add_f32 v[100:101], v[100:101], v[102:103]
v_pk_add_f32 v[96:97], v[96:97], v[100:101]
v_cvt_pk_bf16_f32 v112, v96, v97
v_min_u32 v112, s67, v112
s_nop 1
v_mov_b32_dpp v113, v112 quad_perm:[1,1,1,1] row_mask:0xf bank_mask:0xf
v_mov_b32_dpp v114, v112 quad_perm:[2,2,2,2] row_mask:0xf bank_mask:0xf
v_mov_b32_dpp v115, v112 quad_perm:[3,3,3,3] row_mask:0xf bank_mask:0xf
buffer_store_dwordx4 v[112:115], v13, s[4:7], s50 offen sc1
V_NEXT:
s_barrier
s_nop 15
s_nop 15
s_nop 15
s_nop 15
s_nop 15
s_nop 15
s_nop 15
s_nop 7
s_branch V_LOOP
VR_139:
s_add_u32 s68, s68, 1
s_add_u32 s44, s44, 1
s_cmp_gt_u32 s44, 30000
s_cbranch_scc1 V_END
buffer_load_dwordx4 v[16:19], v4, s[4:7], s65 offen offset:0 sc1
buffer_load_dwordx4 v[20:23], v4, s[4:7], s65 offen offset:1024 sc1
buffer_load_dwordx4 v[24:27], v4, s[4:7], s65 offen offset:2048 sc1
buffer_load_dwordx4 v[28:31], v4, s[4:7], s65 offen offset:3072 sc1
s_waitcnt vmcnt(0)
v_cmp_eq_u32 vcc, -1, v16
s_cbranch_vccz VC_143
s_branch VR_139
VR_140:
s_add_u32 s68, s68, 1
s_add_u32 s44, s44, 1
s_cmp_gt_u32 s44, 30000
s_cbranch_scc1 V_END
buffer_load_dwordx4 v[20:23], v4, s[4:7], s65 offen offset:1024 sc1
buffer_load_dwordx4 v[24:27], v4, s[4:7], s65 offen offset:2048 sc1
buffer_load_dwordx4 v[28:31], v4, s[4:7], s65 offen offset:3072 sc1
s_waitcnt vmcnt(0)
v_cmp_eq_u32 vcc, -1, v20
s_cbranch_vccz VC_144
s_branch VR_140
VR_141:
s_add_u32 s68, s68, 1
s_add_u32 s44, s44, 1
s_cmp_gt_u32 s44, 30000
s_cbranch_scc1 V_END
buffer_load_dwordx4 v[24:27], v4, s[4:7], s65 offen offset:2048 sc1
buffer_load_dwordx4 v[28:31], v4, s[4:7], s65 offen offset:3072 sc1
s_waitcnt vmcnt(0)
v_cmp_eq_u32 vcc, -1, v24
s_cbranch_vccz VC_145
s_branch VR_141
VR_142:
s_add_u32 s68, s68, 1
s_add_u32 s44, s44, 1
s_cmp_gt_u32 s44, 30000
s_cbranch_scc1 V_END
buffer_load_dwordx4 v[28:31], v4, s[4:7], s65 offen offset:3072 sc1
s_waitcnt vmcnt(0)
v_cmp_eq_u32 vcc, -1, v28
s_cbranch_vccz VC_146
s_branch VR_142
OR_153:
s_add_u32 s68, s68, 65536
s_add_u32 s44, s44, 1
s_cmp_gt_u32 s44, 30000
s_cbranch_scc1 V_END
buffer_load_dwordx4 v[32:35], v5, s[4:7], s65 offen offset:0 sc1
buffer_load_dwordx4 v[36:39], v5, s[4:7], s65 offen offset:1024 sc1
buffer_load_dwordx4 v[40:43], v5, s[4:7], s65 offen offset:2048 sc1
buffer_load_dwordx4 v[44:47], v5, s[4:7], s65 offen offset:3072 sc1
buffer_load_dwordx4 v[48:51], v12, s[4:7], s65 offen offset:0 sc1
buffer_load_dwordx4 v[52:55], v12, s[4:7], s65 offen offset:1024 sc1
buffer_load_dwordx4 v[56:59], v12, s[4:7], s65 offen offset:2048 sc1
buffer_load_dwordx4 v[60:63], v12, s[4:7], s65 offen offset:3072 sc1
s_waitcnt vmcnt(0)
v_cmp_eq_u32 vcc, -1, v32
s_cbranch_vccz OC_161
s_branch OR_153
OR_154:
s_add_u32 s68, s68, 65536
s_add_u32 s44, s44, 1
s_cmp_gt_u32 s44, 30000
s_cbranch_scc1 V_END
buffer_load_dwordx4 v[36:39], v5, s[4:7], s65 offen offset:1024 sc1
buffer_load_dwordx4 v[40:43], v5, s[4:7], s65 offen offset:2048 sc1
buffer_load_dwordx4 v[44:47], v5, s[4:7], s65 offen offset:3072 sc1
buffer_load_dwordx4 v[48:51], v12, s[4:7], s65 offen offset:0 sc1
buffer_load_dwordx4 v[52:55], v12, s[4:7], s65 offen offset:1024 sc1
buffer_load_dwordx4 v[56:59], v12, s[4:7], s65 offen offset:2048 sc1
buffer_load_dwordx4 v[60:63], v12, s[4:7], s65 offen offset:3072 sc1
s_waitcnt vmcnt(0)
v_cmp_eq_u32 vcc, -1, v36
s_cbranch_vccz OC_162
s_branch OR_154
OR_155:
s_add_u32 s68, s68, 65536
s_add_u32 s44, s44, 1
s_cmp_gt_u32 s44, 30000
s_cbranch_scc1 V_END
buffer_load_dwordx4 v[40:43], v5, s[4:7], s65 offen offset:2048 sc1
buffer_load_dwordx4 v[44:47], v5, s[4:7], s65 offen offset:3072 sc1
buffer_load_dwordx4 v[48:51], v12, s[4:7], s65 offen offset:0 sc1
buffer_load_dwordx4 v[52:55], v12, s[4:7], s65 offen offset:1024 sc1
buffer_load_dwordx4 v[56:59], v12, s[4:7], s65 offen offset:2048 sc1
buffer_load_dwordx4 v[60:63], v12, s[4:7], s65 offen offset:3072 sc1
s_waitcnt vmcnt(0)
v_cmp_eq_u32 vcc, -1, v40
s_cbranch_vccz OC_163
s_branch OR_155
OR_156:
s_add_u32 s68, s68, 65536
s_add_u32 s44, s44, 1
s_cmp_gt_u32 s44, 30000
s_cbranch_scc1 V_END
buffer_load_dwordx4 v[44:47], v5, s[4:7], s65 offen offset:3072 sc1
buffer_load_dwordx4 v[48:51], v12, s[4:7], s65 offen offset:0 sc1
buffer_load_dwordx4 v[52:55], v12, s[4:7], s65 offen offset:1024 sc1
buffer_load_dwordx4 v[56:59], v12, s[4:7], s65 offen offset:2048 sc1
buffer_load_dwordx4 v[60:63], v12, s[4:7], s65 offen offset:3072 sc1
s_waitcnt vmcnt(0)
v_cmp_eq_u32 vcc, -1, v44
s_cbranch_vccz OC_164
s_branch OR_156
OR_157:
s_add_u32 s68, s68, 65536
s_add_u32 s44, s44, 1
s_cmp_gt_u32 s44, 30000
s_cbranch_scc1 V_END
buffer_load_dwordx4 v[48:51], v12, s[4:7], s65 offen offset:0 sc1
buffer_load_dwordx4 v[52:55], v12, s[4:7], s65 offen offset:1024 sc1
buffer_load_dwordx4 v[56:59], v12, s[4:7], s65 offen offset:2048 sc1
buffer_load_dwordx4 v[60:63], v12, s[4:7], s65 offen offset:3072 sc1
s_waitcnt vmcnt(0)
v_cmp_eq_u32 vcc, -1, v48
s_cbranch_vccz OC_165
s_branch OR_157
OR_158:
s_add_u32 s68, s68, 65536
s_add_u32 s44, s44, 1
s_cmp_gt_u32 s44, 30000
s_cbranch_scc1 V_END
buffer_load_dwordx4 v[52:55], v12, s[4:7], s65 offen offset:1024 sc1
buffer_load_dwordx4 v[56:59], v12, s[4:7], s65 offen offset:2048 sc1
buffer_load_dwordx4 v[60:63], v12, s[4:7], s65 offen offset:3072 sc1
s_waitcnt vmcnt(0)
v_cmp_eq_u32 vcc, -1, v52
s_cbranch_vccz OC_166
s_branch OR_158
OR_159:
s_add_u32 s68, s68, 65536
s_add_u32 s44, s44, 1
s_cmp_gt_u32 s44, 30000
s_cbranch_scc1 V_END
buffer_load_dwordx4 v[56:59], v12, s[4:7], s65 offen offset:2048 sc1
buffer_load_dwordx4 v[60:63], v12, s[4:7], s65 offen offset:3072 sc1
s_waitcnt vmcnt(0)
v_cmp_eq_u32 vcc, -1, v56
s_cbranch_vccz OC_167
s_branch OR_159
OR_160:
s_add_u32 s68, s68, 65536
s_add_u32 s44, s44, 1
s_cmp_gt_u32 s44, 30000
s_cbranch_scc1 V_END
buffer_load_dwordx4 v[60:63], v12, s[4:7], s65 offen offset:3072 sc1
s_waitcnt vmcnt(0)
v_cmp_eq_u32 vcc, -1, v60
s_cbranch_vccz OC_168
s_branch OR_160
V_END:
s_endpgm
R_A:
v_lshlrev_b32 v3, 4, v1
v_and_b32 v11, 15, v1
v_lshrrev_b32 v12, 4, v1
v_add_u32 v5, 4096, v3
v_and_b32 v13, 7, v1
v_lshlrev_b32 v7, 4, v13
v_lshl_add_u32 v7, v12, 7, v7
v_lshlrev_b32 v8, 4, v11
v_and_b32 v13, 1, v12
v_lshl_add_u32 v8, v13, 3, v8
v_mov_b32 v14, 0xf149f2ca
v_mov_b32 v15, 0
v_lshlrev_b32 v12, 2, v12
v_add_u32 v13, 0, v12
v_cmp_le_u32 vcc, v13, v11
s_nop 1
v_cndmask_b32 v16, v14, v15, vcc
v_add_u32 v13, 1, v12
v_cmp_le_u32 vcc, v13, v11
s_nop 1
v_cndmask_b32 v17, v14, v15, vcc
v_add_u32 v13, 2, v12
v_cmp_le_u32 vcc, v13, v11
s_nop 1
v_cndmask_b32 v18, v14, v15, vcc
v_add_u32 v13, 3, v12
v_cmp_le_u32 vcc, v13, v11
s_nop 1
v_cndmask_b32 v19, v14, v15, vcc
v_cmp_gt_u32 vcc, 32, v1
s_nop 1
v_cndmask_b32 v20, v14, v15, vcc
v_cndmask_b32 v21, v14, v15, vcc
v_cndmask_b32 v22, v14, v15, vcc
v_cndmask_b32 v23, v14, v15, vcc
v_mov_b32 v28, 0x3f803f80
v_mov_b32 v29, 0x3f803f80
v_mov_b32 v30, 0x3f803f80
v_mov_b32 v31, 0x3f803f80
s_lshl_b32 s49, s27, 13
s_lshl_b32 s43, s24, 18
s_add_u32 s49, s49, s43
s_add_u32 s50, s49, 25165824
s_add_u32 s51, s49, 41943040
s_add_u32 s52, s49, 58720256
s_and_b32 s49, s27, 3
s_lshl_b32 s49, s49, 11
s_lshr_b32 s47, s27, 2
s_lshl_b32 s47, s47, 14
s_add_u32 s62, s49, s47
s_add_u32 s62, s62, 92405760
s_lshl_b32 s63, s27, 11
s_add_u32 s63, s63, 115343360
s_lshl_b32 s49, s27, 12
s_add_u32 s49, s49, s43
s_add_u32 s55, s49, 75497472
s_and_b32 s49, s27, 3
s_lshl_b32 s49, s49, 2
s_lshr_b32 s43, s27, 2
s_lshl_b32 s43, s43, 7
s_add_u32 s49, s49, s43
s_lshl_b32 s43, s24, 10
s_add_u32 s49, s49, s43
s_add_u32 s56, s49, 119603200
s_lshr_b32 s57, s27, 1
s_lshl_b32 s57, s57, 7
s_add_u32 s57, s57, 119578624
s_mov_b32 s60, s24
s_mov_b32 s66, 0x3e0293ee
v_mov_b32 v9, 0
v_mov_b32 v10, 1
v_mov_b32 v6, 1536
v_mov_b32 v32, 0
s_mov_b32 s44, 0
CW_169:
buffer_load_dwordx4 v[36:39], v32, s[16:19], 0 offen offset:192 sc1
s_waitcnt vmcnt(0)
v_readfirstlane_b32 s43, v36
v_readfirstlane_b32 s47, v37
v_readfirstlane_b32 s48, v38
s_lshl_b32 s43, s43, 20
s_lshl_b32 s48, s48, 11
s_or_b32 s43, s43, s48
s_and_b32 s48, s47, 0x7ff
s_or_b32 s43, s43, s48
s_cmp_eq_u32 s43, 4392959
s_cbranch_scc1 CWOK_170
s_sleep 8
s_add_u32 s44, s44, 1
s_cmp_lt_u32 s44, 40000
s_cbranch_scc1 CW_169
s_branch M_END
CWOK_170:
v_mul_u32_u24 v32, 43, v1
v_lshrrev_b32 v32, 8, v32
v_add_u32 v32, 16, v32
v_lshrrev_b32 v32, v32, v37
v_and_b32 v32, 1, v32
v_cmp_ne_u32 s[86:87], 0, v32
s_nop 3
s_mov_b32 s67, -2
s_mov_b32 s68, 0
s_cmp_lg_u32 s24, 3
s_cbranch_scc1 AAR_171
s_add_u32 s47, s55, 15728640
s_add_u32 s48, s47, 131072
v_mov_b32 v32, -1
v_mov_b32 v33, -1
v_mov_b32 v34, -1
v_mov_b32 v35, -1
buffer_store_dwordx4 v[32:35], v3, s[4:7], s47 offen offset:0 sc1
buffer_store_dwordx4 v[32:35], v3, s[4:7], s47 offen offset:1024 sc1
buffer_store_dwordx4 v[32:35], v3, s[4:7], s47 offen offset:2048 sc1
buffer_store_dwordx4 v[32:35], v3, s[4:7], s47 offen offset:3072 sc1
buffer_store_dwordx4 v[32:35], v3, s[4:7], s48 offen offset:0 sc1
buffer_store_dwordx4 v[32:35], v3, s[4:7], s48 offen offset:1024 sc1
buffer_store_dwordx4 v[32:35], v3, s[4:7], s48 offen offset:2048 sc1
buffer_store_dwordx4 v[32:35], v3, s[4:7], s48 offen offset:3072 sc1
s_waitcnt vmcnt(0)
AAR_171:
A_LOOP:
s_mul_i32 s43, s60, 43
s_lshr_b32 s43, s43, 8
s_mul_i32 s43, s43, 32768
s_mul_i32 s54, s60, 344064
s_add_u32 s54, s54, s43
s_add_u32 s54, s54, s62
s_bitcmp1_b64 s[86:87], s60
s_cselect_b32 s43, 8192, 0
s_add_u32 s54, s54, s43
s_lshl_b32 s53, s60, 16
s_add_u32 s53, s53, s63
s_cmp_lt_u32 s60, 8
s_cselect_b32 s43, 0, 4
s_and_b32 s43, s43, s60
s_cbranch_scc1 ANF_177
s_lshr_b32 s45, s60, 3
s_lshl_b32 s45, s45, 11
s_add_u32 s45, s45, s57
s_add_u32 s46, s45, 8
s_lshr_b32 s47, s60, 1
s_add_u32 s47, s47, 8
s_lshl_b32 s47, s47, 11
s_add_u32 s47, s47, s57
s_and_b32 s43, s27, 1
s_lshl_b32 s43, s43, 4
s_add_u32 s47, s47, s43
s_cmp_lt_u32 s60, 8
s_cselect_b32 s45, s47, s45
v_lshlrev_b32 v62, 2, v1
v_cmp_gt_u32 vcc, 2, v1
v_mov_b32 v63, 2147483648
s_nop 0
v_cndmask_b32 v62, v63, v62, vcc
s_mov_b64 s[42:43], vcc
s_mov_b32 s44, 0
PF_178:
buffer_load_dword v63, v62, s[4:7], s45 offen sc1
s_waitcnt vmcnt(0)
v_cmp_ne_u32 vcc, 0, v63
s_cmp_eq_u64 vcc, s[42:43]
s_cbranch_scc1 PFOK_179
s_sleep 8
s_add_u32 s44, s44, 1
s_cmp_lt_u32 s44, 40000
s_cbranch_scc1 PF_178
s_branch M_END
PFOK_179:
v_lshlrev_b32 v62, 2, v1
v_cmp_gt_u32 vcc, 1, v1
v_mov_b32 v63, 2147483648
s_nop 0
v_cndmask_b32 v62, v63, v62, vcc
s_mov_b64 s[42:43], vcc
s_mov_b32 s44, 0
PF_180:
buffer_load_dword v63, v62, s[4:7], s46 offen sc1
s_waitcnt vmcnt(0)
v_cmp_ne_u32 vcc, 0, v63
s_cmp_eq_u64 vcc, s[42:43]
s_cbranch_scc1 PFOK_181
s_sleep 8
s_add_u32 s44, s44, 1
s_cmp_lt_u32 s44, 40000
s_cbranch_scc1 PF_180
s_branch M_END
PFOK_181:
ANF_177:
buffer_load_dwordx4 v[32:35], v3, s[4:7], s50 offen offset:0 sc1
buffer_load_dwordx4 v[36:39], v3, s[4:7], s50 offen offset:1024 sc1
buffer_load_dwordx4 v[40:43], v3, s[4:7], s50 offen offset:2048 sc1
buffer_load_dwordx4 v[44:47], v3, s[4:7], s50 offen offset:3072 sc1
buffer_load_dwordx4 v[48:51], v5, s[4:7], s50 offen offset:0 sc1
buffer_load_dwordx4 v[52:55], v5, s[4:7], s50 offen offset:1024 sc1
buffer_load_dwordx4 v[56:59], v5, s[4:7], s50 offen offset:2048 sc1
buffer_load_dwordx4 v[60:63], v5, s[4:7], s50 offen offset:3072 sc1
buffer_load_dwordx4 v[64:67], v3, s[4:7], s51 offen offset:0 sc1
buffer_load_dwordx4 v[68:71], v3, s[4:7], s51 offen offset:1024 sc1
buffer_load_dwordx4 v[72:75], v3, s[4:7], s51 offen offset:2048 sc1
buffer_load_dwordx4 v[76:79], v3, s[4:7], s51 offen offset:3072 sc1
buffer_load_dwordx4 v[80:83], v5, s[4:7], s51 offen offset:0 sc1
buffer_load_dwordx4 v[84:87], v5, s[4:7], s51 offen offset:1024 sc1
buffer_load_dwordx4 v[88:91], v5, s[4:7], s51 offen offset:2048 sc1
buffer_load_dwordx4 v[92:95], v5, s[4:7], s51 offen offset:3072 sc1
buffer_load_dwordx4 v[128:131], v7, s[4:7], s53 offen offset:0 sc1
buffer_load_dwordx4 v[132:135], v7, s[4:7], s53 offen offset:512 sc1
buffer_load_dwordx4 v[136:139], v7, s[4:7], s53 offen offset:1024 sc1
buffer_load_dwordx4 v[140:143], v7, s[4:7], s53 offen offset:1536 sc1
buffer_load_dwordx4 v[96:99], v3, s[4:7], s52 offen offset:0 sc1
buffer_load_dwordx4 v[100:103], v3, s[4:7], s52 offen offset:1024 sc1
buffer_load_dwordx4 v[104:107], v3, s[4:7], s52 offen offset:2048 sc1
buffer_load_dwordx4 v[108:111], v3, s[4:7], s52 offen offset:3072 sc1
buffer_load_dwordx4 v[112:115], v5, s[4:7], s52 offen offset:0 sc1
buffer_load_dwordx4 v[116:119], v5, s[4:7], s52 offen offset:1024 sc1
buffer_load_dwordx4 v[120:123], v5, s[4:7], s52 offen offset:2048 sc1
buffer_load_dwordx4 v[124:127], v5, s[4:7], s52 offen offset:3072 sc1
s_mov_b32 s44, 0
s_waitcnt vmcnt(12)
v_mfma_f32_16x16x32_bf16 v[160:163], v[64:67], v[32:35], v[16:19]
v_mfma_f32_16x16x32_bf16 v[168:171], v[64:67], v[48:51], 0
v_mfma_f32_16x16x32_bf16 v[172:175], v[80:83], v[48:51], v[16:19]
v_mfma_f32_16x16x32_bf16 v[160:163], v[68:71], v[36:39], v[160:163]
v_mfma_f32_16x16x32_bf16 v[168:171], v[68:71], v[52:55], v[168:171]
v_mfma_f32_16x16x32_bf16 v[172:175], v[84:87], v[52:55], v[172:175]
v_mfma_f32_16x16x32_bf16 v[160:163], v[72:75], v[40:43], v[160:163]
v_mfma_f32_16x16x32_bf16 v[168:171], v[72:75], v[56:59], v[168:171]
v_mfma_f32_16x16x32_bf16 v[172:175], v[88:91], v[56:59], v[172:175]
v_mfma_f32_16x16x32_bf16 v[160:163], v[76:79], v[44:47], v[160:163]
v_mfma_f32_16x16x32_bf16 v[168:171], v[76:79], v[60:63], v[168:171]
v_mfma_f32_16x16x32_bf16 v[172:175], v[92:95], v[60:63], v[172:175]
s_waitcnt vmcnt(8)
v_max3_u32 v11, v128, v132, v136
v_max_u32 v11, v11, v140
v_cmp_eq_u32 vcc, -1, v11
s_cbranch_vccnz ARK_173
ACK_174:
buffer_load_dwordx2 v[144:145], v8, s[4:7], s54 offen offset:0 sc1
buffer_load_dwordx2 v[146:147], v8, s[4:7], s54 offen offset:256 sc1
buffer_load_dwordx2 v[148:149], v8, s[4:7], s54 offen offset:512 sc1
buffer_load_dwordx2 v[150:151], v8, s[4:7], s54 offen offset:768 sc1
buffer_load_dwordx2 v[152:153], v8, s[4:7], s54 offen offset:1024 sc1
buffer_load_dwordx2 v[154:155], v8, s[4:7], s54 offen offset:1280 sc1
buffer_load_dwordx2 v[156:157], v8, s[4:7], s54 offen offset:1536 sc1
buffer_load_dwordx2 v[158:159], v8, s[4:7], s54 offen offset:1792 sc1
ACK2_182:
v_mfma_f32_16x16x32_bf16 v[164:167], v[128:131], v[32:35], v[20:23]
v_mfma_f32_16x16x32_bf16 v[176:179], v[128:131], v[48:51], v[20:23]
v_mfma_f32_16x16x32_bf16 v[164:167], v[132:135], v[36:39], v[164:167]
v_mfma_f32_16x16x32_bf16 v[176:179], v[132:135], v[52:55], v[176:179]
v_mfma_f32_16x16x32_bf16 v[164:167], v[136:139], v[40:43], v[164:167]
v_mfma_f32_16x16x32_bf16 v[176:179], v[136:139], v[56:59], v[176:179]
v_mfma_f32_16x16x32_bf16 v[164:167], v[140:143], v[44:47], v[164:167]
v_mfma_f32_16x16x32_bf16 v[176:179], v[140:143], v[60:63], v[176:179]
s_nop 2
v_max3_f32 v12, v160, v161, v162
v_max3_f32 v14, v168, v169, v170
v_max3_f32 v15, v171, v172, v173
v_max3_f32 v14, v14, v174, v175
v_max3_f32 v12, v12, v163, v164
v_max3_f32 v13, v165, v166, v167
v_max3_f32 v14, v14, v15, v176
v_max3_f32 v15, v177, v178, v179
v_max_f32 v12, v12, v13
v_max_f32 v14, v14, v15
v_mov_b32 v13, v12
v_mov_b32 v15, v14
s_nop 1
v_permlane32_swap_b32 v12, v13
v_permlane32_swap_b32 v14, v15
s_nop 0
v_max_f32 v12, v12, v13
v_max_f32 v14, v14, v15
v_mov_b32 v13, v12
v_mov_b32 v15, v14
s_nop 1
v_permlane16_swap_b32 v12, v13
v_permlane16_swap_b32 v14, v15
s_nop 0
v_max_f32 v12, v12, v13
v_max_f32 v14, v14, v15
v_mul_f32 v12, s66, v12
v_mul_f32 v14, s66, v14
v_fma_f32 v160, v160, s66, -v12
v_fma_f32 v161, v161, s66, -v12
v_fma_f32 v162, v162, s66, -v12
v_fma_f32 v163, v163, s66, -v12
v_fma_f32 v164, v164, s66, -v12
v_fma_f32 v165, v165, s66, -v12
v_fma_f32 v166, v166, s66, -v12
v_fma_f32 v167, v167, s66, -v12
v_fma_f32 v168, v168, s66, -v14
v_fma_f32 v169, v169, s66, -v14
v_fma_f32 v170, v170, s66, -v14
v_fma_f32 v171, v171, s66, -v14
v_fma_f32 v172, v172, s66, -v14
v_fma_f32 v173, v173, s66, -v14
v_fma_f32 v174, v174, s66, -v14
v_fma_f32 v175, v175, s66, -v14
v_fma_f32 v176, v176, s66, -v14
v_fma_f32 v177, v177, s66, -v14
v_fma_f32 v178, v178, s66, -v14
v_fma_f32 v179, v179, s66, -v14
v_exp_f32 v160, v160
v_exp_f32 v161, v161
v_exp_f32 v162, v162
v_exp_f32 v163, v163
v_exp_f32 v164, v164
v_exp_f32 v165, v165
v_exp_f32 v166, v166
v_exp_f32 v167, v167
v_exp_f32 v168, v168
v_exp_f32 v169, v169
v_exp_f32 v170, v170
v_exp_f32 v171, v171
v_exp_f32 v172, v172
v_exp_f32 v173, v173
v_exp_f32 v174, v174
v_exp_f32 v175, v175
v_exp_f32 v176, v176
v_exp_f32 v177, v177
v_exp_f32 v178, v178
v_exp_f32 v179, v179
v_cvt_pk_bf16_f32 v180, v160, v161
v_cvt_pk_bf16_f32 v181, v162, v163
v_cvt_pk_bf16_f32 v182, v164, v165
v_cvt_pk_bf16_f32 v183, v166, v167
v_cvt_pk_bf16_f32 v184, v168, v169
v_cvt_pk_bf16_f32 v185, v170, v171
v_cvt_pk_bf16_f32 v186, v172, v173
v_cvt_pk_bf16_f32 v187, v174, v175
v_cvt_pk_bf16_f32 v188, v176, v177
v_cvt_pk_bf16_f32 v189, v178, v179
s_waitcnt vmcnt(8)
v_mfma_f32_16x16x16_bf16 v[192:195], v[28:29], v[180:181], 0
v_mfma_f32_16x16x32_bf16 v[196:199], v[28:31], v[184:187], 0
v_mfma_f32_16x16x16_bf16 v[200:203], v[96:97], v[180:181], 0
v_mfma_f32_16x16x32_bf16 v[32:35], v[96:99], v[184:187], 0
v_mfma_f32_16x16x16_bf16 v[204:207], v[100:101], v[180:181], 0
v_mfma_f32_16x16x32_bf16 v[36:39], v[100:103], v[184:187], 0
v_mfma_f32_16x16x16_bf16 v[208:211], v[104:105], v[180:181], 0
v_mfma_f32_16x16x32_bf16 v[40:43], v[104:107], v[184:187], 0
v_mfma_f32_16x16x16_bf16 v[212:215], v[108:109], v[180:181], 0
v_mfma_f32_16x16x32_bf16 v[44:47], v[108:111], v[184:187], 0
v_mfma_f32_16x16x16_bf16 v[216:219], v[112:113], v[180:181], 0
v_mfma_f32_16x16x32_bf16 v[48:51], v[112:115], v[184:187], 0
v_mfma_f32_16x16x16_bf16 v[220:223], v[116:117], v[180:181], 0
v_mfma_f32_16x16x32_bf16 v[52:55], v[116:119], v[184:187], 0
v_mfma_f32_16x16x16_bf16 v[224:227], v[120:121], v[180:181], 0
v_mfma_f32_16x16x32_bf16 v[56:59], v[120:123], v[184:187], 0
v_mfma_f32_16x16x16_bf16 v[228:231], v[124:125], v[180:181], 0
v_mfma_f32_16x16x32_bf16 v[60:63], v[124:127], v[184:187], 0
v_mfma_f32_16x16x16_bf16 v[192:195], v[28:29], v[182:183], v[192:195]
v_mfma_f32_16x16x16_bf16 v[196:199], v[28:29], v[188:189], v[196:199]
s_waitcnt vmcnt(0)
v_max3_u32 v11, v144, v146, v148
v_max3_u32 v11, v11, v150, v152
v_max3_u32 v11, v11, v154, v156
v_max_u32 v11, v11, v158
v_cmp_eq_u32 vcc, -1, v11
s_cbranch_vccnz ARV_175
ACV_176:
v_mfma_f32_16x16x16_bf16 v[200:203], v[144:145], v[182:183], v[200:203]
v_mfma_f32_16x16x16_bf16 v[204:207], v[146:147], v[182:183], v[204:207]
v_mfma_f32_16x16x16_bf16 v[208:211], v[148:149], v[182:183], v[208:211]
v_mfma_f32_16x16x16_bf16 v[212:215], v[150:151], v[182:183], v[212:215]
v_mfma_f32_16x16x16_bf16 v[216:219], v[152:153], v[182:183], v[216:219]
v_mfma_f32_16x16x16_bf16 v[220:223], v[154:155], v[182:183], v[220:223]
v_mfma_f32_16x16x16_bf16 v[224:227], v[156:157], v[182:183], v[224:227]
v_mfma_f32_16x16x16_bf16 v[228:231], v[158:159], v[182:183], v[228:231]
v_rcp_f32 v192, v192
v_rcp_f32 v196, v196
v_mfma_f32_16x16x16_bf16 v[32:35], v[144:145], v[188:189], v[32:35]
v_mfma_f32_16x16x16_bf16 v[36:39], v[146:147], v[188:189], v[36:39]
v_mfma_f32_16x16x16_bf16 v[40:43], v[148:149], v[188:189], v[40:43]
v_mfma_f32_16x16x16_bf16 v[44:47], v[150:151], v[188:189], v[44:47]
v_mfma_f32_16x16x16_bf16 v[48:51], v[152:153], v[188:189], v[48:51]
v_mfma_f32_16x16x16_bf16 v[52:55], v[154:155], v[188:189], v[52:55]
v_mfma_f32_16x16x16_bf16 v[56:59], v[156:157], v[188:189], v[56:59]
v_mfma_f32_16x16x16_bf16 v[60:63], v[158:159], v[188:189], v[60:63]
s_add_u32 s48, s55, 131072
v_pk_mul_f32 v[200:201], v[200:201], v[192:193] op_sel_hi:[1,0]
v_pk_mul_f32 v[202:203], v[202:203], v[192:193] op_sel_hi:[1,0]
v_pk_mul_f32 v[204:205], v[204:205], v[192:193] op_sel_hi:[1,0]
v_pk_mul_f32 v[206:207], v[206:207], v[192:193] op_sel_hi:[1,0]
v_cvt_pk_bf16_f32 v64, v200, v201
v_cvt_pk_bf16_f32 v65, v202, v203
v_cvt_pk_bf16_f32 v66, v204, v205
v_cvt_pk_bf16_f32 v67, v206, v207
v_min_u32 v64, s67, v64
buffer_store_dwordx4 v[64:67], v3, s[4:7], s55 offen offset:0 sc1
v_pk_mul_f32 v[208:209], v[208:209], v[192:193] op_sel_hi:[1,0]
v_pk_mul_f32 v[210:211], v[210:211], v[192:193] op_sel_hi:[1,0]
v_pk_mul_f32 v[212:213], v[212:213], v[192:193] op_sel_hi:[1,0]
v_pk_mul_f32 v[214:215], v[214:215], v[192:193] op_sel_hi:[1,0]
v_cvt_pk_bf16_f32 v68, v208, v209
v_cvt_pk_bf16_f32 v69, v210, v211
v_cvt_pk_bf16_f32 v70, v212, v213
v_cvt_pk_bf16_f32 v71, v214, v215
v_min_u32 v68, s67, v68
buffer_store_dwordx4 v[68:71], v3, s[4:7], s55 offen offset:1024 sc1
v_pk_mul_f32 v[216:217], v[216:217], v[192:193] op_sel_hi:[1,0]
v_pk_mul_f32 v[218:219], v[218:219], v[192:193] op_sel_hi:[1,0]
v_pk_mul_f32 v[220:221], v[220:221], v[192:193] op_sel_hi:[1,0]
v_pk_mul_f32 v[222:223], v[222:223], v[192:193] op_sel_hi:[1,0]
v_cvt_pk_bf16_f32 v72, v216, v217
v_cvt_pk_bf16_f32 v73, v218, v219
v_cvt_pk_bf16_f32 v74, v220, v221
v_cvt_pk_bf16_f32 v75, v222, v223
v_min_u32 v72, s67, v72
buffer_store_dwordx4 v[72:75], v3, s[4:7], s55 offen offset:2048 sc1
v_pk_mul_f32 v[224:225], v[224:225], v[192:193] op_sel_hi:[1,0]
v_pk_mul_f32 v[226:227], v[226:227], v[192:193] op_sel_hi:[1,0]
v_pk_mul_f32 v[228:229], v[228:229], v[192:193] op_sel_hi:[1,0]
v_pk_mul_f32 v[230:231], v[230:231], v[192:193] op_sel_hi:[1,0]
v_cvt_pk_bf16_f32 v76, v224, v225
v_cvt_pk_bf16_f32 v77, v226, v227
v_cvt_pk_bf16_f32 v78, v228, v229
v_cvt_pk_bf16_f32 v79, v230, v231
v_min_u32 v76, s67, v76
buffer_store_dwordx4 v[76:79], v3, s[4:7], s55 offen offset:3072 sc1
v_pk_mul_f32 v[32:33], v[32:33], v[196:197] op_sel_hi:[1,0]
v_pk_mul_f32 v[34:35], v[34:35], v[196:197] op_sel_hi:[1,0]
v_pk_mul_f32 v[36:37], v[36:37], v[196:197] op_sel_hi:[1,0]
v_pk_mul_f32 v[38:39], v[38:39], v[196:197] op_sel_hi:[1,0]
v_cvt_pk_bf16_f32 v80, v32, v33
v_cvt_pk_bf16_f32 v81, v34, v35
v_cvt_pk_bf16_f32 v82, v36, v37
v_cvt_pk_bf16_f32 v83, v38, v39
v_min_u32 v80, s67, v80
buffer_store_dwordx4 v[80:83], v3, s[4:7], s48 offen offset:0 sc1
v_pk_mul_f32 v[40:41], v[40:41], v[196:197] op_sel_hi:[1,0]
v_pk_mul_f32 v[42:43], v[42:43], v[196:197] op_sel_hi:[1,0]
v_pk_mul_f32 v[44:45], v[44:45], v[196:197] op_sel_hi:[1,0]
v_pk_mul_f32 v[46:47], v[46:47], v[196:197] op_sel_hi:[1,0]
v_cvt_pk_bf16_f32 v84, v40, v41
v_cvt_pk_bf16_f32 v85, v42, v43
v_cvt_pk_bf16_f32 v86, v44, v45
v_cvt_pk_bf16_f32 v87, v46, v47
v_min_u32 v84, s67, v84
buffer_store_dwordx4 v[84:87], v3, s[4:7], s48 offen offset:1024 sc1
v_pk_mul_f32 v[48:49], v[48:49], v[196:197] op_sel_hi:[1,0]
v_pk_mul_f32 v[50:51], v[50:51], v[196:197] op_sel_hi:[1,0]
v_pk_mul_f32 v[52:53], v[52:53], v[196:197] op_sel_hi:[1,0]
v_pk_mul_f32 v[54:55], v[54:55], v[196:197] op_sel_hi:[1,0]
v_cvt_pk_bf16_f32 v88, v48, v49
v_cvt_pk_bf16_f32 v89, v50, v51
v_cvt_pk_bf16_f32 v90, v52, v53
v_cvt_pk_bf16_f32 v91, v54, v55
v_min_u32 v88, s67, v88
buffer_store_dwordx4 v[88:91], v3, s[4:7], s48 offen offset:2048 sc1
v_pk_mul_f32 v[56:57], v[56:57], v[196:197] op_sel_hi:[1,0]
v_pk_mul_f32 v[58:59], v[58:59], v[196:197] op_sel_hi:[1,0]
v_pk_mul_f32 v[60:61], v[60:61], v[196:197] op_sel_hi:[1,0]
v_pk_mul_f32 v[62:63], v[62:63], v[196:197] op_sel_hi:[1,0]
v_cvt_pk_bf16_f32 v92, v56, v57
v_cvt_pk_bf16_f32 v93, v58, v59
v_cvt_pk_bf16_f32 v94, v60, v61
v_cvt_pk_bf16_f32 v95, v62, v63
v_min_u32 v92, s67, v92
buffer_store_dwordx4 v[92:95], v3, s[4:7], s48 offen offset:3072 sc1
s_add_u32 s60, s60, 4
s_add_u32 s50, s50, 1048576
s_add_u32 s51, s51, 1048576
s_add_u32 s52, s52, 1048576
s_add_u32 s55, s55, 1048576
s_cmp_eq_u32 s60, 67
s_cbranch_scc1 ANW_183
s_waitcnt vmcnt(0)
ANW_183:
s_mov_b64 exec, 1
buffer_store_dword v10, v9, s[4:7], s56 offen sc1
s_mov_b64 exec, -1
s_add_u32 s56, s56, 4096
s_cmp_lt_u32 s60, 64
s_cbranch_scc1 A_LOOP
s_branch M_END2
ARK_173:
s_add_u32 s44, s44, 1
s_cmp_gt_u32 s44, 30000
s_cbranch_scc1 M_END
s_sleep 4
s_cmp_eq_u32 s60, 1000
s_cselect_b32 s47, 65536, 0
s_sub_u32 s47, s53, s47
buffer_load_dword v11, v6, s[4:7], s47 offen sc1
s_waitcnt vmcnt(0)
v_cmp_eq_u32 vcc, -1, v11
s_cbranch_vccnz ARK_173
s_cmp_eq_u32 s60, 1000
s_cbranch_scc1 ARK3_172
buffer_load_dwordx4 v[128:131], v7, s[4:7], s53 offen offset:0 sc1
buffer_load_dwordx4 v[132:135], v7, s[4:7], s53 offen offset:512 sc1
buffer_load_dwordx4 v[136:139], v7, s[4:7], s53 offen offset:1024 sc1
buffer_load_dwordx4 v[140:143], v7, s[4:7], s53 offen offset:1536 sc1
s_waitcnt vmcnt(0)
v_max3_u32 v11, v128, v132, v136
v_max_u32 v11, v11, v140
v_cmp_eq_u32 vcc, -1, v11
s_cbranch_vccz ACK_174
s_branch ARK_173
ARK3_172:
s_add_u32 s44, s44, 1
s_cmp_gt_u32 s44, 30000
s_cbranch_scc1 M_END
buffer_load_dwordx4 v[128:131], v7, s[4:7], s53 offen offset:0 sc1
buffer_load_dwordx4 v[132:135], v7, s[4:7], s53 offen offset:512 sc1
buffer_load_dwordx4 v[136:139], v7, s[4:7], s53 offen offset:1024 sc1
buffer_load_dwordx4 v[140:143], v7, s[4:7], s53 offen offset:1536 sc1
buffer_load_dwordx2 v[144:145], v8, s[4:7], s54 offen offset:0 sc1
buffer_load_dwordx2 v[146:147], v8, s[4:7], s54 offen offset:256 sc1
buffer_load_dwordx2 v[148:149], v8, s[4:7], s54 offen offset:512 sc1
buffer_load_dwordx2 v[150:151], v8, s[4:7], s54 offen offset:768 sc1
buffer_load_dwordx2 v[152:153], v8, s[4:7], s54 offen offset:1024 sc1
buffer_load_dwordx2 v[154:155], v8, s[4:7], s54 offen offset:1280 sc1
buffer_load_dwordx2 v[156:157], v8, s[4:7], s54 offen offset:1536 sc1
buffer_load_dwordx2 v[158:159], v8, s[4:7], s54 offen offset:1792 sc1
s_waitcnt vmcnt(8)
v_max3_u32 v11, v128, v132, v136
v_max_u32 v11, v11, v140
v_cmp_eq_u32 vcc, -1, v11
s_cbranch_vccz ACK2_182
s_waitcnt vmcnt(0)
s_branch ARK3_172
ARV_175:
s_add_u32 s44, s44, 1
s_cmp_gt_u32 s44, 30000
s_cbranch_scc1 M_END
buffer_load_dwordx2 v[144:145], v8, s[4:7], s54 offen offset:0 sc1
buffer_load_dwordx2 v[146:147], v8, s[4:7], s54 offen offset:256 sc1
buffer_load_dwordx2 v[148:149], v8, s[4:7], s54 offen offset:512 sc1
buffer_load_dwordx2 v[150:151], v8, s[4:7], s54 offen offset:768 sc1
buffer_load_dwordx2 v[152:153], v8, s[4:7], s54 offen offset:1024 sc1
buffer_load_dwordx2 v[154:155], v8, s[4:7], s54 offen offset:1280 sc1
buffer_load_dwordx2 v[156:157], v8, s[4:7], s54 offen offset:1536 sc1
buffer_load_dwordx2 v[158:159], v8, s[4:7], s54 offen offset:1792 sc1
s_waitcnt vmcnt(0)
v_max3_u32 v11, v144, v146, v148
v_max3_u32 v11, v11, v150, v152
v_max3_u32 v11, v11, v154, v156
v_max_u32 v11, v11, v158
v_cmp_eq_u32 vcc, -1, v11
s_cbranch_vccz ACV_176
s_branch ARV_175
R_P:
s_load_dwordx2 s[8:9], s[0:1], 40
s_mov_b32 s10, 8388608
s_mov_b32 s11, 0x20000
s_load_dwordx2 s[12:13], s[0:1], 0
s_mov_b32 s14, 4194304
s_mov_b32 s15, 0x20000
s_load_dwordx2 s[16:17], s[0:1], 96
s_mov_b32 s18, 4194304
s_mov_b32 s19, 0x20000
s_lshl_b32 s40, s24, 15
s_lshl_b32 s42, s24, 21
s_lshl_b32 s43, s27, 6
s_add_u32 s42, s42, s43
v_bfe_u32 v8, v1, 4, 1
v_lshlrev_b32 v8, 1, v8
v_xor_b32 v9, v8, v1
v_and_b32 v9, 3, v9
v_lshrrev_b32 v10, 2, v1
v_lshlrev_b32 v2, 11, v10
v_lshl_add_u32 v2, v9, 4, v2
v_lshlrev_b32 v10, 6, v10
v_and_b32 v9, 3, v1
v_lshl_add_u32 v10, v9, 3, v10
v_add_u32 v10, s40, v10
v_lshl_add_u32 v4, v8, 4, v10
v_xor_b32 v8, 2, v8
v_lshl_add_u32 v5, v8, 4, v10
s_lshl_b32 s43, s27, 6
s_add_u32 s43, s43, 119539712
s_cmp_eq_u32 s24, 3
s_cselect_b32 s43, s43, 2147483648
v_mov_b32 v21, 2147483648
v_mov_b32 v22, 3
v_writelane_b32 v21, s43, 0
s_lshl_b32 s43, s24, 2
s_add_u32 s43, s43, 131136
s_cmp_eq_u32 s24, 3
s_cselect_b32 s43, 131072, s43
v_mov_b32 v14, 131072
v_mov_b32 v15, s43
buffer_atomic_add v22, v21, s[4:7], 0 offen sc0 sc1
s_waitcnt lgkmcnt(0)
s_add_u32 m0, s40, 0
s_add_u32 s41, s42, 0
buffer_load_dwordx4 v2, s[8:11], s41 offen offset:0 lds
s_add_u32 s41, s42, 31744
buffer_load_dwordx4 v2, s[8:11], s41 offen offset:1024 lds
s_add_u32 s41, s42, 63488
buffer_load_dwordx4 v2, s[8:11], s41 offen offset:2048 lds
s_add_u32 s41, s42, 95232
buffer_load_dwordx4 v2, s[8:11], s41 offen offset:3072 lds
s_add_u32 m0, s40, 4096
s_add_u32 s41, s42, 131072
buffer_load_dwordx4 v2, s[8:11], s41 offen offset:0 lds
s_add_u32 s41, s42, 162816
buffer_load_dwordx4 v2, s[8:11], s41 offen offset:1024 lds
s_add_u32 s41, s42, 194560
buffer_load_dwordx4 v2, s[8:11], s41 offen offset:2048 lds
s_add_u32 s41, s42, 226304
buffer_load_dwordx4 v2, s[8:11], s41 offen offset:3072 lds
s_add_u32 m0, s40, 8192
s_add_u32 s41, s42, 262144
buffer_load_dwordx4 v2, s[8:11], s41 offen offset:0 lds
s_add_u32 s41, s42, 293888
buffer_load_dwordx4 v2, s[8:11], s41 offen offset:1024 lds
s_add_u32 s41, s42, 325632
buffer_load_dwordx4 v2, s[8:11], s41 offen offset:2048 lds
s_add_u32 s41, s42, 357376
buffer_load_dwordx4 v2, s[8:11], s41 offen offset:3072 lds
s_add_u32 m0, s40, 12288
s_add_u32 s41, s42, 393216
buffer_load_dwordx4 v2, s[8:11], s41 offen offset:0 lds
s_add_u32 s41, s42, 424960
buffer_load_dwordx4 v2, s[8:11], s41 offen offset:1024 lds
s_add_u32 s41, s42, 456704
buffer_load_dwordx4 v2, s[8:11], s41 offen offset:2048 lds
s_add_u32 s41, s42, 488448
buffer_load_dwordx4 v2, s[8:11], s41 offen offset:3072 lds
s_add_u32 m0, s40, 16384
s_add_u32 s41, s42, 524288
buffer_load_dwordx4 v2, s[8:11], s41 offen offset:0 lds
s_add_u32 s41, s42, 556032
buffer_load_dwordx4 v2, s[8:11], s41 offen offset:1024 lds
s_add_u32 s41, s42, 587776
buffer_load_dwordx4 v2, s[8:11], s41 offen offset:2048 lds
s_add_u32 s41, s42, 619520
buffer_load_dwordx4 v2, s[8:11], s41 offen offset:3072 lds
s_add_u32 m0, s40, 20480
s_add_u32 s41, s42, 655360
buffer_load_dwordx4 v2, s[8:11], s41 offen offset:0 lds
s_add_u32 s41, s42, 687104
buffer_load_dwordx4 v2, s[8:11], s41 offen offset:1024 lds
s_add_u32 s41, s42, 718848
buffer_load_dwordx4 v2, s[8:11], s41 offen offset:2048 lds
s_add_u32 s41, s42, 750592
buffer_load_dwordx4 v2, s[8:11], s41 offen offset:3072 lds
s_add_u32 m0, s40, 24576
s_add_u32 s41, s42, 786432
buffer_load_dwordx4 v2, s[8:11], s41 offen offset:0 lds
s_add_u32 s41, s42, 818176
buffer_load_dwordx4 v2, s[8:11], s41 offen offset:1024 lds
s_add_u32 s41, s42, 849920
buffer_load_dwordx4 v2, s[8:11], s41 offen offset:2048 lds
s_add_u32 s41, s42, 881664
buffer_load_dwordx4 v2, s[8:11], s41 offen offset:3072 lds
s_add_u32 m0, s40, 28672
s_add_u32 s41, s42, 917504
buffer_load_dwordx4 v2, s[8:11], s41 offen offset:0 lds
s_add_u32 s41, s42, 949248
buffer_load_dwordx4 v2, s[8:11], s41 offen offset:1024 lds
s_add_u32 s41, s42, 980992
buffer_load_dwordx4 v2, s[8:11], s41 offen offset:2048 lds
s_add_u32 s41, s42, 1012736
buffer_load_dwordx4 v2, s[8:11], s41 offen offset:3072 lds
s_waitcnt vmcnt(24)
ds_read_b64_tr_b16 a[0:1], v4 offset:0
ds_read_b64_tr_b16 a[2:3], v4 offset:1024
ds_read_b64_tr_b16 a[4:5], v5 offset:0
ds_read_b64_tr_b16 a[6:7], v5 offset:1024
ds_read_b64_tr_b16 a[8:9], v4 offset:2048
ds_read_b64_tr_b16 a[10:11], v4 offset:3072
ds_read_b64_tr_b16 a[12:13], v5 offset:2048
ds_read_b64_tr_b16 a[14:15], v5 offset:3072
ds_read_b64_tr_b16 a[16:17], v4 offset:4096
ds_read_b64_tr_b16 a[18:19], v4 offset:5120
ds_read_b64_tr_b16 a[20:21], v5 offset:4096
ds_read_b64_tr_b16 a[22:23], v5 offset:5120
ds_read_b64_tr_b16 a[24:25], v4 offset:6144
ds_read_b64_tr_b16 a[26:27], v4 offset:7168
ds_read_b64_tr_b16 a[28:29], v5 offset:6144
ds_read_b64_tr_b16 a[30:31], v5 offset:7168
s_waitcnt lgkmcnt(0)
s_add_u32 m0, s40, 0
s_add_u32 s41, s42, 1048576
buffer_load_dwordx4 v2, s[8:11], s41 offen offset:0 lds
s_add_u32 s41, s42, 1080320
buffer_load_dwordx4 v2, s[8:11], s41 offen offset:1024 lds
s_add_u32 s41, s42, 1112064
buffer_load_dwordx4 v2, s[8:11], s41 offen offset:2048 lds
s_add_u32 s41, s42, 1143808
buffer_load_dwordx4 v2, s[8:11], s41 offen offset:3072 lds
s_add_u32 m0, s40, 4096
s_add_u32 s41, s42, 1179648
buffer_load_dwordx4 v2, s[8:11], s41 offen offset:0 lds
s_add_u32 s41, s42, 1211392
buffer_load_dwordx4 v2, s[8:11], s41 offen offset:1024 lds
s_add_u32 s41, s42, 1243136
buffer_load_dwordx4 v2, s[8:11], s41 offen offset:2048 lds
s_add_u32 s41, s42, 1274880
buffer_load_dwordx4 v2, s[8:11], s41 offen offset:3072 lds
s_waitcnt vmcnt(24)
ds_read_b64_tr_b16 a[32:33], v4 offset:8192
ds_read_b64_tr_b16 a[34:35], v4 offset:9216
ds_read_b64_tr_b16 a[36:37], v5 offset:8192
ds_read_b64_tr_b16 a[38:39], v5 offset:9216
ds_read_b64_tr_b16 a[40:41], v4 offset:10240
ds_read_b64_tr_b16 a[42:43], v4 offset:11264
ds_read_b64_tr_b16 a[44:45], v5 offset:10240
ds_read_b64_tr_b16 a[46:47], v5 offset:11264
ds_read_b64_tr_b16 a[48:49], v4 offset:12288
ds_read_b64_tr_b16 a[50:51], v4 offset:13312
ds_read_b64_tr_b16 a[52:53], v5 offset:12288
ds_read_b64_tr_b16 a[54:55], v5 offset:13312
ds_read_b64_tr_b16 a[56:57], v4 offset:14336
ds_read_b64_tr_b16 a[58:59], v4 offset:15360
ds_read_b64_tr_b16 a[60:61], v5 offset:14336
ds_read_b64_tr_b16 a[62:63], v5 offset:15360
s_waitcnt lgkmcnt(0)
s_add_u32 m0, s40, 8192
s_add_u32 s41, s42, 1310720
buffer_load_dwordx4 v2, s[8:11], s41 offen offset:0 lds
s_add_u32 s41, s42, 1342464
buffer_load_dwordx4 v2, s[8:11], s41 offen offset:1024 lds
s_add_u32 s41, s42, 1374208
buffer_load_dwordx4 v2, s[8:11], s41 offen offset:2048 lds
s_add_u32 s41, s42, 1405952
buffer_load_dwordx4 v2, s[8:11], s41 offen offset:3072 lds
s_add_u32 m0, s40, 12288
s_add_u32 s41, s42, 1441792
buffer_load_dwordx4 v2, s[8:11], s41 offen offset:0 lds
s_add_u32 s41, s42, 1473536
buffer_load_dwordx4 v2, s[8:11], s41 offen offset:1024 lds
s_add_u32 s41, s42, 1505280
buffer_load_dwordx4 v2, s[8:11], s41 offen offset:2048 lds
s_add_u32 s41, s42, 1537024
buffer_load_dwordx4 v2, s[8:11], s41 offen offset:3072 lds
s_waitcnt vmcnt(24)
ds_read_b64_tr_b16 a[64:65], v4 offset:16384
ds_read_b64_tr_b16 a[66:67], v4 offset:17408
ds_read_b64_tr_b16 a[68:69], v5 offset:16384
ds_read_b64_tr_b16 a[70:71], v5 offset:17408
ds_read_b64_tr_b16 a[72:73], v4 offset:18432
ds_read_b64_tr_b16 a[74:75], v4 offset:19456
ds_read_b64_tr_b16 a[76:77], v5 offset:18432
ds_read_b64_tr_b16 a[78:79], v5 offset:19456
ds_read_b64_tr_b16 a[80:81], v4 offset:20480
ds_read_b64_tr_b16 a[82:83], v4 offset:21504
ds_read_b64_tr_b16 a[84:85], v5 offset:20480
ds_read_b64_tr_b16 a[86:87], v5 offset:21504
ds_read_b64_tr_b16 a[88:89], v4 offset:22528
ds_read_b64_tr_b16 a[90:91], v4 offset:23552
ds_read_b64_tr_b16 a[92:93], v5 offset:22528
ds_read_b64_tr_b16 a[94:95], v5 offset:23552
s_waitcnt lgkmcnt(0)
s_add_u32 m0, s40, 16384
s_add_u32 s41, s42, 1572864
buffer_load_dwordx4 v2, s[8:11], s41 offen offset:0 lds
s_add_u32 s41, s42, 1604608
buffer_load_dwordx4 v2, s[8:11], s41 offen offset:1024 lds
s_add_u32 s41, s42, 1636352
buffer_load_dwordx4 v2, s[8:11], s41 offen offset:2048 lds
s_add_u32 s41, s42, 1668096
buffer_load_dwordx4 v2, s[8:11], s41 offen offset:3072 lds
s_add_u32 m0, s40, 20480
s_add_u32 s41, s42, 1703936
buffer_load_dwordx4 v2, s[8:11], s41 offen offset:0 lds
s_add_u32 s41, s42, 1735680
buffer_load_dwordx4 v2, s[8:11], s41 offen offset:1024 lds
s_add_u32 s41, s42, 1767424
buffer_load_dwordx4 v2, s[8:11], s41 offen offset:2048 lds
s_add_u32 s41, s42, 1799168
buffer_load_dwordx4 v2, s[8:11], s41 offen offset:3072 lds
s_waitcnt vmcnt(24)
ds_read_b64_tr_b16 a[96:97], v4 offset:24576
ds_read_b64_tr_b16 a[98:99], v4 offset:25600
ds_read_b64_tr_b16 a[100:101], v5 offset:24576
ds_read_b64_tr_b16 a[102:103], v5 offset:25600
ds_read_b64_tr_b16 a[104:105], v4 offset:26624
ds_read_b64_tr_b16 a[106:107], v4 offset:27648
ds_read_b64_tr_b16 a[108:109], v5 offset:26624
ds_read_b64_tr_b16 a[110:111], v5 offset:27648
ds_read_b64_tr_b16 a[112:113], v4 offset:28672
ds_read_b64_tr_b16 a[114:115], v4 offset:29696
ds_read_b64_tr_b16 a[116:117], v5 offset:28672
ds_read_b64_tr_b16 a[118:119], v5 offset:29696
ds_read_b64_tr_b16 a[120:121], v4 offset:30720
ds_read_b64_tr_b16 a[122:123], v4 offset:31744
ds_read_b64_tr_b16 a[124:125], v5 offset:30720
ds_read_b64_tr_b16 a[126:127], v5 offset:31744
s_waitcnt lgkmcnt(0)
s_add_u32 m0, s40, 24576
s_add_u32 s41, s42, 1835008
buffer_load_dwordx4 v2, s[8:11], s41 offen offset:0 lds
s_add_u32 s41, s42, 1866752
buffer_load_dwordx4 v2, s[8:11], s41 offen offset:1024 lds
s_add_u32 s41, s42, 1898496
buffer_load_dwordx4 v2, s[8:11], s41 offen offset:2048 lds
s_add_u32 s41, s42, 1930240
buffer_load_dwordx4 v2, s[8:11], s41 offen offset:3072 lds
s_add_u32 m0, s40, 28672
s_add_u32 s41, s42, 1966080
buffer_load_dwordx4 v2, s[8:11], s41 offen offset:0 lds
s_add_u32 s41, s42, 1997824
buffer_load_dwordx4 v2, s[8:11], s41 offen offset:1024 lds
s_add_u32 s41, s42, 2029568
buffer_load_dwordx4 v2, s[8:11], s41 offen offset:2048 lds
s_add_u32 s41, s42, 2061312
buffer_load_dwordx4 v2, s[8:11], s41 offen offset:3072 lds
s_waitcnt vmcnt(24)
ds_read_b64_tr_b16 a[128:129], v4 offset:0
ds_read_b64_tr_b16 a[130:131], v4 offset:1024
ds_read_b64_tr_b16 a[132:133], v5 offset:0
ds_read_b64_tr_b16 a[134:135], v5 offset:1024
ds_read_b64_tr_b16 a[136:137], v4 offset:2048
ds_read_b64_tr_b16 a[138:139], v4 offset:3072
ds_read_b64_tr_b16 a[140:141], v5 offset:2048
ds_read_b64_tr_b16 a[142:143], v5 offset:3072
ds_read_b64_tr_b16 a[144:145], v4 offset:4096
ds_read_b64_tr_b16 a[146:147], v4 offset:5120
ds_read_b64_tr_b16 a[148:149], v5 offset:4096
ds_read_b64_tr_b16 a[150:151], v5 offset:5120
ds_read_b64_tr_b16 a[152:153], v4 offset:6144
ds_read_b64_tr_b16 a[154:155], v4 offset:7168
ds_read_b64_tr_b16 a[156:157], v5 offset:6144
ds_read_b64_tr_b16 a[158:159], v5 offset:7168
s_waitcnt lgkmcnt(0)
s_waitcnt vmcnt(16)
ds_read_b64_tr_b16 a[160:161], v4 offset:8192
ds_read_b64_tr_b16 a[162:163], v4 offset:9216
ds_read_b64_tr_b16 a[164:165], v5 offset:8192
ds_read_b64_tr_b16 a[166:167], v5 offset:9216
ds_read_b64_tr_b16 a[168:169], v4 offset:10240
ds_read_b64_tr_b16 a[170:171], v4 offset:11264
ds_read_b64_tr_b16 a[172:173], v5 offset:10240
ds_read_b64_tr_b16 a[174:175], v5 offset:11264
ds_read_b64_tr_b16 a[176:177], v4 offset:12288
ds_read_b64_tr_b16 a[178:179], v4 offset:13312
ds_read_b64_tr_b16 a[180:181], v5 offset:12288
ds_read_b64_tr_b16 a[182:183], v5 offset:13312
ds_read_b64_tr_b16 a[184:185], v4 offset:14336
ds_read_b64_tr_b16 a[186:187], v4 offset:15360
ds_read_b64_tr_b16 a[188:189], v5 offset:14336
ds_read_b64_tr_b16 a[190:191], v5 offset:15360
s_waitcnt lgkmcnt(0)
s_waitcnt vmcnt(8)
ds_read_b64_tr_b16 a[192:193], v4 offset:16384
ds_read_b64_tr_b16 a[194:195], v4 offset:17408
ds_read_b64_tr_b16 a[196:197], v5 offset:16384
ds_read_b64_tr_b16 a[198:199], v5 offset:17408
ds_read_b64_tr_b16 a[200:201], v4 offset:18432
ds_read_b64_tr_b16 a[202:203], v4 offset:19456
ds_read_b64_tr_b16 a[204:205], v5 offset:18432
ds_read_b64_tr_b16 a[206:207], v5 offset:19456
ds_read_b64_tr_b16 a[208:209], v4 offset:20480
ds_read_b64_tr_b16 a[210:211], v4 offset:21504
ds_read_b64_tr_b16 a[212:213], v5 offset:20480
ds_read_b64_tr_b16 a[214:215], v5 offset:21504
ds_read_b64_tr_b16 a[216:217], v4 offset:22528
ds_read_b64_tr_b16 a[218:219], v4 offset:23552
ds_read_b64_tr_b16 a[220:221], v5 offset:22528
ds_read_b64_tr_b16 a[222:223], v5 offset:23552
s_waitcnt lgkmcnt(0)
s_waitcnt vmcnt(0)
ds_read_b64_tr_b16 a[224:225], v4 offset:24576
ds_read_b64_tr_b16 a[226:227], v4 offset:25600
ds_read_b64_tr_b16 a[228:229], v5 offset:24576
ds_read_b64_tr_b16 a[230:231], v5 offset:25600
ds_read_b64_tr_b16 a[232:233], v4 offset:26624
ds_read_b64_tr_b16 a[234:235], v4 offset:27648
ds_read_b64_tr_b16 a[236:237], v5 offset:26624
ds_read_b64_tr_b16 a[238:239], v5 offset:27648
ds_read_b64_tr_b16 a[240:241], v4 offset:28672
ds_read_b64_tr_b16 a[242:243], v4 offset:29696
ds_read_b64_tr_b16 a[244:245], v5 offset:28672
ds_read_b64_tr_b16 a[246:247], v5 offset:29696
ds_read_b64_tr_b16 a[248:249], v4 offset:30720
ds_read_b64_tr_b16 a[250:251], v4 offset:31744
ds_read_b64_tr_b16 a[252:253], v5 offset:30720
ds_read_b64_tr_b16 a[254:255], v5 offset:31744
s_waitcnt lgkmcnt(0)
s_waitcnt vmcnt(0)
s_mov_b64 exec, 1
ds_write_b32 v15, v22
s_mov_b64 exec, -1
s_waitcnt lgkmcnt(0)
s_barrier
ds_read_b32 v23, v14
v_lshlrev_b32 v3, 4, v1
s_lshl_b32 s43, s24, 11
v_add_u32 v4, s43, v3
s_lshl_b32 s43, s24, 10
v_add_u32 v5, s43, v3
s_lshl_b32 s43, s24, 3
v_add_u32 v6, s43, v3
v_and_b32 v8, 15, v1
v_lshlrev_b32 v7, 11, v8
v_lshrrev_b32 v8, 4, v1
v_lshl_add_u32 v7, v8, 3, v7
s_lshl_b32 s43, s24, 5
s_lshl_b32 s47, s27, 6
s_add_u32 s43, s43, s47
v_add_u32 v7, s43, v7
s_lshl_b32 s66, s24, 15
s_add_u32 s66, s66, 75497472
s_lshl_b32 s67, s27, 10
s_add_u32 s67, s67, 18874368
s_add_u32 s69, s26, 96
s_and_b32 s72, s27, 7
s_mul_i32 s72, s72, 0
s_mov_b32 s71, 0
s_waitcnt lgkmcnt(0)
v_readfirstlane_b32 s70, v23
v_xor_b32 v14, 8192, v14
v_xor_b32 v15, 8192, v15
s_add_u32 s43, s70, s72
s_and_b32 s43, s43, 15
s_andn2_b32 s47, s70, 15
s_or_b32 s47, s47, s43
s_cmp_lt_u32 s70, 96
s_cselect_b32 s65, s47, s69
s_add_u32 s70, s70, 1
s_add_u32 s43, s70, s72
s_and_b32 s43, s43, 15
s_andn2_b32 s47, s70, 15
s_or_b32 s47, s47, s43
s_cmp_lt_u32 s70, 96
s_cselect_b32 s61, s47, s69
s_add_u32 s43, s65, 4
s_cmp_ge_u32 s65, 96
s_cselect_b32 s61, s43, s61
s_add_u32 s70, s70, 1
s_add_u32 s43, s70, s72
s_and_b32 s43, s43, 15
s_andn2_b32 s47, s70, 15
s_or_b32 s47, s47, s43
s_cmp_lt_u32 s70, 96
s_cselect_b32 s68, s47, s69
s_add_u32 s43, s61, 4
s_cmp_ge_u32 s61, 96
s_cselect_b32 s68, s43, s68
s_lshr_b32 s54, s27, 3
s_lshl_b32 s54, s54, 2
s_add_u32 s54, s54, 119541760
v_lshrrev_b32 v8, 2, v1
v_and_b32 v9, 3, v1
v_lshlrev_b32 v9, 2, v9
v_lshl_add_u32 v9, v8, 7, v9
v_mov_b32 v10, 2147483648
v_cmp_gt_u32 s[56:57], 32, v1
v_cmp_gt_u32 s[58:59], 33, v1
P_WAIT:
s_mov_b32 s71, 1
s_lshr_b32 s43, s65, 1
s_lshl_b32 s43, s43, 10
s_add_u32 s43, s43, 119603200
s_lshr_b32 s47, s65, 3
s_lshl_b32 s47, s47, 7
s_add_u32 s47, s47, s54
v_add_u32 v11, s43, v9
v_mov_b32 v12, s47
s_cmp_lt_u32 s65, 128
s_cselect_b64 s[62:63], s[58:59], 0
v_cndmask_b32 v11, v12, v11, s[56:57]
s_nop 0
v_cndmask_b32 v11, v10, v11, s[62:63]
s_mov_b32 s44, 0
P_POLL:
buffer_load_dword v13, v11, s[4:7], 0 offen sc1
s_waitcnt vmcnt(0)
v_cmp_ne_u32 vcc, 0, v13
s_cmp_eq_u64 vcc, s[58:59]
s_cbranch_scc1 P_GO
s_sleep 1
s_add_u32 s44, s44, 1
s_cmp_lt_u32 s44, 80000
s_cbranch_scc1 P_POLL
s_branch M_END
P_GO:
s_lshl_b32 s50, s65, 17
s_add_u32 s50, s50, s66
s_lshl_b32 s55, s65, 15
s_add_u32 s52, s55, s67
s_lshr_b32 s43, s61, 1
s_lshl_b32 s43, s43, 10
s_add_u32 s43, s43, 119603200
s_lshr_b32 s47, s61, 3
s_lshl_b32 s47, s47, 7
s_add_u32 s47, s47, s54
v_add_u32 v11, s43, v9
v_mov_b32 v12, s47
s_cmp_lt_u32 s61, 128
s_cselect_b64 s[62:63], s[58:59], 0
v_cndmask_b32 v11, v12, v11, s[56:57]
s_nop 0
v_cndmask_b32 v11, v10, v11, s[62:63]
buffer_load_dword v13, v11, s[4:7], 0 offen sc1
buffer_load_dwordx2 v[16:17], v6, s[4:7], s52 offen sc1
buffer_load_dwordx2 v[18:19], v7, s[12:15], s55 offen
s_add_u32 s41, s50, 0
buffer_load_dwordx4 v[64:67], v3, s[4:7], s41 offen offset:0 sc1
buffer_load_dwordx4 v[68:71], v3, s[4:7], s41 offen offset:1024 sc1
buffer_load_dwordx4 v[72:75], v3, s[4:7], s41 offen offset:2048 sc1
buffer_load_dwordx4 v[76:79], v3, s[4:7], s41 offen offset:3072 sc1
s_add_u32 s41, s50, 4096
buffer_load_dwordx4 v[80:83], v3, s[4:7], s41 offen offset:0 sc1
buffer_load_dwordx4 v[84:87], v3, s[4:7], s41 offen offset:1024 sc1
buffer_load_dwordx4 v[88:91], v3, s[4:7], s41 offen offset:2048 sc1
buffer_load_dwordx4 v[92:95], v3, s[4:7], s41 offen offset:3072 sc1
s_add_u32 s41, s50, 8192
buffer_load_dwordx4 v[96:99], v3, s[4:7], s41 offen offset:0 sc1
buffer_load_dwordx4 v[100:103], v3, s[4:7], s41 offen offset:1024 sc1
buffer_load_dwordx4 v[104:107], v3, s[4:7], s41 offen offset:2048 sc1
buffer_load_dwordx4 v[108:111], v3, s[4:7], s41 offen offset:3072 sc1
s_add_u32 s41, s50, 12288
buffer_load_dwordx4 v[112:115], v3, s[4:7], s41 offen offset:0 sc1
buffer_load_dwordx4 v[116:119], v3, s[4:7], s41 offen offset:1024 sc1
buffer_load_dwordx4 v[120:123], v3, s[4:7], s41 offen offset:2048 sc1
buffer_load_dwordx4 v[124:127], v3, s[4:7], s41 offen offset:3072 sc1
s_add_u32 s41, s50, 16384
buffer_load_dwordx4 v[128:131], v3, s[4:7], s41 offen offset:0 sc1
buffer_load_dwordx4 v[132:135], v3, s[4:7], s41 offen offset:1024 sc1
buffer_load_dwordx4 v[136:139], v3, s[4:7], s41 offen offset:2048 sc1
buffer_load_dwordx4 v[140:143], v3, s[4:7], s41 offen offset:3072 sc1
s_add_u32 s41, s50, 20480
buffer_load_dwordx4 v[144:147], v3, s[4:7], s41 offen offset:0 sc1
buffer_load_dwordx4 v[148:151], v3, s[4:7], s41 offen offset:1024 sc1
buffer_load_dwordx4 v[152:155], v3, s[4:7], s41 offen offset:2048 sc1
buffer_load_dwordx4 v[156:159], v3, s[4:7], s41 offen offset:3072 sc1
s_add_u32 s41, s50, 24576
buffer_load_dwordx4 v[160:163], v3, s[4:7], s41 offen offset:0 sc1
buffer_load_dwordx4 v[164:167], v3, s[4:7], s41 offen offset:1024 sc1
buffer_load_dwordx4 v[168:171], v3, s[4:7], s41 offen offset:2048 sc1
buffer_load_dwordx4 v[172:175], v3, s[4:7], s41 offen offset:3072 sc1
s_add_u32 s41, s50, 28672
buffer_load_dwordx4 v[176:179], v3, s[4:7], s41 offen offset:0 sc1
buffer_load_dwordx4 v[180:183], v3, s[4:7], s41 offen offset:1024 sc1
buffer_load_dwordx4 v[184:187], v3, s[4:7], s41 offen offset:2048 sc1
buffer_load_dwordx4 v[188:191], v3, s[4:7], s41 offen offset:3072 sc1
s_mov_b32 s65, s61
s_mov_b32 s61, s68
P_LOOP:
s_mov_b32 s49, s55
s_cmp_lt_u32 s61, 96
s_cbranch_scc1 P_TK
v_mov_b32 v21, v10
P_TK:
v_mov_b32 v22, 1
s_waitcnt vmcnt(32)
buffer_atomic_add v22, v21, s[4:7], 0 offen sc0 sc1
v_cmp_ne_u32 vcc, 0, v13
v_lshlrev_b32 v48, 16, v16
v_and_b32 v49, 0xffff0000, v16
v_lshlrev_b32 v50, 16, v17
v_and_b32 v51, 0xffff0000, v17
v_lshlrev_b32 v52, 16, v18
v_and_b32 v53, 0xffff0000, v18
v_lshlrev_b32 v54, 16, v19
v_and_b32 v55, 0xffff0000, v19
s_cmp_eq_u64 vcc, s[58:59]
s_cselect_b32 s48, 1, 0
s_cbranch_scc0 P_SOLO
s_lshl_b32 s50, s65, 17
s_add_u32 s50, s50, s66
s_lshl_b32 s55, s65, 15
s_add_u32 s52, s55, s67
s_lshr_b32 s43, s61, 1
s_lshl_b32 s43, s43, 10
s_add_u32 s43, s43, 119603200
s_lshr_b32 s47, s61, 3
s_lshl_b32 s47, s47, 7
s_add_u32 s47, s47, s54
v_add_u32 v11, s43, v9
v_mov_b32 v12, s47
s_cmp_lt_u32 s61, 128
s_cselect_b64 s[62:63], s[58:59], 0
v_cndmask_b32 v11, v12, v11, s[56:57]
s_nop 0
v_cndmask_b32 v11, v10, v11, s[62:63]
buffer_load_dword v13, v11, s[4:7], 0 offen sc1
buffer_load_dwordx2 v[16:17], v6, s[4:7], s52 offen sc1
buffer_load_dwordx2 v[18:19], v7, s[12:15], s55 offen
s_waitcnt vmcnt(35)
v_mfma_f32_16x16x32_bf16 v[24:27], a[0:3], v[64:67], 0
v_mfma_f32_16x16x32_bf16 v[28:31], a[4:7], v[64:67], 0
s_add_u32 s41, s50, 0
buffer_load_dwordx4 v[64:67], v3, s[4:7], s41 offen offset:0 sc1
s_waitcnt vmcnt(35)
v_mfma_f32_16x16x32_bf16 v[24:27], a[8:11], v[68:71], v[24:27]
v_mfma_f32_16x16x32_bf16 v[28:31], a[12:15], v[68:71], v[28:31]
buffer_load_dwordx4 v[68:71], v3, s[4:7], s41 offen offset:1024 sc1
s_waitcnt vmcnt(35)
v_mfma_f32_16x16x32_bf16 v[24:27], a[16:19], v[72:75], v[24:27]
v_mfma_f32_16x16x32_bf16 v[28:31], a[20:23], v[72:75], v[28:31]
buffer_load_dwordx4 v[72:75], v3, s[4:7], s41 offen offset:2048 sc1
s_waitcnt vmcnt(35)
v_mfma_f32_16x16x32_bf16 v[24:27], a[24:27], v[76:79], v[24:27]
v_mfma_f32_16x16x32_bf16 v[28:31], a[28:31], v[76:79], v[28:31]
buffer_load_dwordx4 v[76:79], v3, s[4:7], s41 offen offset:3072 sc1
s_waitcnt vmcnt(35)
v_mfma_f32_16x16x32_bf16 v[24:27], a[32:35], v[80:83], v[24:27]
v_mfma_f32_16x16x32_bf16 v[28:31], a[36:39], v[80:83], v[28:31]
s_add_u32 s41, s50, 4096
buffer_load_dwordx4 v[80:83], v3, s[4:7], s41 offen offset:0 sc1
s_waitcnt vmcnt(35)
v_mfma_f32_16x16x32_bf16 v[24:27], a[40:43], v[84:87], v[24:27]
v_mfma_f32_16x16x32_bf16 v[28:31], a[44:47], v[84:87], v[28:31]
buffer_load_dwordx4 v[84:87], v3, s[4:7], s41 offen offset:1024 sc1
s_waitcnt vmcnt(35)
v_mfma_f32_16x16x32_bf16 v[24:27], a[48:51], v[88:91], v[24:27]
v_mfma_f32_16x16x32_bf16 v[28:31], a[52:55], v[88:91], v[28:31]
buffer_load_dwordx4 v[88:91], v3, s[4:7], s41 offen offset:2048 sc1
s_waitcnt vmcnt(35)
v_mfma_f32_16x16x32_bf16 v[24:27], a[56:59], v[92:95], v[24:27]
v_mfma_f32_16x16x32_bf16 v[28:31], a[60:63], v[92:95], v[28:31]
buffer_load_dwordx4 v[92:95], v3, s[4:7], s41 offen offset:3072 sc1
s_waitcnt vmcnt(35)
v_mfma_f32_16x16x32_bf16 v[24:27], a[64:67], v[96:99], v[24:27]
v_mfma_f32_16x16x32_bf16 v[28:31], a[68:71], v[96:99], v[28:31]
s_add_u32 s41, s50, 8192
buffer_load_dwordx4 v[96:99], v3, s[4:7], s41 offen offset:0 sc1
s_waitcnt vmcnt(35)
v_mfma_f32_16x16x32_bf16 v[24:27], a[72:75], v[100:103], v[24:27]
v_mfma_f32_16x16x32_bf16 v[28:31], a[76:79], v[100:103], v[28:31]
buffer_load_dwordx4 v[100:103], v3, s[4:7], s41 offen offset:1024 sc1
s_waitcnt vmcnt(35)
v_mfma_f32_16x16x32_bf16 v[24:27], a[80:83], v[104:107], v[24:27]
v_mfma_f32_16x16x32_bf16 v[28:31], a[84:87], v[104:107], v[28:31]
buffer_load_dwordx4 v[104:107], v3, s[4:7], s41 offen offset:2048 sc1
s_waitcnt vmcnt(35)
v_mfma_f32_16x16x32_bf16 v[24:27], a[88:91], v[108:111], v[24:27]
v_mfma_f32_16x16x32_bf16 v[28:31], a[92:95], v[108:111], v[28:31]
buffer_load_dwordx4 v[108:111], v3, s[4:7], s41 offen offset:3072 sc1
s_waitcnt vmcnt(35)
v_mfma_f32_16x16x32_bf16 v[24:27], a[96:99], v[112:115], v[24:27]
v_mfma_f32_16x16x32_bf16 v[28:31], a[100:103], v[112:115], v[28:31]
s_add_u32 s41, s50, 12288
buffer_load_dwordx4 v[112:115], v3, s[4:7], s41 offen offset:0 sc1
s_waitcnt vmcnt(35)
v_mfma_f32_16x16x32_bf16 v[24:27], a[104:107], v[116:119], v[24:27]
v_mfma_f32_16x16x32_bf16 v[28:31], a[108:111], v[116:119], v[28:31]
buffer_load_dwordx4 v[116:119], v3, s[4:7], s41 offen offset:1024 sc1
s_waitcnt vmcnt(35)
v_mfma_f32_16x16x32_bf16 v[24:27], a[112:115], v[120:123], v[24:27]
v_mfma_f32_16x16x32_bf16 v[28:31], a[116:119], v[120:123], v[28:31]
buffer_load_dwordx4 v[120:123], v3, s[4:7], s41 offen offset:2048 sc1
s_waitcnt vmcnt(35)
v_mfma_f32_16x16x32_bf16 v[24:27], a[120:123], v[124:127], v[24:27]
v_mfma_f32_16x16x32_bf16 v[28:31], a[124:127], v[124:127], v[28:31]
buffer_load_dwordx4 v[124:127], v3, s[4:7], s41 offen offset:3072 sc1
s_waitcnt vmcnt(35)
v_mfma_f32_16x16x32_bf16 v[24:27], a[128:131], v[128:131], v[24:27]
v_mfma_f32_16x16x32_bf16 v[28:31], a[132:135], v[128:131], v[28:31]
s_add_u32 s41, s50, 16384
buffer_load_dwordx4 v[128:131], v3, s[4:7], s41 offen offset:0 sc1
s_waitcnt vmcnt(35)
v_mfma_f32_16x16x32_bf16 v[24:27], a[136:139], v[132:135], v[24:27]
v_mfma_f32_16x16x32_bf16 v[28:31], a[140:143], v[132:135], v[28:31]
buffer_load_dwordx4 v[132:135], v3, s[4:7], s41 offen offset:1024 sc1
s_waitcnt vmcnt(35)
v_mfma_f32_16x16x32_bf16 v[24:27], a[144:147], v[136:139], v[24:27]
v_mfma_f32_16x16x32_bf16 v[28:31], a[148:151], v[136:139], v[28:31]
buffer_load_dwordx4 v[136:139], v3, s[4:7], s41 offen offset:2048 sc1
s_waitcnt vmcnt(35)
v_mfma_f32_16x16x32_bf16 v[24:27], a[152:155], v[140:143], v[24:27]
v_mfma_f32_16x16x32_bf16 v[28:31], a[156:159], v[140:143], v[28:31]
buffer_load_dwordx4 v[140:143], v3, s[4:7], s41 offen offset:3072 sc1
s_waitcnt vmcnt(35)
v_mfma_f32_16x16x32_bf16 v[24:27], a[160:163], v[144:147], v[24:27]
v_mfma_f32_16x16x32_bf16 v[28:31], a[164:167], v[144:147], v[28:31]
s_add_u32 s41, s50, 20480
buffer_load_dwordx4 v[144:147], v3, s[4:7], s41 offen offset:0 sc1
s_waitcnt vmcnt(35)
v_mfma_f32_16x16x32_bf16 v[24:27], a[168:171], v[148:151], v[24:27]
v_mfma_f32_16x16x32_bf16 v[28:31], a[172:175], v[148:151], v[28:31]
buffer_load_dwordx4 v[148:151], v3, s[4:7], s41 offen offset:1024 sc1
s_waitcnt vmcnt(35)
v_mfma_f32_16x16x32_bf16 v[24:27], a[176:179], v[152:155], v[24:27]
v_mfma_f32_16x16x32_bf16 v[28:31], a[180:183], v[152:155], v[28:31]
buffer_load_dwordx4 v[152:155], v3, s[4:7], s41 offen offset:2048 sc1
s_waitcnt vmcnt(35)
v_mfma_f32_16x16x32_bf16 v[24:27], a[184:187], v[156:159], v[24:27]
v_mfma_f32_16x16x32_bf16 v[28:31], a[188:191], v[156:159], v[28:31]
buffer_load_dwordx4 v[156:159], v3, s[4:7], s41 offen offset:3072 sc1
s_waitcnt vmcnt(35)
v_mfma_f32_16x16x32_bf16 v[24:27], a[192:195], v[160:163], v[24:27]
v_mfma_f32_16x16x32_bf16 v[28:31], a[196:199], v[160:163], v[28:31]
s_add_u32 s41, s50, 24576
buffer_load_dwordx4 v[160:163], v3, s[4:7], s41 offen offset:0 sc1
s_waitcnt vmcnt(35)
v_mfma_f32_16x16x32_bf16 v[24:27], a[200:203], v[164:167], v[24:27]
v_mfma_f32_16x16x32_bf16 v[28:31], a[204:207], v[164:167], v[28:31]
buffer_load_dwordx4 v[164:167], v3, s[4:7], s41 offen offset:1024 sc1
s_waitcnt vmcnt(35)
v_mfma_f32_16x16x32_bf16 v[24:27], a[208:211], v[168:171], v[24:27]
v_mfma_f32_16x16x32_bf16 v[28:31], a[212:215], v[168:171], v[28:31]
buffer_load_dwordx4 v[168:171], v3, s[4:7], s41 offen offset:2048 sc1
s_waitcnt vmcnt(35)
v_mfma_f32_16x16x32_bf16 v[24:27], a[216:219], v[172:175], v[24:27]
v_mfma_f32_16x16x32_bf16 v[28:31], a[220:223], v[172:175], v[28:31]
buffer_load_dwordx4 v[172:175], v3, s[4:7], s41 offen offset:3072 sc1
s_waitcnt vmcnt(35)
v_mfma_f32_16x16x32_bf16 v[24:27], a[224:227], v[176:179], v[24:27]
v_mfma_f32_16x16x32_bf16 v[28:31], a[228:231], v[176:179], v[28:31]
s_add_u32 s41, s50, 28672
buffer_load_dwordx4 v[176:179], v3, s[4:7], s41 offen offset:0 sc1
s_waitcnt vmcnt(35)
v_mfma_f32_16x16x32_bf16 v[24:27], a[232:235], v[180:183], v[24:27]
v_mfma_f32_16x16x32_bf16 v[28:31], a[236:239], v[180:183], v[28:31]
buffer_load_dwordx4 v[180:183], v3, s[4:7], s41 offen offset:1024 sc1
s_waitcnt vmcnt(35)
v_mfma_f32_16x16x32_bf16 v[24:27], a[240:243], v[184:187], v[24:27]
v_mfma_f32_16x16x32_bf16 v[28:31], a[244:247], v[184:187], v[28:31]
buffer_load_dwordx4 v[184:187], v3, s[4:7], s41 offen offset:2048 sc1
s_waitcnt vmcnt(35)
v_mfma_f32_16x16x32_bf16 v[24:27], a[248:251], v[188:191], v[24:27]
v_mfma_f32_16x16x32_bf16 v[28:31], a[252:255], v[188:191], v[28:31]
buffer_load_dwordx4 v[188:191], v3, s[4:7], s41 offen offset:3072 sc1
s_waitcnt vmcnt(35)
s_branch P_RED
P_SOLO:
s_mov_b32 s44, 0
P_SOLO2:
s_waitcnt vmcnt(32)
v_mfma_f32_16x16x32_bf16 v[24:27], a[0:3], v[64:67], 0
v_mfma_f32_16x16x32_bf16 v[28:31], a[4:7], v[64:67], 0
s_waitcnt vmcnt(31)
v_mfma_f32_16x16x32_bf16 v[24:27], a[8:11], v[68:71], v[24:27]
v_mfma_f32_16x16x32_bf16 v[28:31], a[12:15], v[68:71], v[28:31]
s_waitcnt vmcnt(30)
v_mfma_f32_16x16x32_bf16 v[24:27], a[16:19], v[72:75], v[24:27]
v_mfma_f32_16x16x32_bf16 v[28:31], a[20:23], v[72:75], v[28:31]
s_waitcnt vmcnt(29)
v_mfma_f32_16x16x32_bf16 v[24:27], a[24:27], v[76:79], v[24:27]
v_mfma_f32_16x16x32_bf16 v[28:31], a[28:31], v[76:79], v[28:31]
s_waitcnt vmcnt(28)
v_mfma_f32_16x16x32_bf16 v[24:27], a[32:35], v[80:83], v[24:27]
v_mfma_f32_16x16x32_bf16 v[28:31], a[36:39], v[80:83], v[28:31]
s_waitcnt vmcnt(27)
v_mfma_f32_16x16x32_bf16 v[24:27], a[40:43], v[84:87], v[24:27]
v_mfma_f32_16x16x32_bf16 v[28:31], a[44:47], v[84:87], v[28:31]
s_waitcnt vmcnt(26)
v_mfma_f32_16x16x32_bf16 v[24:27], a[48:51], v[88:91], v[24:27]
v_mfma_f32_16x16x32_bf16 v[28:31], a[52:55], v[88:91], v[28:31]
s_waitcnt vmcnt(25)
v_mfma_f32_16x16x32_bf16 v[24:27], a[56:59], v[92:95], v[24:27]
v_mfma_f32_16x16x32_bf16 v[28:31], a[60:63], v[92:95], v[28:31]
s_waitcnt vmcnt(24)
v_mfma_f32_16x16x32_bf16 v[24:27], a[64:67], v[96:99], v[24:27]
v_mfma_f32_16x16x32_bf16 v[28:31], a[68:71], v[96:99], v[28:31]
s_waitcnt vmcnt(23)
v_mfma_f32_16x16x32_bf16 v[24:27], a[72:75], v[100:103], v[24:27]
v_mfma_f32_16x16x32_bf16 v[28:31], a[76:79], v[100:103], v[28:31]
s_waitcnt vmcnt(22)
v_mfma_f32_16x16x32_bf16 v[24:27], a[80:83], v[104:107], v[24:27]
v_mfma_f32_16x16x32_bf16 v[28:31], a[84:87], v[104:107], v[28:31]
s_waitcnt vmcnt(21)
v_mfma_f32_16x16x32_bf16 v[24:27], a[88:91], v[108:111], v[24:27]
v_mfma_f32_16x16x32_bf16 v[28:31], a[92:95], v[108:111], v[28:31]
s_waitcnt vmcnt(20)
v_mfma_f32_16x16x32_bf16 v[24:27], a[96:99], v[112:115], v[24:27]
v_mfma_f32_16x16x32_bf16 v[28:31], a[100:103], v[112:115], v[28:31]
s_waitcnt vmcnt(19)
v_mfma_f32_16x16x32_bf16 v[24:27], a[104:107], v[116:119], v[24:27]
v_mfma_f32_16x16x32_bf16 v[28:31], a[108:111], v[116:119], v[28:31]
s_waitcnt vmcnt(18)
v_mfma_f32_16x16x32_bf16 v[24:27], a[112:115], v[120:123], v[24:27]
v_mfma_f32_16x16x32_bf16 v[28:31], a[116:119], v[120:123], v[28:31]
s_waitcnt vmcnt(17)
v_mfma_f32_16x16x32_bf16 v[24:27], a[120:123], v[124:127], v[24:27]
v_mfma_f32_16x16x32_bf16 v[28:31], a[124:127], v[124:127], v[28:31]
s_waitcnt vmcnt(16)
v_mfma_f32_16x16x32_bf16 v[24:27], a[128:131], v[128:131], v[24:27]
v_mfma_f32_16x16x32_bf16 v[28:31], a[132:135], v[128:131], v[28:31]
s_waitcnt vmcnt(15)
v_mfma_f32_16x16x32_bf16 v[24:27], a[136:139], v[132:135], v[24:27]
v_mfma_f32_16x16x32_bf16 v[28:31], a[140:143], v[132:135], v[28:31]
s_waitcnt vmcnt(14)
v_mfma_f32_16x16x32_bf16 v[24:27], a[144:147], v[136:139], v[24:27]
v_mfma_f32_16x16x32_bf16 v[28:31], a[148:151], v[136:139], v[28:31]
s_waitcnt vmcnt(13)
v_mfma_f32_16x16x32_bf16 v[24:27], a[152:155], v[140:143], v[24:27]
v_mfma_f32_16x16x32_bf16 v[28:31], a[156:159], v[140:143], v[28:31]
s_waitcnt vmcnt(12)
v_mfma_f32_16x16x32_bf16 v[24:27], a[160:163], v[144:147], v[24:27]
v_mfma_f32_16x16x32_bf16 v[28:31], a[164:167], v[144:147], v[28:31]
s_waitcnt vmcnt(11)
v_mfma_f32_16x16x32_bf16 v[24:27], a[168:171], v[148:151], v[24:27]
v_mfma_f32_16x16x32_bf16 v[28:31], a[172:175], v[148:151], v[28:31]
s_waitcnt vmcnt(10)
v_mfma_f32_16x16x32_bf16 v[24:27], a[176:179], v[152:155], v[24:27]
v_mfma_f32_16x16x32_bf16 v[28:31], a[180:183], v[152:155], v[28:31]
s_waitcnt vmcnt(9)
v_mfma_f32_16x16x32_bf16 v[24:27], a[184:187], v[156:159], v[24:27]
v_mfma_f32_16x16x32_bf16 v[28:31], a[188:191], v[156:159], v[28:31]
s_waitcnt vmcnt(8)
v_mfma_f32_16x16x32_bf16 v[24:27], a[192:195], v[160:163], v[24:27]
v_mfma_f32_16x16x32_bf16 v[28:31], a[196:199], v[160:163], v[28:31]
s_waitcnt vmcnt(7)
v_mfma_f32_16x16x32_bf16 v[24:27], a[200:203], v[164:167], v[24:27]
v_mfma_f32_16x16x32_bf16 v[28:31], a[204:207], v[164:167], v[28:31]
s_waitcnt vmcnt(6)
v_mfma_f32_16x16x32_bf16 v[24:27], a[208:211], v[168:171], v[24:27]
v_mfma_f32_16x16x32_bf16 v[28:31], a[212:215], v[168:171], v[28:31]
s_waitcnt vmcnt(5)
v_mfma_f32_16x16x32_bf16 v[24:27], a[216:219], v[172:175], v[24:27]
v_mfma_f32_16x16x32_bf16 v[28:31], a[220:223], v[172:175], v[28:31]
s_waitcnt vmcnt(4)
v_mfma_f32_16x16x32_bf16 v[24:27], a[224:227], v[176:179], v[24:27]
v_mfma_f32_16x16x32_bf16 v[28:31], a[228:231], v[176:179], v[28:31]
s_waitcnt vmcnt(3)
v_mfma_f32_16x16x32_bf16 v[24:27], a[232:235], v[180:183], v[24:27]
v_mfma_f32_16x16x32_bf16 v[28:31], a[236:239], v[180:183], v[28:31]
s_waitcnt vmcnt(2)
v_mfma_f32_16x16x32_bf16 v[24:27], a[240:243], v[184:187], v[24:27]
v_mfma_f32_16x16x32_bf16 v[28:31], a[244:247], v[184:187], v[28:31]
s_waitcnt vmcnt(1)
v_mfma_f32_16x16x32_bf16 v[24:27], a[248:251], v[188:191], v[24:27]
v_mfma_f32_16x16x32_bf16 v[28:31], a[252:255], v[188:191], v[28:31]
s_cmp_lt_u32 s49, 4128768
s_cbranch_scc1 P_VAL
v_max3_u32 v12, v64, v68, v72
v_max3_u32 v12, v12, v76, v80
v_max3_u32 v12, v12, v84, v88
v_max3_u32 v12, v12, v92, v96
v_max3_u32 v12, v12, v100, v104
v_max3_u32 v12, v12, v108, v112
v_max3_u32 v12, v12, v116, v120
v_max3_u32 v12, v12, v124, v128
v_max3_u32 v12, v12, v132, v136
v_max3_u32 v12, v12, v140, v144
v_max3_u32 v12, v12, v148, v152
v_max3_u32 v12, v12, v156, v160
v_max3_u32 v12, v12, v164, v168
v_max3_u32 v12, v12, v172, v176
v_max3_u32 v12, v12, v180, v184
v_max_u32 v12, v12, v188
v_cmp_eq_u32 vcc, -1, v12
s_cbranch_vccz P_VAL
s_add_u32 s44, s44, 1
s_cmp_gt_u32 s44, 30000
s_cbranch_scc1 M_END
s_add_u32 s41, s50, 0
buffer_load_dwordx4 v[64:67], v3, s[4:7], s41 offen offset:0 sc1
buffer_load_dwordx4 v[68:71], v3, s[4:7], s41 offen offset:1024 sc1
buffer_load_dwordx4 v[72:75], v3, s[4:7], s41 offen offset:2048 sc1
buffer_load_dwordx4 v[76:79], v3, s[4:7], s41 offen offset:3072 sc1
s_add_u32 s41, s50, 4096
buffer_load_dwordx4 v[80:83], v3, s[4:7], s41 offen offset:0 sc1
buffer_load_dwordx4 v[84:87], v3, s[4:7], s41 offen offset:1024 sc1
buffer_load_dwordx4 v[88:91], v3, s[4:7], s41 offen offset:2048 sc1
buffer_load_dwordx4 v[92:95], v3, s[4:7], s41 offen offset:3072 sc1
s_add_u32 s41, s50, 8192
buffer_load_dwordx4 v[96:99], v3, s[4:7], s41 offen offset:0 sc1
buffer_load_dwordx4 v[100:103], v3, s[4:7], s41 offen offset:1024 sc1
buffer_load_dwordx4 v[104:107], v3, s[4:7], s41 offen offset:2048 sc1
buffer_load_dwordx4 v[108:111], v3, s[4:7], s41 offen offset:3072 sc1
s_add_u32 s41, s50, 12288
buffer_load_dwordx4 v[112:115], v3, s[4:7], s41 offen offset:0 sc1
buffer_load_dwordx4 v[116:119], v3, s[4:7], s41 offen offset:1024 sc1
buffer_load_dwordx4 v[120:123], v3, s[4:7], s41 offen offset:2048 sc1
buffer_load_dwordx4 v[124:127], v3, s[4:7], s41 offen offset:3072 sc1
s_add_u32 s41, s50, 16384
buffer_load_dwordx4 v[128:131], v3, s[4:7], s41 offen offset:0 sc1
buffer_load_dwordx4 v[132:135], v3, s[4:7], s41 offen offset:1024 sc1
buffer_load_dwordx4 v[136:139], v3, s[4:7], s41 offen offset:2048 sc1
buffer_load_dwordx4 v[140:143], v3, s[4:7], s41 offen offset:3072 sc1
s_add_u32 s41, s50, 20480
buffer_load_dwordx4 v[144:147], v3, s[4:7], s41 offen offset:0 sc1
buffer_load_dwordx4 v[148:151], v3, s[4:7], s41 offen offset:1024 sc1
buffer_load_dwordx4 v[152:155], v3, s[4:7], s41 offen offset:2048 sc1
buffer_load_dwordx4 v[156:159], v3, s[4:7], s41 offen offset:3072 sc1
s_add_u32 s41, s50, 24576
buffer_load_dwordx4 v[160:163], v3, s[4:7], s41 offen offset:0 sc1
buffer_load_dwordx4 v[164:167], v3, s[4:7], s41 offen offset:1024 sc1
buffer_load_dwordx4 v[168:171], v3, s[4:7], s41 offen offset:2048 sc1
buffer_load_dwordx4 v[172:175], v3, s[4:7], s41 offen offset:3072 sc1
s_add_u32 s41, s50, 28672
buffer_load_dwordx4 v[176:179], v3, s[4:7], s41 offen offset:0 sc1
buffer_load_dwordx4 v[180:183], v3, s[4:7], s41 offen offset:1024 sc1
buffer_load_dwordx4 v[184:187], v3, s[4:7], s41 offen offset:2048 sc1
buffer_load_dwordx4 v[188:191], v3, s[4:7], s41 offen offset:3072 sc1
buffer_load_dword v13, v10, s[4:7], 0 offen
s_branch P_SOLO2
P_VAL:
s_waitcnt vmcnt(0)
P_RED:
s_mov_b64 exec, 1
ds_write_b32 v15, v22
s_mov_b64 exec, -1
s_nop 7
ds_write_b128 v4, v[24:27]
ds_write_b128 v4, v[28:31] offset:1024
s_waitcnt lgkmcnt(0)
s_barrier
ds_read_b32 v23, v14
s_cmp_ge_u32 s24, 2
s_cbranch_scc1 P_NEXT
ds_read_b128 v[32:35], v5 offset:0
ds_read_b128 v[36:39], v5 offset:2048
ds_read_b128 v[40:43], v5 offset:4096
ds_read_b128 v[44:47], v5 offset:6144
s_waitcnt lgkmcnt(0)
v_add_f32 v32, v32, v36
v_add_f32 v40, v40, v44
v_add_f32 v33, v33, v37
v_add_f32 v41, v41, v45
v_add_f32 v34, v34, v38
v_add_f32 v42, v42, v46
v_add_f32 v35, v35, v39
v_add_f32 v43, v43, v47
v_add_f32 v32, v32, v40
v_add_f32 v33, v33, v41
v_add_f32 v34, v34, v42
v_add_f32 v35, v35, v43
v_cvt_pk_bf16_f32 v56, v32, v33
v_cvt_pk_bf16_f32 v57, v34, v35
v_lshlrev_b32 v32, 16, v56
v_and_b32 v33, 0xffff0000, v56
v_lshlrev_b32 v34, 16, v57
v_and_b32 v35, 0xffff0000, v57
v_mul_f32 v32, v32, v48
v_mul_f32 v33, v33, v49
v_mul_f32 v34, v34, v50
v_mul_f32 v35, v35, v51
v_cvt_pk_bf16_f32 v56, v32, v33
v_cvt_pk_bf16_f32 v57, v34, v35
v_lshlrev_b32 v32, 16, v56
v_and_b32 v33, 0xffff0000, v56
v_lshlrev_b32 v34, 16, v57
v_and_b32 v35, 0xffff0000, v57
v_add_f32 v32, v32, v52
v_add_f32 v33, v33, v53
v_add_f32 v34, v34, v54
v_add_f32 v35, v35, v55
v_cvt_pk_bf16_f32 v58, v32, v33
v_cvt_pk_bf16_f32 v59, v34, v35
buffer_store_dwordx2 v[58:59], v7, s[16:19], s49 offen
P_NEXT:
v_xor_b32 v4, 8192, v4
v_xor_b32 v5, 8192, v5
s_waitcnt lgkmcnt(0)
v_readfirstlane_b32 s70, v23
v_xor_b32 v14, 8192, v14
v_xor_b32 v15, 8192, v15
s_add_u32 s43, s70, s72
s_and_b32 s43, s43, 15
s_andn2_b32 s47, s70, 15
s_or_b32 s47, s47, s43
s_cmp_lt_u32 s70, 96
s_cselect_b32 s68, s47, s69
s_add_u32 s43, s61, 4
s_cmp_ge_u32 s61, 96
s_cselect_b32 s68, s43, s68
s_cmp_eq_u32 s48, 0
s_cbranch_scc1 P_OUT
s_mov_b32 s65, s61
s_mov_b32 s61, s68
s_branch P_LOOP
P_OUT:
s_cmp_lt_u32 s65, 128
s_cbranch_scc1 P_WAIT
s_branch M_END2
M_END2:
M_END:
s_endpgm
.section .rodata,"a"
.p2align 6
.amdhsa_kernel recurrent_scan__memory_aug_recurrent_mem_tr__dense_activation_gelu__prompt_kernel
  .amdhsa_next_free_vgpr 512
  .amdhsa_next_free_sgpr 102
  .amdhsa_accum_offset 256
  .amdhsa_group_segment_fixed_size 0
  .amdhsa_kernarg_size 120
  .amdhsa_user_sgpr_count 2
  .amdhsa_user_sgpr_kernarg_segment_ptr 1
  .amdhsa_system_sgpr_workgroup_id_x 1
.end_amdhsa_kernel
```
